```python
import torch

def _softmax(x, axis=-1):
    return torch.softmax(x, dim=axis)

def _gelu(x):
    return torch.nn.functional.gelu(x, approximate='tanh')

def _silu(x):
    return torch.nn.functional.silu(x)

def _sigmoid(x):
    return torch.sigmoid(x)

def _layernorm(x, axis=-1, eps=1e-05):
    m = x.mean(dim=axis, keepdim=True)
    v = x.var(dim=axis, keepdim=True, unbiased=False)
    return (x - m) / torch.sqrt(v + eps)

def _scatter_add(tgt, idx, src, axis=0):
    return tgt.clone().index_add_(axis, idx, src)

def _segment_sum(src, seg, n):
    out = torch.zeros((n,) + src.shape[1:], dtype=src.dtype)
    return out.index_add_(0, seg, src)

def _pad(x, pw):
    flat = tuple((v for pair in reversed(pw) for v in pair))
    return torch.nn.functional.pad(x, flat)
kernel_name = 'adaLN_cond__compressed_kv_cla__moe_arch_mod__prompt'

def setup_inputs():

    _w = lambda a: (lambda t: t.to(torch.bfloat16) if t.is_floating_point() else t)(torch.as_tensor(a))

    def _A_setup():
        B, H, Sq, Sk, D, M = (1, 32, 2048, 2048, 128, 512)
        Dc = 4 * D
        return {'x': _w((lambda *s: torch.randn(*s, dtype=torch.bfloat16) * 0.1)(B, Sq, M)), 'c_kv': _w((lambda *s: torch.randn(*s, dtype=torch.bfloat16) * 3.2)(B, Sk, Dc)), 'w_q': _w((lambda *s: torch.randn(*s, dtype=torch.bfloat16) * 0.8)(M, H, D) * M ** (-0.5)), 'w_uk': _w((lambda *s: torch.randn(*s, dtype=torch.bfloat16) * 0.8)(Dc, H, D) * Dc ** (-0.5)), 'w_uv': _w((lambda *s: torch.randn(*s, dtype=torch.bfloat16) * 3.2)(Dc, H, D) * Dc ** (-0.5)), 'w_o': _w((lambda *s: torch.randn(*s, dtype=torch.bfloat16) * 3.2)(H, D, M) * (H * D) ** (-0.5))}
    _A_in = _A_setup()

    def _B_setup():
        B, S, D, F, C = (1, 2048, 512, 1792, 1)
        return {'x': _w((lambda *s: torch.randn(*s, dtype=torch.bfloat16) * 0.1)(B, S, D)), 'w_r': _w((lambda *s: torch.randn(*s, dtype=torch.bfloat16) * 3.2)(D)), 'w_gate': _w((lambda *s: torch.randn(*s, dtype=torch.bfloat16) * 3.2)(D, F)), 'w_up': _w((lambda *s: torch.randn(*s, dtype=torch.bfloat16) * 3.2)(D, F)), 'w_down': _w((lambda *s: torch.randn(*s, dtype=torch.bfloat16) * 3.2)(F, D))}
    _B_in = _B_setup()
    return {'A_x': _A_in['x'], 'A_c_kv': _A_in['c_kv'], 'A_w_q': _A_in['w_q'], 'A_w_uk': _A_in['w_uk'], 'A_w_uv': _A_in['w_uv'], 'A_w_o': _A_in['w_o'], 'B_x': _B_in['x'], 'B_w_r': _B_in['w_r'], 'B_w_gate': _B_in['w_gate'], 'B_w_up': _B_in['w_up'], 'B_w_down': _B_in['w_down'], 'c': _w((lambda *s: torch.randn(*s, dtype=torch.bfloat16) * 0.2)(1, 512) * 8.0), 'w_mod': _w((lambda *s: torch.randn(*s, dtype=torch.bfloat16) * 0.2)(512, 6 * 512) * 512 ** (-0.5) * 8.0)}

def reference(A_x, A_c_kv, A_w_q, A_w_uk, A_w_uv, A_w_o, B_x, B_w_r, B_w_gate, B_w_up, B_w_down, c, w_mod):

    def _A_ref(x, c_kv, w_q, w_uk, w_uv, w_o):
        B, Sq, M = (x.shape[0], x.shape[1], x.shape[2])
        Sk = c_kv.shape[1]
        H, D = (w_q.shape[1], w_q.shape[2])
        q = torch.einsum('bqm,mhd->bhqd', x, w_q)
        k = torch.einsum('bkc,chd->bhkd', c_kv, w_uk)
        v = torch.einsum('bkc,chd->bhkd', c_kv, w_uv)
        scores = torch.einsum('bhqd,bhkd->bhqk', q, k) * D ** (-0.5)
        off = Sk - Sq
        qi = torch.arange(Sq)[:, None]
        kj = torch.arange(Sk)[None, :]
        cmask = kj <= qi + off
        scores = torch.where(cmask[None, None], scores, -1000000000.0)
        p = _softmax(scores, axis=-1)
        ctx = torch.einsum('bhqk,bhkd->bhqd', p, v)
        return torch.einsum('bhqd,hdm->bqm', ctx, w_o)

    def _B_ref(x, w_r, w_gate, w_up, w_down):
        B, S, D = x.shape
        C = 1
        r = x @ w_r
        idx = torch.argsort(-r, axis=-1)[:, :C]
        idx_e = (lambda x, n, axis: torch.repeat_interleave(x, n, dim=axis))(idx.reshape(B, C, 1), D, axis=2)
        x_sel = (lambda x, i, axis: torch.take_along_dim(x, i, dim=axis))(x, idx_e, axis=1)
        g = _silu(x_sel @ w_gate)
        u = x_sel @ w_up
        y = g * u @ w_down
        r_sel = _sigmoid((lambda x, i, axis: torch.take_along_dim(x, i, dim=axis))(r, idx, axis=1))
        y = y * r_sel.reshape(B, C, 1)
        b_off = (torch.arange(B) * S).reshape(B, 1)
        flat_idx = (idx + b_off).reshape(B * C)
        zero = (x * 0.0).reshape(B * S, D)
        upd = _scatter_add(zero, flat_idx, y.reshape(B * C, D), axis=0)
        return x + upd.reshape(B, S, D)
    x = A_x
    mod = (_silu(c) @ w_mod).reshape(c.shape[0], 6, 1, -1)
    sa, ca, ga, sb, cb, gb = (mod[:, 0].clone(), mod[:, 1].clone(), mod[:, 2].clone(), mod[:, 3].clone(), mod[:, 4].clone(), mod[:, 5].clone())
    h = _layernorm(x, axis=-1) * (1 + ca) + sa
    x = x + ga * _A_ref(h, A_c_kv, A_w_q, A_w_uk, A_w_uv, A_w_o)
    h = _layernorm(x, axis=-1) * (1 + cb) + sb
    x = x + gb * _B_ref(h, B_w_r, B_w_gate, B_w_up, B_w_down)
    return x
```

```asm
; @launch grid=(256,1,1) block=(256,1,1) lds=163840
.amdgcn_target "amdgcn-amd-amdhsa--gfx950"
.text
.p2align 8
.globl adaLN_cond__compressed_kv_cla__moe_arch_mod__prompt_kernel
.type adaLN_cond__compressed_kv_cla__moe_arch_mod__prompt_kernel,@function
adaLN_cond__compressed_kv_cla__moe_arch_mod__prompt_kernel:
    s_cmp_lt_u32 s2, 256
    s_cbranch_scc1 L_go
    s_endpgm
L_go:
    s_load_dwordx8 s[36:43], s[0:1], 0
    s_load_dwordx4 s[44:47], s[0:1], 32
    s_load_dwordx4 s[52:55], s[0:1], 88
    s_load_dwordx2 s[6:7], s[0:1], 120
    v_lshrrev_b32 v20, 6, v0
    v_and_b32 v21, 63, v0
    v_readfirstlane_b32 s32, v20
    s_and_b32 s4, s2, 7
    s_lshr_b32 s5, s2, 3
    s_lshl_b32 s33, s4, 2
    s_lshr_b32 s34, s5, 2
    s_and_b32 s3, s5, 3
    s_add_u32 s33, s33, s3
    v_lshrrev_b32 v16, 3, v21
    v_and_b32 v17, 7, v21
    v_lshrrev_b32 v18, 4, v21
    v_and_b32 v19, 15, v21
    v_lshlrev_b32 v2, 4, v21
    v_add_u32 v22, 0, v18
    v_and_b32 v22, 7, v22
    v_xor_b32 v22, v17, v22
    v_lshlrev_b32 v22, 4, v22
    v_lshl_add_u32 v22, v16, 10, v22
    v_add_u32 v6, 0, v22
    v_add_u32 v22, 4, v18
    v_and_b32 v22, 7, v22
    v_xor_b32 v22, v17, v22
    v_lshlrev_b32 v22, 4, v22
    v_lshl_add_u32 v22, v16, 10, v22
    v_add_u32 v7, 7168, v22
    v_add_u32 v22, 8, v18
    v_and_b32 v22, 7, v22
    v_xor_b32 v22, v17, v22
    v_lshlrev_b32 v22, 4, v22
    v_lshl_add_u32 v22, v16, 10, v22
    v_add_u32 v8, 14336, v22
    v_add_u32 v22, 12, v18
    v_and_b32 v22, 7, v22
    v_xor_b32 v22, v17, v22
    v_lshlrev_b32 v22, 4, v22
    v_lshl_add_u32 v22, v16, 10, v22
    v_add_u32 v9, 21504, v22
    v_or_b32 v22, 0, v18
    v_lshrrev_b32 v23, 1, v19
    v_xor_b32 v22, v23, v22
    v_lshlrev_b32 v22, 1, v22
    v_and_b32 v23, 1, v19
    v_or_b32 v22, v22, v23
    v_lshlrev_b32 v22, 4, v22
    v_lshl_add_u32 v22, v18, 13, v22
    v_add_u32 v10, 0, v22
    v_or_b32 v22, 0, v18
    v_lshrrev_b32 v23, 1, v19
    v_xor_b32 v22, v23, v22
    v_lshlrev_b32 v22, 1, v22
    v_and_b32 v23, 1, v19
    v_or_b32 v22, v22, v23
    v_lshlrev_b32 v22, 4, v22
    v_lshl_add_u32 v22, v18, 13, v22
    v_add_u32 v11, 31744, v22
    v_or_b32 v22, 4, v18
    v_lshrrev_b32 v23, 1, v19
    v_xor_b32 v22, v23, v22
    v_lshlrev_b32 v22, 1, v22
    v_and_b32 v23, 1, v19
    v_or_b32 v22, v22, v23
    v_lshlrev_b32 v22, 4, v22
    v_lshl_add_u32 v22, v18, 13, v22
    v_add_u32 v12, 63488, v22
    v_or_b32 v22, 4, v18
    v_lshrrev_b32 v23, 1, v19
    v_xor_b32 v22, v23, v22
    v_lshlrev_b32 v22, 1, v22
    v_and_b32 v23, 1, v19
    v_or_b32 v22, v22, v23
    v_lshlrev_b32 v22, 4, v22
    v_lshl_add_u32 v22, v18, 13, v22
    v_add_u32 v13, 95232, v22
    s_and_b32 s84, s32, 1
    s_lshr_b32 s85, s32, 1
    s_lshl_b32 s86, s84, 4
    s_lshl_b32 s87, s85, 3
    s_add_u32 s86, s86, s87
    s_add_u32 s86, s86, s34
    s_lshl_b32 s88, s86, 16
    s_lshl_b32 s89, s84, 18
    s_lshl_b32 s87, s33, 8
    s_add_u32 s89, s89, s87
    s_lshl_b32 s90, s32, 13
    s_lshl_b32 s91, s32, 17
    s_add_u32 s91, s91, s87
    s_and_b32 s3, s5, 3
    s_lshl_b32 s3, s3, 3
    s_add_u32 s3, s3, s34
    s_lshl_b32 s3, s3, 6
    s_lshl_b32 s83, s32, 4
    s_add_u32 s83, s83, s3
    s_lshl_b32 s83, s83, 10
    s_lshl_b32 s3, s34, 1
    s_add_u32 s3, s3, s84
    s_lshl_b32 s3, s3, 15
    s_add_u32 s50, s87, s3
    v_and_b32 v22, 3, v16
    v_mul_u32_u24 v22, 6144, v22
    v_min_u32 v23, 1, v17
    v_lshl_add_u32 v31, v23, 7, v22
    s_lshl2_add_u32 s35, s5, s32
    s_mul_i32 s35, s35, 24576
    s_lshl_b32 s3, s4, 8
    s_add_u32 s35, s35, s3
    s_add_u32 s3, s3, 1792
    v_cmp_lt_u32 vcc, 1, v23
    v_add_u32 v22, s3, v31
    s_nop 0
    v_cndmask_b32 v31, v31, v22, vcc
    s_waitcnt lgkmcnt(0)
    s_mov_b32 s56, s38
    s_mov_b32 s57, s39
    s_mov_b32 s58, 0x200000
    s_mov_b32 s59, 0x20000
    s_cmp_lt_u32 s32, 2
    s_cselect_b32 s60, s42, s44
    s_cselect_b32 s61, s43, s45
    s_mov_b32 s62, 0x400000
    s_mov_b32 s63, 0x20000
    s_mov_b32 s24, s54
    s_mov_b32 s25, s55
    s_mov_b32 s26, 0x300000
    s_mov_b32 s27, 0x20000
    s_mov_b32 m0, s90
    s_mov_b32 s3, s88
    buffer_load_dwordx4 v6, s[56:59], s3 offen offset:0 lds
    buffer_load_dwordx4 v7, s[56:59], s3 offen offset:1024 lds
    buffer_load_dwordx4 v8, s[56:59], s3 offen offset:2048 lds
    buffer_load_dwordx4 v9, s[56:59], s3 offen offset:3072 lds
    s_add_u32 m0, s90, 0x1000
    s_add_u32 s3, s88, 0x8000
    buffer_load_dwordx4 v6, s[56:59], s3 offen offset:0 lds
    buffer_load_dwordx4 v7, s[56:59], s3 offen offset:1024 lds
    buffer_load_dwordx4 v8, s[56:59], s3 offen offset:2048 lds
    buffer_load_dwordx4 v9, s[56:59], s3 offen offset:3072 lds
    s_add_u32 m0, s90, 0x10000
    s_mov_b32 s3, s89
    buffer_load_dwordx4 v10, s[60:63], s3 offen offset:0 lds
    buffer_load_dwordx4 v11, s[60:63], s3 offen offset:1024 lds
    buffer_load_dwordx4 v12, s[60:63], s3 offen offset:2048 lds
    buffer_load_dwordx4 v13, s[60:63], s3 offen offset:3072 lds
    s_add_u32 s20, s6, 0x3c00000
    s_addc_u32 s21, s7, 0
    s_mov_b32 s22, 0x200000
    s_mov_b32 s23, 0x20000
    s_load_dword s80, s[20:21], 0
    s_and_b32 s3, s33, 3
    s_lshl_b32 s3, s3, 20
    s_add_u32 s91, s91, s3
    s_add_u32 s51, s50, s3
    s_lshl_b32 s3, s85, 19
    s_add_u32 s51, s51, s3
    s_mov_b32 s12, s40
    s_mov_b32 s13, s41
    s_mov_b32 s14, 0x400000
    s_mov_b32 s15, 0x20000
    s_mov_b32 s16, s6
    s_mov_b32 s17, s7
    s_mov_b32 s18, 0x5000000
    s_mov_b32 s19, 0x20000
    s_lshr_b32 s3, s2, 1
    s_lshl_b32 s3, s3, 14
    s_and_b32 s75, s2, 1
    s_lshl_b32 s75, s75, 7
    s_add_u32 s75, s75, s3
    s_lshl_b32 s3, s32, 12
    s_add_u32 s75, s75, s3
    s_add_u32 s75, s75, 0x100000
    s_lshl_b32 s77, s2, 3
    s_add_u32 s77, s77, 0x8000
    s_lshl_b32 s78, s33, 7
    s_lshl_b32 s3, s34, 3
    s_add_u32 s78, s78, s3
    s_add_u32 s78, s78, 0x9000
    s_lshl_b32 s79, s34, 8
    s_lshl_b32 s3, s33, 3
    s_add_u32 s79, s79, s3
    s_add_u32 s79, s79, 0xa000
    s_lshl_b32 s3, s84, 3
    s_add_u32 s3, s3, s34
    s_lshl_b32 s3, s3, 15
    s_lshl_b32 s86, s85, 11
    s_add_u32 s68, s3, s86
    s_add_u32 s69, s68, 8192
    s_add_u32 s70, s68, 524288
    s_add_u32 s71, s69, 524288
    s_lshl_b32 s86, s85, 13
    s_add_u32 s72, s3, s86
    s_add_u32 s73, s72, 524288
    v_lshrrev_b32 v22, 1, v19
    v_xor_b32 v22, v18, v22
    v_lshlrev_b32 v22, 4, v22
    v_lshl_add_u32 v22, v19, 7, v22
    s_lshl_b32 s3, s84, 14
    v_add_u32 v14, s3, v22
    v_xor_b32 v15, 64, v14
    v_lshrrev_b32 v22, 2, v19
    v_and_b32 v23, 1, v18
    v_lshl_or_b32 v23, v23, 2, v22
    v_lshl_add_u32 v22, v18, 3, v22
    v_lshlrev_b32 v22, 8, v22
    v_lshl_add_u32 v22, v23, 5, v22
    v_and_b32 v23, 3, v19
    v_lshl_add_u32 v28, v23, 3, v22
    s_lshl_b32 s3, s85, 7
    s_or_b32 s39, s3, 0x10000
    v_xor_b32 v24, s39, v28
    v_xor_b32 v25, 32, v24
    v_xor_b32 v26, 64, v24
    v_xor_b32 v27, 96, v24
    s_mov_b32 s84, s46
    s_mov_b32 s85, s47
    s_mov_b32 s86, 0x400000
    s_mov_b32 s87, 0x20000
    s_lshl_b32 s3, s33, 20
    s_add_u32 s64, s6, 0x400000
    s_addc_u32 s65, s7, 0
    s_add_u32 s64, s64, s3
    s_addc_u32 s65, s65, 0
    s_mov_b32 s66, 0x100000
    s_mov_b32 s67, 0x20000
    s_sub_u32 s3, 15, s34
    s_lshl_b32 s3, s3, 3
    s_lshl_b32 s4, s34, 3
    s_add_u32 s96, s3, s32
    s_xor_b32 s97, s96, 7
    s_add_u32 s98, s4, s32
    s_xor_b32 s99, s98, 7
    s_xor_b32 s100, s96, 1
    s_xor_b32 s101, s97, 1
    s_lshr_b32 s3, s96, 2
    s_lshl_b32 s3, s3, 19
    s_and_b32 s4, s96, 3
    s_lshl_b32 s4, s4, 12
    s_add_u32 s3, s3, s4
    s_lshl_b32 s4, s33, 14
    s_add_u32 s3, s3, s4
    s_add_u32 s44, s3, 0x2400000
    s_lshr_b32 s3, s97, 2
    s_lshl_b32 s3, s3, 19
    s_and_b32 s4, s97, 3
    s_lshl_b32 s4, s4, 12
    s_add_u32 s3, s3, s4
    s_lshl_b32 s4, s33, 14
    s_add_u32 s3, s3, s4
    s_add_u32 s45, s3, 0x2400000
    s_lshr_b32 s3, s98, 2
    s_lshl_b32 s3, s3, 19
    s_and_b32 s4, s98, 3
    s_lshl_b32 s4, s4, 12
    s_add_u32 s3, s3, s4
    s_lshl_b32 s4, s33, 14
    s_add_u32 s3, s3, s4
    s_add_u32 s46, s3, 0x2400000
    s_lshr_b32 s3, s99, 2
    s_lshl_b32 s3, s3, 19
    s_and_b32 s4, s99, 3
    s_lshl_b32 s4, s4, 12
    s_add_u32 s3, s3, s4
    s_lshl_b32 s4, s33, 14
    s_add_u32 s3, s3, s4
    s_add_u32 s47, s3, 0x2400000
    s_lshl_b32 s40, s96, 14
    s_add_u32 s40, s40, 0x100000
    s_lshl_b32 s41, s97, 14
    s_add_u32 s41, s41, 0x100000
    s_lshl_b32 s42, s98, 14
    s_add_u32 s42, s42, 0x100000
    s_lshl_b32 s43, s99, 14
    s_add_u32 s43, s43, 0x100000
    s_and_b32 s54, s34, 1
    s_lshl_b32 s54, s54, 16
    s_and_b32 s3, s32, 1
    s_lshl_b32 s3, s3, 15
    s_or_b32 s49, s3, 0x10000
    s_mov_b32 s48, 0
    s_lshl_b32 s38, s32, 12
    s_mov_b32 s82, 400000
    v_lshlrev_b32 v0, 24, v0
    s_waitcnt lgkmcnt(0)
    s_mul_i32 s80, s80, 0x9e3779b1
    s_add_u32 s80, s80, 0x7f4a7c15
    s_mul_i32 s81, s80, 0x9e3779b1
    s_add_u32 s81, s81, 0x7f4a7c15
    s_getpc_b64 s[92:93]
L_pc:
    s_lshl_b32 s3, s5, 12
    v_lshrrev_b32 v16, 20, v0
    v_add_u32 v16, s3, v16
    v_min_u32 v16, L_codeend-L_pc-4, v16
    v_mov_b32 v17, 0
    v_lshl_add_u64 v[16:17], v[16:17], 0, s[92:93]
    s_add_u32 m0, s90, 0x11000
    s_add_u32 s3, s89, 0x20000
    buffer_load_dwordx4 v10, s[60:63], s3 offen offset:0 lds
    buffer_load_dwordx4 v11, s[60:63], s3 offen offset:1024 lds
    buffer_load_dwordx4 v12, s[60:63], s3 offen offset:2048 lds
    buffer_load_dwordx4 v13, s[60:63], s3 offen offset:3072 lds
    buffer_load_dword a195, v6, s[56:59], s83 offen offset:128
    buffer_load_dword a196, v7, s[56:59], s83 offen offset:1152
    s_add_u32 s3, s50, 0x80000
    buffer_load_dword a197, v10, s[60:63], s3 offen
    buffer_load_dword a225, v31, s[24:27], s35 offen
    s_add_u32 m0, s90, 0x8000
    s_add_u32 s3, s88, 0x80
    buffer_load_dwordx4 v6, s[56:59], s3 offen offset:0 lds
    buffer_load_dwordx4 v7, s[56:59], s3 offen offset:1024 lds
    buffer_load_dwordx4 v8, s[56:59], s3 offen offset:2048 lds
    buffer_load_dwordx4 v9, s[56:59], s3 offen offset:3072 lds
    s_add_u32 m0, s90, 0x9000
    s_add_u32 s3, s88, 0x8080
    buffer_load_dwordx4 v6, s[56:59], s3 offen offset:0 lds
    buffer_load_dwordx4 v7, s[56:59], s3 offen offset:1024 lds
    buffer_load_dwordx4 v8, s[56:59], s3 offen offset:2048 lds
    buffer_load_dwordx4 v9, s[56:59], s3 offen offset:3072 lds
    s_mov_b32 s28, s52
    s_mov_b32 s29, s53
    s_mov_b32 s30, 0x400
    s_mov_b32 s31, 0x20000
    s_mov_b32 s8, s36
    s_mov_b32 s9, s37
    s_mov_b32 s10, 0x200000
    s_mov_b32 s11, 0x20000
    s_and_b32 s4, s2, 7
    s_lshl3_add_u32 s6, s4, s34
    s_and_b32 s3, s5, 1
    s_lshl1_add_u32 s3, s6, s3
    s_add_u32 s3, s3, 64
    s_bitcmp1_b32 s5, 1
    s_cselect_b32 s6, s3, s6
    s_lshl_b32 s74, s6, 5
    s_lshl_b32 s3, s32, 8
    v_and_b32 v5, 62, v21
    v_add_u32 v5, s3, v5
    s_and_b32 s3, s5, 3
    s_cmp_eq_u32 s3, 1
    s_cselect_b32 s3, 0x80000000, 0
    v_lshrrev_b32 v3, 1, v21
    v_mul_u32_u24 v3, 6144, v3
    v_and_b32 v22, 1, v21
    v_lshl_or_b32 v3, v22, 4, v3
    v_or_b32 v3, s3, v3
    s_mul_i32 s52, s32, 786432
    s_add_u32 s52, s52, s74
    s_lshl_b32 s53, s2, 13
    s_lshl_b32 s3, s32, 11
    s_add_u32 s53, s53, s3
    s_waitcnt vmcnt(12)
    s_barrier
    ds_read_b64_tr_b16 a[160:161], v24 offset:0
    ds_read_b64_tr_b16 a[162:163], v24 offset:1024
    ds_read_b64_tr_b16 a[164:165], v24 offset:8192
    ds_read_b64_tr_b16 a[166:167], v24 offset:9216
    ds_read_b128 a[0:3], v14 offset:0
    ds_read_b128 a[4:7], v15 offset:0
    ds_read_b128 a[8:11], v14 offset:2048
    ds_read_b128 a[12:15], v15 offset:2048
    ds_read_b128 a[16:19], v14 offset:4096
    ds_read_b128 a[20:23], v15 offset:4096
    ds_read_b64_tr_b16 a[168:169], v25 offset:0
    ds_read_b64_tr_b16 a[170:171], v25 offset:1024
    ds_read_b64_tr_b16 a[172:173], v25 offset:8192
    ds_read_b64_tr_b16 a[174:175], v25 offset:9216
    ds_read_b128 a[24:27], v14 offset:6144
    ds_read_b128 a[28:31], v15 offset:6144
    ds_read_b128 a[32:35], v14 offset:8192
    ds_read_b128 a[36:39], v15 offset:8192
    ds_read_b128 a[40:43], v14 offset:10240
    ds_read_b128 a[44:47], v15 offset:10240
    ds_read_b128 a[48:51], v14 offset:12288
    ds_read_b128 a[52:55], v15 offset:12288
    ds_read_b128 a[56:59], v14 offset:14336
    ds_read_b128 a[60:63], v15 offset:14336
    s_waitcnt lgkmcnt(15)
    v_mfma_f32_16x16x32_bf16 v[32:35], a[160:163], a[0:3], 0
    buffer_load_ushort v28, v5, s[28:31], 0 offen offset:0
    v_mfma_f32_16x16x32_bf16 v[32:35], a[164:167], a[4:7], v[32:35]
    buffer_load_dword a198, v6, s[56:59], s83 offen offset:256
    v_mfma_f32_16x16x32_bf16 v[36:39], a[160:163], a[8:11], 0
    buffer_load_dword a199, v7, s[56:59], s83 offen offset:1280
    v_mfma_f32_16x16x32_bf16 v[36:39], a[164:167], a[12:15], v[36:39]
    buffer_load_ushort v29, v5, s[28:31], 0 offen offset:64
    v_mfma_f32_16x16x32_bf16 v[40:43], a[160:163], a[16:19], 0
    s_add_u32 s3, s50, 0x100000
    buffer_load_dword a200, v10, s[60:63], s3 offen
    s_waitcnt lgkmcnt(11)
    v_mfma_f32_16x16x32_bf16 v[40:43], a[164:167], a[20:23], v[40:43]
    buffer_load_ushort v30, v5, s[28:31], 0 offen offset:128
    s_waitcnt lgkmcnt(6)
    v_mfma_f32_16x16x32_bf16 v[44:47], a[160:163], a[24:27], 0
    buffer_load_ushort v31, v5, s[28:31], 0 offen offset:192
    v_mfma_f32_16x16x32_bf16 v[44:47], a[164:167], a[28:31], v[44:47]
    global_load_dword a224, v[16:17], off
    v_mfma_f32_16x16x32_bf16 v[48:51], a[160:163], a[32:35], 0
    s_add_u32 m0, s90, 0x18000
    s_add_u32 s3, s89, 0x80000
    buffer_load_dwordx4 v10, s[60:63], s3 offen offset:0 lds
    v_mfma_f32_16x16x32_bf16 v[48:51], a[164:167], a[36:39], v[48:51]
    ds_read_b64_tr_b16 a[176:177], v26 offset:0
    ds_read_b64_tr_b16 a[178:179], v26 offset:1024
    s_waitcnt lgkmcnt(2)
    v_mfma_f32_16x16x32_bf16 v[52:55], a[160:163], a[40:43], 0
    buffer_load_dwordx4 v11, s[60:63], s3 offen offset:1024 lds
    v_mfma_f32_16x16x32_bf16 v[52:55], a[164:167], a[44:47], v[52:55]
    ds_read_b64_tr_b16 a[180:181], v26 offset:8192
    ds_read_b64_tr_b16 a[182:183], v26 offset:9216
    v_mfma_f32_16x16x32_bf16 v[56:59], a[160:163], a[48:51], 0
    buffer_load_dwordx4 v12, s[60:63], s3 offen offset:2048 lds
    v_mfma_f32_16x16x32_bf16 v[56:59], a[164:167], a[52:55], v[56:59]
    ds_read_b64_tr_b16 a[184:185], v27 offset:0
    ds_read_b64_tr_b16 a[186:187], v27 offset:1024
    v_mfma_f32_16x16x32_bf16 v[60:63], a[160:163], a[56:59], 0
    buffer_load_dwordx4 v13, s[60:63], s3 offen offset:3072 lds
    v_mfma_f32_16x16x32_bf16 v[60:63], a[164:167], a[60:63], v[60:63]
    ds_read_b64_tr_b16 a[188:189], v27 offset:8192
    ds_read_b64_tr_b16 a[190:191], v27 offset:9216
    v_mfma_f32_16x16x32_bf16 v[64:67], a[168:171], a[0:3], 0
    s_add_u32 m0, s90, 0x19000
    s_add_u32 s3, s89, 0xa0000
    buffer_load_dwordx4 v10, s[60:63], s3 offen offset:0 lds
    v_mfma_f32_16x16x32_bf16 v[64:67], a[172:175], a[4:7], v[64:67]
    ds_read_b64_tr_b16 a[160:161], v24 offset:16384
    ds_read_b64_tr_b16 a[162:163], v24 offset:17408
    v_mfma_f32_16x16x32_bf16 v[68:71], a[168:171], a[8:11], 0
    buffer_load_dwordx4 v11, s[60:63], s3 offen offset:1024 lds
    v_mfma_f32_16x16x32_bf16 v[68:71], a[172:175], a[12:15], v[68:71]
    ds_read_b64_tr_b16 a[164:165], v24 offset:24576
    ds_read_b64_tr_b16 a[166:167], v24 offset:25600
    v_mfma_f32_16x16x32_bf16 v[72:75], a[168:171], a[16:19], 0
    buffer_load_dwordx4 v12, s[60:63], s3 offen offset:2048 lds
    v_mfma_f32_16x16x32_bf16 v[72:75], a[172:175], a[20:23], v[72:75]
    v_mfma_f32_16x16x32_bf16 v[76:79], a[168:171], a[24:27], 0
    buffer_load_dwordx4 v13, s[60:63], s3 offen offset:3072 lds
    v_mfma_f32_16x16x32_bf16 v[76:79], a[172:175], a[28:31], v[76:79]
    v_mfma_f32_16x16x32_bf16 v[80:83], a[168:171], a[32:35], 0
    v_mfma_f32_16x16x32_bf16 v[80:83], a[172:175], a[36:39], v[80:83]
    v_mfma_f32_16x16x32_bf16 v[84:87], a[168:171], a[40:43], 0
    buffer_load_dwordx4 a[88:91], v3, s[24:27], s52 offen
    s_add_u32 s52, s52, 196608
    v_mfma_f32_16x16x32_bf16 v[84:87], a[172:175], a[44:47], v[84:87]
    v_mfma_f32_16x16x32_bf16 v[88:91], a[168:171], a[48:51], 0
    buffer_load_dwordx4 a[92:95], v3, s[24:27], s52 offen
    s_add_u32 s52, s52, 196608
    v_mfma_f32_16x16x32_bf16 v[88:91], a[172:175], a[52:55], v[88:91]
    v_mfma_f32_16x16x32_bf16 v[92:95], a[168:171], a[56:59], 0
    buffer_load_dwordx4 a[96:99], v3, s[24:27], s52 offen
    s_add_u32 s52, s52, 196608
    v_mfma_f32_16x16x32_bf16 v[92:95], a[172:175], a[60:63], v[92:95]
    s_waitcnt lgkmcnt(0)
    v_mfma_f32_16x16x32_bf16 v[96:99], a[176:179], a[0:3], 0
    buffer_load_dwordx4 a[100:103], v3, s[24:27], s52 offen
    v_mfma_f32_16x16x32_bf16 v[96:99], a[180:183], a[4:7], v[96:99]
    ds_read_b64_tr_b16 a[168:169], v25 offset:16384
    ds_read_b64_tr_b16 a[170:171], v25 offset:17408
    v_mfma_f32_16x16x32_bf16 v[100:103], a[176:179], a[8:11], 0
    ds_read_b64_tr_b16 a[172:173], v25 offset:24576
    ds_read_b64_tr_b16 a[174:175], v25 offset:25600
    v_mfma_f32_16x16x32_bf16 v[100:103], a[180:183], a[12:15], v[100:103]
    v_mfma_f32_16x16x32_bf16 v[104:107], a[176:179], a[16:19], 0
    v_mfma_f32_16x16x32_bf16 v[104:107], a[180:183], a[20:23], v[104:107]
    v_mfma_f32_16x16x32_bf16 v[108:111], a[176:179], a[24:27], 0
    v_mfma_f32_16x16x32_bf16 v[108:111], a[180:183], a[28:31], v[108:111]
    v_mfma_f32_16x16x32_bf16 v[112:115], a[176:179], a[32:35], 0
    v_mfma_f32_16x16x32_bf16 v[112:115], a[180:183], a[36:39], v[112:115]
    v_mfma_f32_16x16x32_bf16 v[116:119], a[176:179], a[40:43], 0
    v_mfma_f32_16x16x32_bf16 v[116:119], a[180:183], a[44:47], v[116:119]
    v_mfma_f32_16x16x32_bf16 v[120:123], a[176:179], a[48:51], 0
    v_mfma_f32_16x16x32_bf16 v[120:123], a[180:183], a[52:55], v[120:123]
    v_mfma_f32_16x16x32_bf16 v[124:127], a[176:179], a[56:59], 0
    v_mfma_f32_16x16x32_bf16 v[124:127], a[180:183], a[60:63], v[124:127]
    v_mfma_f32_16x16x32_bf16 v[128:131], a[184:187], a[0:3], 0
    ds_read_b64_tr_b16 a[176:177], v26 offset:16384
    ds_read_b64_tr_b16 a[178:179], v26 offset:17408
    v_mfma_f32_16x16x32_bf16 v[128:131], a[188:191], a[4:7], v[128:131]
    ds_read_b64_tr_b16 a[180:181], v26 offset:24576
    ds_read_b64_tr_b16 a[182:183], v26 offset:25600
    v_mfma_f32_16x16x32_bf16 v[132:135], a[184:187], a[8:11], 0
    s_waitcnt vmcnt(19)
    v_lshlrev_b32 v28, 16, v28
    s_waitcnt vmcnt(16)
    v_lshlrev_b32 v29, 16, v29
    s_waitcnt vmcnt(14)
    v_lshlrev_b32 v30, 16, v30
    v_mfma_f32_16x16x32_bf16 v[132:135], a[188:191], a[12:15], v[132:135]
    s_waitcnt vmcnt(13)
    v_lshlrev_b32 v31, 16, v31
    v_mul_f32 v16, 0xbfb8aa3b, v28
    v_mul_f32 v17, 0xbfb8aa3b, v29
    v_mfma_f32_16x16x32_bf16 v[136:139], a[184:187], a[16:19], 0
    v_mul_f32 v18, 0xbfb8aa3b, v30
    v_mul_f32 v19, 0xbfb8aa3b, v31
    v_exp_f32 v16, v16
    v_mfma_f32_16x16x32_bf16 v[136:139], a[188:191], a[20:23], v[136:139]
    v_exp_f32 v17, v17
    v_exp_f32 v18, v18
    v_mfma_f32_16x16x32_bf16 v[140:143], a[184:187], a[24:27], 0
    v_exp_f32 v19, v19
    v_add_f32 v16, 1.0, v16
    v_mfma_f32_16x16x32_bf16 v[140:143], a[188:191], a[28:31], v[140:143]
    v_add_f32 v17, 1.0, v17
    v_add_f32 v18, 1.0, v18
    v_add_f32 v19, 1.0, v19
    v_mfma_f32_16x16x32_bf16 v[144:147], a[184:187], a[32:35], 0
    v_rcp_f32 v16, v16
    v_mfma_f32_16x16x32_bf16 v[144:147], a[188:191], a[36:39], v[144:147]
    v_rcp_f32 v17, v17
    v_mfma_f32_16x16x32_bf16 v[148:151], a[184:187], a[40:43], 0
    v_rcp_f32 v18, v18
    v_mfma_f32_16x16x32_bf16 v[148:151], a[188:191], a[44:47], v[148:151]
    v_rcp_f32 v19, v19
    v_mfma_f32_16x16x32_bf16 v[152:155], a[184:187], a[48:51], 0
    buffer_load_dwordx4 a[64:67], v2, s[8:11], s53 offen offset:0
    v_mfma_f32_16x16x32_bf16 v[152:155], a[188:191], a[52:55], v[152:155]
    v_mul_f32 v28, v16, v28
    v_mul_f32 v29, v17, v29
    v_mfma_f32_16x16x32_bf16 v[156:159], a[184:187], a[56:59], 0
    v_mul_f32 v30, v18, v30
    v_mul_f32 v31, v19, v31
    v_mfma_f32_16x16x32_bf16 v[156:159], a[188:191], a[60:63], v[156:159]
    v_cvt_pk_bf16_f32 v28, v28, v28
    v_cvt_pk_bf16_f32 v29, v29, v29
    v_mfma_f32_16x16x32_bf16 v[160:163], a[0:3], a[160:163], 0
    v_cvt_pk_bf16_f32 v30, v30, v30
    v_cvt_pk_bf16_f32 v31, v31, v31
    v_mfma_f32_16x16x32_bf16 v[160:163], a[4:7], a[164:167], v[160:163]
    v_lshlrev_b32 v28, 16, v28
    v_lshlrev_b32 v29, 16, v29
    v_mfma_f32_16x16x32_bf16 v[164:167], a[8:11], a[160:163], 0
    buffer_load_dwordx4 a[68:71], v2, s[8:11], s53 offen offset:1024
    v_mfma_f32_16x16x32_bf16 v[164:167], a[12:15], a[164:167], v[164:167]
    v_lshlrev_b32 v30, 16, v30
    v_lshlrev_b32 v31, 16, v31
    v_mfma_f32_16x16x32_bf16 v[168:171], a[16:19], a[160:163], 0
    ds_read_b64_tr_b16 a[184:185], v27 offset:16384
    ds_read_b64_tr_b16 a[186:187], v27 offset:17408
    v_mfma_f32_16x16x32_bf16 v[168:171], a[20:23], a[164:167], v[168:171]
    ds_read_b64_tr_b16 a[188:189], v27 offset:24576
    ds_read_b64_tr_b16 a[190:191], v27 offset:25600
    v_mfma_f32_16x16x32_bf16 v[172:175], a[24:27], a[160:163], 0
    s_waitcnt vmcnt(5)
    v_accvgpr_read_b32 v4, a88
    v_lshlrev_b32 v3, 16, v4
    v_and_b32 v4, 0xffff0000, v4
    v_mfma_f32_16x16x32_bf16 v[172:175], a[28:31], a[164:167], v[172:175]
    v_mul_f32 v16, v28, v3
    v_mul_f32 v17, v28, v4
    v_accvgpr_read_b32 v5, a89
    v_mfma_f32_16x16x32_bf16 v[176:179], a[32:35], a[160:163], 0
    v_lshlrev_b32 v3, 16, v5
    v_and_b32 v5, 0xffff0000, v5
    v_mul_f32 v18, v28, v3
    v_mfma_f32_16x16x32_bf16 v[176:179], a[36:39], a[164:167], v[176:179]
    v_mul_f32 v19, v28, v5
    v_accvgpr_read_b32 v4, a90
    v_lshlrev_b32 v3, 16, v4
    v_mfma_f32_16x16x32_bf16 v[180:183], a[40:43], a[160:163], 0
    v_and_b32 v4, 0xffff0000, v4
    v_mul_f32 v20, v28, v3
    v_mul_f32 v21, v28, v4
    v_mfma_f32_16x16x32_bf16 v[180:183], a[44:47], a[164:167], v[180:183]
    v_accvgpr_read_b32 v5, a91
    v_lshlrev_b32 v3, 16, v5
    v_and_b32 v5, 0xffff0000, v5
    v_mfma_f32_16x16x32_bf16 v[184:187], a[48:51], a[160:163], 0
    v_mul_f32 v22, v28, v3
    v_mul_f32 v23, v28, v5
    s_waitcnt vmcnt(4)
    v_accvgpr_read_b32 v4, a92
    v_mfma_f32_16x16x32_bf16 v[184:187], a[52:55], a[164:167], v[184:187]
    v_lshlrev_b32 v3, 16, v4
    v_and_b32 v4, 0xffff0000, v4
    v_fmac_f32 v16, v29, v3
    v_mfma_f32_16x16x32_bf16 v[188:191], a[56:59], a[160:163], 0
    v_fmac_f32 v17, v29, v4
    v_accvgpr_read_b32 v5, a93
    v_lshlrev_b32 v3, 16, v5
    v_mfma_f32_16x16x32_bf16 v[188:191], a[60:63], a[164:167], v[188:191]
    v_and_b32 v5, 0xffff0000, v5
    v_fmac_f32 v18, v29, v3
    v_fmac_f32 v19, v29, v5
    s_waitcnt lgkmcnt(0)
    v_mfma_f32_16x16x32_bf16 v[192:195], a[0:3], a[168:171], 0
    v_accvgpr_read_b32 v4, a94
    v_lshlrev_b32 v3, 16, v4
    v_and_b32 v4, 0xffff0000, v4
    v_mfma_f32_16x16x32_bf16 v[192:195], a[4:7], a[172:175], v[192:195]
    v_fmac_f32 v20, v29, v3
    v_fmac_f32 v21, v29, v4
    v_accvgpr_read_b32 v5, a95
    v_mfma_f32_16x16x32_bf16 v[196:199], a[8:11], a[168:171], 0
    v_lshlrev_b32 v3, 16, v5
    v_and_b32 v5, 0xffff0000, v5
    v_fmac_f32 v22, v29, v3
    v_mfma_f32_16x16x32_bf16 v[196:199], a[12:15], a[172:175], v[196:199]
    v_fmac_f32 v23, v29, v5
    s_waitcnt vmcnt(3)
    v_accvgpr_read_b32 v4, a96
    v_lshlrev_b32 v3, 16, v4
    v_mfma_f32_16x16x32_bf16 v[200:203], a[16:19], a[168:171], 0
    v_and_b32 v4, 0xffff0000, v4
    v_fmac_f32 v16, v30, v3
    v_fmac_f32 v17, v30, v4
    v_mfma_f32_16x16x32_bf16 v[200:203], a[20:23], a[172:175], v[200:203]
    v_accvgpr_read_b32 v5, a97
    v_lshlrev_b32 v3, 16, v5
    v_and_b32 v5, 0xffff0000, v5
    v_mfma_f32_16x16x32_bf16 v[204:207], a[24:27], a[168:171], 0
    v_fmac_f32 v18, v30, v3
    v_fmac_f32 v19, v30, v5
    v_accvgpr_read_b32 v4, a98
    v_mfma_f32_16x16x32_bf16 v[204:207], a[28:31], a[172:175], v[204:207]
    v_lshlrev_b32 v3, 16, v4
    v_and_b32 v4, 0xffff0000, v4
    v_fmac_f32 v20, v30, v3
    v_mfma_f32_16x16x32_bf16 v[208:211], a[32:35], a[168:171], 0
    v_fmac_f32 v21, v30, v4
    v_accvgpr_read_b32 v5, a99
    v_lshlrev_b32 v3, 16, v5
    v_mfma_f32_16x16x32_bf16 v[208:211], a[36:39], a[172:175], v[208:211]
    v_and_b32 v5, 0xffff0000, v5
    v_fmac_f32 v22, v30, v3
    v_fmac_f32 v23, v30, v5
    v_mfma_f32_16x16x32_bf16 v[212:215], a[40:43], a[168:171], 0
    s_waitcnt vmcnt(2)
    v_accvgpr_read_b32 v4, a100
    v_lshlrev_b32 v3, 16, v4
    v_and_b32 v4, 0xffff0000, v4
    v_mfma_f32_16x16x32_bf16 v[212:215], a[44:47], a[172:175], v[212:215]
    v_fmac_f32 v16, v31, v3
    v_fmac_f32 v17, v31, v4
    v_accvgpr_read_b32 v5, a101
    v_mfma_f32_16x16x32_bf16 v[216:219], a[48:51], a[168:171], 0
    v_lshlrev_b32 v3, 16, v5
    v_and_b32 v5, 0xffff0000, v5
    v_fmac_f32 v18, v31, v3
    v_mfma_f32_16x16x32_bf16 v[216:219], a[52:55], a[172:175], v[216:219]
    v_fmac_f32 v19, v31, v5
    v_accvgpr_read_b32 v4, a102
    v_lshlrev_b32 v3, 16, v4
    v_mfma_f32_16x16x32_bf16 v[220:223], a[56:59], a[168:171], 0
    v_and_b32 v4, 0xffff0000, v4
    v_fmac_f32 v20, v31, v3
    v_fmac_f32 v21, v31, v4
    v_mfma_f32_16x16x32_bf16 v[220:223], a[60:63], a[172:175], v[220:223]
    v_accvgpr_read_b32 v5, a103
    v_lshlrev_b32 v3, 16, v5
    v_and_b32 v5, 0xffff0000, v5
    v_mfma_f32_16x16x32_bf16 v[224:227], a[0:3], a[176:179], 0
    v_fmac_f32 v22, v31, v3
    v_fmac_f32 v23, v31, v5
    v_permlane32_swap_b32 v16, v20
    v_mfma_f32_16x16x32_bf16 v[224:227], a[4:7], a[180:183], v[224:227]
    v_permlane32_swap_b32 v17, v21
    v_permlane32_swap_b32 v18, v22
    v_permlane32_swap_b32 v19, v23
    v_mfma_f32_16x16x32_bf16 v[228:231], a[8:11], a[176:179], 0
    v_add_f32 v16, v16, v20
    v_add_f32 v17, v17, v21
    v_add_f32 v18, v18, v22
    v_add_f32 v19, v19, v23
    s_nop 0
    v_permlane16_swap_b32 v16, v18
    s_nop 0
    v_permlane16_swap_b32 v17, v19
    v_add_f32 v16, v16, v18
    v_add_f32 v17, v17, v19
    v_lshrrev_b32 v28, 8, v2
    v_and_b32 v29, 16, v2
    v_lshl_or_b32 v28, v28, 2, v29
    s_lshl_b32 s4, s32, 6
    s_add_u32 s4, s4, 0x24000
    v_lshl_add_u32 v28, v28, 1, s4
    v_add_f32_dpp v16, v16, v16 quad_perm:[2,3,0,1] row_mask:0xf bank_mask:0xf
    v_add_f32_dpp v17, v17, v17 quad_perm:[2,3,0,1] row_mask:0xf bank_mask:0xf
    s_nop 0
    v_add_f32_dpp v16, v16, v16 row_ror:4 row_mask:0xf bank_mask:0xf
    s_nop 0
    v_add_f32_dpp v17, v17, v17 row_ror:4 row_mask:0xf bank_mask:0xf
    s_nop 0
    v_add_f32_dpp v16, v16, v16 row_ror:8 row_mask:0xf bank_mask:0xf
    s_nop 0
    v_add_f32_dpp v17, v17, v17 row_ror:8 row_mask:0xf bank_mask:0xf
    ds_write_b64 v28, v[16:17]
    v_mfma_f32_16x16x32_bf16 v[228:231], a[12:15], a[180:183], v[228:231]
    s_waitcnt vmcnt(6) lgkmcnt(0)
    s_barrier
    v_mfma_f32_16x16x32_bf16 v[232:235], a[16:19], a[176:179], 0
    s_mov_b32 m0, s90
    s_add_u32 s3, s88, 0x100
    buffer_load_dwordx4 v6, s[56:59], s3 offen offset:0 lds
    v_mfma_f32_16x16x32_bf16 v[232:235], a[20:23], a[180:183], v[232:235]
    v_and_b32 v20, 0x30, v2
    v_bfe_u32 v21, v2, 6, 2
    v_lshlrev_b32 v28, 4, v21
    v_mfma_f32_16x16x32_bf16 v[236:239], a[24:27], a[176:179], 0
    v_lshl_or_b32 v20, v20, 2, v28
    v_add_u32 v20, 0x24000, v20
    ds_read_b128 v[16:19], v20
    v_mfma_f32_16x16x32_bf16 v[236:239], a[28:31], a[180:183], v[236:239]
    ds_read_b64_tr_b16 a[160:161], v24 offset:32768
    s_and_b32 s4, s33, 3
    s_cmp_lg_u32 s4, 0
    s_cselect_b32 s4, 0x80000000, 0
    v_mfma_f32_16x16x32_bf16 v[240:243], a[32:35], a[176:179], 0
    v_and_b32 v29, 0xf3000000, v0
    v_or3_b32 v28, v28, v29, s4
    buffer_load_dwordx4 v7, s[56:59], s3 offen offset:1024 lds
    v_mfma_f32_16x16x32_bf16 v[240:243], a[36:39], a[180:183], v[240:243]
    ds_read_b64_tr_b16 a[162:163], v24 offset:33792
    ds_read_b64_tr_b16 a[164:165], v24 offset:40960
    s_bitcmp1_b32 s33, 1
    s_cselect_b32 s4, 0, 0x80000000
    v_mfma_f32_16x16x32_bf16 v[244:247], a[40:43], a[176:179], 0
    v_lshl_or_b32 v29, v21, 3, v29
    v_or_b32 v29, s4, v29
    v_mov_b32 v21, s80
    v_mfma_f32_16x16x32_bf16 v[244:247], a[44:47], a[180:183], v[244:247]
    v_mov_b32 v23, s81
    s_waitcnt lgkmcnt(3)
    v_add_f32_dpp v16, v16, v16 quad_perm:[1,0,3,2] row_mask:0xf bank_mask:0xf
    v_add_f32_dpp v17, v17, v17 quad_perm:[1,0,3,2] row_mask:0xf bank_mask:0xf
    v_mfma_f32_16x16x32_bf16 v[248:251], a[48:51], a[176:179], 0
    v_add_f32_dpp v18, v18, v18 quad_perm:[1,0,3,2] row_mask:0xf bank_mask:0xf
    v_add_f32_dpp v19, v19, v19 quad_perm:[1,0,3,2] row_mask:0xf bank_mask:0xf
    v_mfma_f32_16x16x32_bf16 v[248:251], a[52:55], a[180:183], v[248:251]
    buffer_load_dwordx4 v8, s[56:59], s3 offen offset:2048 lds
    v_mfma_f32_16x16x32_bf16 v[252:255], a[56:59], a[176:179], 0
    v_add_f32_dpp v16, v16, v16 quad_perm:[2,3,0,1] row_mask:0xf bank_mask:0xf
    ds_read_b64_tr_b16 a[166:167], v24 offset:41984
    v_mfma_f32_16x16x32_bf16 v[252:255], a[60:63], a[180:183], v[252:255]
    v_add_f32_dpp v17, v17, v17 quad_perm:[2,3,0,1] row_mask:0xf bank_mask:0xf
    v_add_f32_dpp v18, v18, v18 quad_perm:[2,3,0,1] row_mask:0xf bank_mask:0xf
    v_mfma_f32_16x16x32_bf16 a[128:131], a[0:3], a[184:187], 0
    v_add_f32_dpp v19, v19, v19 quad_perm:[2,3,0,1] row_mask:0xf bank_mask:0xf
    v_cvt_pk_bf16_f32 v20, v16, v17
    v_mfma_f32_16x16x32_bf16 a[128:131], a[4:7], a[188:191], a[128:131]
    buffer_load_dwordx4 v9, s[56:59], s3 offen offset:3072 lds
    v_mfma_f32_16x16x32_bf16 a[132:135], a[8:11], a[184:187], 0
    ds_read_b128 a[0:3], v14 offset:32768
    v_cvt_pk_bf16_f32 v22, v18, v19
    v_mfma_f32_16x16x32_bf16 a[132:135], a[12:15], a[188:191], a[132:135]
    ds_read_b128 a[4:7], v15 offset:32768
    v_cvt_pk_bf16_f32 v17, v18, v19
    v_mfma_f32_16x16x32_bf16 a[136:139], a[16:19], a[184:187], 0
    ds_read_b128 a[8:11], v14 offset:34816
    v_mov_b32 v16, v20
    v_mfma_f32_16x16x32_bf16 a[136:139], a[20:23], a[188:191], a[136:139]
    ds_read_b128 a[12:15], v15 offset:34816
    ds_read_b128 a[16:19], v14 offset:36864
    v_mfma_f32_16x16x32_bf16 a[140:143], a[24:27], a[184:187], 0
    s_add_u32 m0, s90, 0x1000
    s_add_u32 s3, s88, 0x8100
    buffer_load_dwordx4 v6, s[56:59], s3 offen offset:0 lds
    v_mfma_f32_16x16x32_bf16 a[140:143], a[28:31], a[188:191], a[140:143]
    ds_read_b128 a[20:23], v15 offset:36864
    ds_read_b128 a[24:27], v14 offset:38912
    v_mfma_f32_16x16x32_bf16 a[144:147], a[32:35], a[184:187], 0
    s_lshl_b32 s4, s74, 1
    s_add_u32 s4, s4, 0x2000
    buffer_store_dwordx4 v[20:23], v28, s[20:23], s4 offen sc1
    v_mfma_f32_16x16x32_bf16 a[144:147], a[36:39], a[188:191], a[144:147]
    ds_read_b128 a[28:31], v15 offset:38912
    ds_read_b128 a[32:35], v14 offset:40960
    v_mfma_f32_16x16x32_bf16 a[148:151], a[40:43], a[184:187], 0
    s_add_u32 s4, s74, 0x5000
    buffer_store_dwordx2 v[16:17], v29, s[20:23], s4 offen sc1
    v_mfma_f32_16x16x32_bf16 a[148:151], a[44:47], a[188:191], a[148:151]
    ds_read_b128 a[36:39], v15 offset:40960
    ds_read_b128 a[40:43], v14 offset:43008
    v_mfma_f32_16x16x32_bf16 a[152:155], a[48:51], a[184:187], 0
    buffer_load_dwordx4 v7, s[56:59], s3 offen offset:1024 lds
    v_mfma_f32_16x16x32_bf16 a[152:155], a[52:55], a[188:191], a[152:155]
    ds_read_b128 a[44:47], v15 offset:43008
    ds_read_b64_tr_b16 a[168:169], v25 offset:32768
    v_mfma_f32_16x16x32_bf16 a[156:159], a[56:59], a[184:187], 0
    ds_read_b128 a[48:51], v14 offset:45056
    ds_read_b128 a[52:55], v15 offset:45056
    v_mfma_f32_16x16x32_bf16 a[156:159], a[60:63], a[188:191], a[156:159]
    ds_read_b128 a[56:59], v14 offset:47104
    ds_read_b128 a[60:63], v15 offset:47104
    s_waitcnt lgkmcnt(10)
    v_mfma_f32_16x16x32_bf16 v[32:35], a[160:163], a[0:3], v[32:35]
    buffer_load_dwordx4 v8, s[56:59], s3 offen offset:2048 lds
    v_mfma_f32_16x16x32_bf16 v[32:35], a[164:167], a[4:7], v[32:35]
    ds_read_b64_tr_b16 a[170:171], v25 offset:33792
    ds_read_b64_tr_b16 a[172:173], v25 offset:40960
    v_mfma_f32_16x16x32_bf16 v[36:39], a[160:163], a[8:11], v[36:39]
    ds_read_b64_tr_b16 a[174:175], v25 offset:41984
    ds_read_b64_tr_b16 a[176:177], v26 offset:32768
    v_mfma_f32_16x16x32_bf16 v[36:39], a[164:167], a[12:15], v[36:39]
    buffer_load_dwordx4 v9, s[56:59], s3 offen offset:3072 lds
    v_mfma_f32_16x16x32_bf16 v[40:43], a[160:163], a[16:19], v[40:43]
    ds_read_b64_tr_b16 a[178:179], v26 offset:33792
    ds_read_b64_tr_b16 a[180:181], v26 offset:40960
    v_mfma_f32_16x16x32_bf16 v[40:43], a[164:167], a[20:23], v[40:43]
    ds_read_b64_tr_b16 a[182:183], v26 offset:41984
    ds_read_b64_tr_b16 a[184:185], v27 offset:32768
    v_mfma_f32_16x16x32_bf16 v[44:47], a[160:163], a[24:27], v[44:47]
    ds_read_b64_tr_b16 a[186:187], v27 offset:33792
    ds_read_b64_tr_b16 a[188:189], v27 offset:40960
    s_waitcnt lgkmcnt(10)
    v_mfma_f32_16x16x32_bf16 v[44:47], a[164:167], a[28:31], v[44:47]
    ds_read_b64_tr_b16 a[190:191], v27 offset:41984
    v_mfma_f32_16x16x32_bf16 v[48:51], a[160:163], a[32:35], v[48:51]
    s_add_u32 m0, s90, 0x10000
    s_add_u32 s3, s89, 0x100000
    buffer_load_dwordx4 v10, s[60:63], s3 offen offset:0 lds
    v_mfma_f32_16x16x32_bf16 v[48:51], a[164:167], a[36:39], v[48:51]
    v_mfma_f32_16x16x32_bf16 v[52:55], a[160:163], a[40:43], v[52:55]
    v_mfma_f32_16x16x32_bf16 v[52:55], a[164:167], a[44:47], v[52:55]
    v_mfma_f32_16x16x32_bf16 v[56:59], a[160:163], a[48:51], v[56:59]
    s_waitcnt vmcnt(12)
    v_accvgpr_read_b32 v28, a64
    v_accvgpr_read_b32 v29, a65
    buffer_load_dwordx4 v11, s[60:63], s3 offen offset:1024 lds
    v_mfma_f32_16x16x32_bf16 v[56:59], a[164:167], a[52:55], v[56:59]
    v_accvgpr_read_b32 v30, a66
    v_accvgpr_read_b32 v31, a67
    v_lshlrev_b32 v16, 16, v28
    v_mfma_f32_16x16x32_bf16 v[60:63], a[160:163], a[56:59], v[60:63]
    v_and_b32 v17, 0xffff0000, v28
    v_lshlrev_b32 v18, 16, v29
    v_mfma_f32_16x16x32_bf16 v[60:63], a[164:167], a[60:63], v[60:63]
    v_and_b32 v19, 0xffff0000, v29
    v_lshlrev_b32 v20, 16, v30
    s_waitcnt lgkmcnt(0)
    v_mfma_f32_16x16x32_bf16 v[64:67], a[168:171], a[0:3], v[64:67]
    v_and_b32 v21, 0xffff0000, v30
    v_lshlrev_b32 v22, 16, v31
    v_mfma_f32_16x16x32_bf16 v[64:67], a[172:175], a[4:7], v[64:67]
    buffer_load_dwordx4 v12, s[60:63], s3 offen offset:2048 lds
    v_mfma_f32_16x16x32_bf16 v[68:71], a[168:171], a[8:11], v[68:71]
    v_and_b32 v23, 0xffff0000, v31
    v_add_f32 v3, v16, v17
    v_mfma_f32_16x16x32_bf16 v[68:71], a[172:175], a[12:15], v[68:71]
    v_add_f32 v3, v3, v18
    v_add_f32 v3, v3, v19
    v_mfma_f32_16x16x32_bf16 v[72:75], a[168:171], a[16:19], v[72:75]
    v_add_f32 v3, v3, v20
    v_add_f32 v3, v3, v21
    v_mfma_f32_16x16x32_bf16 v[72:75], a[172:175], a[20:23], v[72:75]
    buffer_load_dwordx4 v13, s[60:63], s3 offen offset:3072 lds
    v_mfma_f32_16x16x32_bf16 v[76:79], a[168:171], a[24:27], v[76:79]
    v_add_f32 v3, v3, v22
    ds_read_b64_tr_b16 a[160:161], v24 offset:49152
    v_mfma_f32_16x16x32_bf16 v[76:79], a[172:175], a[28:31], v[76:79]
    v_add_f32 v3, v3, v23
    ds_read_b64_tr_b16 a[162:163], v24 offset:50176
    v_mfma_f32_16x16x32_bf16 v[80:83], a[168:171], a[32:35], v[80:83]
    v_add_f32_dpp v3, v3, v3 quad_perm:[1,0,3,2] row_mask:0xf bank_mask:0xf
    s_nop 1
    v_add_f32_dpp v3, v3, v3 quad_perm:[2,3,0,1] row_mask:0xf bank_mask:0xf
    v_mfma_f32_16x16x32_bf16 v[80:83], a[172:175], a[36:39], v[80:83]
    s_nop 0
    v_add_f32_dpp v3, v3, v3 row_half_mirror row_mask:0xf bank_mask:0xf
    s_nop 1
    v_add_f32_dpp v3, v3, v3 row_mirror row_mask:0xf bank_mask:0xf
    v_mfma_f32_16x16x32_bf16 v[84:87], a[168:171], a[40:43], v[84:87]
    s_add_u32 m0, s90, 0x11000
    s_add_u32 s3, s89, 0x120000
    buffer_load_dwordx4 v10, s[60:63], s3 offen offset:0 lds
    v_mfma_f32_16x16x32_bf16 v[84:87], a[172:175], a[44:47], v[84:87]
    v_mov_b32 v28, v3
    s_nop 1
    v_permlane16_swap_b32 v3, v28
    v_mfma_f32_16x16x32_bf16 v[88:91], a[168:171], a[48:51], v[88:91]
    v_add_f32 v3, v3, v28
    ds_read_b64_tr_b16 a[164:165], v24 offset:57344
    v_mfma_f32_16x16x32_bf16 v[88:91], a[172:175], a[52:55], v[88:91]
    v_mov_b32 v28, v3
    s_nop 1
    v_permlane32_swap_b32 v3, v28
    v_mfma_f32_16x16x32_bf16 v[92:95], a[168:171], a[56:59], v[92:95]
    buffer_load_dwordx4 v11, s[60:63], s3 offen offset:1024 lds
    v_mfma_f32_16x16x32_bf16 v[92:95], a[172:175], a[60:63], v[92:95]
    v_add_f32 v3, v3, v28
    v_mul_f32 v3, 0x3b000000, v3
    v_mfma_f32_16x16x32_bf16 v[96:99], a[176:179], a[0:3], v[96:99]
    v_sub_f32 v16, v16, v3
    v_sub_f32 v17, v17, v3
    v_mfma_f32_16x16x32_bf16 v[96:99], a[180:183], a[4:7], v[96:99]
    v_sub_f32 v18, v18, v3
    v_sub_f32 v19, v19, v3
    v_mfma_f32_16x16x32_bf16 v[100:103], a[176:179], a[8:11], v[100:103]
    v_sub_f32 v20, v20, v3
    v_sub_f32 v21, v21, v3
    v_mfma_f32_16x16x32_bf16 v[100:103], a[180:183], a[12:15], v[100:103]
    buffer_load_dwordx4 v12, s[60:63], s3 offen offset:2048 lds
    v_mfma_f32_16x16x32_bf16 v[104:107], a[176:179], a[16:19], v[104:107]
    v_sub_f32 v22, v22, v3
    v_sub_f32 v23, v23, v3
    v_mfma_f32_16x16x32_bf16 v[104:107], a[180:183], a[20:23], v[104:107]
    v_mul_f32 v3, v16, v16
    ds_read_b64_tr_b16 a[166:167], v24 offset:58368
    v_mfma_f32_16x16x32_bf16 v[108:111], a[176:179], a[24:27], v[108:111]
    v_fmac_f32 v3, v17, v17
    v_fmac_f32 v3, v18, v18
    v_mfma_f32_16x16x32_bf16 v[108:111], a[180:183], a[28:31], v[108:111]
    buffer_load_dwordx4 v13, s[60:63], s3 offen offset:3072 lds
    v_mfma_f32_16x16x32_bf16 v[112:115], a[176:179], a[32:35], v[112:115]
    v_fmac_f32 v3, v19, v19
    v_fmac_f32 v3, v20, v20
    v_mfma_f32_16x16x32_bf16 v[112:115], a[180:183], a[36:39], v[112:115]
    v_fmac_f32 v3, v21, v21
    v_fmac_f32 v3, v22, v22
    v_mfma_f32_16x16x32_bf16 v[116:119], a[176:179], a[40:43], v[116:119]
    v_fmac_f32 v3, v23, v23
    s_nop 1
    v_add_f32_dpp v3, v3, v3 quad_perm:[1,0,3,2] row_mask:0xf bank_mask:0xf
    v_mfma_f32_16x16x32_bf16 v[116:119], a[180:183], a[44:47], v[116:119]
    s_nop 0
    v_add_f32_dpp v3, v3, v3 quad_perm:[2,3,0,1] row_mask:0xf bank_mask:0xf
    s_nop 1
    v_add_f32_dpp v3, v3, v3 row_half_mirror row_mask:0xf bank_mask:0xf
    v_mfma_f32_16x16x32_bf16 v[120:123], a[176:179], a[48:51], v[120:123]
    buffer_load_dword a204, v6, s[56:59], s83 offen offset:512
    v_mfma_f32_16x16x32_bf16 v[120:123], a[180:183], a[52:55], v[120:123]
    v_add_f32_dpp v3, v3, v3 row_mirror row_mask:0xf bank_mask:0xf
    ds_read_b64_tr_b16 a[168:169], v25 offset:49152
    v_mfma_f32_16x16x32_bf16 v[124:127], a[176:179], a[56:59], v[124:127]
    v_mov_b32 v28, v3
    ds_read_b64_tr_b16 a[170:171], v25 offset:50176
    v_mfma_f32_16x16x32_bf16 v[124:127], a[180:183], a[60:63], v[124:127]
    v_permlane16_swap_b32 v3, v28
    v_add_f32 v3, v3, v28
    v_mfma_f32_16x16x32_bf16 v[128:131], a[184:187], a[0:3], v[128:131]
    buffer_load_dword a201, v6, s[56:59], s83 offen offset:384
    v_mfma_f32_16x16x32_bf16 v[128:131], a[188:191], a[4:7], v[128:131]
    buffer_load_dword a205, v7, s[56:59], s83 offen offset:1536
    v_mfma_f32_16x16x32_bf16 v[132:135], a[184:187], a[8:11], v[132:135]
    v_mov_b32 v28, v3
    s_nop 1
    v_permlane32_swap_b32 v3, v28
    v_mfma_f32_16x16x32_bf16 v[132:135], a[188:191], a[12:15], v[132:135]
    buffer_load_dword a202, v7, s[56:59], s83 offen offset:1408
    v_mfma_f32_16x16x32_bf16 v[136:139], a[184:187], a[16:19], v[136:139]
    v_add_f32 v3, v3, v28
    v_mov_b32 v28, 0x3727c5ac
    v_mfma_f32_16x16x32_bf16 v[136:139], a[188:191], a[20:23], v[136:139]
    v_fmac_f32 v28, 0x3b000000, v3
    ds_read_b64_tr_b16 a[172:173], v25 offset:57344
    v_mfma_f32_16x16x32_bf16 v[140:143], a[184:187], a[24:27], v[140:143]
    s_add_u32 s3, s50, 0x200000
    buffer_load_dword a206, v10, s[60:63], s3 offen
    v_mfma_f32_16x16x32_bf16 v[140:143], a[188:191], a[28:31], v[140:143]
    s_add_u32 s3, s50, 0x180000
    buffer_load_dword a203, v10, s[60:63], s3 offen
    v_mfma_f32_16x16x32_bf16 v[144:147], a[184:187], a[32:35], v[144:147]
    v_rsq_f32 v28, v28
    v_mfma_f32_16x16x32_bf16 v[144:147], a[188:191], a[36:39], v[144:147]
    v_mul_f32 v16, v28, v16
    v_mul_f32 v17, v28, v17
    v_mfma_f32_16x16x32_bf16 v[148:151], a[184:187], a[40:43], v[148:151]
    v_mul_f32 v18, v28, v18
    v_mul_f32 v19, v28, v19
    v_mfma_f32_16x16x32_bf16 v[148:151], a[188:191], a[44:47], v[148:151]
    s_mov_b32 s3, s51
    s_and_b32 s3, s3, 0x3fffff
    buffer_load_dword a124, v10, s[12:15], s3 offen
    v_mfma_f32_16x16x32_bf16 v[152:155], a[184:187], a[48:51], v[152:155]
    v_mul_f32 v20, v28, v20
    v_mul_f32 v21, v28, v21
    v_mfma_f32_16x16x32_bf16 v[152:155], a[188:191], a[52:55], v[152:155]
    v_mul_f32 v22, v28, v22
    v_mul_f32 v23, v28, v23
    v_mfma_f32_16x16x32_bf16 v[156:159], a[184:187], a[56:59], v[156:159]
    v_accvgpr_write_b32 a72, v16
    v_accvgpr_write_b32 a73, v17
    v_mfma_f32_16x16x32_bf16 v[156:159], a[188:191], a[60:63], v[156:159]
    v_accvgpr_write_b32 a74, v18
    ds_read_b64_tr_b16 a[174:175], v25 offset:58368
    s_waitcnt lgkmcnt(1)
    v_mfma_f32_16x16x32_bf16 v[160:163], a[0:3], a[160:163], v[160:163]
    v_accvgpr_write_b32 a75, v19
    v_accvgpr_write_b32 a76, v20
    v_mfma_f32_16x16x32_bf16 v[160:163], a[4:7], a[164:167], v[160:163]
    v_accvgpr_write_b32 a77, v21
    v_accvgpr_write_b32 a78, v22
    v_mfma_f32_16x16x32_bf16 v[164:167], a[8:11], a[160:163], v[164:167]
    v_accvgpr_write_b32 a79, v23
    ds_read_b64_tr_b16 a[176:177], v26 offset:49152
    v_mfma_f32_16x16x32_bf16 v[164:167], a[12:15], a[164:167], v[164:167]
    ds_read_b64_tr_b16 a[178:179], v26 offset:50176
    ds_read_b64_tr_b16 a[180:181], v26 offset:57344
    v_mfma_f32_16x16x32_bf16 v[168:171], a[16:19], a[160:163], v[168:171]
    s_waitcnt vmcnt(25)
    v_accvgpr_read_b32 v28, a68
    v_accvgpr_read_b32 v29, a69
    v_mfma_f32_16x16x32_bf16 v[168:171], a[20:23], a[164:167], v[168:171]
    v_accvgpr_read_b32 v30, a70
    v_accvgpr_read_b32 v31, a71
    v_mfma_f32_16x16x32_bf16 v[172:175], a[24:27], a[160:163], v[172:175]
    v_lshlrev_b32 v16, 16, v28
    v_and_b32 v17, 0xffff0000, v28
    v_mfma_f32_16x16x32_bf16 v[172:175], a[28:31], a[164:167], v[172:175]
    v_lshlrev_b32 v18, 16, v29
    v_and_b32 v19, 0xffff0000, v29
    v_mfma_f32_16x16x32_bf16 v[176:179], a[32:35], a[160:163], v[176:179]
    v_lshlrev_b32 v20, 16, v30
    v_and_b32 v21, 0xffff0000, v30
    v_mfma_f32_16x16x32_bf16 v[176:179], a[36:39], a[164:167], v[176:179]
    v_lshlrev_b32 v22, 16, v31
    v_and_b32 v23, 0xffff0000, v31
    v_mfma_f32_16x16x32_bf16 v[180:183], a[40:43], a[160:163], v[180:183]
    v_add_f32 v3, v16, v17
    v_add_f32 v3, v3, v18
    v_mfma_f32_16x16x32_bf16 v[180:183], a[44:47], a[164:167], v[180:183]
    v_add_f32 v3, v3, v19
    v_add_f32 v3, v3, v20
    v_mfma_f32_16x16x32_bf16 v[184:187], a[48:51], a[160:163], v[184:187]
    v_add_f32 v3, v3, v21
    v_add_f32 v3, v3, v22
    v_mfma_f32_16x16x32_bf16 v[184:187], a[52:55], a[164:167], v[184:187]
    v_add_f32 v3, v3, v23
    ds_read_b64_tr_b16 a[182:183], v26 offset:58368
    v_mfma_f32_16x16x32_bf16 v[188:191], a[56:59], a[160:163], v[188:191]
    v_add_f32_dpp v3, v3, v3 quad_perm:[1,0,3,2] row_mask:0xf bank_mask:0xf
    s_nop 1
    v_add_f32_dpp v3, v3, v3 quad_perm:[2,3,0,1] row_mask:0xf bank_mask:0xf
    v_mfma_f32_16x16x32_bf16 v[188:191], a[60:63], a[164:167], v[188:191]
    s_nop 0
    v_add_f32_dpp v3, v3, v3 row_half_mirror row_mask:0xf bank_mask:0xf
    s_nop 1
    v_add_f32_dpp v3, v3, v3 row_mirror row_mask:0xf bank_mask:0xf
    v_mfma_f32_16x16x32_bf16 v[192:195], a[0:3], a[168:171], v[192:195]
    v_lshlrev_b32 v5, 1, v2
    v_add_u32 v5, 0x2000, v5
    s_waitcnt lgkmcnt(1)
    v_mfma_f32_16x16x32_bf16 v[192:195], a[4:7], a[172:175], v[192:195]
    buffer_load_dwordx4 a[88:91], v5, s[20:23], 0 offen offset:0 sc1
    v_mov_b32 v28, v3
    v_mfma_f32_16x16x32_bf16 v[196:199], a[8:11], a[168:171], v[196:199]
    s_nop 0
    v_permlane16_swap_b32 v3, v28
    v_add_f32 v3, v3, v28
    v_mfma_f32_16x16x32_bf16 v[196:199], a[12:15], a[172:175], v[196:199]
    v_mov_b32 v28, v3
    s_nop 1
    v_permlane32_swap_b32 v3, v28
    v_mfma_f32_16x16x32_bf16 v[200:203], a[16:19], a[168:171], v[200:203]
    buffer_load_dwordx4 a[92:95], v5, s[20:23], 0 offen offset:16 sc1
    v_add_f32 v3, v3, v28
    v_mfma_f32_16x16x32_bf16 v[200:203], a[20:23], a[172:175], v[200:203]
    v_mul_f32 v3, 0x3b000000, v3
    v_sub_f32 v16, v16, v3
    v_mfma_f32_16x16x32_bf16 v[204:207], a[24:27], a[168:171], v[204:207]
    ds_read_b64_tr_b16 a[184:185], v27 offset:49152
    ds_read_b64_tr_b16 a[186:187], v27 offset:50176
    v_mfma_f32_16x16x32_bf16 v[204:207], a[28:31], a[172:175], v[204:207]
    ds_read_b64_tr_b16 a[188:189], v27 offset:57344
    ds_read_b64_tr_b16 a[190:191], v27 offset:58368
    v_mfma_f32_16x16x32_bf16 v[208:211], a[32:35], a[168:171], v[208:211]
    buffer_load_dwordx4 a[96:99], v5, s[20:23], 0 offen offset:2048 sc1
    v_sub_f32 v17, v17, v3
    v_mfma_f32_16x16x32_bf16 v[208:211], a[36:39], a[172:175], v[208:211]
    v_sub_f32 v18, v18, v3
    v_sub_f32 v19, v19, v3
    v_mfma_f32_16x16x32_bf16 v[212:215], a[40:43], a[168:171], v[212:215]
    buffer_load_dwordx4 a[100:103], v5, s[20:23], 0 offen offset:2064 sc1
    v_sub_f32 v20, v20, v3
    v_mfma_f32_16x16x32_bf16 v[212:215], a[44:47], a[172:175], v[212:215]
    v_sub_f32 v21, v21, v3
    v_sub_f32 v22, v22, v3
    v_mfma_f32_16x16x32_bf16 v[216:219], a[48:51], a[168:171], v[216:219]
    v_sub_f32 v23, v23, v3
    v_mul_f32 v3, v16, v16
    v_mfma_f32_16x16x32_bf16 v[216:219], a[52:55], a[172:175], v[216:219]
    v_fmac_f32 v3, v17, v17
    v_fmac_f32 v3, v18, v18
    v_mfma_f32_16x16x32_bf16 v[220:223], a[56:59], a[168:171], v[220:223]
    v_fmac_f32 v3, v19, v19
    v_fmac_f32 v3, v20, v20
    v_mfma_f32_16x16x32_bf16 v[220:223], a[60:63], a[172:175], v[220:223]
    v_fmac_f32 v3, v21, v21
    v_fmac_f32 v3, v22, v22
    v_mfma_f32_16x16x32_bf16 v[224:227], a[0:3], a[176:179], v[224:227]
    v_fmac_f32 v3, v23, v23
    s_nop 1
    v_add_f32_dpp v3, v3, v3 quad_perm:[1,0,3,2] row_mask:0xf bank_mask:0xf
    s_waitcnt lgkmcnt(0)
    v_mfma_f32_16x16x32_bf16 v[224:227], a[4:7], a[180:183], v[224:227]
    v_add_f32_dpp v3, v3, v3 quad_perm:[2,3,0,1] row_mask:0xf bank_mask:0xf
    s_nop 1
    v_add_f32_dpp v3, v3, v3 row_half_mirror row_mask:0xf bank_mask:0xf
    v_mfma_f32_16x16x32_bf16 v[228:231], a[8:11], a[176:179], v[228:231]
    s_nop 0
    v_add_f32_dpp v3, v3, v3 row_mirror row_mask:0xf bank_mask:0xf
    v_mov_b32 v28, v3
    v_mfma_f32_16x16x32_bf16 v[228:231], a[12:15], a[180:183], v[228:231]
    s_nop 0
    v_permlane16_swap_b32 v3, v28
    v_add_f32 v3, v3, v28
    s_waitcnt vmcnt(11) lgkmcnt(0)
    s_barrier
    v_mfma_f32_16x16x32_bf16 v[232:235], a[16:19], a[176:179], v[232:235]
    s_add_u32 m0, s90, 0x8000
    s_add_u32 s3, s88, 0x180
    buffer_load_dwordx4 v6, s[56:59], s3 offen offset:0 lds
    v_mfma_f32_16x16x32_bf16 v[232:235], a[20:23], a[180:183], v[232:235]
    v_mov_b32 v28, v3
    s_nop 1
    v_permlane32_swap_b32 v3, v28
    v_add_f32 v3, v3, v28
    v_mfma_f32_16x16x32_bf16 v[236:239], a[24:27], a[176:179], v[236:239]
    v_mov_b32 v28, 0x3727c5ac
    ds_read_b64_tr_b16 a[160:161], v24 offset:0
    ds_read_b64_tr_b16 a[162:163], v24 offset:1024
    v_mfma_f32_16x16x32_bf16 v[236:239], a[28:31], a[180:183], v[236:239]
    v_fmac_f32 v28, 0x3b000000, v3
    ds_read_b64_tr_b16 a[164:165], v24 offset:8192
    v_rsq_f32 v28, v28
    v_mfma_f32_16x16x32_bf16 v[240:243], a[32:35], a[176:179], v[240:243]
    v_mul_f32 v16, v28, v16
    ds_read_b64_tr_b16 a[166:167], v24 offset:9216
    buffer_load_dwordx4 v7, s[56:59], s3 offen offset:1024 lds
    v_mfma_f32_16x16x32_bf16 v[240:243], a[36:39], a[180:183], v[240:243]
    v_mul_f32 v17, v28, v17
    v_mul_f32 v18, v28, v18
    ds_read_b64_tr_b16 a[168:169], v25 offset:0
    v_mfma_f32_16x16x32_bf16 v[244:247], a[40:43], a[176:179], v[244:247]
    v_mul_f32 v19, v28, v19
    ds_read_b64_tr_b16 a[170:171], v25 offset:1024
    ds_read_b64_tr_b16 a[172:173], v25 offset:8192
    v_mfma_f32_16x16x32_bf16 v[244:247], a[44:47], a[180:183], v[244:247]
    v_mul_f32 v20, v28, v20
    ds_read_b64_tr_b16 a[174:175], v25 offset:9216
    v_mfma_f32_16x16x32_bf16 v[248:251], a[48:51], a[176:179], v[248:251]
    v_mul_f32 v21, v28, v21
    v_mul_f32 v22, v28, v22
    v_mfma_f32_16x16x32_bf16 v[248:251], a[52:55], a[180:183], v[248:251]
    buffer_load_dwordx4 v8, s[56:59], s3 offen offset:2048 lds
    v_mfma_f32_16x16x32_bf16 v[252:255], a[56:59], a[176:179], v[252:255]
    v_mul_f32 v23, v28, v23
    v_accvgpr_write_b32 a80, v16
    v_mfma_f32_16x16x32_bf16 v[252:255], a[60:63], a[180:183], v[252:255]
    v_accvgpr_write_b32 a81, v17
    v_accvgpr_write_b32 a82, v18
    v_mfma_f32_16x16x32_bf16 a[128:131], a[0:3], a[184:187], a[128:131]
    v_accvgpr_write_b32 a83, v19
    ds_read_b64_tr_b16 a[176:177], v26 offset:0
    ds_read_b64_tr_b16 a[178:179], v26 offset:1024
    v_mfma_f32_16x16x32_bf16 a[128:131], a[4:7], a[188:191], a[128:131]
    v_accvgpr_write_b32 a84, v20
    v_accvgpr_write_b32 a85, v21
    buffer_load_dwordx4 v9, s[56:59], s3 offen offset:3072 lds
    v_mfma_f32_16x16x32_bf16 a[132:135], a[8:11], a[184:187], a[132:135]
    ds_read_b128 a[0:3], v14 offset:0
    v_accvgpr_write_b32 a86, v22
    ds_read_b64_tr_b16 a[180:181], v26 offset:8192
    v_mfma_f32_16x16x32_bf16 a[132:135], a[12:15], a[188:191], a[132:135]
    ds_read_b128 a[4:7], v15 offset:0
    v_accvgpr_write_b32 a87, v23
    ds_read_b64_tr_b16 a[182:183], v26 offset:9216
    v_mfma_f32_16x16x32_bf16 a[136:139], a[16:19], a[184:187], a[136:139]
    ds_read_b128 a[8:11], v14 offset:2048
    ds_read_b128 a[12:15], v15 offset:2048
    v_mfma_f32_16x16x32_bf16 a[136:139], a[20:23], a[188:191], a[136:139]
    ds_read_b128 a[16:19], v14 offset:4096
    ds_read_b128 a[20:23], v15 offset:4096
    v_mfma_f32_16x16x32_bf16 a[140:143], a[24:27], a[184:187], a[140:143]
    s_add_u32 m0, s90, 0x9000
    s_add_u32 s3, s88, 0x8180
    buffer_load_dwordx4 v6, s[56:59], s3 offen offset:0 lds
    v_mfma_f32_16x16x32_bf16 a[140:143], a[28:31], a[188:191], a[140:143]
    s_waitcnt vmcnt(8)
    v_accvgpr_read_b32 v16, a89
    v_accvgpr_read_b32 v17, a91
    s_waitcnt vmcnt(7)
    v_accvgpr_read_b32 v18, a93
    v_mfma_f32_16x16x32_bf16 a[144:147], a[32:35], a[184:187], a[144:147]
    ds_read_b128 a[24:27], v14 offset:6144
    v_accvgpr_read_b32 v19, a95
    s_waitcnt vmcnt(6)
    v_accvgpr_read_b32 v20, a97
    v_mfma_f32_16x16x32_bf16 a[144:147], a[36:39], a[188:191], a[144:147]
    ds_read_b128 a[28:31], v15 offset:6144
    v_accvgpr_read_b32 v21, a99
    s_waitcnt vmcnt(5)
    v_accvgpr_read_b32 v22, a101
    v_mfma_f32_16x16x32_bf16 a[148:151], a[40:43], a[184:187], a[148:151]
    ds_read_b128 a[32:35], v14 offset:8192
    v_accvgpr_read_b32 v23, a103
    buffer_load_dwordx4 v7, s[56:59], s3 offen offset:1024 lds
    v_mfma_f32_16x16x32_bf16 a[148:151], a[44:47], a[188:191], a[148:151]
    ds_read_b128 a[36:39], v15 offset:8192
    v_cmp_eq_u64_e64 s[4:5], s[80:81], v[16:17]
    v_cmp_eq_u64 vcc, s[80:81], v[18:19]
    v_mfma_f32_16x16x32_bf16 a[152:155], a[48:51], a[184:187], a[152:155]
    ds_read_b128 a[40:43], v14 offset:10240
    s_and_b64 s[4:5], s[4:5], vcc
    v_cmp_eq_u64 vcc, s[80:81], v[20:21]
    v_mfma_f32_16x16x32_bf16 a[152:155], a[52:55], a[188:191], a[152:155]
    ds_read_b128 a[44:47], v15 offset:10240
    s_and_b64 s[4:5], s[4:5], vcc
    v_cmp_eq_u64 vcc, s[80:81], v[22:23]
    v_mfma_f32_16x16x32_bf16 a[156:159], a[56:59], a[184:187], a[156:159]
    ds_read_b128 a[48:51], v14 offset:12288
    s_and_b64 s[4:5], s[4:5], vcc
    ds_read_b128 a[52:55], v15 offset:12288
    v_mfma_f32_16x16x32_bf16 a[156:159], a[60:63], a[188:191], a[156:159]
    ds_read_b128 a[56:59], v14 offset:14336
    ds_read_b128 a[60:63], v15 offset:14336
    buffer_load_dwordx4 v8, s[56:59], s3 offen offset:2048 lds
    s_cmp_eq_u64 s[4:5], -1
    s_cbranch_scc0 L_mod_retry
L_mod_back:
    s_waitcnt lgkmcnt(7)
    v_mfma_f32_16x16x32_bf16 v[32:35], a[160:163], a[0:3], v[32:35]
    v_accvgpr_read_b32 v28, a96
    v_accvgpr_read_b32 v29, a98
    v_mfma_f32_16x16x32_bf16 v[32:35], a[164:167], a[4:7], v[32:35]
    v_accvgpr_read_b32 v30, a88
    v_accvgpr_read_b32 v31, a90
    v_mfma_f32_16x16x32_bf16 v[36:39], a[160:163], a[8:11], v[36:39]
    v_lshlrev_b32 v16, 16, v28
    v_and_b32 v17, 0xffff0000, v28
    v_mfma_f32_16x16x32_bf16 v[36:39], a[164:167], a[12:15], v[36:39]
    buffer_load_dwordx4 v9, s[56:59], s3 offen offset:3072 lds
    v_mfma_f32_16x16x32_bf16 v[40:43], a[160:163], a[16:19], v[40:43]
    v_lshlrev_b32 v18, 16, v29
    v_and_b32 v19, 0xffff0000, v29
    v_mfma_f32_16x16x32_bf16 v[40:43], a[164:167], a[20:23], v[40:43]
    v_lshlrev_b32 v20, 16, v30
    v_and_b32 v21, 0xffff0000, v30
    v_mfma_f32_16x16x32_bf16 v[44:47], a[160:163], a[24:27], v[44:47]
    v_lshlrev_b32 v22, 16, v31
    v_and_b32 v23, 0xffff0000, v31
    v_mfma_f32_16x16x32_bf16 v[44:47], a[164:167], a[28:31], v[44:47]
    v_add_f32 v16, 1.0, v16
    v_add_f32 v17, 1.0, v17
    v_mfma_f32_16x16x32_bf16 v[48:51], a[160:163], a[32:35], v[48:51]
    s_add_u32 m0, s90, 0x18000
    s_add_u32 s3, s89, 0x180000
    buffer_load_dwordx4 v10, s[60:63], s3 offen offset:0 lds
    s_waitcnt lgkmcnt(0)
    v_mfma_f32_16x16x32_bf16 v[48:51], a[164:167], a[36:39], v[48:51]
    v_add_f32 v18, 1.0, v18
    v_add_f32 v19, 1.0, v19
    v_mfma_f32_16x16x32_bf16 v[52:55], a[160:163], a[40:43], v[52:55]
    v_cvt_pk_bf16_f32 v28, v16, v17
    v_cvt_pk_bf16_f32 v29, v18, v19
    v_mfma_f32_16x16x32_bf16 v[52:55], a[164:167], a[44:47], v[52:55]
    v_mul_f32 v20, 0x3e0293ee, v20
    v_mul_f32 v21, 0x3e0293ee, v21
    v_mfma_f32_16x16x32_bf16 v[56:59], a[160:163], a[48:51], v[56:59]
    buffer_load_dwordx4 v11, s[60:63], s3 offen offset:1024 lds
    v_mfma_f32_16x16x32_bf16 v[56:59], a[164:167], a[52:55], v[56:59]
    v_mul_f32 v22, 0x3e0293ee, v22
    v_mul_f32 v23, 0x3e0293ee, v23
    v_mfma_f32_16x16x32_bf16 v[60:63], a[160:163], a[56:59], v[60:63]
    v_lshlrev_b32 v16, 16, v28
    v_and_b32 v17, 0xffff0000, v28
    v_mfma_f32_16x16x32_bf16 v[60:63], a[164:167], a[60:63], v[60:63]
    v_lshlrev_b32 v18, 16, v29
    v_and_b32 v19, 0xffff0000, v29
    v_mfma_f32_16x16x32_bf16 v[64:67], a[168:171], a[0:3], v[64:67]
    v_mul_f32 v16, 0x3e0293ee, v16
    v_mul_f32 v17, 0x3e0293ee, v17
    v_mfma_f32_16x16x32_bf16 v[64:67], a[172:175], a[4:7], v[64:67]
    buffer_load_dwordx4 v12, s[60:63], s3 offen offset:2048 lds
    v_mfma_f32_16x16x32_bf16 v[68:71], a[168:171], a[8:11], v[68:71]
    v_mul_f32 v18, 0x3e0293ee, v18
    v_mul_f32 v19, 0x3e0293ee, v19
    v_mfma_f32_16x16x32_bf16 v[68:71], a[172:175], a[12:15], v[68:71]
    v_accvgpr_read_b32 v28, a72
    v_accvgpr_read_b32 v29, a73
    v_mfma_f32_16x16x32_bf16 v[72:75], a[168:171], a[16:19], v[72:75]
    v_accvgpr_read_b32 v30, a74
    v_accvgpr_read_b32 v31, a75
    v_mfma_f32_16x16x32_bf16 v[72:75], a[172:175], a[20:23], v[72:75]
    buffer_load_dwordx4 v13, s[60:63], s3 offen offset:3072 lds
    v_mfma_f32_16x16x32_bf16 v[76:79], a[168:171], a[24:27], v[76:79]
    v_fma_f32 v28, v28, v16, v20
    v_fma_f32 v29, v29, v17, v21
    v_mfma_f32_16x16x32_bf16 v[76:79], a[172:175], a[28:31], v[76:79]
    v_fma_f32 v30, v30, v18, v22
    v_fma_f32 v31, v31, v19, v23
    v_mfma_f32_16x16x32_bf16 v[80:83], a[168:171], a[32:35], v[80:83]
    v_cvt_pk_bf16_f32 v28, v28, v29
    v_cvt_pk_bf16_f32 v29, v30, v31
    v_mfma_f32_16x16x32_bf16 v[80:83], a[172:175], a[36:39], v[80:83]
    v_accvgpr_write_b32 a64, v28
    v_accvgpr_write_b32 a65, v29
    v_mfma_f32_16x16x32_bf16 v[84:87], a[168:171], a[40:43], v[84:87]
    s_add_u32 m0, s90, 0x19000
    s_add_u32 s3, s89, 0x1a0000
    buffer_load_dwordx4 v10, s[60:63], s3 offen offset:0 lds
    v_mfma_f32_16x16x32_bf16 v[84:87], a[172:175], a[44:47], v[84:87]
    v_accvgpr_read_b32 v28, a80
    v_accvgpr_read_b32 v29, a81
    v_mfma_f32_16x16x32_bf16 v[88:91], a[168:171], a[48:51], v[88:91]
    v_accvgpr_read_b32 v30, a82
    v_accvgpr_read_b32 v31, a83
    v_mfma_f32_16x16x32_bf16 v[88:91], a[172:175], a[52:55], v[88:91]
    ds_read_b64_tr_b16 a[184:185], v27 offset:0
    ds_read_b64_tr_b16 a[186:187], v27 offset:1024
    v_mfma_f32_16x16x32_bf16 v[92:95], a[168:171], a[56:59], v[92:95]
    buffer_load_dwordx4 v11, s[60:63], s3 offen offset:1024 lds
    v_mfma_f32_16x16x32_bf16 v[92:95], a[172:175], a[60:63], v[92:95]
    ds_read_b64_tr_b16 a[188:189], v27 offset:8192
    ds_read_b64_tr_b16 a[190:191], v27 offset:9216
    v_mfma_f32_16x16x32_bf16 v[96:99], a[176:179], a[0:3], v[96:99]
    v_fma_f32 v28, v28, v16, v20
    v_fma_f32 v29, v29, v17, v21
    v_mfma_f32_16x16x32_bf16 v[96:99], a[180:183], a[4:7], v[96:99]
    v_fma_f32 v30, v30, v18, v22
    v_fma_f32 v31, v31, v19, v23
    v_mfma_f32_16x16x32_bf16 v[100:103], a[176:179], a[8:11], v[100:103]
    v_cvt_pk_bf16_f32 v28, v28, v29
    v_cvt_pk_bf16_f32 v29, v30, v31
    v_mfma_f32_16x16x32_bf16 v[100:103], a[180:183], a[12:15], v[100:103]
    buffer_load_dwordx4 v12, s[60:63], s3 offen offset:2048 lds
    v_mfma_f32_16x16x32_bf16 v[104:107], a[176:179], a[16:19], v[104:107]
    v_accvgpr_write_b32 a68, v28
    v_accvgpr_write_b32 a69, v29
    v_mfma_f32_16x16x32_bf16 v[104:107], a[180:183], a[20:23], v[104:107]
    v_accvgpr_read_b32 v28, a100
    v_accvgpr_read_b32 v29, a102
    v_mfma_f32_16x16x32_bf16 v[108:111], a[176:179], a[24:27], v[108:111]
    v_accvgpr_read_b32 v30, a92
    v_accvgpr_read_b32 v31, a94
    v_mfma_f32_16x16x32_bf16 v[108:111], a[180:183], a[28:31], v[108:111]
    buffer_load_dwordx4 v13, s[60:63], s3 offen offset:3072 lds
    v_mfma_f32_16x16x32_bf16 v[112:115], a[176:179], a[32:35], v[112:115]
    v_lshlrev_b32 v16, 16, v28
    v_and_b32 v17, 0xffff0000, v28
    v_mfma_f32_16x16x32_bf16 v[112:115], a[180:183], a[36:39], v[112:115]
    v_lshlrev_b32 v18, 16, v29
    v_and_b32 v19, 0xffff0000, v29
    v_mfma_f32_16x16x32_bf16 v[116:119], a[176:179], a[40:43], v[116:119]
    v_lshlrev_b32 v20, 16, v30
    v_and_b32 v21, 0xffff0000, v30
    v_mfma_f32_16x16x32_bf16 v[116:119], a[180:183], a[44:47], v[116:119]
    v_lshlrev_b32 v22, 16, v31
    v_and_b32 v23, 0xffff0000, v31
    v_mfma_f32_16x16x32_bf16 v[120:123], a[176:179], a[48:51], v[120:123]
    buffer_load_dword a207, v6, s[56:59], s83 offen offset:640
    v_mfma_f32_16x16x32_bf16 v[120:123], a[180:183], a[52:55], v[120:123]
    v_add_f32 v16, 1.0, v16
    v_add_f32 v17, 1.0, v17
    v_mfma_f32_16x16x32_bf16 v[124:127], a[176:179], a[56:59], v[124:127]
    ds_read_b64_tr_b16 a[160:161], v24 offset:16384
    ds_read_b64_tr_b16 a[162:163], v24 offset:17408
    v_mfma_f32_16x16x32_bf16 v[124:127], a[180:183], a[60:63], v[124:127]
    ds_read_b64_tr_b16 a[164:165], v24 offset:24576
    ds_read_b64_tr_b16 a[166:167], v24 offset:25600
    s_waitcnt lgkmcnt(4)
    v_mfma_f32_16x16x32_bf16 v[128:131], a[184:187], a[0:3], v[128:131]
    v_add_f32 v18, 1.0, v18
    v_add_f32 v19, 1.0, v19
    v_mfma_f32_16x16x32_bf16 v[128:131], a[188:191], a[4:7], v[128:131]
    buffer_load_dword a208, v7, s[56:59], s83 offen offset:1664
    v_mfma_f32_16x16x32_bf16 v[132:135], a[184:187], a[8:11], v[132:135]
    v_cvt_pk_bf16_f32 v28, v16, v17
    v_cvt_pk_bf16_f32 v29, v18, v19
    v_mfma_f32_16x16x32_bf16 v[132:135], a[188:191], a[12:15], v[132:135]
    v_mul_f32 v20, 0x3e0293ee, v20
    v_mul_f32 v21, 0x3e0293ee, v21
    v_mfma_f32_16x16x32_bf16 v[136:139], a[184:187], a[16:19], v[136:139]
    v_mul_f32 v22, 0x3e0293ee, v22
    v_mul_f32 v23, 0x3e0293ee, v23
    v_mfma_f32_16x16x32_bf16 v[136:139], a[188:191], a[20:23], v[136:139]
    v_lshlrev_b32 v16, 16, v28
    v_and_b32 v17, 0xffff0000, v28
    v_mfma_f32_16x16x32_bf16 v[140:143], a[184:187], a[24:27], v[140:143]
    s_add_u32 s3, s50, 0x280000
    buffer_load_dword a209, v10, s[60:63], s3 offen
    v_mfma_f32_16x16x32_bf16 v[140:143], a[188:191], a[28:31], v[140:143]
    v_lshlrev_b32 v18, 16, v29
    v_and_b32 v19, 0xffff0000, v29
    v_mfma_f32_16x16x32_bf16 v[144:147], a[184:187], a[32:35], v[144:147]
    v_mul_f32 v16, 0x3e0293ee, v16
    v_mul_f32 v17, 0x3e0293ee, v17
    v_mfma_f32_16x16x32_bf16 v[144:147], a[188:191], a[36:39], v[144:147]
    v_mul_f32 v18, 0x3e0293ee, v18
    v_mul_f32 v19, 0x3e0293ee, v19
    v_mfma_f32_16x16x32_bf16 v[148:151], a[184:187], a[40:43], v[148:151]
    v_accvgpr_read_b32 v28, a76
    v_accvgpr_read_b32 v29, a77
    v_mfma_f32_16x16x32_bf16 v[148:151], a[188:191], a[44:47], v[148:151]
    s_add_u32 s3, s51, 0x100000
    s_and_b32 s3, s3, 0x3fffff
    buffer_load_dword a125, v10, s[12:15], s3 offen
    v_mfma_f32_16x16x32_bf16 v[152:155], a[184:187], a[48:51], v[152:155]
    v_accvgpr_read_b32 v30, a78
    v_accvgpr_read_b32 v31, a79
    v_mfma_f32_16x16x32_bf16 v[152:155], a[188:191], a[52:55], v[152:155]
    v_fma_f32 v28, v28, v16, v20
    v_fma_f32 v29, v29, v17, v21
    v_mfma_f32_16x16x32_bf16 v[156:159], a[184:187], a[56:59], v[156:159]
    ds_read_b64_tr_b16 a[168:169], v25 offset:16384
    ds_read_b64_tr_b16 a[170:171], v25 offset:17408
    v_mfma_f32_16x16x32_bf16 v[156:159], a[188:191], a[60:63], v[156:159]
    ds_read_b64_tr_b16 a[172:173], v25 offset:24576
    ds_read_b64_tr_b16 a[174:175], v25 offset:25600
    s_waitcnt lgkmcnt(4)
    v_mfma_f32_16x16x32_bf16 v[160:163], a[0:3], a[160:163], v[160:163]
    v_fma_f32 v30, v30, v18, v22
    v_fma_f32 v31, v31, v19, v23
    v_mfma_f32_16x16x32_bf16 v[160:163], a[4:7], a[164:167], v[160:163]
    v_cvt_pk_bf16_f32 v28, v28, v29
    v_cvt_pk_bf16_f32 v29, v30, v31
    v_mfma_f32_16x16x32_bf16 v[164:167], a[8:11], a[160:163], v[164:167]
    v_accvgpr_write_b32 a66, v28
    v_accvgpr_write_b32 a67, v29
    v_mfma_f32_16x16x32_bf16 v[164:167], a[12:15], a[164:167], v[164:167]
    v_accvgpr_read_b32 v28, a84
    v_accvgpr_read_b32 v29, a85
    v_mfma_f32_16x16x32_bf16 v[168:171], a[16:19], a[160:163], v[168:171]
    v_accvgpr_read_b32 v30, a86
    v_accvgpr_read_b32 v31, a87
    v_mfma_f32_16x16x32_bf16 v[168:171], a[20:23], a[164:167], v[168:171]
    v_fma_f32 v28, v28, v16, v20
    v_fma_f32 v29, v29, v17, v21
    v_mfma_f32_16x16x32_bf16 v[172:175], a[24:27], a[160:163], v[172:175]
    v_fma_f32 v30, v30, v18, v22
    v_fma_f32 v31, v31, v19, v23
    v_mfma_f32_16x16x32_bf16 v[172:175], a[28:31], a[164:167], v[172:175]
    v_cvt_pk_bf16_f32 v28, v28, v29
    v_cvt_pk_bf16_f32 v29, v30, v31
    v_mfma_f32_16x16x32_bf16 v[176:179], a[32:35], a[160:163], v[176:179]
    v_accvgpr_write_b32 a70, v28
    v_accvgpr_write_b32 a71, v29
    v_mfma_f32_16x16x32_bf16 v[176:179], a[36:39], a[164:167], v[176:179]
    s_lshl_b32 s4, s32, 5
    v_and_b32 v5, 0x70, v2
    v_mfma_f32_16x16x32_bf16 v[180:183], a[40:43], a[160:163], v[180:183]
    v_xor_b32 v5, s4, v5
    v_lshl_add_u32 v5, v2, 3, v5
    v_mfma_f32_16x16x32_bf16 v[180:183], a[44:47], a[164:167], v[180:183]
    v_add_u32 v5, 0x26000, v5
    v_xor_b32 v16, 16, v5
    v_mfma_f32_16x16x32_bf16 v[184:187], a[48:51], a[160:163], v[184:187]
    ds_write_b128 v5, a[64:67]
    ds_write_b128 v16, a[68:71]
    v_mfma_f32_16x16x32_bf16 v[184:187], a[52:55], a[164:167], v[184:187]
    ds_read_b64_tr_b16 a[176:177], v26 offset:16384
    ds_read_b64_tr_b16 a[178:179], v26 offset:17408
    v_mfma_f32_16x16x32_bf16 v[188:191], a[56:59], a[160:163], v[188:191]
    ds_read_b64_tr_b16 a[180:181], v26 offset:24576
    ds_read_b64_tr_b16 a[182:183], v26 offset:25600
    v_mfma_f32_16x16x32_bf16 v[188:191], a[60:63], a[164:167], v[188:191]
    ds_read_b64_tr_b16 a[184:185], v27 offset:16384
    ds_read_b64_tr_b16 a[186:187], v27 offset:17408
    s_waitcnt lgkmcnt(8)
    v_mfma_f32_16x16x32_bf16 v[192:195], a[0:3], a[168:171], v[192:195]
    ds_read_b64_tr_b16 a[188:189], v27 offset:24576
    ds_read_b64_tr_b16 a[190:191], v27 offset:25600
    v_mfma_f32_16x16x32_bf16 v[192:195], a[4:7], a[172:175], v[192:195]
    v_mfma_f32_16x16x32_bf16 v[196:199], a[8:11], a[168:171], v[196:199]
    v_mfma_f32_16x16x32_bf16 v[196:199], a[12:15], a[172:175], v[196:199]
    s_waitcnt lgkmcnt(0)
    s_barrier
    v_mfma_f32_16x16x32_bf16 v[200:203], a[16:19], a[168:171], v[200:203]
    s_lshl_b32 s4, s32, 11
    s_add_u32 s4, s4, 0x26000
    v_mfma_f32_16x16x32_bf16 v[200:203], a[20:23], a[172:175], v[200:203]
    v_lshrrev_b32 v5, 3, v2
    v_and_b32 v5, 0x70, v5
    v_mfma_f32_16x16x32_bf16 v[204:207], a[24:27], a[168:171], v[204:207]
    v_xor_b32 v5, v5, v2
    v_add_u32 v5, s4, v5
    v_mfma_f32_16x16x32_bf16 v[204:207], a[28:31], a[172:175], v[204:207]
    ds_read_b128 v[16:19], v5 offset:0
    v_mfma_f32_16x16x32_bf16 v[208:211], a[32:35], a[168:171], v[208:211]
    ds_read_b128 v[20:23], v5 offset:1024
    v_mfma_f32_16x16x32_bf16 v[208:211], a[36:39], a[172:175], v[208:211]
    v_mfma_f32_16x16x32_bf16 v[212:215], a[40:43], a[168:171], v[212:215]
    v_and_b32 v5, 0x380, v2
    v_mfma_f32_16x16x32_bf16 v[212:215], a[44:47], a[172:175], v[212:215]
    v_mfma_f32_16x16x32_bf16 v[216:219], a[48:51], a[168:171], v[216:219]
    v_add_u32 v5, v5, v2
    v_mfma_f32_16x16x32_bf16 v[216:219], a[52:55], a[172:175], v[216:219]
    v_mfma_f32_16x16x32_bf16 v[220:223], a[56:59], a[168:171], v[220:223]
    s_waitcnt lgkmcnt(1)
    buffer_store_dwordx4 v[16:19], v5, s[16:19], s75 offen offset:0 sc1
    v_mfma_f32_16x16x32_bf16 v[220:223], a[60:63], a[172:175], v[220:223]
    v_mfma_f32_16x16x32_bf16 v[224:227], a[0:3], a[176:179], v[224:227]
    s_waitcnt lgkmcnt(0)
    buffer_store_dwordx4 v[20:23], v5, s[16:19], s75 offen offset:2048 sc1
    v_mfma_f32_16x16x32_bf16 v[224:227], a[4:7], a[180:183], v[224:227]
    v_mfma_f32_16x16x32_bf16 v[228:231], a[8:11], a[176:179], v[228:231]
    v_mfma_f32_16x16x32_bf16 v[228:231], a[12:15], a[180:183], v[228:231]
    s_waitcnt vmcnt(6) lgkmcnt(0)
    s_barrier
    v_mfma_f32_16x16x32_bf16 v[232:235], a[16:19], a[176:179], v[232:235]
    s_mov_b32 m0, s90
    s_add_u32 s3, s88, 0x200
    buffer_load_dwordx4 v6, s[56:59], s3 offen offset:0 lds
    v_mfma_f32_16x16x32_bf16 v[232:235], a[20:23], a[180:183], v[232:235]
    ds_read_b64_tr_b16 a[160:161], v24 offset:32768
    ds_read_b64_tr_b16 a[162:163], v24 offset:33792
    v_mfma_f32_16x16x32_bf16 v[236:239], a[24:27], a[176:179], v[236:239]
    ds_read_b64_tr_b16 a[164:165], v24 offset:40960
    ds_read_b64_tr_b16 a[166:167], v24 offset:41984
    v_mfma_f32_16x16x32_bf16 v[236:239], a[28:31], a[180:183], v[236:239]
    v_mfma_f32_16x16x32_bf16 v[240:243], a[32:35], a[176:179], v[240:243]
    buffer_load_dwordx4 v7, s[56:59], s3 offen offset:1024 lds
    v_mfma_f32_16x16x32_bf16 v[240:243], a[36:39], a[180:183], v[240:243]
    ds_read_b64_tr_b16 a[168:169], v25 offset:32768
    ds_read_b64_tr_b16 a[170:171], v25 offset:33792
    v_mfma_f32_16x16x32_bf16 v[244:247], a[40:43], a[176:179], v[244:247]
    ds_read_b64_tr_b16 a[172:173], v25 offset:40960
    ds_read_b64_tr_b16 a[174:175], v25 offset:41984
    v_mfma_f32_16x16x32_bf16 v[244:247], a[44:47], a[180:183], v[244:247]
    v_mfma_f32_16x16x32_bf16 v[248:251], a[48:51], a[176:179], v[248:251]
    v_mfma_f32_16x16x32_bf16 v[248:251], a[52:55], a[180:183], v[248:251]
    buffer_load_dwordx4 v8, s[56:59], s3 offen offset:2048 lds
    v_mfma_f32_16x16x32_bf16 v[252:255], a[56:59], a[176:179], v[252:255]
    v_mfma_f32_16x16x32_bf16 v[252:255], a[60:63], a[180:183], v[252:255]
    v_mfma_f32_16x16x32_bf16 a[128:131], a[0:3], a[184:187], a[128:131]
    ds_read_b64_tr_b16 a[176:177], v26 offset:32768
    ds_read_b64_tr_b16 a[178:179], v26 offset:33792
    v_mfma_f32_16x16x32_bf16 a[128:131], a[4:7], a[188:191], a[128:131]
    buffer_load_dwordx4 v9, s[56:59], s3 offen offset:3072 lds
    v_mfma_f32_16x16x32_bf16 a[132:135], a[8:11], a[184:187], a[132:135]
    ds_read_b128 a[0:3], v14 offset:32768
    ds_read_b64_tr_b16 a[180:181], v26 offset:40960
    v_mfma_f32_16x16x32_bf16 a[132:135], a[12:15], a[188:191], a[132:135]
    ds_read_b128 a[4:7], v15 offset:32768
    ds_read_b64_tr_b16 a[182:183], v26 offset:41984
    v_mfma_f32_16x16x32_bf16 a[136:139], a[16:19], a[184:187], a[136:139]
    ds_read_b128 a[8:11], v14 offset:34816
    ds_read_b128 a[12:15], v15 offset:34816
    v_mfma_f32_16x16x32_bf16 a[136:139], a[20:23], a[188:191], a[136:139]
    ds_read_b128 a[16:19], v14 offset:36864
    ds_read_b128 a[20:23], v15 offset:36864
    v_mfma_f32_16x16x32_bf16 a[140:143], a[24:27], a[184:187], a[140:143]
    s_add_u32 m0, s90, 0x1000
    s_add_u32 s3, s88, 0x8200
    buffer_load_dwordx4 v6, s[56:59], s3 offen offset:0 lds
    v_mfma_f32_16x16x32_bf16 a[140:143], a[28:31], a[188:191], a[140:143]
    ds_read_b128 a[24:27], v14 offset:38912
    ds_read_b128 a[28:31], v15 offset:38912
    v_mfma_f32_16x16x32_bf16 a[144:147], a[32:35], a[184:187], a[144:147]
    ds_read_b128 a[32:35], v14 offset:40960
    v_mfma_f32_16x16x32_bf16 a[144:147], a[36:39], a[188:191], a[144:147]
    ds_read_b128 a[36:39], v15 offset:40960
    v_mfma_f32_16x16x32_bf16 a[148:151], a[40:43], a[184:187], a[148:151]
    buffer_load_dwordx4 v7, s[56:59], s3 offen offset:1024 lds
    v_mfma_f32_16x16x32_bf16 a[148:151], a[44:47], a[188:191], a[148:151]
    ds_read_b128 a[40:43], v14 offset:43008
    ds_read_b128 a[44:47], v15 offset:43008
    v_mfma_f32_16x16x32_bf16 a[152:155], a[48:51], a[184:187], a[152:155]
    ds_read_b128 a[48:51], v14 offset:45056
    v_mfma_f32_16x16x32_bf16 a[152:155], a[52:55], a[188:191], a[152:155]
    ds_read_b128 a[52:55], v15 offset:45056
    v_mfma_f32_16x16x32_bf16 a[156:159], a[56:59], a[184:187], a[156:159]
    ds_read_b128 a[56:59], v14 offset:47104
    v_mfma_f32_16x16x32_bf16 a[156:159], a[60:63], a[188:191], a[156:159]
    buffer_load_dwordx4 v8, s[56:59], s3 offen offset:2048 lds
    s_waitcnt lgkmcnt(7)
    v_mfma_f32_16x16x32_bf16 v[32:35], a[160:163], a[0:3], v[32:35]
    ds_read_b64_tr_b16 a[184:185], v27 offset:32768
    ds_read_b128 a[60:63], v15 offset:47104
    v_mfma_f32_16x16x32_bf16 v[32:35], a[164:167], a[4:7], v[32:35]
    ds_read_b64_tr_b16 a[186:187], v27 offset:33792
    ds_read_b64_tr_b16 a[188:189], v27 offset:40960
    v_mfma_f32_16x16x32_bf16 v[36:39], a[160:163], a[8:11], v[36:39]
    ds_read_b64_tr_b16 a[190:191], v27 offset:41984
    v_mfma_f32_16x16x32_bf16 v[36:39], a[164:167], a[12:15], v[36:39]
    buffer_load_dwordx4 v9, s[56:59], s3 offen offset:3072 lds
    v_mfma_f32_16x16x32_bf16 v[40:43], a[160:163], a[16:19], v[40:43]
    v_mfma_f32_16x16x32_bf16 v[40:43], a[164:167], a[20:23], v[40:43]
    v_mfma_f32_16x16x32_bf16 v[44:47], a[160:163], a[24:27], v[44:47]
    v_mfma_f32_16x16x32_bf16 v[44:47], a[164:167], a[28:31], v[44:47]
    s_waitcnt lgkmcnt(5)
    v_mfma_f32_16x16x32_bf16 v[48:51], a[160:163], a[32:35], v[48:51]
    s_add_u32 m0, s90, 0x10000
    s_add_u32 s3, s89, 0x200000
    buffer_load_dwordx4 v10, s[60:63], s3 offen offset:0 lds
    v_mfma_f32_16x16x32_bf16 v[48:51], a[164:167], a[36:39], v[48:51]
    v_mfma_f32_16x16x32_bf16 v[52:55], a[160:163], a[40:43], v[52:55]
    v_mfma_f32_16x16x32_bf16 v[52:55], a[164:167], a[44:47], v[52:55]
    v_mfma_f32_16x16x32_bf16 v[56:59], a[160:163], a[48:51], v[56:59]
    buffer_load_dwordx4 v11, s[60:63], s3 offen offset:1024 lds
    v_mfma_f32_16x16x32_bf16 v[56:59], a[164:167], a[52:55], v[56:59]
    v_mfma_f32_16x16x32_bf16 v[60:63], a[160:163], a[56:59], v[60:63]
    s_waitcnt lgkmcnt(0)
    v_mfma_f32_16x16x32_bf16 v[60:63], a[164:167], a[60:63], v[60:63]
    v_mfma_f32_16x16x32_bf16 v[64:67], a[168:171], a[0:3], v[64:67]
    ds_read_b64_tr_b16 a[160:161], v24 offset:49152
    ds_read_b64_tr_b16 a[162:163], v24 offset:50176
    v_mfma_f32_16x16x32_bf16 v[64:67], a[172:175], a[4:7], v[64:67]
    buffer_load_dwordx4 v12, s[60:63], s3 offen offset:2048 lds
    v_mfma_f32_16x16x32_bf16 v[68:71], a[168:171], a[8:11], v[68:71]
    ds_read_b64_tr_b16 a[164:165], v24 offset:57344
    ds_read_b64_tr_b16 a[166:167], v24 offset:58368
    v_mfma_f32_16x16x32_bf16 v[68:71], a[172:175], a[12:15], v[68:71]
    v_mfma_f32_16x16x32_bf16 v[72:75], a[168:171], a[16:19], v[72:75]
    v_mfma_f32_16x16x32_bf16 v[72:75], a[172:175], a[20:23], v[72:75]
    buffer_load_dwordx4 v13, s[60:63], s3 offen offset:3072 lds
    v_mfma_f32_16x16x32_bf16 v[76:79], a[168:171], a[24:27], v[76:79]
    v_mfma_f32_16x16x32_bf16 v[76:79], a[172:175], a[28:31], v[76:79]
    v_mfma_f32_16x16x32_bf16 v[80:83], a[168:171], a[32:35], v[80:83]
    v_mfma_f32_16x16x32_bf16 v[80:83], a[172:175], a[36:39], v[80:83]
    v_mfma_f32_16x16x32_bf16 v[84:87], a[168:171], a[40:43], v[84:87]
    s_add_u32 m0, s90, 0x11000
    s_add_u32 s3, s89, 0x220000
    buffer_load_dwordx4 v10, s[60:63], s3 offen offset:0 lds
    v_mfma_f32_16x16x32_bf16 v[84:87], a[172:175], a[44:47], v[84:87]
    s_waitcnt vmcnt(13)
    s_barrier
    v_mfma_f32_16x16x32_bf16 v[88:91], a[168:171], a[48:51], v[88:91]
    v_mov_b32 v4, s80
    v_mov_b32 v5, s81
    v_mfma_f32_16x16x32_bf16 v[88:91], a[172:175], a[52:55], v[88:91]
    buffer_store_dwordx2 v[4:5], v0, s[20:23], s77 offen sc1
    v_mfma_f32_16x16x32_bf16 v[92:95], a[168:171], a[56:59], v[92:95]
    buffer_load_dwordx4 v11, s[60:63], s3 offen offset:1024 lds
    v_mfma_f32_16x16x32_bf16 v[92:95], a[172:175], a[60:63], v[92:95]
    v_mfma_f32_16x16x32_bf16 v[96:99], a[176:179], a[0:3], v[96:99]
    ds_read_b64_tr_b16 a[168:169], v25 offset:49152
    ds_read_b64_tr_b16 a[170:171], v25 offset:50176
    v_mfma_f32_16x16x32_bf16 v[96:99], a[180:183], a[4:7], v[96:99]
    ds_read_b64_tr_b16 a[172:173], v25 offset:57344
    ds_read_b64_tr_b16 a[174:175], v25 offset:58368
    v_mfma_f32_16x16x32_bf16 v[100:103], a[176:179], a[8:11], v[100:103]
    v_mfma_f32_16x16x32_bf16 v[100:103], a[180:183], a[12:15], v[100:103]
    buffer_load_dwordx4 v12, s[60:63], s3 offen offset:2048 lds
    v_mfma_f32_16x16x32_bf16 v[104:107], a[176:179], a[16:19], v[104:107]
    v_mfma_f32_16x16x32_bf16 v[104:107], a[180:183], a[20:23], v[104:107]
    v_mfma_f32_16x16x32_bf16 v[108:111], a[176:179], a[24:27], v[108:111]
    v_mfma_f32_16x16x32_bf16 v[108:111], a[180:183], a[28:31], v[108:111]
    buffer_load_dwordx4 v13, s[60:63], s3 offen offset:3072 lds
    v_mfma_f32_16x16x32_bf16 v[112:115], a[176:179], a[32:35], v[112:115]
    v_mfma_f32_16x16x32_bf16 v[112:115], a[180:183], a[36:39], v[112:115]
    v_mfma_f32_16x16x32_bf16 v[116:119], a[176:179], a[40:43], v[116:119]
    v_mfma_f32_16x16x32_bf16 v[116:119], a[180:183], a[44:47], v[116:119]
    v_mfma_f32_16x16x32_bf16 v[120:123], a[176:179], a[48:51], v[120:123]
    buffer_load_dword a210, v6, s[56:59], s83 offen offset:768
    v_mfma_f32_16x16x32_bf16 v[120:123], a[180:183], a[52:55], v[120:123]
    v_mfma_f32_16x16x32_bf16 v[124:127], a[176:179], a[56:59], v[124:127]
    v_mfma_f32_16x16x32_bf16 v[124:127], a[180:183], a[60:63], v[124:127]
    v_mfma_f32_16x16x32_bf16 v[128:131], a[184:187], a[0:3], v[128:131]
    ds_read_b64_tr_b16 a[176:177], v26 offset:49152
    ds_read_b64_tr_b16 a[178:179], v26 offset:50176
    v_mfma_f32_16x16x32_bf16 v[128:131], a[188:191], a[4:7], v[128:131]
    buffer_load_dword a211, v7, s[56:59], s83 offen offset:1792
    v_mfma_f32_16x16x32_bf16 v[132:135], a[184:187], a[8:11], v[132:135]
    ds_read_b64_tr_b16 a[180:181], v26 offset:57344
    ds_read_b64_tr_b16 a[182:183], v26 offset:58368
    v_mfma_f32_16x16x32_bf16 v[132:135], a[188:191], a[12:15], v[132:135]
    v_mfma_f32_16x16x32_bf16 v[136:139], a[184:187], a[16:19], v[136:139]
    v_mfma_f32_16x16x32_bf16 v[136:139], a[188:191], a[20:23], v[136:139]
    v_mfma_f32_16x16x32_bf16 v[140:143], a[184:187], a[24:27], v[140:143]
    s_add_u32 s3, s50, 0x300000
    buffer_load_dword a212, v10, s[60:63], s3 offen
    v_mfma_f32_16x16x32_bf16 v[140:143], a[188:191], a[28:31], v[140:143]
    v_mfma_f32_16x16x32_bf16 v[144:147], a[184:187], a[32:35], v[144:147]
    v_mfma_f32_16x16x32_bf16 v[144:147], a[188:191], a[36:39], v[144:147]
    v_mfma_f32_16x16x32_bf16 v[148:151], a[184:187], a[40:43], v[148:151]
    v_mfma_f32_16x16x32_bf16 v[148:151], a[188:191], a[44:47], v[148:151]
    s_add_u32 s3, s51, 0x200000
    s_and_b32 s3, s3, 0x3fffff
    buffer_load_dword a126, v10, s[12:15], s3 offen
    v_mfma_f32_16x16x32_bf16 v[152:155], a[184:187], a[48:51], v[152:155]
    v_mfma_f32_16x16x32_bf16 v[152:155], a[188:191], a[52:55], v[152:155]
    v_mfma_f32_16x16x32_bf16 v[156:159], a[184:187], a[56:59], v[156:159]
    v_mfma_f32_16x16x32_bf16 v[156:159], a[188:191], a[60:63], v[156:159]
    s_waitcnt lgkmcnt(0)
    v_mfma_f32_16x16x32_bf16 v[160:163], a[0:3], a[160:163], v[160:163]
    ds_read_b64_tr_b16 a[184:185], v27 offset:49152
    ds_read_b64_tr_b16 a[186:187], v27 offset:50176
    v_mfma_f32_16x16x32_bf16 v[160:163], a[4:7], a[164:167], v[160:163]
    ds_read_b64_tr_b16 a[188:189], v27 offset:57344
    ds_read_b64_tr_b16 a[190:191], v27 offset:58368
    v_mfma_f32_16x16x32_bf16 v[164:167], a[8:11], a[160:163], v[164:167]
    v_mfma_f32_16x16x32_bf16 v[164:167], a[12:15], a[164:167], v[164:167]
    v_mfma_f32_16x16x32_bf16 v[168:171], a[16:19], a[160:163], v[168:171]
    v_mfma_f32_16x16x32_bf16 v[168:171], a[20:23], a[164:167], v[168:171]
    v_mfma_f32_16x16x32_bf16 v[172:175], a[24:27], a[160:163], v[172:175]
    v_mfma_f32_16x16x32_bf16 v[172:175], a[28:31], a[164:167], v[172:175]
    v_mfma_f32_16x16x32_bf16 v[176:179], a[32:35], a[160:163], v[176:179]
    v_mfma_f32_16x16x32_bf16 v[176:179], a[36:39], a[164:167], v[176:179]
    v_mfma_f32_16x16x32_bf16 v[180:183], a[40:43], a[160:163], v[180:183]
    v_mfma_f32_16x16x32_bf16 v[180:183], a[44:47], a[164:167], v[180:183]
    v_mfma_f32_16x16x32_bf16 v[184:187], a[48:51], a[160:163], v[184:187]
    v_mfma_f32_16x16x32_bf16 v[184:187], a[52:55], a[164:167], v[184:187]
    v_mfma_f32_16x16x32_bf16 v[188:191], a[56:59], a[160:163], v[188:191]
    v_mfma_f32_16x16x32_bf16 v[188:191], a[60:63], a[164:167], v[188:191]
    v_mfma_f32_16x16x32_bf16 v[192:195], a[0:3], a[168:171], v[192:195]
    v_mfma_f32_16x16x32_bf16 v[192:195], a[4:7], a[172:175], v[192:195]
    v_mfma_f32_16x16x32_bf16 v[196:199], a[8:11], a[168:171], v[196:199]
    v_mfma_f32_16x16x32_bf16 v[196:199], a[12:15], a[172:175], v[196:199]
    v_mfma_f32_16x16x32_bf16 v[200:203], a[16:19], a[168:171], v[200:203]
    v_mfma_f32_16x16x32_bf16 v[200:203], a[20:23], a[172:175], v[200:203]
    v_mfma_f32_16x16x32_bf16 v[204:207], a[24:27], a[168:171], v[204:207]
    v_mfma_f32_16x16x32_bf16 v[204:207], a[28:31], a[172:175], v[204:207]
    v_mfma_f32_16x16x32_bf16 v[208:211], a[32:35], a[168:171], v[208:211]
    v_mfma_f32_16x16x32_bf16 v[208:211], a[36:39], a[172:175], v[208:211]
    v_mfma_f32_16x16x32_bf16 v[212:215], a[40:43], a[168:171], v[212:215]
    v_mfma_f32_16x16x32_bf16 v[212:215], a[44:47], a[172:175], v[212:215]
    v_mfma_f32_16x16x32_bf16 v[216:219], a[48:51], a[168:171], v[216:219]
    v_mfma_f32_16x16x32_bf16 v[216:219], a[52:55], a[172:175], v[216:219]
    v_mfma_f32_16x16x32_bf16 v[220:223], a[56:59], a[168:171], v[220:223]
    v_mfma_f32_16x16x32_bf16 v[220:223], a[60:63], a[172:175], v[220:223]
    v_mfma_f32_16x16x32_bf16 v[224:227], a[0:3], a[176:179], v[224:227]
    v_mfma_f32_16x16x32_bf16 v[224:227], a[4:7], a[180:183], v[224:227]
    v_mfma_f32_16x16x32_bf16 v[228:231], a[8:11], a[176:179], v[228:231]
    v_mfma_f32_16x16x32_bf16 v[228:231], a[12:15], a[180:183], v[228:231]
    s_waitcnt vmcnt(4) lgkmcnt(0)
    s_barrier
    v_mfma_f32_16x16x32_bf16 v[232:235], a[16:19], a[176:179], v[232:235]
    s_add_u32 m0, s90, 0x8000
    s_add_u32 s3, s88, 0x280
    buffer_load_dwordx4 v6, s[56:59], s3 offen offset:0 lds
    v_mfma_f32_16x16x32_bf16 v[232:235], a[20:23], a[180:183], v[232:235]
    ds_read_b64_tr_b16 a[160:161], v24 offset:0
    ds_read_b64_tr_b16 a[162:163], v24 offset:1024
    v_mfma_f32_16x16x32_bf16 v[236:239], a[24:27], a[176:179], v[236:239]
    ds_read_b64_tr_b16 a[164:165], v24 offset:8192
    ds_read_b64_tr_b16 a[166:167], v24 offset:9216
    v_mfma_f32_16x16x32_bf16 v[236:239], a[28:31], a[180:183], v[236:239]
    v_mfma_f32_16x16x32_bf16 v[240:243], a[32:35], a[176:179], v[240:243]
    buffer_load_dwordx4 v7, s[56:59], s3 offen offset:1024 lds
    v_mfma_f32_16x16x32_bf16 v[240:243], a[36:39], a[180:183], v[240:243]
    ds_read_b64_tr_b16 a[168:169], v25 offset:0
    ds_read_b64_tr_b16 a[170:171], v25 offset:1024
    v_mfma_f32_16x16x32_bf16 v[244:247], a[40:43], a[176:179], v[244:247]
    ds_read_b64_tr_b16 a[172:173], v25 offset:8192
    ds_read_b64_tr_b16 a[174:175], v25 offset:9216
    v_mfma_f32_16x16x32_bf16 v[244:247], a[44:47], a[180:183], v[244:247]
    v_mfma_f32_16x16x32_bf16 v[248:251], a[48:51], a[176:179], v[248:251]
    v_mfma_f32_16x16x32_bf16 v[248:251], a[52:55], a[180:183], v[248:251]
    buffer_load_dwordx4 v8, s[56:59], s3 offen offset:2048 lds
    v_mfma_f32_16x16x32_bf16 v[252:255], a[56:59], a[176:179], v[252:255]
    v_mfma_f32_16x16x32_bf16 v[252:255], a[60:63], a[180:183], v[252:255]
    v_mfma_f32_16x16x32_bf16 a[128:131], a[0:3], a[184:187], a[128:131]
    ds_read_b64_tr_b16 a[176:177], v26 offset:0
    ds_read_b64_tr_b16 a[178:179], v26 offset:1024
    v_mfma_f32_16x16x32_bf16 a[128:131], a[4:7], a[188:191], a[128:131]
    buffer_load_dwordx4 v9, s[56:59], s3 offen offset:3072 lds
    v_mfma_f32_16x16x32_bf16 a[132:135], a[8:11], a[184:187], a[132:135]
    ds_read_b128 a[0:3], v14 offset:0
    ds_read_b64_tr_b16 a[180:181], v26 offset:8192
    v_mfma_f32_16x16x32_bf16 a[132:135], a[12:15], a[188:191], a[132:135]
    ds_read_b128 a[4:7], v15 offset:0
    ds_read_b64_tr_b16 a[182:183], v26 offset:9216
    v_mfma_f32_16x16x32_bf16 a[136:139], a[16:19], a[184:187], a[136:139]
    ds_read_b128 a[8:11], v14 offset:2048
    ds_read_b128 a[12:15], v15 offset:2048
    v_mfma_f32_16x16x32_bf16 a[136:139], a[20:23], a[188:191], a[136:139]
    ds_read_b128 a[16:19], v14 offset:4096
    ds_read_b128 a[20:23], v15 offset:4096
    v_mfma_f32_16x16x32_bf16 a[140:143], a[24:27], a[184:187], a[140:143]
    s_add_u32 m0, s90, 0x9000
    s_add_u32 s3, s88, 0x8280
    buffer_load_dwordx4 v6, s[56:59], s3 offen offset:0 lds
    v_mfma_f32_16x16x32_bf16 a[140:143], a[28:31], a[188:191], a[140:143]
    ds_read_b128 a[24:27], v14 offset:6144
    ds_read_b128 a[28:31], v15 offset:6144
    v_mfma_f32_16x16x32_bf16 a[144:147], a[32:35], a[184:187], a[144:147]
    ds_read_b128 a[32:35], v14 offset:8192
    v_mfma_f32_16x16x32_bf16 a[144:147], a[36:39], a[188:191], a[144:147]
    ds_read_b128 a[36:39], v15 offset:8192
    v_mfma_f32_16x16x32_bf16 a[148:151], a[40:43], a[184:187], a[148:151]
    buffer_load_dwordx4 v7, s[56:59], s3 offen offset:1024 lds
    v_mfma_f32_16x16x32_bf16 a[148:151], a[44:47], a[188:191], a[148:151]
    ds_read_b128 a[40:43], v14 offset:10240
    ds_read_b128 a[44:47], v15 offset:10240
    v_mfma_f32_16x16x32_bf16 a[152:155], a[48:51], a[184:187], a[152:155]
    ds_read_b128 a[48:51], v14 offset:12288
    v_mfma_f32_16x16x32_bf16 a[152:155], a[52:55], a[188:191], a[152:155]
    ds_read_b128 a[52:55], v15 offset:12288
    v_mfma_f32_16x16x32_bf16 a[156:159], a[56:59], a[184:187], a[156:159]
    ds_read_b128 a[56:59], v14 offset:14336
    v_mfma_f32_16x16x32_bf16 a[156:159], a[60:63], a[188:191], a[156:159]
    buffer_load_dwordx4 v8, s[56:59], s3 offen offset:2048 lds
    s_waitcnt lgkmcnt(7)
    v_mfma_f32_16x16x32_bf16 v[32:35], a[160:163], a[0:3], v[32:35]
    ds_read_b64_tr_b16 a[184:185], v27 offset:0
    ds_read_b128 a[60:63], v15 offset:14336
    v_mfma_f32_16x16x32_bf16 v[32:35], a[164:167], a[4:7], v[32:35]
    ds_read_b64_tr_b16 a[186:187], v27 offset:1024
    ds_read_b64_tr_b16 a[188:189], v27 offset:8192
    v_mfma_f32_16x16x32_bf16 v[36:39], a[160:163], a[8:11], v[36:39]
    ds_read_b64_tr_b16 a[190:191], v27 offset:9216
    v_mfma_f32_16x16x32_bf16 v[36:39], a[164:167], a[12:15], v[36:39]
    buffer_load_dwordx4 v9, s[56:59], s3 offen offset:3072 lds
    v_mfma_f32_16x16x32_bf16 v[40:43], a[160:163], a[16:19], v[40:43]
    v_mfma_f32_16x16x32_bf16 v[40:43], a[164:167], a[20:23], v[40:43]
    v_mfma_f32_16x16x32_bf16 v[44:47], a[160:163], a[24:27], v[44:47]
    v_mfma_f32_16x16x32_bf16 v[44:47], a[164:167], a[28:31], v[44:47]
    s_waitcnt lgkmcnt(5)
    v_mfma_f32_16x16x32_bf16 v[48:51], a[160:163], a[32:35], v[48:51]
    s_add_u32 m0, s90, 0x18000
    s_add_u32 s3, s89, 0x280000
    buffer_load_dwordx4 v10, s[60:63], s3 offen offset:0 lds
    v_mfma_f32_16x16x32_bf16 v[48:51], a[164:167], a[36:39], v[48:51]
    v_mfma_f32_16x16x32_bf16 v[52:55], a[160:163], a[40:43], v[52:55]
    v_mfma_f32_16x16x32_bf16 v[52:55], a[164:167], a[44:47], v[52:55]
    v_mfma_f32_16x16x32_bf16 v[56:59], a[160:163], a[48:51], v[56:59]
    buffer_load_dwordx4 v11, s[60:63], s3 offen offset:1024 lds
    v_mfma_f32_16x16x32_bf16 v[56:59], a[164:167], a[52:55], v[56:59]
    v_mfma_f32_16x16x32_bf16 v[60:63], a[160:163], a[56:59], v[60:63]
    s_waitcnt lgkmcnt(0)
    v_mfma_f32_16x16x32_bf16 v[60:63], a[164:167], a[60:63], v[60:63]
    v_mfma_f32_16x16x32_bf16 v[64:67], a[168:171], a[0:3], v[64:67]
    ds_read_b64_tr_b16 a[160:161], v24 offset:16384
    ds_read_b64_tr_b16 a[162:163], v24 offset:17408
    v_mfma_f32_16x16x32_bf16 v[64:67], a[172:175], a[4:7], v[64:67]
    buffer_load_dwordx4 v12, s[60:63], s3 offen offset:2048 lds
    v_mfma_f32_16x16x32_bf16 v[68:71], a[168:171], a[8:11], v[68:71]
    ds_read_b64_tr_b16 a[164:165], v24 offset:24576
    ds_read_b64_tr_b16 a[166:167], v24 offset:25600
    v_mfma_f32_16x16x32_bf16 v[68:71], a[172:175], a[12:15], v[68:71]
    v_mfma_f32_16x16x32_bf16 v[72:75], a[168:171], a[16:19], v[72:75]
    v_mfma_f32_16x16x32_bf16 v[72:75], a[172:175], a[20:23], v[72:75]
    buffer_load_dwordx4 v13, s[60:63], s3 offen offset:3072 lds
    v_mfma_f32_16x16x32_bf16 v[76:79], a[168:171], a[24:27], v[76:79]
    v_mfma_f32_16x16x32_bf16 v[76:79], a[172:175], a[28:31], v[76:79]
    v_mfma_f32_16x16x32_bf16 v[80:83], a[168:171], a[32:35], v[80:83]
    v_mfma_f32_16x16x32_bf16 v[80:83], a[172:175], a[36:39], v[80:83]
    v_mfma_f32_16x16x32_bf16 v[84:87], a[168:171], a[40:43], v[84:87]
    s_add_u32 m0, s90, 0x19000
    s_add_u32 s3, s89, 0x2a0000
    buffer_load_dwordx4 v10, s[60:63], s3 offen offset:0 lds
    v_mfma_f32_16x16x32_bf16 v[84:87], a[172:175], a[44:47], v[84:87]
    v_mfma_f32_16x16x32_bf16 v[88:91], a[168:171], a[48:51], v[88:91]
    v_mfma_f32_16x16x32_bf16 v[88:91], a[172:175], a[52:55], v[88:91]
    v_mfma_f32_16x16x32_bf16 v[92:95], a[168:171], a[56:59], v[92:95]
    buffer_load_dwordx4 v11, s[60:63], s3 offen offset:1024 lds
    v_mfma_f32_16x16x32_bf16 v[92:95], a[172:175], a[60:63], v[92:95]
    v_mfma_f32_16x16x32_bf16 v[96:99], a[176:179], a[0:3], v[96:99]
    ds_read_b64_tr_b16 a[168:169], v25 offset:16384
    ds_read_b64_tr_b16 a[170:171], v25 offset:17408
    v_mfma_f32_16x16x32_bf16 v[96:99], a[180:183], a[4:7], v[96:99]
    ds_read_b64_tr_b16 a[172:173], v25 offset:24576
    ds_read_b64_tr_b16 a[174:175], v25 offset:25600
    v_mfma_f32_16x16x32_bf16 v[100:103], a[176:179], a[8:11], v[100:103]
    v_mfma_f32_16x16x32_bf16 v[100:103], a[180:183], a[12:15], v[100:103]
    buffer_load_dwordx4 v12, s[60:63], s3 offen offset:2048 lds
    v_mfma_f32_16x16x32_bf16 v[104:107], a[176:179], a[16:19], v[104:107]
    v_mfma_f32_16x16x32_bf16 v[104:107], a[180:183], a[20:23], v[104:107]
    v_mfma_f32_16x16x32_bf16 v[108:111], a[176:179], a[24:27], v[108:111]
    v_mfma_f32_16x16x32_bf16 v[108:111], a[180:183], a[28:31], v[108:111]
    buffer_load_dwordx4 v13, s[60:63], s3 offen offset:3072 lds
    v_mfma_f32_16x16x32_bf16 v[112:115], a[176:179], a[32:35], v[112:115]
    v_mfma_f32_16x16x32_bf16 v[112:115], a[180:183], a[36:39], v[112:115]
    v_mfma_f32_16x16x32_bf16 v[116:119], a[176:179], a[40:43], v[116:119]
    v_mfma_f32_16x16x32_bf16 v[116:119], a[180:183], a[44:47], v[116:119]
    v_mfma_f32_16x16x32_bf16 v[120:123], a[176:179], a[48:51], v[120:123]
    buffer_load_dword a213, v6, s[56:59], s83 offen offset:896
    v_mfma_f32_16x16x32_bf16 v[120:123], a[180:183], a[52:55], v[120:123]
    v_mfma_f32_16x16x32_bf16 v[124:127], a[176:179], a[56:59], v[124:127]
    v_mfma_f32_16x16x32_bf16 v[124:127], a[180:183], a[60:63], v[124:127]
    v_mfma_f32_16x16x32_bf16 v[128:131], a[184:187], a[0:3], v[128:131]
    ds_read_b64_tr_b16 a[176:177], v26 offset:16384
    ds_read_b64_tr_b16 a[178:179], v26 offset:17408
    v_mfma_f32_16x16x32_bf16 v[128:131], a[188:191], a[4:7], v[128:131]
    buffer_load_dword a214, v7, s[56:59], s83 offen offset:1920
    v_mfma_f32_16x16x32_bf16 v[132:135], a[184:187], a[8:11], v[132:135]
    ds_read_b64_tr_b16 a[180:181], v26 offset:24576
    ds_read_b64_tr_b16 a[182:183], v26 offset:25600
    v_mfma_f32_16x16x32_bf16 v[132:135], a[188:191], a[12:15], v[132:135]
    v_mfma_f32_16x16x32_bf16 v[136:139], a[184:187], a[16:19], v[136:139]
    v_mfma_f32_16x16x32_bf16 v[136:139], a[188:191], a[20:23], v[136:139]
    v_mfma_f32_16x16x32_bf16 v[140:143], a[184:187], a[24:27], v[140:143]
    s_add_u32 s3, s50, 0x380000
    buffer_load_dword a215, v10, s[60:63], s3 offen
    v_mfma_f32_16x16x32_bf16 v[140:143], a[188:191], a[28:31], v[140:143]
    v_mfma_f32_16x16x32_bf16 v[144:147], a[184:187], a[32:35], v[144:147]
    v_mfma_f32_16x16x32_bf16 v[144:147], a[188:191], a[36:39], v[144:147]
    v_mfma_f32_16x16x32_bf16 v[148:151], a[184:187], a[40:43], v[148:151]
    v_mfma_f32_16x16x32_bf16 v[148:151], a[188:191], a[44:47], v[148:151]
    s_add_u32 s3, s51, 0x300000
    s_and_b32 s3, s3, 0x3fffff
    buffer_load_dword a127, v10, s[12:15], s3 offen
    v_mfma_f32_16x16x32_bf16 v[152:155], a[184:187], a[48:51], v[152:155]
    v_mfma_f32_16x16x32_bf16 v[152:155], a[188:191], a[52:55], v[152:155]
    v_mfma_f32_16x16x32_bf16 v[156:159], a[184:187], a[56:59], v[156:159]
    v_mfma_f32_16x16x32_bf16 v[156:159], a[188:191], a[60:63], v[156:159]
    s_waitcnt lgkmcnt(0)
    v_mfma_f32_16x16x32_bf16 v[160:163], a[0:3], a[160:163], v[160:163]
    ds_read_b64_tr_b16 a[184:185], v27 offset:16384
    ds_read_b64_tr_b16 a[186:187], v27 offset:17408
    v_mfma_f32_16x16x32_bf16 v[160:163], a[4:7], a[164:167], v[160:163]
    ds_read_b64_tr_b16 a[188:189], v27 offset:24576
    ds_read_b64_tr_b16 a[190:191], v27 offset:25600
    v_mfma_f32_16x16x32_bf16 v[164:167], a[8:11], a[160:163], v[164:167]
    v_mfma_f32_16x16x32_bf16 v[164:167], a[12:15], a[164:167], v[164:167]
    v_mfma_f32_16x16x32_bf16 v[168:171], a[16:19], a[160:163], v[168:171]
    v_mfma_f32_16x16x32_bf16 v[168:171], a[20:23], a[164:167], v[168:171]
    v_mfma_f32_16x16x32_bf16 v[172:175], a[24:27], a[160:163], v[172:175]
    v_mfma_f32_16x16x32_bf16 v[172:175], a[28:31], a[164:167], v[172:175]
    s_add_u32 m0, s38, 0x20000
    s_mov_b32 s3, s91
    s_and_b32 s3, s3, 0x3fffff
    buffer_load_dwordx4 v10, s[12:15], s3 offen offset:0 lds
    v_mfma_f32_16x16x32_bf16 v[176:179], a[32:35], a[160:163], v[176:179]
    buffer_load_dwordx4 v11, s[12:15], s3 offen offset:1024 lds
    v_mfma_f32_16x16x32_bf16 v[176:179], a[36:39], a[164:167], v[176:179]
    v_mfma_f32_16x16x32_bf16 v[180:183], a[40:43], a[160:163], v[180:183]
    v_mfma_f32_16x16x32_bf16 v[180:183], a[44:47], a[164:167], v[180:183]
    v_mfma_f32_16x16x32_bf16 v[184:187], a[48:51], a[160:163], v[184:187]
    buffer_load_dwordx4 v12, s[12:15], s3 offen offset:2048 lds
    v_mfma_f32_16x16x32_bf16 v[184:187], a[52:55], a[164:167], v[184:187]
    v_mfma_f32_16x16x32_bf16 v[188:191], a[56:59], a[160:163], v[188:191]
    v_mfma_f32_16x16x32_bf16 v[188:191], a[60:63], a[164:167], v[188:191]
    v_mfma_f32_16x16x32_bf16 v[192:195], a[0:3], a[168:171], v[192:195]
    buffer_load_dwordx4 v13, s[12:15], s3 offen offset:3072 lds
    v_mfma_f32_16x16x32_bf16 v[192:195], a[4:7], a[172:175], v[192:195]
    v_mfma_f32_16x16x32_bf16 v[196:199], a[8:11], a[168:171], v[196:199]
    v_mfma_f32_16x16x32_bf16 v[196:199], a[12:15], a[172:175], v[196:199]
    v_mfma_f32_16x16x32_bf16 v[200:203], a[16:19], a[168:171], v[200:203]
    v_mfma_f32_16x16x32_bf16 v[200:203], a[20:23], a[172:175], v[200:203]
    v_mfma_f32_16x16x32_bf16 v[204:207], a[24:27], a[168:171], v[204:207]
    v_mfma_f32_16x16x32_bf16 v[204:207], a[28:31], a[172:175], v[204:207]
    s_add_u32 m0, s38, 0x24000
    s_add_u32 s3, s91, 0x80000
    s_and_b32 s3, s3, 0x3fffff
    buffer_load_dwordx4 v10, s[12:15], s3 offen offset:0 lds
    v_mfma_f32_16x16x32_bf16 v[208:211], a[32:35], a[168:171], v[208:211]
    buffer_load_dwordx4 v11, s[12:15], s3 offen offset:1024 lds
    v_mfma_f32_16x16x32_bf16 v[208:211], a[36:39], a[172:175], v[208:211]
    v_mfma_f32_16x16x32_bf16 v[212:215], a[40:43], a[168:171], v[212:215]
    v_mfma_f32_16x16x32_bf16 v[212:215], a[44:47], a[172:175], v[212:215]
    v_mfma_f32_16x16x32_bf16 v[216:219], a[48:51], a[168:171], v[216:219]
    buffer_load_dwordx4 v12, s[12:15], s3 offen offset:2048 lds
    v_mfma_f32_16x16x32_bf16 v[216:219], a[52:55], a[172:175], v[216:219]
    v_mfma_f32_16x16x32_bf16 v[220:223], a[56:59], a[168:171], v[220:223]
    v_mfma_f32_16x16x32_bf16 v[220:223], a[60:63], a[172:175], v[220:223]
    v_mfma_f32_16x16x32_bf16 v[224:227], a[0:3], a[176:179], v[224:227]
    buffer_load_dwordx4 v13, s[12:15], s3 offen offset:3072 lds
    v_mfma_f32_16x16x32_bf16 v[224:227], a[4:7], a[180:183], v[224:227]
    v_mfma_f32_16x16x32_bf16 v[228:231], a[8:11], a[176:179], v[228:231]
    s_lshl_b32 s4, s96, 4
    s_add_u32 s4, s4, 0x8000
    v_mov_b32 v21, s4
    v_mfma_f32_16x16x32_bf16 v[228:231], a[12:15], a[180:183], v[228:231]
    s_lshl_b32 s4, s97, 4
    s_add_u32 s4, s4, 0x8000
    v_writelane_b32 v21, s4, 1
    s_waitcnt vmcnt(12) lgkmcnt(0)
    s_barrier
    v_mfma_f32_16x16x32_bf16 v[232:235], a[16:19], a[176:179], v[232:235]
    s_mov_b32 m0, s90
    s_add_u32 s3, s88, 0x300
    buffer_load_dwordx4 v6, s[56:59], s3 offen offset:0 lds
    v_mfma_f32_16x16x32_bf16 v[232:235], a[20:23], a[180:183], v[232:235]
    ds_read_b64_tr_b16 a[160:161], v24 offset:32768
    ds_read_b64_tr_b16 a[162:163], v24 offset:33792
    v_mfma_f32_16x16x32_bf16 v[236:239], a[24:27], a[176:179], v[236:239]
    ds_read_b64_tr_b16 a[164:165], v24 offset:40960
    ds_read_b64_tr_b16 a[166:167], v24 offset:41984
    v_mfma_f32_16x16x32_bf16 v[236:239], a[28:31], a[180:183], v[236:239]
    v_mfma_f32_16x16x32_bf16 v[240:243], a[32:35], a[176:179], v[240:243]
    buffer_load_dwordx4 v7, s[56:59], s3 offen offset:1024 lds
    v_mfma_f32_16x16x32_bf16 v[240:243], a[36:39], a[180:183], v[240:243]
    ds_read_b64_tr_b16 a[168:169], v25 offset:32768
    ds_read_b64_tr_b16 a[170:171], v25 offset:33792
    v_mfma_f32_16x16x32_bf16 v[244:247], a[40:43], a[176:179], v[244:247]
    ds_read_b64_tr_b16 a[172:173], v25 offset:40960
    ds_read_b64_tr_b16 a[174:175], v25 offset:41984
    v_mfma_f32_16x16x32_bf16 v[244:247], a[44:47], a[180:183], v[244:247]
    v_mfma_f32_16x16x32_bf16 v[248:251], a[48:51], a[176:179], v[248:251]
    v_mfma_f32_16x16x32_bf16 v[248:251], a[52:55], a[180:183], v[248:251]
    buffer_load_dwordx4 v8, s[56:59], s3 offen offset:2048 lds
    v_mfma_f32_16x16x32_bf16 v[252:255], a[56:59], a[176:179], v[252:255]
    v_mfma_f32_16x16x32_bf16 v[252:255], a[60:63], a[180:183], v[252:255]
    s_lshl_b32 s4, s98, 4
    s_add_u32 s4, s4, 0x8000
    v_writelane_b32 v21, s4, 2
    v_mfma_f32_16x16x32_bf16 a[128:131], a[0:3], a[184:187], a[128:131]
    ds_read_b64_tr_b16 a[176:177], v26 offset:32768
    ds_read_b64_tr_b16 a[178:179], v26 offset:33792
    v_mfma_f32_16x16x32_bf16 a[128:131], a[4:7], a[188:191], a[128:131]
    buffer_load_dwordx4 v9, s[56:59], s3 offen offset:3072 lds
    v_mfma_f32_16x16x32_bf16 a[132:135], a[8:11], a[184:187], a[132:135]
    ds_read_b128 a[0:3], v14 offset:32768
    ds_read_b64_tr_b16 a[180:181], v26 offset:40960
    v_mfma_f32_16x16x32_bf16 a[132:135], a[12:15], a[188:191], a[132:135]
    ds_read_b128 a[4:7], v15 offset:32768
    ds_read_b64_tr_b16 a[182:183], v26 offset:41984
    v_mfma_f32_16x16x32_bf16 a[136:139], a[16:19], a[184:187], a[136:139]
    ds_read_b128 a[8:11], v14 offset:34816
    ds_read_b128 a[12:15], v15 offset:34816
    v_mfma_f32_16x16x32_bf16 a[136:139], a[20:23], a[188:191], a[136:139]
    ds_read_b128 a[16:19], v14 offset:36864
    ds_read_b128 a[20:23], v15 offset:36864
    v_mfma_f32_16x16x32_bf16 a[140:143], a[24:27], a[184:187], a[140:143]
    s_add_u32 m0, s90, 0x1000
    s_add_u32 s3, s88, 0x8300
    buffer_load_dwordx4 v6, s[56:59], s3 offen offset:0 lds
    v_mfma_f32_16x16x32_bf16 a[140:143], a[28:31], a[188:191], a[140:143]
    ds_read_b128 a[24:27], v14 offset:38912
    ds_read_b128 a[28:31], v15 offset:38912
    v_mfma_f32_16x16x32_bf16 a[144:147], a[32:35], a[184:187], a[144:147]
    s_lshl_b32 s4, s99, 4
    s_add_u32 s4, s4, 0x8000
    v_writelane_b32 v21, s4, 3
    v_mfma_f32_16x16x32_bf16 a[144:147], a[36:39], a[188:191], a[144:147]
    ds_read_b128 a[32:35], v14 offset:40960
    ds_read_b128 a[36:39], v15 offset:40960
    v_mfma_f32_16x16x32_bf16 a[148:151], a[40:43], a[184:187], a[148:151]
    buffer_load_dwordx4 v7, s[56:59], s3 offen offset:1024 lds
    v_mfma_f32_16x16x32_bf16 a[148:151], a[44:47], a[188:191], a[148:151]
    ds_read_b128 a[40:43], v14 offset:43008
    ds_read_b128 a[44:47], v15 offset:43008
    v_mfma_f32_16x16x32_bf16 a[152:155], a[48:51], a[184:187], a[152:155]
    ds_read_b128 a[48:51], v14 offset:45056
    v_mfma_f32_16x16x32_bf16 a[152:155], a[52:55], a[188:191], a[152:155]
    ds_read_b128 a[52:55], v15 offset:45056
    v_mfma_f32_16x16x32_bf16 a[156:159], a[56:59], a[184:187], a[156:159]
    ds_read_b128 a[56:59], v14 offset:47104
    v_mfma_f32_16x16x32_bf16 a[156:159], a[60:63], a[188:191], a[156:159]
    buffer_load_dwordx4 v8, s[56:59], s3 offen offset:2048 lds
    s_waitcnt lgkmcnt(7)
    v_mfma_f32_16x16x32_bf16 v[32:35], a[160:163], a[0:3], v[32:35]
    ds_read_b64_tr_b16 a[184:185], v27 offset:32768
    ds_read_b128 a[60:63], v15 offset:47104
    v_mfma_f32_16x16x32_bf16 v[32:35], a[164:167], a[4:7], v[32:35]
    buffer_load_dwordx4 v[28:31], v21, s[20:23], 0 offen sc1
    v_mfma_f32_16x16x32_bf16 v[36:39], a[160:163], a[8:11], v[36:39]
    ds_read_b64_tr_b16 a[186:187], v27 offset:33792
    ds_read_b64_tr_b16 a[188:189], v27 offset:40960
    v_mfma_f32_16x16x32_bf16 v[36:39], a[164:167], a[12:15], v[36:39]
    buffer_load_dwordx4 v9, s[56:59], s3 offen offset:3072 lds
    v_mfma_f32_16x16x32_bf16 v[40:43], a[160:163], a[16:19], v[40:43]
    ds_read_b64_tr_b16 a[190:191], v27 offset:41984
    v_mfma_f32_16x16x32_bf16 v[40:43], a[164:167], a[20:23], v[40:43]
    v_mfma_f32_16x16x32_bf16 v[44:47], a[160:163], a[24:27], v[44:47]
    v_mfma_f32_16x16x32_bf16 v[44:47], a[164:167], a[28:31], v[44:47]
    s_waitcnt lgkmcnt(5)
    v_mfma_f32_16x16x32_bf16 v[48:51], a[160:163], a[32:35], v[48:51]
    s_add_u32 m0, s90, 0x10000
    s_add_u32 s3, s89, 0x300000
    buffer_load_dwordx4 v10, s[60:63], s3 offen offset:0 lds
    v_mfma_f32_16x16x32_bf16 v[48:51], a[164:167], a[36:39], v[48:51]
    v_mfma_f32_16x16x32_bf16 v[52:55], a[160:163], a[40:43], v[52:55]
    v_mfma_f32_16x16x32_bf16 v[52:55], a[164:167], a[44:47], v[52:55]
    v_mfma_f32_16x16x32_bf16 v[56:59], a[160:163], a[48:51], v[56:59]
    buffer_load_dwordx4 v11, s[60:63], s3 offen offset:1024 lds
    v_mfma_f32_16x16x32_bf16 v[56:59], a[164:167], a[52:55], v[56:59]
    v_mfma_f32_16x16x32_bf16 v[60:63], a[160:163], a[56:59], v[60:63]
    s_waitcnt lgkmcnt(0)
    v_mfma_f32_16x16x32_bf16 v[60:63], a[164:167], a[60:63], v[60:63]
    v_mfma_f32_16x16x32_bf16 v[64:67], a[168:171], a[0:3], v[64:67]
    ds_read_b64_tr_b16 a[160:161], v24 offset:49152
    ds_read_b64_tr_b16 a[162:163], v24 offset:50176
    v_mfma_f32_16x16x32_bf16 v[64:67], a[172:175], a[4:7], v[64:67]
    buffer_load_dwordx4 v12, s[60:63], s3 offen offset:2048 lds
    v_mfma_f32_16x16x32_bf16 v[68:71], a[168:171], a[8:11], v[68:71]
    ds_read_b64_tr_b16 a[164:165], v24 offset:57344
    ds_read_b64_tr_b16 a[166:167], v24 offset:58368
    v_mfma_f32_16x16x32_bf16 v[68:71], a[172:175], a[12:15], v[68:71]
    v_mfma_f32_16x16x32_bf16 v[72:75], a[168:171], a[16:19], v[72:75]
    v_mfma_f32_16x16x32_bf16 v[72:75], a[172:175], a[20:23], v[72:75]
    buffer_load_dwordx4 v13, s[60:63], s3 offen offset:3072 lds
    v_mfma_f32_16x16x32_bf16 v[76:79], a[168:171], a[24:27], v[76:79]
    v_mfma_f32_16x16x32_bf16 v[76:79], a[172:175], a[28:31], v[76:79]
    v_mfma_f32_16x16x32_bf16 v[80:83], a[168:171], a[32:35], v[80:83]
    v_mfma_f32_16x16x32_bf16 v[80:83], a[172:175], a[36:39], v[80:83]
    v_mfma_f32_16x16x32_bf16 v[84:87], a[168:171], a[40:43], v[84:87]
    s_add_u32 m0, s90, 0x11000
    s_add_u32 s3, s89, 0x320000
    buffer_load_dwordx4 v10, s[60:63], s3 offen offset:0 lds
    v_mfma_f32_16x16x32_bf16 v[84:87], a[172:175], a[44:47], v[84:87]
    v_mfma_f32_16x16x32_bf16 v[88:91], a[168:171], a[48:51], v[88:91]
    v_mfma_f32_16x16x32_bf16 v[88:91], a[172:175], a[52:55], v[88:91]
    v_mfma_f32_16x16x32_bf16 v[92:95], a[168:171], a[56:59], v[92:95]
    buffer_load_dwordx4 v11, s[60:63], s3 offen offset:1024 lds
    v_mfma_f32_16x16x32_bf16 v[92:95], a[172:175], a[60:63], v[92:95]
    v_mfma_f32_16x16x32_bf16 v[96:99], a[176:179], a[0:3], v[96:99]
    ds_read_b64_tr_b16 a[168:169], v25 offset:49152
    ds_read_b64_tr_b16 a[170:171], v25 offset:50176
    v_mfma_f32_16x16x32_bf16 v[96:99], a[180:183], a[4:7], v[96:99]
    ds_read_b64_tr_b16 a[172:173], v25 offset:57344
    ds_read_b64_tr_b16 a[174:175], v25 offset:58368
    v_mfma_f32_16x16x32_bf16 v[100:103], a[176:179], a[8:11], v[100:103]
    v_mfma_f32_16x16x32_bf16 v[100:103], a[180:183], a[12:15], v[100:103]
    buffer_load_dwordx4 v12, s[60:63], s3 offen offset:2048 lds
    v_mfma_f32_16x16x32_bf16 v[104:107], a[176:179], a[16:19], v[104:107]
    v_mfma_f32_16x16x32_bf16 v[104:107], a[180:183], a[20:23], v[104:107]
    v_mfma_f32_16x16x32_bf16 v[108:111], a[176:179], a[24:27], v[108:111]
    v_mfma_f32_16x16x32_bf16 v[108:111], a[180:183], a[28:31], v[108:111]
    buffer_load_dwordx4 v13, s[60:63], s3 offen offset:3072 lds
    v_mfma_f32_16x16x32_bf16 v[112:115], a[176:179], a[32:35], v[112:115]
    s_waitcnt vmcnt(9)
    v_cmp_eq_u64_e64 s[4:5], s[80:81], v[28:29]
    v_cmp_eq_u64 vcc, s[80:81], v[30:31]
    v_mfma_f32_16x16x32_bf16 v[112:115], a[180:183], a[36:39], v[112:115]
    s_and_b64 s[4:5], s[4:5], vcc
    v_mfma_f32_16x16x32_bf16 v[116:119], a[176:179], a[40:43], v[116:119]
    v_mfma_f32_16x16x32_bf16 v[116:119], a[180:183], a[44:47], v[116:119]
    s_cmp_eq_u64 s[4:5], -1
    s_cbranch_scc0 L_hf_retry
L_hf_back:
    v_mfma_f32_16x16x32_bf16 v[120:123], a[176:179], a[48:51], v[120:123]
    s_and_b32 s4, s33, 3
    s_lshl_b32 s4, s4, 12
    v_mfma_f32_16x16x32_bf16 v[120:123], a[180:183], a[52:55], v[120:123]
    v_add_u32 v30, s4, v2
    v_mfma_f32_16x16x32_bf16 v[124:127], a[176:179], a[56:59], v[124:127]
    buffer_load_dwordx4 a[192:195], v30, s[16:19], s40 offen offset:0 sc1
    v_mfma_f32_16x16x32_bf16 v[124:127], a[180:183], a[60:63], v[124:127]
    v_mfma_f32_16x16x32_bf16 v[128:131], a[184:187], a[0:3], v[128:131]
    ds_read_b64_tr_b16 a[176:177], v26 offset:49152
    ds_read_b64_tr_b16 a[178:179], v26 offset:50176
    v_mfma_f32_16x16x32_bf16 v[128:131], a[188:191], a[4:7], v[128:131]
    ds_read_b64_tr_b16 a[180:181], v26 offset:57344
    ds_read_b64_tr_b16 a[182:183], v26 offset:58368
    v_mfma_f32_16x16x32_bf16 v[132:135], a[184:187], a[8:11], v[132:135]
    v_mfma_f32_16x16x32_bf16 v[132:135], a[188:191], a[12:15], v[132:135]
    v_mfma_f32_16x16x32_bf16 v[136:139], a[184:187], a[16:19], v[136:139]
    buffer_load_dwordx4 a[196:199], v30, s[16:19], s40 offen offset:1024 sc1
    v_mfma_f32_16x16x32_bf16 v[136:139], a[188:191], a[20:23], v[136:139]
    v_mfma_f32_16x16x32_bf16 v[140:143], a[184:187], a[24:27], v[140:143]
    v_mfma_f32_16x16x32_bf16 v[140:143], a[188:191], a[28:31], v[140:143]
    v_mfma_f32_16x16x32_bf16 v[144:147], a[184:187], a[32:35], v[144:147]
    v_mfma_f32_16x16x32_bf16 v[144:147], a[188:191], a[36:39], v[144:147]
    v_mfma_f32_16x16x32_bf16 v[148:151], a[184:187], a[40:43], v[148:151]
    v_mfma_f32_16x16x32_bf16 v[148:151], a[188:191], a[44:47], v[148:151]
    buffer_load_dwordx4 a[200:203], v30, s[16:19], s41 offen offset:0 sc1
    v_mfma_f32_16x16x32_bf16 v[152:155], a[184:187], a[48:51], v[152:155]
    v_mfma_f32_16x16x32_bf16 v[152:155], a[188:191], a[52:55], v[152:155]
    v_mfma_f32_16x16x32_bf16 v[156:159], a[184:187], a[56:59], v[156:159]
    v_mfma_f32_16x16x32_bf16 v[156:159], a[188:191], a[60:63], v[156:159]
    s_waitcnt lgkmcnt(0)
    v_mfma_f32_16x16x32_bf16 v[160:163], a[0:3], a[160:163], v[160:163]
    ds_read_b64_tr_b16 a[184:185], v27 offset:49152
    ds_read_b64_tr_b16 a[186:187], v27 offset:50176
    v_mfma_f32_16x16x32_bf16 v[160:163], a[4:7], a[164:167], v[160:163]
    ds_read_b64_tr_b16 a[188:189], v27 offset:57344
    ds_read_b64_tr_b16 a[190:191], v27 offset:58368
    v_mfma_f32_16x16x32_bf16 v[164:167], a[8:11], a[160:163], v[164:167]
    buffer_load_dwordx4 a[204:207], v30, s[16:19], s41 offen offset:1024 sc1
    v_mfma_f32_16x16x32_bf16 v[164:167], a[12:15], a[164:167], v[164:167]
    v_mfma_f32_16x16x32_bf16 v[168:171], a[16:19], a[160:163], v[168:171]
    v_mfma_f32_16x16x32_bf16 v[168:171], a[20:23], a[164:167], v[168:171]
    v_mfma_f32_16x16x32_bf16 v[172:175], a[24:27], a[160:163], v[172:175]
    v_mfma_f32_16x16x32_bf16 v[172:175], a[28:31], a[164:167], v[172:175]
    v_mfma_f32_16x16x32_bf16 v[176:179], a[32:35], a[160:163], v[176:179]
    v_mfma_f32_16x16x32_bf16 v[176:179], a[36:39], a[164:167], v[176:179]
    buffer_load_dwordx4 a[208:211], v30, s[16:19], s42 offen offset:0 sc1
    v_mfma_f32_16x16x32_bf16 v[180:183], a[40:43], a[160:163], v[180:183]
    v_mfma_f32_16x16x32_bf16 v[180:183], a[44:47], a[164:167], v[180:183]
    v_mfma_f32_16x16x32_bf16 v[184:187], a[48:51], a[160:163], v[184:187]
    v_mfma_f32_16x16x32_bf16 v[184:187], a[52:55], a[164:167], v[184:187]
    v_mfma_f32_16x16x32_bf16 v[188:191], a[56:59], a[160:163], v[188:191]
    v_mfma_f32_16x16x32_bf16 v[188:191], a[60:63], a[164:167], v[188:191]
    buffer_load_dwordx4 a[212:215], v30, s[16:19], s42 offen offset:1024 sc1
    v_mfma_f32_16x16x32_bf16 v[192:195], a[0:3], a[168:171], v[192:195]
    v_mfma_f32_16x16x32_bf16 v[192:195], a[4:7], a[172:175], v[192:195]
    v_mfma_f32_16x16x32_bf16 v[196:199], a[8:11], a[168:171], v[196:199]
    v_mfma_f32_16x16x32_bf16 v[196:199], a[12:15], a[172:175], v[196:199]
    v_mfma_f32_16x16x32_bf16 v[200:203], a[16:19], a[168:171], v[200:203]
    v_mfma_f32_16x16x32_bf16 v[200:203], a[20:23], a[172:175], v[200:203]
    v_mfma_f32_16x16x32_bf16 v[204:207], a[24:27], a[168:171], v[204:207]
    buffer_load_dwordx4 a[216:219], v30, s[16:19], s43 offen offset:0 sc1
    v_mfma_f32_16x16x32_bf16 v[204:207], a[28:31], a[172:175], v[204:207]
    v_mfma_f32_16x16x32_bf16 v[208:211], a[32:35], a[168:171], v[208:211]
    v_mfma_f32_16x16x32_bf16 v[208:211], a[36:39], a[172:175], v[208:211]
    v_mfma_f32_16x16x32_bf16 v[212:215], a[40:43], a[168:171], v[212:215]
    v_mfma_f32_16x16x32_bf16 v[212:215], a[44:47], a[172:175], v[212:215]
    v_mfma_f32_16x16x32_bf16 v[216:219], a[48:51], a[168:171], v[216:219]
    v_mfma_f32_16x16x32_bf16 v[216:219], a[52:55], a[172:175], v[216:219]
    buffer_load_dwordx4 a[220:223], v30, s[16:19], s43 offen offset:1024 sc1
    v_mfma_f32_16x16x32_bf16 v[220:223], a[56:59], a[168:171], v[220:223]
    v_mfma_f32_16x16x32_bf16 v[220:223], a[60:63], a[172:175], v[220:223]
    v_mfma_f32_16x16x32_bf16 v[224:227], a[0:3], a[176:179], v[224:227]
    v_mfma_f32_16x16x32_bf16 v[224:227], a[4:7], a[180:183], v[224:227]
    v_mfma_f32_16x16x32_bf16 v[228:231], a[8:11], a[176:179], v[228:231]
    v_mfma_f32_16x16x32_bf16 v[228:231], a[12:15], a[180:183], v[228:231]
    s_waitcnt vmcnt(8) lgkmcnt(0)
    s_barrier
    v_mfma_f32_16x16x32_bf16 v[232:235], a[16:19], a[176:179], v[232:235]
    s_add_u32 m0, s90, 0x8000
    s_add_u32 s3, s88, 0x380
    buffer_load_dwordx4 v6, s[56:59], s3 offen offset:0 lds
    v_mfma_f32_16x16x32_bf16 v[232:235], a[20:23], a[180:183], v[232:235]
    ds_read_b64_tr_b16 a[160:161], v24 offset:0
    ds_read_b64_tr_b16 a[162:163], v24 offset:1024
    v_mfma_f32_16x16x32_bf16 v[236:239], a[24:27], a[176:179], v[236:239]
    ds_read_b64_tr_b16 a[164:165], v24 offset:8192
    ds_read_b64_tr_b16 a[166:167], v24 offset:9216
    v_mfma_f32_16x16x32_bf16 v[236:239], a[28:31], a[180:183], v[236:239]
    v_mfma_f32_16x16x32_bf16 v[240:243], a[32:35], a[176:179], v[240:243]
    buffer_load_dwordx4 v7, s[56:59], s3 offen offset:1024 lds
    v_mfma_f32_16x16x32_bf16 v[240:243], a[36:39], a[180:183], v[240:243]
    ds_read_b64_tr_b16 a[168:169], v25 offset:0
    ds_read_b64_tr_b16 a[170:171], v25 offset:1024
    v_mfma_f32_16x16x32_bf16 v[244:247], a[40:43], a[176:179], v[244:247]
    ds_read_b64_tr_b16 a[172:173], v25 offset:8192
    ds_read_b64_tr_b16 a[174:175], v25 offset:9216
    v_mfma_f32_16x16x32_bf16 v[244:247], a[44:47], a[180:183], v[244:247]
    v_mfma_f32_16x16x32_bf16 v[248:251], a[48:51], a[176:179], v[248:251]
    v_mfma_f32_16x16x32_bf16 v[248:251], a[52:55], a[180:183], v[248:251]
    buffer_load_dwordx4 v8, s[56:59], s3 offen offset:2048 lds
    v_mfma_f32_16x16x32_bf16 v[252:255], a[56:59], a[176:179], v[252:255]
    v_mfma_f32_16x16x32_bf16 v[252:255], a[60:63], a[180:183], v[252:255]
    v_mfma_f32_16x16x32_bf16 a[128:131], a[0:3], a[184:187], a[128:131]
    ds_read_b64_tr_b16 a[176:177], v26 offset:0
    ds_read_b64_tr_b16 a[178:179], v26 offset:1024
    v_mfma_f32_16x16x32_bf16 a[128:131], a[4:7], a[188:191], a[128:131]
    buffer_load_dwordx4 v9, s[56:59], s3 offen offset:3072 lds
    v_mfma_f32_16x16x32_bf16 a[132:135], a[8:11], a[184:187], a[132:135]
    ds_read_b128 a[0:3], v14 offset:0
    ds_read_b64_tr_b16 a[180:181], v26 offset:8192
    v_mfma_f32_16x16x32_bf16 a[132:135], a[12:15], a[188:191], a[132:135]
    ds_read_b128 a[4:7], v15 offset:0
    ds_read_b64_tr_b16 a[182:183], v26 offset:9216
    v_mfma_f32_16x16x32_bf16 a[136:139], a[16:19], a[184:187], a[136:139]
    ds_read_b128 a[8:11], v14 offset:2048
    ds_read_b128 a[12:15], v15 offset:2048
    v_mfma_f32_16x16x32_bf16 a[136:139], a[20:23], a[188:191], a[136:139]
    ds_read_b128 a[16:19], v14 offset:4096
    ds_read_b128 a[20:23], v15 offset:4096
    v_mfma_f32_16x16x32_bf16 a[140:143], a[24:27], a[184:187], a[140:143]
    s_add_u32 m0, s90, 0x9000
    s_add_u32 s3, s88, 0x8380
    buffer_load_dwordx4 v6, s[56:59], s3 offen offset:0 lds
    v_mfma_f32_16x16x32_bf16 a[140:143], a[28:31], a[188:191], a[140:143]
    ds_read_b128 a[24:27], v14 offset:6144
    ds_read_b128 a[28:31], v15 offset:6144
    v_mfma_f32_16x16x32_bf16 a[144:147], a[32:35], a[184:187], a[144:147]
    ds_read_b128 a[32:35], v14 offset:8192
    v_mfma_f32_16x16x32_bf16 a[144:147], a[36:39], a[188:191], a[144:147]
    ds_read_b128 a[36:39], v15 offset:8192
    v_mfma_f32_16x16x32_bf16 a[148:151], a[40:43], a[184:187], a[148:151]
    buffer_load_dwordx4 v7, s[56:59], s3 offen offset:1024 lds
    v_mfma_f32_16x16x32_bf16 a[148:151], a[44:47], a[188:191], a[148:151]
    ds_read_b128 a[40:43], v14 offset:10240
    ds_read_b128 a[44:47], v15 offset:10240
    v_mfma_f32_16x16x32_bf16 a[152:155], a[48:51], a[184:187], a[152:155]
    ds_read_b128 a[48:51], v14 offset:12288
    v_mfma_f32_16x16x32_bf16 a[152:155], a[52:55], a[188:191], a[152:155]
    ds_read_b128 a[52:55], v15 offset:12288
    v_mfma_f32_16x16x32_bf16 a[156:159], a[56:59], a[184:187], a[156:159]
    ds_read_b128 a[56:59], v14 offset:14336
    v_mfma_f32_16x16x32_bf16 a[156:159], a[60:63], a[188:191], a[156:159]
    buffer_load_dwordx4 v8, s[56:59], s3 offen offset:2048 lds
    s_waitcnt lgkmcnt(7)
    v_mfma_f32_16x16x32_bf16 v[32:35], a[160:163], a[0:3], v[32:35]
    ds_read_b64_tr_b16 a[184:185], v27 offset:0
    ds_read_b128 a[60:63], v15 offset:14336
    v_mfma_f32_16x16x32_bf16 v[32:35], a[164:167], a[4:7], v[32:35]
    ds_read_b64_tr_b16 a[186:187], v27 offset:1024
    ds_read_b64_tr_b16 a[188:189], v27 offset:8192
    v_mfma_f32_16x16x32_bf16 v[36:39], a[160:163], a[8:11], v[36:39]
    ds_read_b64_tr_b16 a[190:191], v27 offset:9216
    v_mfma_f32_16x16x32_bf16 v[36:39], a[164:167], a[12:15], v[36:39]
    buffer_load_dwordx4 v9, s[56:59], s3 offen offset:3072 lds
    v_mfma_f32_16x16x32_bf16 v[40:43], a[160:163], a[16:19], v[40:43]
    v_mfma_f32_16x16x32_bf16 v[40:43], a[164:167], a[20:23], v[40:43]
    v_mfma_f32_16x16x32_bf16 v[44:47], a[160:163], a[24:27], v[44:47]
    v_mfma_f32_16x16x32_bf16 v[44:47], a[164:167], a[28:31], v[44:47]
    s_waitcnt lgkmcnt(5)
    v_mfma_f32_16x16x32_bf16 v[48:51], a[160:163], a[32:35], v[48:51]
    s_add_u32 m0, s90, 0x18000
    s_add_u32 s3, s89, 0x380000
    buffer_load_dwordx4 v10, s[60:63], s3 offen offset:0 lds
    v_mfma_f32_16x16x32_bf16 v[48:51], a[164:167], a[36:39], v[48:51]
    v_mfma_f32_16x16x32_bf16 v[52:55], a[160:163], a[40:43], v[52:55]
    v_mfma_f32_16x16x32_bf16 v[52:55], a[164:167], a[44:47], v[52:55]
    v_mfma_f32_16x16x32_bf16 v[56:59], a[160:163], a[48:51], v[56:59]
    buffer_load_dwordx4 v11, s[60:63], s3 offen offset:1024 lds
    v_mfma_f32_16x16x32_bf16 v[56:59], a[164:167], a[52:55], v[56:59]
    v_mfma_f32_16x16x32_bf16 v[60:63], a[160:163], a[56:59], v[60:63]
    s_waitcnt lgkmcnt(0)
    v_mfma_f32_16x16x32_bf16 v[60:63], a[164:167], a[60:63], v[60:63]
    v_mfma_f32_16x16x32_bf16 v[64:67], a[168:171], a[0:3], v[64:67]
    ds_read_b64_tr_b16 a[160:161], v24 offset:16384
    ds_read_b64_tr_b16 a[162:163], v24 offset:17408
    v_mfma_f32_16x16x32_bf16 v[64:67], a[172:175], a[4:7], v[64:67]
    buffer_load_dwordx4 v12, s[60:63], s3 offen offset:2048 lds
    v_mfma_f32_16x16x32_bf16 v[68:71], a[168:171], a[8:11], v[68:71]
    ds_read_b64_tr_b16 a[164:165], v24 offset:24576
    ds_read_b64_tr_b16 a[166:167], v24 offset:25600
    v_mfma_f32_16x16x32_bf16 v[68:71], a[172:175], a[12:15], v[68:71]
    v_mfma_f32_16x16x32_bf16 v[72:75], a[168:171], a[16:19], v[72:75]
    v_mfma_f32_16x16x32_bf16 v[72:75], a[172:175], a[20:23], v[72:75]
    buffer_load_dwordx4 v13, s[60:63], s3 offen offset:3072 lds
    v_mfma_f32_16x16x32_bf16 v[76:79], a[168:171], a[24:27], v[76:79]
    v_mfma_f32_16x16x32_bf16 v[76:79], a[172:175], a[28:31], v[76:79]
    v_mfma_f32_16x16x32_bf16 v[80:83], a[168:171], a[32:35], v[80:83]
    v_mfma_f32_16x16x32_bf16 v[80:83], a[172:175], a[36:39], v[80:83]
    v_mfma_f32_16x16x32_bf16 v[84:87], a[168:171], a[40:43], v[84:87]
    s_add_u32 m0, s90, 0x19000
    s_add_u32 s3, s89, 0x3a0000
    buffer_load_dwordx4 v10, s[60:63], s3 offen offset:0 lds
    v_mfma_f32_16x16x32_bf16 v[84:87], a[172:175], a[44:47], v[84:87]
    v_mfma_f32_16x16x32_bf16 v[88:91], a[168:171], a[48:51], v[88:91]
    v_mfma_f32_16x16x32_bf16 v[88:91], a[172:175], a[52:55], v[88:91]
    v_mfma_f32_16x16x32_bf16 v[92:95], a[168:171], a[56:59], v[92:95]
    buffer_load_dwordx4 v11, s[60:63], s3 offen offset:1024 lds
    v_mfma_f32_16x16x32_bf16 v[92:95], a[172:175], a[60:63], v[92:95]
    v_mfma_f32_16x16x32_bf16 v[96:99], a[176:179], a[0:3], v[96:99]
    v_add_u32 v3, 4096, v2
    ds_read_b64_tr_b16 a[168:169], v25 offset:16384
    v_mfma_f32_16x16x32_bf16 v[96:99], a[180:183], a[4:7], v[96:99]
    ds_read_b64_tr_b16 a[170:171], v25 offset:17408
    ds_read_b64_tr_b16 a[172:173], v25 offset:24576
    v_mfma_f32_16x16x32_bf16 v[100:103], a[176:179], a[8:11], v[100:103]
    ds_read_b64_tr_b16 a[174:175], v25 offset:25600
    v_mfma_f32_16x16x32_bf16 v[100:103], a[180:183], a[12:15], v[100:103]
    buffer_load_dwordx4 v12, s[60:63], s3 offen offset:2048 lds
    v_mfma_f32_16x16x32_bf16 v[104:107], a[176:179], a[16:19], v[104:107]
    v_mfma_f32_16x16x32_bf16 v[104:107], a[180:183], a[20:23], v[104:107]
    v_mfma_f32_16x16x32_bf16 v[108:111], a[176:179], a[24:27], v[108:111]
    v_mfma_f32_16x16x32_bf16 v[108:111], a[180:183], a[28:31], v[108:111]
    buffer_load_dwordx4 v13, s[60:63], s3 offen offset:3072 lds
    v_mfma_f32_16x16x32_bf16 v[112:115], a[176:179], a[32:35], v[112:115]
    v_mfma_f32_16x16x32_bf16 v[112:115], a[180:183], a[36:39], v[112:115]
    v_mfma_f32_16x16x32_bf16 v[116:119], a[176:179], a[40:43], v[116:119]
    v_mfma_f32_16x16x32_bf16 v[116:119], a[180:183], a[44:47], v[116:119]
    v_mfma_f32_16x16x32_bf16 v[120:123], a[176:179], a[48:51], v[120:123]
    v_mfma_f32_16x16x32_bf16 v[120:123], a[180:183], a[52:55], v[120:123]
    v_mfma_f32_16x16x32_bf16 v[124:127], a[176:179], a[56:59], v[124:127]
    buffer_load_dwordx4 a[224:227], v30, s[16:19], s40 offen offset:2048 sc1
    v_mfma_f32_16x16x32_bf16 v[124:127], a[180:183], a[60:63], v[124:127]
    v_add_u32 v4, 16384, v2
    v_mfma_f32_16x16x32_bf16 v[128:131], a[184:187], a[0:3], v[128:131]
    ds_read_b64_tr_b16 a[176:177], v26 offset:16384
    ds_read_b64_tr_b16 a[178:179], v26 offset:17408
    v_mfma_f32_16x16x32_bf16 v[128:131], a[188:191], a[4:7], v[128:131]
    ds_read_b64_tr_b16 a[180:181], v26 offset:24576
    ds_read_b64_tr_b16 a[182:183], v26 offset:25600
    v_mfma_f32_16x16x32_bf16 v[132:135], a[184:187], a[8:11], v[132:135]
    v_mfma_f32_16x16x32_bf16 v[132:135], a[188:191], a[12:15], v[132:135]
    v_mfma_f32_16x16x32_bf16 v[136:139], a[184:187], a[16:19], v[136:139]
    v_mfma_f32_16x16x32_bf16 v[136:139], a[188:191], a[20:23], v[136:139]
    buffer_load_dwordx4 a[228:231], v30, s[16:19], s40 offen offset:3072 sc1
    v_mfma_f32_16x16x32_bf16 v[140:143], a[184:187], a[24:27], v[140:143]
    v_mfma_f32_16x16x32_bf16 v[140:143], a[188:191], a[28:31], v[140:143]
    v_mfma_f32_16x16x32_bf16 v[144:147], a[184:187], a[32:35], v[144:147]
    v_mfma_f32_16x16x32_bf16 v[144:147], a[188:191], a[36:39], v[144:147]
    v_mfma_f32_16x16x32_bf16 v[148:151], a[184:187], a[40:43], v[148:151]
    v_mfma_f32_16x16x32_bf16 v[148:151], a[188:191], a[44:47], v[148:151]
    v_mfma_f32_16x16x32_bf16 v[152:155], a[184:187], a[48:51], v[152:155]
    buffer_load_dwordx4 a[232:235], v30, s[16:19], s41 offen offset:2048 sc1
    v_mfma_f32_16x16x32_bf16 v[152:155], a[188:191], a[52:55], v[152:155]
    v_mfma_f32_16x16x32_bf16 v[156:159], a[184:187], a[56:59], v[156:159]
    v_mfma_f32_16x16x32_bf16 v[156:159], a[188:191], a[60:63], v[156:159]
    s_waitcnt lgkmcnt(0)
    v_mfma_f32_16x16x32_bf16 v[160:163], a[0:3], a[160:163], v[160:163]
    ds_read_b64_tr_b16 a[184:185], v27 offset:16384
    ds_read_b64_tr_b16 a[186:187], v27 offset:17408
    v_mfma_f32_16x16x32_bf16 v[160:163], a[4:7], a[164:167], v[160:163]
    ds_read_b64_tr_b16 a[188:189], v27 offset:24576
    ds_read_b64_tr_b16 a[190:191], v27 offset:25600
    v_mfma_f32_16x16x32_bf16 v[164:167], a[8:11], a[160:163], v[164:167]
    v_add_u32 v5, 20480, v2
    v_mfma_f32_16x16x32_bf16 v[164:167], a[12:15], a[164:167], v[164:167]
    buffer_load_dwordx4 a[236:239], v30, s[16:19], s41 offen offset:3072 sc1
    v_mfma_f32_16x16x32_bf16 v[168:171], a[16:19], a[160:163], v[168:171]
    v_mfma_f32_16x16x32_bf16 v[168:171], a[20:23], a[164:167], v[168:171]
    v_mfma_f32_16x16x32_bf16 v[172:175], a[24:27], a[160:163], v[172:175]
    v_mfma_f32_16x16x32_bf16 v[172:175], a[28:31], a[164:167], v[172:175]
    v_mfma_f32_16x16x32_bf16 v[176:179], a[32:35], a[160:163], v[176:179]
    v_mfma_f32_16x16x32_bf16 v[176:179], a[36:39], a[164:167], v[176:179]
    v_mfma_f32_16x16x32_bf16 v[180:183], a[40:43], a[160:163], v[180:183]
    buffer_load_dwordx4 a[240:243], v30, s[16:19], s42 offen offset:2048 sc1
    v_mfma_f32_16x16x32_bf16 v[180:183], a[44:47], a[164:167], v[180:183]
    v_mfma_f32_16x16x32_bf16 v[184:187], a[48:51], a[160:163], v[184:187]
    v_mfma_f32_16x16x32_bf16 v[184:187], a[52:55], a[164:167], v[184:187]
    v_mfma_f32_16x16x32_bf16 v[188:191], a[56:59], a[160:163], v[188:191]
    v_mfma_f32_16x16x32_bf16 v[188:191], a[60:63], a[164:167], v[188:191]
    v_mfma_f32_16x16x32_bf16 v[192:195], a[0:3], a[168:171], v[192:195]
    v_mfma_f32_16x16x32_bf16 v[192:195], a[4:7], a[172:175], v[192:195]
    buffer_load_dwordx4 a[244:247], v30, s[16:19], s42 offen offset:3072 sc1
    v_mfma_f32_16x16x32_bf16 v[196:199], a[8:11], a[168:171], v[196:199]
    v_mfma_f32_16x16x32_bf16 v[196:199], a[12:15], a[172:175], v[196:199]
    v_mfma_f32_16x16x32_bf16 v[200:203], a[16:19], a[168:171], v[200:203]
    v_mfma_f32_16x16x32_bf16 v[200:203], a[20:23], a[172:175], v[200:203]
    v_mfma_f32_16x16x32_bf16 v[204:207], a[24:27], a[168:171], v[204:207]
    v_mfma_f32_16x16x32_bf16 v[204:207], a[28:31], a[172:175], v[204:207]
    v_mfma_f32_16x16x32_bf16 v[208:211], a[32:35], a[168:171], v[208:211]
    buffer_load_dwordx4 a[248:251], v30, s[16:19], s43 offen offset:2048 sc1
    v_mfma_f32_16x16x32_bf16 v[208:211], a[36:39], a[172:175], v[208:211]
    v_mfma_f32_16x16x32_bf16 v[212:215], a[40:43], a[168:171], v[212:215]
    v_mfma_f32_16x16x32_bf16 v[212:215], a[44:47], a[172:175], v[212:215]
    v_mfma_f32_16x16x32_bf16 v[216:219], a[48:51], a[168:171], v[216:219]
    v_mfma_f32_16x16x32_bf16 v[216:219], a[52:55], a[172:175], v[216:219]
    v_mfma_f32_16x16x32_bf16 v[220:223], a[56:59], a[168:171], v[220:223]
    v_mfma_f32_16x16x32_bf16 v[220:223], a[60:63], a[172:175], v[220:223]
    buffer_load_dwordx4 a[252:255], v30, s[16:19], s43 offen offset:3072 sc1
    v_mfma_f32_16x16x32_bf16 v[224:227], a[0:3], a[176:179], v[224:227]
    v_mfma_f32_16x16x32_bf16 v[224:227], a[4:7], a[180:183], v[224:227]
    v_mfma_f32_16x16x32_bf16 v[228:231], a[8:11], a[176:179], v[228:231]
    v_mfma_f32_16x16x32_bf16 v[228:231], a[12:15], a[180:183], v[228:231]
    s_waitcnt vmcnt(8) lgkmcnt(0)
    s_barrier
    v_mfma_f32_16x16x32_bf16 v[232:235], a[16:19], a[176:179], v[232:235]
    ds_read_b64_tr_b16 a[160:161], v24 offset:32768
    ds_read_b64_tr_b16 a[162:163], v24 offset:33792
    v_mfma_f32_16x16x32_bf16 v[232:235], a[20:23], a[180:183], v[232:235]
    ds_read_b64_tr_b16 a[164:165], v24 offset:40960
    ds_read_b64_tr_b16 a[166:167], v24 offset:41984
    v_mfma_f32_16x16x32_bf16 v[236:239], a[24:27], a[176:179], v[236:239]
    v_mfma_f32_16x16x32_bf16 v[236:239], a[28:31], a[180:183], v[236:239]
    v_mfma_f32_16x16x32_bf16 v[240:243], a[32:35], a[176:179], v[240:243]
    ds_read_b64_tr_b16 a[168:169], v25 offset:32768
    ds_read_b64_tr_b16 a[170:171], v25 offset:33792
    v_mfma_f32_16x16x32_bf16 v[240:243], a[36:39], a[180:183], v[240:243]
    ds_read_b64_tr_b16 a[172:173], v25 offset:40960
    ds_read_b64_tr_b16 a[174:175], v25 offset:41984
    v_mfma_f32_16x16x32_bf16 v[244:247], a[40:43], a[176:179], v[244:247]
    v_mfma_f32_16x16x32_bf16 v[244:247], a[44:47], a[180:183], v[244:247]
    s_mov_b32 m0, s38
    s_add_u32 s3, s91, 0x100000
    s_and_b32 s3, s3, 0x3fffff
    buffer_load_dwordx4 v10, s[12:15], s3 offen offset:0 lds
    v_mfma_f32_16x16x32_bf16 v[248:251], a[48:51], a[176:179], v[248:251]
    v_mfma_f32_16x16x32_bf16 v[248:251], a[52:55], a[180:183], v[248:251]
    v_mfma_f32_16x16x32_bf16 v[252:255], a[56:59], a[176:179], v[252:255]
    v_mfma_f32_16x16x32_bf16 v[252:255], a[60:63], a[180:183], v[252:255]
    buffer_load_dwordx4 v11, s[12:15], s3 offen offset:1024 lds
    v_mfma_f32_16x16x32_bf16 a[128:131], a[0:3], a[184:187], a[128:131]
    ds_read_b64_tr_b16 a[176:177], v26 offset:32768
    ds_read_b64_tr_b16 a[178:179], v26 offset:33792
    v_mfma_f32_16x16x32_bf16 a[128:131], a[4:7], a[188:191], a[128:131]
    ds_read_b64_tr_b16 a[180:181], v26 offset:40960
    ds_read_b64_tr_b16 a[182:183], v26 offset:41984
    v_mfma_f32_16x16x32_bf16 a[132:135], a[8:11], a[184:187], a[132:135]
    ds_read_b128 a[0:3], v14 offset:32768
    ds_read_b128 a[4:7], v15 offset:32768
    v_mfma_f32_16x16x32_bf16 a[132:135], a[12:15], a[188:191], a[132:135]
    ds_read_b128 a[8:11], v14 offset:34816
    ds_read_b128 a[12:15], v15 offset:34816
    v_mfma_f32_16x16x32_bf16 a[136:139], a[16:19], a[184:187], a[136:139]
    ds_read_b128 a[16:19], v14 offset:36864
    v_mfma_f32_16x16x32_bf16 a[136:139], a[20:23], a[188:191], a[136:139]
    ds_read_b128 a[20:23], v15 offset:36864
    v_mfma_f32_16x16x32_bf16 a[140:143], a[24:27], a[184:187], a[140:143]
    buffer_load_dwordx4 v12, s[12:15], s3 offen offset:2048 lds
    v_mfma_f32_16x16x32_bf16 a[140:143], a[28:31], a[188:191], a[140:143]
    ds_read_b128 a[24:27], v14 offset:38912
    ds_read_b128 a[28:31], v15 offset:38912
    v_mfma_f32_16x16x32_bf16 a[144:147], a[32:35], a[184:187], a[144:147]
    ds_read_b128 a[32:35], v14 offset:40960
    v_mfma_f32_16x16x32_bf16 a[144:147], a[36:39], a[188:191], a[144:147]
    ds_read_b128 a[36:39], v15 offset:40960
    v_mfma_f32_16x16x32_bf16 a[148:151], a[40:43], a[184:187], a[148:151]
    ds_read_b128 a[40:43], v14 offset:43008
    v_mfma_f32_16x16x32_bf16 a[148:151], a[44:47], a[188:191], a[148:151]
    ds_read_b128 a[44:47], v15 offset:43008
    v_mfma_f32_16x16x32_bf16 a[152:155], a[48:51], a[184:187], a[152:155]
    ds_read_b128 a[48:51], v14 offset:45056
    v_mfma_f32_16x16x32_bf16 a[152:155], a[52:55], a[188:191], a[152:155]
    ds_read_b128 a[52:55], v15 offset:45056
    v_mfma_f32_16x16x32_bf16 a[156:159], a[56:59], a[184:187], a[156:159]
    buffer_load_dwordx4 v13, s[12:15], s3 offen offset:3072 lds
    v_mfma_f32_16x16x32_bf16 a[156:159], a[60:63], a[188:191], a[156:159]
    ds_read_b128 a[56:59], v14 offset:47104
    ds_read_b128 a[60:63], v15 offset:47104
    s_waitcnt lgkmcnt(8)
    v_mfma_f32_16x16x32_bf16 v[32:35], a[160:163], a[0:3], v[32:35]
    ds_read_b64_tr_b16 a[184:185], v27 offset:32768
    ds_read_b64_tr_b16 a[186:187], v27 offset:33792
    v_mfma_f32_16x16x32_bf16 v[32:35], a[164:167], a[4:7], v[32:35]
    ds_read_b64_tr_b16 a[188:189], v27 offset:40960
    ds_read_b64_tr_b16 a[190:191], v27 offset:41984
    v_mfma_f32_16x16x32_bf16 v[36:39], a[160:163], a[8:11], v[36:39]
    v_mfma_f32_16x16x32_bf16 v[36:39], a[164:167], a[12:15], v[36:39]
    v_mfma_f32_16x16x32_bf16 v[40:43], a[160:163], a[16:19], v[40:43]
    v_mfma_f32_16x16x32_bf16 v[40:43], a[164:167], a[20:23], v[40:43]
    v_mfma_f32_16x16x32_bf16 v[44:47], a[160:163], a[24:27], v[44:47]
    v_mfma_f32_16x16x32_bf16 v[44:47], a[164:167], a[28:31], v[44:47]
    s_waitcnt lgkmcnt(5)
    v_mfma_f32_16x16x32_bf16 v[48:51], a[160:163], a[32:35], v[48:51]
    s_add_u32 m0, s38, 0x4000
    s_add_u32 s3, s91, 0x180000
    s_and_b32 s3, s3, 0x3fffff
    buffer_load_dwordx4 v10, s[12:15], s3 offen offset:0 lds
    v_mfma_f32_16x16x32_bf16 v[48:51], a[164:167], a[36:39], v[48:51]
    v_mfma_f32_16x16x32_bf16 v[52:55], a[160:163], a[40:43], v[52:55]
    v_mfma_f32_16x16x32_bf16 v[52:55], a[164:167], a[44:47], v[52:55]
    v_mfma_f32_16x16x32_bf16 v[56:59], a[160:163], a[48:51], v[56:59]
    buffer_load_dwordx4 v11, s[12:15], s3 offen offset:1024 lds
    v_mfma_f32_16x16x32_bf16 v[56:59], a[164:167], a[52:55], v[56:59]
    v_mfma_f32_16x16x32_bf16 v[60:63], a[160:163], a[56:59], v[60:63]
    s_waitcnt lgkmcnt(0)
    v_mfma_f32_16x16x32_bf16 v[60:63], a[164:167], a[60:63], v[60:63]
    v_mfma_f32_16x16x32_bf16 v[64:67], a[168:171], a[0:3], v[64:67]
    ds_read_b64_tr_b16 a[160:161], v24 offset:49152
    ds_read_b64_tr_b16 a[162:163], v24 offset:50176
    v_mfma_f32_16x16x32_bf16 v[64:67], a[172:175], a[4:7], v[64:67]
    ds_read_b64_tr_b16 a[164:165], v24 offset:57344
    ds_read_b64_tr_b16 a[166:167], v24 offset:58368
    v_mfma_f32_16x16x32_bf16 v[68:71], a[168:171], a[8:11], v[68:71]
    v_mfma_f32_16x16x32_bf16 v[68:71], a[172:175], a[12:15], v[68:71]
    v_mfma_f32_16x16x32_bf16 v[72:75], a[168:171], a[16:19], v[72:75]
    buffer_load_dwordx4 v12, s[12:15], s3 offen offset:2048 lds
    v_mfma_f32_16x16x32_bf16 v[72:75], a[172:175], a[20:23], v[72:75]
    v_mfma_f32_16x16x32_bf16 v[76:79], a[168:171], a[24:27], v[76:79]
    v_mfma_f32_16x16x32_bf16 v[76:79], a[172:175], a[28:31], v[76:79]
    v_mfma_f32_16x16x32_bf16 v[80:83], a[168:171], a[32:35], v[80:83]
    v_mfma_f32_16x16x32_bf16 v[80:83], a[172:175], a[36:39], v[80:83]
    v_mfma_f32_16x16x32_bf16 v[84:87], a[168:171], a[40:43], v[84:87]
    v_mfma_f32_16x16x32_bf16 v[84:87], a[172:175], a[44:47], v[84:87]
    buffer_load_dwordx4 v13, s[12:15], s3 offen offset:3072 lds
    v_mfma_f32_16x16x32_bf16 v[88:91], a[168:171], a[48:51], v[88:91]
    v_mfma_f32_16x16x32_bf16 v[88:91], a[172:175], a[52:55], v[88:91]
    v_mfma_f32_16x16x32_bf16 v[92:95], a[168:171], a[56:59], v[92:95]
    v_mfma_f32_16x16x32_bf16 v[92:95], a[172:175], a[60:63], v[92:95]
    v_mfma_f32_16x16x32_bf16 v[96:99], a[176:179], a[0:3], v[96:99]
    ds_read_b64_tr_b16 a[168:169], v25 offset:49152
    ds_read_b64_tr_b16 a[170:171], v25 offset:50176
    v_mfma_f32_16x16x32_bf16 v[96:99], a[180:183], a[4:7], v[96:99]
    ds_read_b64_tr_b16 a[172:173], v25 offset:57344
    ds_read_b64_tr_b16 a[174:175], v25 offset:58368
    v_mfma_f32_16x16x32_bf16 v[100:103], a[176:179], a[8:11], v[100:103]
    v_mfma_f32_16x16x32_bf16 v[100:103], a[180:183], a[12:15], v[100:103]
    v_cvt_pk_bf16_f32 v32, v32, v33
    v_cvt_pk_bf16_f32 v33, v34, v35
    v_mfma_f32_16x16x32_bf16 v[104:107], a[176:179], a[16:19], v[104:107]
    v_cvt_pk_bf16_f32 v34, v64, v65
    v_cvt_pk_bf16_f32 v35, v66, v67
    v_mfma_f32_16x16x32_bf16 v[104:107], a[180:183], a[20:23], v[104:107]
    buffer_store_dwordx4 v[32:35], v2, s[64:67], s68 offen offset:0 sc1
    v_mfma_f32_16x16x32_bf16 v[108:111], a[176:179], a[24:27], v[108:111]
    s_add_u32 m0, s38, 0x10000
    s_add_u32 s3, s91, 0x200000
    s_and_b32 s3, s3, 0x3fffff
    buffer_load_dwordx4 v10, s[12:15], s3 offen offset:0 lds
    v_mfma_f32_16x16x32_bf16 v[108:111], a[180:183], a[28:31], v[108:111]
    v_cvt_pk_bf16_f32 v36, v36, v37
    v_cvt_pk_bf16_f32 v37, v38, v39
    v_mfma_f32_16x16x32_bf16 v[112:115], a[176:179], a[32:35], v[112:115]
    v_cvt_pk_bf16_f32 v38, v68, v69
    v_cvt_pk_bf16_f32 v39, v70, v71
    v_mfma_f32_16x16x32_bf16 v[112:115], a[180:183], a[36:39], v[112:115]
    buffer_store_dwordx4 v[36:39], v3, s[64:67], s68 offen offset:0 sc1
    v_mfma_f32_16x16x32_bf16 v[116:119], a[176:179], a[40:43], v[116:119]
    buffer_load_dwordx4 v11, s[12:15], s3 offen offset:1024 lds
    v_mfma_f32_16x16x32_bf16 v[116:119], a[180:183], a[44:47], v[116:119]
    v_cvt_pk_bf16_f32 v40, v40, v41
    v_cvt_pk_bf16_f32 v41, v42, v43
    v_mfma_f32_16x16x32_bf16 v[120:123], a[176:179], a[48:51], v[120:123]
    v_cvt_pk_bf16_f32 v42, v72, v73
    v_cvt_pk_bf16_f32 v43, v74, v75
    v_mfma_f32_16x16x32_bf16 v[120:123], a[180:183], a[52:55], v[120:123]
    buffer_store_dwordx4 v[40:43], v2, s[64:67], s69 offen offset:0 sc1
    v_mfma_f32_16x16x32_bf16 v[124:127], a[176:179], a[56:59], v[124:127]
    v_cvt_pk_bf16_f32 v44, v44, v45
    v_cvt_pk_bf16_f32 v45, v46, v47
    v_mfma_f32_16x16x32_bf16 v[124:127], a[180:183], a[60:63], v[124:127]
    v_cvt_pk_bf16_f32 v46, v76, v77
    v_cvt_pk_bf16_f32 v47, v78, v79
    v_mfma_f32_16x16x32_bf16 v[128:131], a[184:187], a[0:3], v[128:131]
    buffer_store_dwordx4 v[44:47], v3, s[64:67], s69 offen offset:0 sc1
    v_mfma_f32_16x16x32_bf16 v[128:131], a[188:191], a[4:7], v[128:131]
    buffer_load_dwordx4 v12, s[12:15], s3 offen offset:2048 lds
    v_mfma_f32_16x16x32_bf16 v[132:135], a[184:187], a[8:11], v[132:135]
    v_cvt_pk_bf16_f32 v64, v48, v49
    v_cvt_pk_bf16_f32 v65, v50, v51
    v_mfma_f32_16x16x32_bf16 v[132:135], a[188:191], a[12:15], v[132:135]
    v_cvt_pk_bf16_f32 v66, v80, v81
    v_cvt_pk_bf16_f32 v67, v82, v83
    v_mfma_f32_16x16x32_bf16 v[136:139], a[184:187], a[16:19], v[136:139]
    v_cvt_pk_bf16_f32 v68, v52, v53
    v_cvt_pk_bf16_f32 v69, v54, v55
    v_mfma_f32_16x16x32_bf16 v[136:139], a[188:191], a[20:23], v[136:139]
    v_cvt_pk_bf16_f32 v70, v84, v85
    v_cvt_pk_bf16_f32 v71, v86, v87
    v_mfma_f32_16x16x32_bf16 v[140:143], a[184:187], a[24:27], v[140:143]
    v_cvt_pk_bf16_f32 v72, v56, v57
    v_cvt_pk_bf16_f32 v73, v58, v59
    v_mfma_f32_16x16x32_bf16 v[140:143], a[188:191], a[28:31], v[140:143]
    v_cvt_pk_bf16_f32 v74, v88, v89
    v_cvt_pk_bf16_f32 v75, v90, v91
    v_mfma_f32_16x16x32_bf16 v[144:147], a[184:187], a[32:35], v[144:147]
    v_cvt_pk_bf16_f32 v76, v60, v61
    v_cvt_pk_bf16_f32 v77, v62, v63
    v_mfma_f32_16x16x32_bf16 v[144:147], a[188:191], a[36:39], v[144:147]
    buffer_load_dwordx4 v13, s[12:15], s3 offen offset:3072 lds
    v_mfma_f32_16x16x32_bf16 v[148:151], a[184:187], a[40:43], v[148:151]
    v_cvt_pk_bf16_f32 v78, v92, v93
    v_cvt_pk_bf16_f32 v79, v94, v95
    v_mfma_f32_16x16x32_bf16 v[148:151], a[188:191], a[44:47], v[148:151]
    ds_read_b64_tr_b16 a[176:177], v26 offset:49152
    ds_read_b64_tr_b16 a[178:179], v26 offset:50176
    v_mfma_f32_16x16x32_bf16 v[152:155], a[184:187], a[48:51], v[152:155]
    ds_read_b64_tr_b16 a[180:181], v26 offset:57344
    ds_read_b64_tr_b16 a[182:183], v26 offset:58368
    v_mfma_f32_16x16x32_bf16 v[152:155], a[188:191], a[52:55], v[152:155]
    v_mfma_f32_16x16x32_bf16 v[156:159], a[184:187], a[56:59], v[156:159]
    v_mfma_f32_16x16x32_bf16 v[156:159], a[188:191], a[60:63], v[156:159]
    s_waitcnt lgkmcnt(4)
    v_mfma_f32_16x16x32_bf16 v[160:163], a[0:3], a[160:163], v[160:163]
    ds_read_b64_tr_b16 a[184:185], v27 offset:49152
    ds_read_b64_tr_b16 a[186:187], v27 offset:50176
    v_mfma_f32_16x16x32_bf16 v[160:163], a[4:7], a[164:167], v[160:163]
    ds_read_b64_tr_b16 a[188:189], v27 offset:57344
    ds_read_b64_tr_b16 a[190:191], v27 offset:58368
    v_mfma_f32_16x16x32_bf16 v[164:167], a[8:11], a[160:163], v[164:167]
    v_mfma_f32_16x16x32_bf16 v[164:167], a[12:15], a[164:167], v[164:167]
    s_add_u32 m0, s38, 0x14000
    s_add_u32 s3, s91, 0x280000
    s_and_b32 s3, s3, 0x3fffff
    buffer_load_dwordx4 v10, s[12:15], s3 offen offset:0 lds
    v_mfma_f32_16x16x32_bf16 v[168:171], a[16:19], a[160:163], v[168:171]
    v_cvt_pk_bf16_f32 v48, v96, v97
    v_cvt_pk_bf16_f32 v49, v98, v99
    v_cvt_pk_bf16_f32 v50, v128, v129
    v_mfma_f32_16x16x32_bf16 v[168:171], a[20:23], a[164:167], v[168:171]
    v_cvt_pk_bf16_f32 v51, v130, v131
    buffer_store_dwordx4 v[48:51], v2, s[64:67], s68 offen offset:1024 sc1
    v_mfma_f32_16x16x32_bf16 v[172:175], a[24:27], a[160:163], v[172:175]
    v_cvt_pk_bf16_f32 v52, v100, v101
    v_cvt_pk_bf16_f32 v53, v102, v103
    v_cvt_pk_bf16_f32 v54, v132, v133
    v_mfma_f32_16x16x32_bf16 v[172:175], a[28:31], a[164:167], v[172:175]
    v_cvt_pk_bf16_f32 v55, v134, v135
    buffer_load_dwordx4 v11, s[12:15], s3 offen offset:1024 lds
    v_mfma_f32_16x16x32_bf16 v[176:179], a[32:35], a[160:163], v[176:179]
    buffer_store_dwordx4 v[52:55], v3, s[64:67], s68 offen offset:1024 sc1
    v_cvt_pk_bf16_f32 v56, v104, v105
    v_mfma_f32_16x16x32_bf16 v[176:179], a[36:39], a[164:167], v[176:179]
    v_cvt_pk_bf16_f32 v57, v106, v107
    v_cvt_pk_bf16_f32 v58, v136, v137
    v_cvt_pk_bf16_f32 v59, v138, v139
    v_mfma_f32_16x16x32_bf16 v[180:183], a[40:43], a[160:163], v[180:183]
    buffer_store_dwordx4 v[56:59], v2, s[64:67], s69 offen offset:1024 sc1
    v_cvt_pk_bf16_f32 v60, v108, v109
    v_mfma_f32_16x16x32_bf16 v[180:183], a[44:47], a[164:167], v[180:183]
    v_cvt_pk_bf16_f32 v61, v110, v111
    v_cvt_pk_bf16_f32 v62, v140, v141
    v_cvt_pk_bf16_f32 v63, v142, v143
    v_mfma_f32_16x16x32_bf16 v[184:187], a[48:51], a[160:163], v[184:187]
    buffer_store_dwordx4 v[60:63], v3, s[64:67], s69 offen offset:1024 sc1
    v_cvt_pk_bf16_f32 v80, v112, v113
    v_mfma_f32_16x16x32_bf16 v[184:187], a[52:55], a[164:167], v[184:187]
    v_cvt_pk_bf16_f32 v81, v114, v115
    v_cvt_pk_bf16_f32 v82, v144, v145
    v_mfma_f32_16x16x32_bf16 v[188:191], a[56:59], a[160:163], v[188:191]
    v_cvt_pk_bf16_f32 v83, v146, v147
    v_cvt_pk_bf16_f32 v84, v116, v117
    v_mfma_f32_16x16x32_bf16 v[188:191], a[60:63], a[164:167], v[188:191]
    buffer_load_dwordx4 v12, s[12:15], s3 offen offset:2048 lds
    v_mfma_f32_16x16x32_bf16 v[192:195], a[0:3], a[168:171], v[192:195]
    v_cvt_pk_bf16_f32 v85, v118, v119
    v_cvt_pk_bf16_f32 v86, v148, v149
    v_mfma_f32_16x16x32_bf16 v[192:195], a[4:7], a[172:175], v[192:195]
    v_cvt_pk_bf16_f32 v87, v150, v151
    v_cvt_pk_bf16_f32 v88, v120, v121
    v_mfma_f32_16x16x32_bf16 v[196:199], a[8:11], a[168:171], v[196:199]
    v_cvt_pk_bf16_f32 v89, v122, v123
    v_cvt_pk_bf16_f32 v90, v152, v153
    v_mfma_f32_16x16x32_bf16 v[196:199], a[12:15], a[172:175], v[196:199]
    v_cvt_pk_bf16_f32 v91, v154, v155
    v_cvt_pk_bf16_f32 v92, v124, v125
    v_mfma_f32_16x16x32_bf16 v[200:203], a[16:19], a[168:171], v[200:203]
    v_cvt_pk_bf16_f32 v93, v126, v127
    v_cvt_pk_bf16_f32 v94, v156, v157
    v_mfma_f32_16x16x32_bf16 v[200:203], a[20:23], a[172:175], v[200:203]
    v_cvt_pk_bf16_f32 v95, v158, v159
    v_cvt_pk_bf16_f32 v32, v160, v161
    v_mfma_f32_16x16x32_bf16 v[204:207], a[24:27], a[168:171], v[204:207]
    buffer_load_dwordx4 v13, s[12:15], s3 offen offset:3072 lds
    v_mfma_f32_16x16x32_bf16 v[204:207], a[28:31], a[172:175], v[204:207]
    v_cvt_pk_bf16_f32 v33, v162, v163
    v_cvt_pk_bf16_f32 v34, v164, v165
    v_mfma_f32_16x16x32_bf16 v[208:211], a[32:35], a[168:171], v[208:211]
    v_add_u32 v9, 0x1000, v30
    v_and_b32 v9, 0x3fff, v9
    v_mfma_f32_16x16x32_bf16 v[208:211], a[36:39], a[172:175], v[208:211]
    v_cvt_pk_bf16_f32 v35, v166, v167
    v_cvt_pk_bf16_f32 v36, v168, v169
    v_mfma_f32_16x16x32_bf16 v[212:215], a[40:43], a[168:171], v[212:215]
    v_cvt_pk_bf16_f32 v37, v170, v171
    v_cvt_pk_bf16_f32 v38, v172, v173
    v_mfma_f32_16x16x32_bf16 v[212:215], a[44:47], a[172:175], v[212:215]
    v_cvt_pk_bf16_f32 v39, v174, v175
    v_cvt_pk_bf16_f32 v96, v176, v177
    v_mfma_f32_16x16x32_bf16 v[216:219], a[48:51], a[168:171], v[216:219]
    v_cvt_pk_bf16_f32 v97, v178, v179
    v_cvt_pk_bf16_f32 v98, v180, v181
    v_mfma_f32_16x16x32_bf16 v[216:219], a[52:55], a[172:175], v[216:219]
    v_cvt_pk_bf16_f32 v99, v182, v183
    v_cvt_pk_bf16_f32 v100, v184, v185
    v_mfma_f32_16x16x32_bf16 v[220:223], a[56:59], a[168:171], v[220:223]
    v_cvt_pk_bf16_f32 v101, v186, v187
    v_cvt_pk_bf16_f32 v102, v188, v189
    v_mfma_f32_16x16x32_bf16 v[220:223], a[60:63], a[172:175], v[220:223]
    v_cvt_pk_bf16_f32 v103, v190, v191
    s_xor_b32 s39, s39, 0x20000
    s_waitcnt lgkmcnt(0)
    v_mfma_f32_16x16x32_bf16 v[224:227], a[0:3], a[176:179], v[224:227]
    v_xor_b32 v24, s39, v24
    v_xor_b32 v25, 32, v24
    v_mfma_f32_16x16x32_bf16 v[224:227], a[4:7], a[180:183], v[224:227]
    v_xor_b32 v26, 64, v24
    v_xor_b32 v27, 96, v24
    v_mfma_f32_16x16x32_bf16 v[228:231], a[8:11], a[176:179], v[228:231]
    v_xor_b32 v28, 128, v24
    v_xor_b32 v29, 160, v24
    v_mfma_f32_16x16x32_bf16 v[228:231], a[12:15], a[180:183], v[228:231]
    v_xor_b32 v30, 192, v24
    v_xor_b32 v31, 224, v24
    s_waitcnt vmcnt(63) lgkmcnt(0)
    s_barrier
    v_mfma_f32_16x16x32_bf16 v[232:235], a[16:19], a[176:179], v[232:235]
    ds_read_b64_tr_b16 a[64:65], v24 offset:0
    ds_read_b64_tr_b16 a[66:67], v24 offset:1024
    v_mfma_f32_16x16x32_bf16 v[232:235], a[20:23], a[180:183], v[232:235]
    ds_read_b64_tr_b16 a[68:69], v24 offset:8192
    ds_read_b64_tr_b16 a[70:71], v24 offset:9216
    v_mfma_f32_16x16x32_bf16 v[236:239], a[24:27], a[176:179], v[236:239]
    ds_read_b64_tr_b16 a[72:73], v25 offset:0
    ds_read_b64_tr_b16 a[74:75], v25 offset:1024
    v_mfma_f32_16x16x32_bf16 v[236:239], a[28:31], a[180:183], v[236:239]
    ds_read_b64_tr_b16 a[76:77], v25 offset:8192
    ds_read_b64_tr_b16 a[78:79], v25 offset:9216
    v_mfma_f32_16x16x32_bf16 v[240:243], a[32:35], a[176:179], v[240:243]
    ds_read_b64_tr_b16 a[80:81], v26 offset:0
    ds_read_b64_tr_b16 a[82:83], v26 offset:1024
    v_mfma_f32_16x16x32_bf16 v[240:243], a[36:39], a[180:183], v[240:243]
    ds_read_b64_tr_b16 a[84:85], v26 offset:8192
    ds_read_b64_tr_b16 a[86:87], v26 offset:9216
    v_mfma_f32_16x16x32_bf16 v[244:247], a[40:43], a[176:179], v[244:247]
    ds_read_b64_tr_b16 a[88:89], v27 offset:0
    ds_read_b64_tr_b16 a[90:91], v27 offset:1024
    v_mfma_f32_16x16x32_bf16 v[244:247], a[44:47], a[180:183], v[244:247]
    ds_read_b64_tr_b16 a[92:93], v27 offset:8192
    ds_read_b64_tr_b16 a[94:95], v27 offset:9216
    v_mfma_f32_16x16x32_bf16 v[248:251], a[48:51], a[176:179], v[248:251]
    ds_read_b64_tr_b16 a[96:97], v28 offset:0
    ds_read_b64_tr_b16 a[98:99], v28 offset:1024
    v_mfma_f32_16x16x32_bf16 v[248:251], a[52:55], a[180:183], v[248:251]
    ds_read_b64_tr_b16 a[100:101], v28 offset:8192
    ds_read_b64_tr_b16 a[102:103], v28 offset:9216
    v_mfma_f32_16x16x32_bf16 v[252:255], a[56:59], a[176:179], v[252:255]
    ds_read_b64_tr_b16 a[104:105], v29 offset:0
    ds_read_b64_tr_b16 a[106:107], v29 offset:1024
    v_mfma_f32_16x16x32_bf16 v[252:255], a[60:63], a[180:183], v[252:255]
    ds_read_b64_tr_b16 a[108:109], v29 offset:8192
    ds_read_b64_tr_b16 a[110:111], v29 offset:9216
    v_mfma_f32_16x16x32_bf16 a[128:131], a[0:3], a[184:187], a[128:131]
    ds_read_b64_tr_b16 a[112:113], v30 offset:0
    ds_read_b64_tr_b16 a[114:115], v30 offset:1024
    v_mfma_f32_16x16x32_bf16 a[128:131], a[4:7], a[188:191], a[128:131]
    ds_read_b64_tr_b16 a[116:117], v30 offset:8192
    ds_read_b64_tr_b16 a[118:119], v30 offset:9216
    v_mfma_f32_16x16x32_bf16 a[132:135], a[8:11], a[184:187], a[132:135]
    ds_read_b64_tr_b16 a[120:121], v31 offset:0
    ds_read_b64_tr_b16 a[122:123], v31 offset:1024
    v_mfma_f32_16x16x32_bf16 a[132:135], a[12:15], a[188:191], a[132:135]
    ds_read_b64_tr_b16 a[124:125], v31 offset:8192
    ds_read_b64_tr_b16 a[126:127], v31 offset:9216
    v_mfma_f32_16x16x32_bf16 a[136:139], a[16:19], a[184:187], a[136:139]
    v_cvt_pk_bf16_f32 v40, v192, v193
    v_cvt_pk_bf16_f32 v41, v194, v195
    v_mfma_f32_16x16x32_bf16 a[136:139], a[20:23], a[188:191], a[136:139]
    v_cvt_pk_bf16_f32 v42, v196, v197
    v_cvt_pk_bf16_f32 v43, v198, v199
    v_mfma_f32_16x16x32_bf16 a[140:143], a[24:27], a[184:187], a[140:143]
    v_cvt_pk_bf16_f32 v44, v200, v201
    v_cvt_pk_bf16_f32 v45, v202, v203
    v_mfma_f32_16x16x32_bf16 a[140:143], a[28:31], a[188:191], a[140:143]
    v_cvt_pk_bf16_f32 v46, v204, v205
    v_cvt_pk_bf16_f32 v47, v206, v207
    v_mfma_f32_16x16x32_bf16 a[144:147], a[32:35], a[184:187], a[144:147]
    v_cvt_pk_bf16_f32 v104, v208, v209
    v_cvt_pk_bf16_f32 v105, v210, v211
    v_mfma_f32_16x16x32_bf16 a[144:147], a[36:39], a[188:191], a[144:147]
    v_cvt_pk_bf16_f32 v106, v212, v213
    v_cvt_pk_bf16_f32 v107, v214, v215
    v_mfma_f32_16x16x32_bf16 a[148:151], a[40:43], a[184:187], a[148:151]
    v_cvt_pk_bf16_f32 v108, v216, v217
    v_cvt_pk_bf16_f32 v109, v218, v219
    v_mfma_f32_16x16x32_bf16 a[148:151], a[44:47], a[188:191], a[148:151]
    v_cvt_pk_bf16_f32 v110, v220, v221
    v_cvt_pk_bf16_f32 v111, v222, v223
    v_mfma_f32_16x16x32_bf16 a[152:155], a[48:51], a[184:187], a[152:155]
    v_cvt_pk_bf16_f32 v48, v224, v225
    v_cvt_pk_bf16_f32 v49, v226, v227
    v_mfma_f32_16x16x32_bf16 a[152:155], a[52:55], a[188:191], a[152:155]
    v_cvt_pk_bf16_f32 v50, v228, v229
    v_cvt_pk_bf16_f32 v51, v230, v231
    v_mfma_f32_16x16x32_bf16 a[156:159], a[56:59], a[184:187], a[156:159]
    v_cvt_pk_bf16_f32 v52, v232, v233
    v_cvt_pk_bf16_f32 v53, v234, v235
    v_mfma_f32_16x16x32_bf16 a[156:159], a[60:63], a[188:191], a[156:159]
    v_cvt_pk_bf16_f32 v54, v236, v237
    v_cvt_pk_bf16_f32 v55, v238, v239
    s_mov_b32 s68, 0x100000
L_q:
    s_waitcnt lgkmcnt(0)
    v_mfma_f32_16x16x32_bf16 v[128:131], a[64:67], a[192:195], 0
    buffer_load_dwordx4 a[0:3], v9, s[16:19], s40 offen offset:0 sc1
    v_mfma_f32_16x16x32_bf16 v[128:131], a[68:71], a[196:199], v[128:131]
    buffer_store_dwordx4 v[32:35], v4, s[64:67], s72 offen offset:0 sc1
    v_mfma_f32_16x16x32_bf16 v[132:135], a[72:75], a[192:195], 0
    v_cvt_pk_bf16_f32 v112, v240, v241
    v_cvt_pk_bf16_f32 v113, v242, v243
    v_mfma_f32_16x16x32_bf16 v[132:135], a[76:79], a[196:199], v[132:135]
    v_cvt_pk_bf16_f32 v114, v244, v245
    v_cvt_pk_bf16_f32 v115, v246, v247
    v_mfma_f32_16x16x32_bf16 v[136:139], a[80:83], a[192:195], 0
    v_cvt_pk_bf16_f32 v116, v248, v249
    v_cvt_pk_bf16_f32 v117, v250, v251
    v_mfma_f32_16x16x32_bf16 v[136:139], a[84:87], a[196:199], v[136:139]
    v_cvt_pk_bf16_f32 v118, v252, v253
    v_cvt_pk_bf16_f32 v119, v254, v255
    v_mfma_f32_16x16x32_bf16 v[140:143], a[88:91], a[192:195], 0
    v_accvgpr_read_b32 v16, a128
    v_accvgpr_read_b32 v17, a129
    v_mfma_f32_16x16x32_bf16 v[140:143], a[92:95], a[196:199], v[140:143]
    v_accvgpr_read_b32 v18, a130
    v_accvgpr_read_b32 v19, a131
    v_mfma_f32_16x16x32_bf16 v[144:147], a[96:99], a[192:195], 0
    buffer_load_dwordx4 a[4:7], v9, s[16:19], s40 offen offset:1024 sc1
    v_mfma_f32_16x16x32_bf16 v[144:147], a[100:103], a[196:199], v[144:147]
    buffer_store_dwordx4 v[36:39], v4, s[64:67], s72 offen offset:1024 sc1
    v_mfma_f32_16x16x32_bf16 v[148:151], a[104:107], a[192:195], 0
    v_accvgpr_read_b32 v20, a132
    v_accvgpr_read_b32 v21, a133
    v_mfma_f32_16x16x32_bf16 v[148:151], a[108:111], a[196:199], v[148:151]
    v_accvgpr_read_b32 v22, a134
    v_accvgpr_read_b32 v23, a135
    v_mfma_f32_16x16x32_bf16 v[152:155], a[112:115], a[192:195], 0
    v_cvt_pk_bf16_f32 v56, v16, v17
    v_cvt_pk_bf16_f32 v57, v18, v19
    v_mfma_f32_16x16x32_bf16 v[152:155], a[116:119], a[196:199], v[152:155]
    v_cvt_pk_bf16_f32 v58, v20, v21
    v_cvt_pk_bf16_f32 v59, v22, v23
    v_mfma_f32_16x16x32_bf16 v[156:159], a[120:123], a[192:195], 0
    v_accvgpr_read_b32 v16, a136
    v_accvgpr_read_b32 v17, a137
    v_mfma_f32_16x16x32_bf16 v[156:159], a[124:127], a[196:199], v[156:159]
    v_accvgpr_read_b32 v18, a138
    v_accvgpr_read_b32 v19, a139
    v_mfma_f32_16x16x32_bf16 v[160:163], a[64:67], a[200:203], 0
    buffer_load_dwordx4 a[8:11], v9, s[16:19], s41 offen offset:0 sc1
    v_mfma_f32_16x16x32_bf16 v[160:163], a[68:71], a[204:207], v[160:163]
    v_accvgpr_read_b32 v20, a140
    v_accvgpr_read_b32 v21, a141
    v_mfma_f32_16x16x32_bf16 v[164:167], a[72:75], a[200:203], 0
    buffer_store_dwordx4 v[40:43], v4, s[64:67], s72 offen offset:2048 sc1
    v_mfma_f32_16x16x32_bf16 v[164:167], a[76:79], a[204:207], v[164:167]
    v_accvgpr_read_b32 v22, a142
    v_accvgpr_read_b32 v23, a143
    v_mfma_f32_16x16x32_bf16 v[168:171], a[80:83], a[200:203], 0
    v_cvt_pk_bf16_f32 v60, v16, v17
    v_cvt_pk_bf16_f32 v61, v18, v19
    v_mfma_f32_16x16x32_bf16 v[168:171], a[84:87], a[204:207], v[168:171]
    v_cvt_pk_bf16_f32 v62, v20, v21
    v_cvt_pk_bf16_f32 v63, v22, v23
    v_mfma_f32_16x16x32_bf16 v[172:175], a[88:91], a[200:203], 0
    v_accvgpr_read_b32 v16, a144
    v_accvgpr_read_b32 v17, a145
    v_mfma_f32_16x16x32_bf16 v[172:175], a[92:95], a[204:207], v[172:175]
    v_accvgpr_read_b32 v18, a146
    v_accvgpr_read_b32 v19, a147
    v_mfma_f32_16x16x32_bf16 v[176:179], a[96:99], a[200:203], 0
    buffer_load_dwordx4 a[12:15], v9, s[16:19], s41 offen offset:1024 sc1
    v_mfma_f32_16x16x32_bf16 v[176:179], a[100:103], a[204:207], v[176:179]
    v_accvgpr_read_b32 v20, a148
    v_accvgpr_read_b32 v21, a149
    v_mfma_f32_16x16x32_bf16 v[180:183], a[104:107], a[200:203], 0
    v_accvgpr_read_b32 v22, a150
    v_accvgpr_read_b32 v23, a151
    v_mfma_f32_16x16x32_bf16 v[180:183], a[108:111], a[204:207], v[180:183]
    buffer_store_dwordx4 v[44:47], v4, s[64:67], s72 offen offset:3072 sc1
    v_mfma_f32_16x16x32_bf16 v[184:187], a[112:115], a[200:203], 0
    v_cvt_pk_bf16_f32 v120, v16, v17
    v_cvt_pk_bf16_f32 v121, v18, v19
    v_mfma_f32_16x16x32_bf16 v[184:187], a[116:119], a[204:207], v[184:187]
    v_cvt_pk_bf16_f32 v122, v20, v21
    v_cvt_pk_bf16_f32 v123, v22, v23
    v_mfma_f32_16x16x32_bf16 v[188:191], a[120:123], a[200:203], 0
    v_accvgpr_read_b32 v16, a152
    v_accvgpr_read_b32 v17, a153
    v_mfma_f32_16x16x32_bf16 v[188:191], a[124:127], a[204:207], v[188:191]
    v_accvgpr_read_b32 v18, a154
    v_accvgpr_read_b32 v19, a155
    v_mfma_f32_16x16x32_bf16 v[192:195], a[64:67], a[208:211], 0
    v_accvgpr_read_b32 v20, a156
    v_accvgpr_read_b32 v21, a157
    v_mfma_f32_16x16x32_bf16 v[192:195], a[68:71], a[212:215], v[192:195]
    v_accvgpr_read_b32 v22, a158
    v_accvgpr_read_b32 v23, a159
    v_mfma_f32_16x16x32_bf16 v[196:199], a[72:75], a[208:211], 0
    v_cvt_pk_bf16_f32 v124, v16, v17
    v_cvt_pk_bf16_f32 v125, v18, v19
    v_cvt_pk_bf16_f32 v126, v20, v21
    v_cvt_pk_bf16_f32 v127, v22, v23
    v_mfma_f32_16x16x32_bf16 v[196:199], a[76:79], a[212:215], v[196:199]
    buffer_load_dwordx4 a[16:19], v9, s[16:19], s42 offen offset:0 sc1
    v_mfma_f32_16x16x32_bf16 v[200:203], a[80:83], a[208:211], 0
    buffer_store_dwordx4 v[48:51], v5, s[64:67], s72 offen offset:0 sc1
    v_mfma_f32_16x16x32_bf16 v[200:203], a[84:87], a[212:215], v[200:203]
    ds_read_b64_tr_b16 a[160:161], v28 offset:16384
    ds_read_b64_tr_b16 a[162:163], v28 offset:17408
    v_mfma_f32_16x16x32_bf16 v[204:207], a[88:91], a[208:211], 0
    ds_read_b64_tr_b16 a[164:165], v28 offset:24576
    ds_read_b64_tr_b16 a[166:167], v28 offset:25600
    v_mfma_f32_16x16x32_bf16 v[204:207], a[92:95], a[212:215], v[204:207]
    ds_read_b64_tr_b16 a[168:169], v29 offset:16384
    ds_read_b64_tr_b16 a[170:171], v29 offset:17408
    v_mfma_f32_16x16x32_bf16 v[208:211], a[96:99], a[208:211], 0
    ds_read_b64_tr_b16 a[172:173], v29 offset:24576
    ds_read_b64_tr_b16 a[174:175], v29 offset:25600
    v_mfma_f32_16x16x32_bf16 v[208:211], a[100:103], a[212:215], v[208:211]
    buffer_load_dwordx4 a[20:23], v9, s[16:19], s42 offen offset:1024 sc1
    v_mfma_f32_16x16x32_bf16 v[212:215], a[104:107], a[208:211], 0
    buffer_store_dwordx4 v[52:55], v5, s[64:67], s72 offen offset:1024 sc1
    v_mfma_f32_16x16x32_bf16 v[212:215], a[108:111], a[212:215], v[212:215]
    ds_read_b64_tr_b16 a[176:177], v30 offset:16384
    ds_read_b64_tr_b16 a[178:179], v30 offset:17408
    v_mfma_f32_16x16x32_bf16 v[216:219], a[112:115], a[208:211], 0
    ds_read_b64_tr_b16 a[180:181], v30 offset:24576
    ds_read_b64_tr_b16 a[182:183], v30 offset:25600
    v_mfma_f32_16x16x32_bf16 v[216:219], a[116:119], a[212:215], v[216:219]
    ds_read_b64_tr_b16 a[184:185], v31 offset:16384
    ds_read_b64_tr_b16 a[186:187], v31 offset:17408
    v_mfma_f32_16x16x32_bf16 v[220:223], a[120:123], a[208:211], 0
    ds_read_b64_tr_b16 a[188:189], v31 offset:24576
    ds_read_b64_tr_b16 a[190:191], v31 offset:25600
    v_mfma_f32_16x16x32_bf16 v[220:223], a[124:127], a[212:215], v[220:223]
    ds_read_b64_tr_b16 a[128:129], v24 offset:16384
    ds_read_b64_tr_b16 a[130:131], v24 offset:17408
    v_mfma_f32_16x16x32_bf16 v[224:227], a[64:67], a[216:219], 0
    buffer_store_dwordx4 v[56:59], v5, s[64:67], s72 offen offset:2048 sc1
    v_mfma_f32_16x16x32_bf16 v[224:227], a[68:71], a[220:223], v[224:227]
    buffer_load_dwordx4 a[24:27], v9, s[16:19], s43 offen offset:0 sc1
    v_mfma_f32_16x16x32_bf16 v[228:231], a[72:75], a[216:219], 0
    ds_read_b64_tr_b16 a[132:133], v24 offset:24576
    ds_read_b64_tr_b16 a[134:135], v24 offset:25600
    v_mfma_f32_16x16x32_bf16 v[228:231], a[76:79], a[220:223], v[228:231]
    ds_read_b64_tr_b16 a[136:137], v25 offset:16384
    ds_read_b64_tr_b16 a[138:139], v25 offset:17408
    v_mfma_f32_16x16x32_bf16 v[232:235], a[80:83], a[216:219], 0
    ds_read_b64_tr_b16 a[140:141], v25 offset:24576
    ds_read_b64_tr_b16 a[142:143], v25 offset:25600
    v_mfma_f32_16x16x32_bf16 v[232:235], a[84:87], a[220:223], v[232:235]
    ds_read_b64_tr_b16 a[144:145], v26 offset:16384
    ds_read_b64_tr_b16 a[146:147], v26 offset:17408
    v_mfma_f32_16x16x32_bf16 v[236:239], a[88:91], a[216:219], 0
    buffer_store_dwordx4 v[60:63], v5, s[64:67], s72 offen offset:3072 sc1
    v_mfma_f32_16x16x32_bf16 v[236:239], a[92:95], a[220:223], v[236:239]
    ds_read_b64_tr_b16 a[148:149], v26 offset:24576
    ds_read_b64_tr_b16 a[150:151], v26 offset:25600
    v_mfma_f32_16x16x32_bf16 v[240:243], a[96:99], a[216:219], 0
    ds_read_b64_tr_b16 a[152:153], v27 offset:16384
    ds_read_b64_tr_b16 a[154:155], v27 offset:17408
    v_mfma_f32_16x16x32_bf16 v[240:243], a[100:103], a[220:223], v[240:243]
    buffer_load_dwordx4 a[28:31], v9, s[16:19], s43 offen offset:1024 sc1
    v_mfma_f32_16x16x32_bf16 v[244:247], a[104:107], a[216:219], 0
    ds_read_b64_tr_b16 a[156:157], v27 offset:24576
    ds_read_b64_tr_b16 a[158:159], v27 offset:25600
    v_mfma_f32_16x16x32_bf16 v[244:247], a[108:111], a[220:223], v[244:247]
    v_mfma_f32_16x16x32_bf16 v[248:251], a[112:115], a[216:219], 0
    v_mfma_f32_16x16x32_bf16 v[248:251], a[116:119], a[220:223], v[248:251]
    v_mfma_f32_16x16x32_bf16 v[252:255], a[120:123], a[216:219], 0
    v_mfma_f32_16x16x32_bf16 v[252:255], a[124:127], a[220:223], v[252:255]
    s_waitcnt vmcnt(32) lgkmcnt(0)
    s_barrier
    v_mfma_f32_16x16x32_bf16 v[128:131], a[128:131], a[224:227], v[128:131]
    v_xor_b32 v24, 0x20000, v24
    ds_read_b64_tr_b16 a[64:65], v24 offset:0
    v_mfma_f32_16x16x32_bf16 v[128:131], a[132:135], a[228:231], v[128:131]
    ds_read_b64_tr_b16 a[66:67], v24 offset:1024
    ds_read_b64_tr_b16 a[68:69], v24 offset:8192
    v_mfma_f32_16x16x32_bf16 v[132:135], a[136:139], a[224:227], v[132:135]
    buffer_load_dwordx4 a[32:35], v9, s[16:19], s40 offen offset:2048 sc1
    v_mfma_f32_16x16x32_bf16 v[132:135], a[140:143], a[228:231], v[132:135]
    ds_read_b64_tr_b16 a[70:71], v24 offset:9216
    v_mfma_f32_16x16x32_bf16 v[136:139], a[144:147], a[224:227], v[136:139]
    v_mfma_f32_16x16x32_bf16 v[136:139], a[148:151], a[228:231], v[136:139]
    v_mfma_f32_16x16x32_bf16 v[140:143], a[152:155], a[224:227], v[140:143]
    v_xor_b32 v25, 0x20000, v25
    ds_read_b64_tr_b16 a[72:73], v25 offset:0
    v_mfma_f32_16x16x32_bf16 v[140:143], a[156:159], a[228:231], v[140:143]
    ds_read_b64_tr_b16 a[74:75], v25 offset:1024
    ds_read_b64_tr_b16 a[76:77], v25 offset:8192
    v_mfma_f32_16x16x32_bf16 v[144:147], a[160:163], a[224:227], v[144:147]
    ds_read_b64_tr_b16 a[78:79], v25 offset:9216
    v_mfma_f32_16x16x32_bf16 v[144:147], a[164:167], a[228:231], v[144:147]
    buffer_load_dwordx4 a[36:39], v9, s[16:19], s40 offen offset:3072 sc1
    v_mfma_f32_16x16x32_bf16 v[148:151], a[168:171], a[224:227], v[148:151]
    v_mfma_f32_16x16x32_bf16 v[148:151], a[172:175], a[228:231], v[148:151]
    v_mfma_f32_16x16x32_bf16 v[152:155], a[176:179], a[224:227], v[152:155]
    v_xor_b32 v26, 0x20000, v26
    ds_read_b64_tr_b16 a[80:81], v26 offset:0
    v_mfma_f32_16x16x32_bf16 v[152:155], a[180:183], a[228:231], v[152:155]
    ds_read_b64_tr_b16 a[82:83], v26 offset:1024
    ds_read_b64_tr_b16 a[84:85], v26 offset:8192
    v_mfma_f32_16x16x32_bf16 v[156:159], a[184:187], a[224:227], v[156:159]
    ds_read_b64_tr_b16 a[86:87], v26 offset:9216
    v_mfma_f32_16x16x32_bf16 v[156:159], a[188:191], a[228:231], v[156:159]
    v_mfma_f32_16x16x32_bf16 v[160:163], a[128:131], a[232:235], v[160:163]
    v_mfma_f32_16x16x32_bf16 v[160:163], a[132:135], a[236:239], v[160:163]
    buffer_load_dwordx4 a[40:43], v9, s[16:19], s41 offen offset:2048 sc1
    v_mfma_f32_16x16x32_bf16 v[164:167], a[136:139], a[232:235], v[164:167]
    v_xor_b32 v27, 0x20000, v27
    ds_read_b64_tr_b16 a[88:89], v27 offset:0
    v_mfma_f32_16x16x32_bf16 v[164:167], a[140:143], a[236:239], v[164:167]
    ds_read_b64_tr_b16 a[90:91], v27 offset:1024
    ds_read_b64_tr_b16 a[92:93], v27 offset:8192
    v_mfma_f32_16x16x32_bf16 v[168:171], a[144:147], a[232:235], v[168:171]
    ds_read_b64_tr_b16 a[94:95], v27 offset:9216
    v_mfma_f32_16x16x32_bf16 v[168:171], a[148:151], a[236:239], v[168:171]
    v_mfma_f32_16x16x32_bf16 v[172:175], a[152:155], a[232:235], v[172:175]
    v_mfma_f32_16x16x32_bf16 v[172:175], a[156:159], a[236:239], v[172:175]
    v_mfma_f32_16x16x32_bf16 v[176:179], a[160:163], a[232:235], v[176:179]
    v_xor_b32 v28, 0x20000, v28
    ds_read_b64_tr_b16 a[96:97], v28 offset:0
    v_mfma_f32_16x16x32_bf16 v[176:179], a[164:167], a[236:239], v[176:179]
    buffer_load_dwordx4 a[44:47], v9, s[16:19], s41 offen offset:3072 sc1
    v_mfma_f32_16x16x32_bf16 v[180:183], a[168:171], a[232:235], v[180:183]
    ds_read_b64_tr_b16 a[98:99], v28 offset:1024
    ds_read_b64_tr_b16 a[100:101], v28 offset:8192
    v_mfma_f32_16x16x32_bf16 v[180:183], a[172:175], a[236:239], v[180:183]
    ds_read_b64_tr_b16 a[102:103], v28 offset:9216
    v_mfma_f32_16x16x32_bf16 v[184:187], a[176:179], a[232:235], v[184:187]
    v_mfma_f32_16x16x32_bf16 v[184:187], a[180:183], a[236:239], v[184:187]
    v_mfma_f32_16x16x32_bf16 v[188:191], a[184:187], a[232:235], v[188:191]
    v_xor_b32 v29, 0x20000, v29
    ds_read_b64_tr_b16 a[104:105], v29 offset:0
    v_mfma_f32_16x16x32_bf16 v[188:191], a[188:191], a[236:239], v[188:191]
    ds_read_b64_tr_b16 a[106:107], v29 offset:1024
    ds_read_b64_tr_b16 a[108:109], v29 offset:8192
    v_mfma_f32_16x16x32_bf16 v[192:195], a[128:131], a[240:243], v[192:195]
    s_cmp_le_u32 s34, 1
    s_cselect_b32 s66, s68, 0
    buffer_store_dwordx4 v[64:67], v2, s[64:67], s70 offen offset:0 sc1
    v_mfma_f32_16x16x32_bf16 v[192:195], a[132:135], a[244:247], v[192:195]
    buffer_load_dwordx4 a[48:51], v9, s[16:19], s42 offen offset:2048 sc1
    v_mfma_f32_16x16x32_bf16 v[196:199], a[136:139], a[240:243], v[196:199]
    ds_read_b64_tr_b16 a[110:111], v29 offset:9216
    v_mfma_f32_16x16x32_bf16 v[196:199], a[140:143], a[244:247], v[196:199]
    v_mfma_f32_16x16x32_bf16 v[200:203], a[144:147], a[240:243], v[200:203]
    v_xor_b32 v30, 0x20000, v30
    ds_read_b64_tr_b16 a[112:113], v30 offset:0
    v_mfma_f32_16x16x32_bf16 v[200:203], a[148:151], a[244:247], v[200:203]
    ds_read_b64_tr_b16 a[114:115], v30 offset:1024
    ds_read_b64_tr_b16 a[116:117], v30 offset:8192
    v_mfma_f32_16x16x32_bf16 v[204:207], a[152:155], a[240:243], v[204:207]
    ds_read_b64_tr_b16 a[118:119], v30 offset:9216
    v_mfma_f32_16x16x32_bf16 v[204:207], a[156:159], a[244:247], v[204:207]
    v_mfma_f32_16x16x32_bf16 v[208:211], a[160:163], a[240:243], v[208:211]
    buffer_load_dwordx4 a[52:55], v9, s[16:19], s42 offen offset:3072 sc1
    v_mfma_f32_16x16x32_bf16 v[208:211], a[164:167], a[244:247], v[208:211]
    v_mfma_f32_16x16x32_bf16 v[212:215], a[168:171], a[240:243], v[212:215]
    v_xor_b32 v31, 0x20000, v31
    ds_read_b64_tr_b16 a[120:121], v31 offset:0
    v_mfma_f32_16x16x32_bf16 v[212:215], a[172:175], a[244:247], v[212:215]
    ds_read_b64_tr_b16 a[122:123], v31 offset:1024
    ds_read_b64_tr_b16 a[124:125], v31 offset:8192
    v_mfma_f32_16x16x32_bf16 v[216:219], a[176:179], a[240:243], v[216:219]
    ds_read_b64_tr_b16 a[126:127], v31 offset:9216
    v_mfma_f32_16x16x32_bf16 v[216:219], a[180:183], a[244:247], v[216:219]
    v_mfma_f32_16x16x32_bf16 v[220:223], a[184:187], a[240:243], v[220:223]
    v_mfma_f32_16x16x32_bf16 v[220:223], a[188:191], a[244:247], v[220:223]
    v_mfma_f32_16x16x32_bf16 v[224:227], a[128:131], a[248:251], v[224:227]
    buffer_load_dwordx4 a[56:59], v9, s[16:19], s43 offen offset:2048 sc1
    v_mfma_f32_16x16x32_bf16 v[224:227], a[132:135], a[252:255], v[224:227]
    v_mfma_f32_16x16x32_bf16 v[228:231], a[136:139], a[248:251], v[228:231]
    v_mfma_f32_16x16x32_bf16 v[228:231], a[140:143], a[252:255], v[228:231]
    v_mfma_f32_16x16x32_bf16 v[232:235], a[144:147], a[248:251], v[232:235]
    buffer_store_dwordx4 v[68:71], v3, s[64:67], s70 offen offset:0 sc1
    v_mfma_f32_16x16x32_bf16 v[232:235], a[148:151], a[252:255], v[232:235]
    v_mfma_f32_16x16x32_bf16 v[236:239], a[152:155], a[248:251], v[236:239]
    v_mfma_f32_16x16x32_bf16 v[236:239], a[156:159], a[252:255], v[236:239]
    v_mfma_f32_16x16x32_bf16 v[240:243], a[160:163], a[248:251], v[240:243]
    buffer_load_dwordx4 a[60:63], v9, s[16:19], s43 offen offset:3072 sc1
    v_mfma_f32_16x16x32_bf16 v[240:243], a[164:167], a[252:255], v[240:243]
    v_mfma_f32_16x16x32_bf16 v[244:247], a[168:171], a[248:251], v[244:247]
    v_mfma_f32_16x16x32_bf16 v[244:247], a[172:175], a[252:255], v[244:247]
    v_mfma_f32_16x16x32_bf16 v[248:251], a[176:179], a[248:251], v[248:251]
    v_mfma_f32_16x16x32_bf16 v[248:251], a[180:183], a[252:255], v[248:251]
    v_mfma_f32_16x16x32_bf16 v[252:255], a[184:187], a[248:251], v[252:255]
    v_mfma_f32_16x16x32_bf16 v[252:255], a[188:191], a[252:255], v[252:255]
    v_add_u32 v9, 0x1000, v9
    v_and_b32 v9, 0x3fff, v9
    s_waitcnt vmcnt(25) lgkmcnt(0)
    v_mfma_f32_16x16x32_bf16 v[128:131], a[64:67], a[0:3], v[128:131]
    buffer_load_dwordx4 a[192:195], v9, s[16:19], s40 offen offset:0 sc1
    s_waitcnt vmcnt(24)
    v_mfma_f32_16x16x32_bf16 v[128:131], a[68:71], a[4:7], v[128:131]
    ds_read_b64_tr_b16 a[128:129], v24 offset:16384
    ds_read_b64_tr_b16 a[130:131], v24 offset:17408
    v_mfma_f32_16x16x32_bf16 v[132:135], a[72:75], a[0:3], v[132:135]
    ds_read_b64_tr_b16 a[132:133], v24 offset:24576
    ds_read_b64_tr_b16 a[134:135], v24 offset:25600
    v_mfma_f32_16x16x32_bf16 v[132:135], a[76:79], a[4:7], v[132:135]
    v_mfma_f32_16x16x32_bf16 v[136:139], a[80:83], a[0:3], v[136:139]
    v_mfma_f32_16x16x32_bf16 v[136:139], a[84:87], a[4:7], v[136:139]
    v_mfma_f32_16x16x32_bf16 v[140:143], a[88:91], a[0:3], v[140:143]
    ds_read_b64_tr_b16 a[136:137], v25 offset:16384
    ds_read_b64_tr_b16 a[138:139], v25 offset:17408
    v_mfma_f32_16x16x32_bf16 v[140:143], a[92:95], a[4:7], v[140:143]
    ds_read_b64_tr_b16 a[140:141], v25 offset:24576
    ds_read_b64_tr_b16 a[142:143], v25 offset:25600
    v_mfma_f32_16x16x32_bf16 v[144:147], a[96:99], a[0:3], v[144:147]
    buffer_store_dwordx4 v[72:75], v2, s[64:67], s71 offen offset:0 sc1
    v_mfma_f32_16x16x32_bf16 v[144:147], a[100:103], a[4:7], v[144:147]
    buffer_load_dwordx4 a[196:199], v9, s[16:19], s40 offen offset:1024 sc1
    v_mfma_f32_16x16x32_bf16 v[148:151], a[104:107], a[0:3], v[148:151]
    v_mfma_f32_16x16x32_bf16 v[148:151], a[108:111], a[4:7], v[148:151]
    s_add_u32 m0, s38, 0x18000
    s_add_u32 s3, s91, 0x300000
    s_and_b32 s3, s3, 0x3fffff
    buffer_load_dwordx4 v10, s[12:15], s3 offen offset:0 lds
    s_waitcnt vmcnt(15)
    s_barrier
    v_mfma_f32_16x16x32_bf16 v[152:155], a[112:115], a[0:3], v[152:155]
    v_mov_b32 v32, s80
    v_mov_b32 v33, s81
    v_mfma_f32_16x16x32_bf16 v[152:155], a[116:119], a[4:7], v[152:155]
    buffer_store_dwordx2 v[32:33], v0, s[20:23], s78 offen sc1
    s_add_u32 s78, s78, 64
    v_mfma_f32_16x16x32_bf16 v[156:159], a[120:123], a[0:3], v[156:159]
    ds_read_b64_tr_b16 a[144:145], v26 offset:16384
    ds_read_b64_tr_b16 a[146:147], v26 offset:17408
    v_mfma_f32_16x16x32_bf16 v[156:159], a[124:127], a[4:7], v[156:159]
    ds_read_b64_tr_b16 a[148:149], v26 offset:24576
    ds_read_b64_tr_b16 a[150:151], v26 offset:25600
    v_mfma_f32_16x16x32_bf16 v[160:163], a[64:67], a[8:11], v[160:163]
    buffer_load_dwordx4 a[200:203], v9, s[16:19], s41 offen offset:0 sc1
    v_mfma_f32_16x16x32_bf16 v[160:163], a[68:71], a[12:15], v[160:163]
    v_mfma_f32_16x16x32_bf16 v[164:167], a[72:75], a[8:11], v[164:167]
    ds_read_b64_tr_b16 a[152:153], v27 offset:16384
    ds_read_b64_tr_b16 a[154:155], v27 offset:17408
    v_mfma_f32_16x16x32_bf16 v[164:167], a[76:79], a[12:15], v[164:167]
    ds_read_b64_tr_b16 a[156:157], v27 offset:24576
    ds_read_b64_tr_b16 a[158:159], v27 offset:25600
    v_mfma_f32_16x16x32_bf16 v[168:171], a[80:83], a[8:11], v[168:171]
    v_mfma_f32_16x16x32_bf16 v[168:171], a[84:87], a[12:15], v[168:171]
    v_mfma_f32_16x16x32_bf16 v[172:175], a[88:91], a[8:11], v[172:175]
    v_mfma_f32_16x16x32_bf16 v[172:175], a[92:95], a[12:15], v[172:175]
    buffer_load_dwordx4 v11, s[12:15], s3 offen offset:1024 lds
    v_mfma_f32_16x16x32_bf16 v[176:179], a[96:99], a[8:11], v[176:179]
    buffer_load_dwordx4 a[204:207], v9, s[16:19], s41 offen offset:1024 sc1
    v_mfma_f32_16x16x32_bf16 v[176:179], a[100:103], a[12:15], v[176:179]
    ds_read_b64_tr_b16 a[160:161], v28 offset:16384
    ds_read_b64_tr_b16 a[162:163], v28 offset:17408
    v_mfma_f32_16x16x32_bf16 v[180:183], a[104:107], a[8:11], v[180:183]
    ds_read_b64_tr_b16 a[164:165], v28 offset:24576
    ds_read_b64_tr_b16 a[166:167], v28 offset:25600
    v_mfma_f32_16x16x32_bf16 v[180:183], a[108:111], a[12:15], v[180:183]
    v_mfma_f32_16x16x32_bf16 v[184:187], a[112:115], a[8:11], v[184:187]
    buffer_store_dwordx4 v[76:79], v3, s[64:67], s71 offen offset:0 sc1
    v_mfma_f32_16x16x32_bf16 v[184:187], a[116:119], a[12:15], v[184:187]
    v_mfma_f32_16x16x32_bf16 v[188:191], a[120:123], a[8:11], v[188:191]
    ds_read_b64_tr_b16 a[168:169], v29 offset:16384
    ds_read_b64_tr_b16 a[170:171], v29 offset:17408
    v_mfma_f32_16x16x32_bf16 v[188:191], a[124:127], a[12:15], v[188:191]
    ds_read_b64_tr_b16 a[172:173], v29 offset:24576
    ds_read_b64_tr_b16 a[174:175], v29 offset:25600
    v_mfma_f32_16x16x32_bf16 v[192:195], a[64:67], a[16:19], v[192:195]
    buffer_load_dwordx4 a[208:211], v9, s[16:19], s42 offen offset:0 sc1
    v_mfma_f32_16x16x32_bf16 v[192:195], a[68:71], a[20:23], v[192:195]
    v_mfma_f32_16x16x32_bf16 v[196:199], a[72:75], a[16:19], v[196:199]
    v_mfma_f32_16x16x32_bf16 v[196:199], a[76:79], a[20:23], v[196:199]
    v_mfma_f32_16x16x32_bf16 v[200:203], a[80:83], a[16:19], v[200:203]
    ds_read_b64_tr_b16 a[176:177], v30 offset:16384
    ds_read_b64_tr_b16 a[178:179], v30 offset:17408
    v_mfma_f32_16x16x32_bf16 v[200:203], a[84:87], a[20:23], v[200:203]
    ds_read_b64_tr_b16 a[180:181], v30 offset:24576
    ds_read_b64_tr_b16 a[182:183], v30 offset:25600
    v_mfma_f32_16x16x32_bf16 v[204:207], a[88:91], a[16:19], v[204:207]
    buffer_load_dwordx4 v12, s[12:15], s3 offen offset:2048 lds
    v_mfma_f32_16x16x32_bf16 v[204:207], a[92:95], a[20:23], v[204:207]
    v_mfma_f32_16x16x32_bf16 v[208:211], a[96:99], a[16:19], v[208:211]
    buffer_load_dwordx4 a[212:215], v9, s[16:19], s42 offen offset:1024 sc1
    v_mfma_f32_16x16x32_bf16 v[208:211], a[100:103], a[20:23], v[208:211]
    v_mfma_f32_16x16x32_bf16 v[212:215], a[104:107], a[16:19], v[212:215]
    ds_read_b64_tr_b16 a[184:185], v31 offset:16384
    ds_read_b64_tr_b16 a[186:187], v31 offset:17408
    v_mfma_f32_16x16x32_bf16 v[212:215], a[108:111], a[20:23], v[212:215]
    ds_read_b64_tr_b16 a[188:189], v31 offset:24576
    ds_read_b64_tr_b16 a[190:191], v31 offset:25600
    v_mfma_f32_16x16x32_bf16 v[216:219], a[112:115], a[16:19], v[216:219]
    v_mfma_f32_16x16x32_bf16 v[216:219], a[116:119], a[20:23], v[216:219]
    v_mfma_f32_16x16x32_bf16 v[220:223], a[120:123], a[16:19], v[220:223]
    v_mfma_f32_16x16x32_bf16 v[220:223], a[124:127], a[20:23], v[220:223]
    v_mfma_f32_16x16x32_bf16 v[224:227], a[64:67], a[24:27], v[224:227]
    buffer_store_dwordx4 v[80:83], v2, s[64:67], s70 offen offset:1024 sc1
    s_waitcnt vmcnt(23)
    v_mfma_f32_16x16x32_bf16 v[224:227], a[68:71], a[28:31], v[224:227]
    buffer_load_dwordx4 a[216:219], v9, s[16:19], s43 offen offset:0 sc1
    v_mfma_f32_16x16x32_bf16 v[228:231], a[72:75], a[24:27], v[228:231]
    v_mfma_f32_16x16x32_bf16 v[228:231], a[76:79], a[28:31], v[228:231]
    v_mfma_f32_16x16x32_bf16 v[232:235], a[80:83], a[24:27], v[232:235]
    v_mfma_f32_16x16x32_bf16 v[232:235], a[84:87], a[28:31], v[232:235]
    buffer_load_dwordx4 v13, s[12:15], s3 offen offset:3072 lds
    v_mfma_f32_16x16x32_bf16 v[236:239], a[88:91], a[24:27], v[236:239]
    v_mfma_f32_16x16x32_bf16 v[236:239], a[92:95], a[28:31], v[236:239]
    v_mfma_f32_16x16x32_bf16 v[240:243], a[96:99], a[24:27], v[240:243]
    buffer_load_dwordx4 a[220:223], v9, s[16:19], s43 offen offset:1024 sc1
    v_mfma_f32_16x16x32_bf16 v[240:243], a[100:103], a[28:31], v[240:243]
    v_mfma_f32_16x16x32_bf16 v[244:247], a[104:107], a[24:27], v[244:247]
    v_mfma_f32_16x16x32_bf16 v[244:247], a[108:111], a[28:31], v[244:247]
    v_mfma_f32_16x16x32_bf16 v[248:251], a[112:115], a[24:27], v[248:251]
    v_mfma_f32_16x16x32_bf16 v[248:251], a[116:119], a[28:31], v[248:251]
    v_mfma_f32_16x16x32_bf16 v[252:255], a[120:123], a[24:27], v[252:255]
    v_mfma_f32_16x16x32_bf16 v[252:255], a[124:127], a[28:31], v[252:255]
    s_waitcnt vmcnt(42) lgkmcnt(0)
    s_barrier
    s_waitcnt vmcnt(25)
    v_mfma_f32_16x16x32_bf16 v[128:131], a[128:131], a[32:35], v[128:131]
    buffer_load_dwordx4 a[224:227], v9, s[16:19], s40 offen offset:2048 sc1
    s_waitcnt vmcnt(25)
    v_mfma_f32_16x16x32_bf16 v[128:131], a[132:135], a[36:39], v[128:131]
    v_lshrrev_b32 v6, 6, v2
    v_and_b32 v6, 12, v6
    v_mfma_f32_16x16x32_bf16 v[132:135], a[136:139], a[32:35], v[132:135]
    v_bfe_u32 v7, v2, 4, 4
    v_cmp_le_u32_e64 s[24:25], v6, v7
    v_mfma_f32_16x16x32_bf16 v[132:135], a[140:143], a[36:39], v[132:135]
    v_add_u32 v6, 1, v6
    v_cmp_le_u32_e64 s[26:27], v6, v7
    v_mfma_f32_16x16x32_bf16 v[136:139], a[144:147], a[32:35], v[136:139]
    buffer_store_dwordx4 v[84:87], v3, s[64:67], s70 offen offset:1024 sc1
    v_mfma_f32_16x16x32_bf16 v[136:139], a[148:151], a[36:39], v[136:139]
    v_add_u32 v6, 1, v6
    v_xor_b32 v24, 0x10000, v24
    v_mfma_f32_16x16x32_bf16 v[140:143], a[152:155], a[32:35], v[140:143]
    v_cmp_le_u32_e64 s[28:29], v6, v7
    ds_read_b64_tr_b16 a[64:65], v24 offset:0
    v_mfma_f32_16x16x32_bf16 v[140:143], a[156:159], a[36:39], v[140:143]
    s_add_u32 m0, s38, 0x1c000
    s_add_u32 s3, s91, 0x380000
    s_and_b32 s3, s3, 0x3fffff
    buffer_load_dwordx4 v10, s[12:15], s3 offen offset:0 lds
    v_mfma_f32_16x16x32_bf16 v[144:147], a[160:163], a[32:35], v[144:147]
    buffer_load_dwordx4 a[228:231], v9, s[16:19], s40 offen offset:3072 sc1
    v_mfma_f32_16x16x32_bf16 v[144:147], a[164:167], a[36:39], v[144:147]
    v_add_u32 v6, 1, v6
    v_cmp_le_u32_e64 s[30:31], v6, v7
    v_mfma_f32_16x16x32_bf16 v[148:151], a[168:171], a[32:35], v[148:151]
    ds_read_b64_tr_b16 a[66:67], v24 offset:1024
    ds_read_b64_tr_b16 a[68:69], v24 offset:8192
    v_mfma_f32_16x16x32_bf16 v[148:151], a[172:175], a[36:39], v[148:151]
    v_add_u32 v6, 1, v6
    ds_read_b64_tr_b16 a[70:71], v24 offset:9216
    v_mfma_f32_16x16x32_bf16 v[152:155], a[176:179], a[32:35], v[152:155]
    s_mov_b64 s[8:9], s[64:65]
    s_sub_u32 s4, 16, s34
    v_mfma_f32_16x16x32_bf16 v[152:155], a[180:183], a[36:39], v[152:155]
    v_xor_b32 v25, 0x10000, v25
    ds_read_b64_tr_b16 a[72:73], v25 offset:0
    v_mfma_f32_16x16x32_bf16 v[156:159], a[184:187], a[32:35], v[156:159]
    s_lshl_b32 s10, s4, 16
    s_mov_b32 s11, 0x20000
    v_mfma_f32_16x16x32_bf16 v[156:159], a[188:191], a[36:39], v[156:159]
    ds_read_b64_tr_b16 a[74:75], v25 offset:1024
    ds_read_b64_tr_b16 a[76:77], v25 offset:8192
    s_waitcnt vmcnt(27)
    v_mfma_f32_16x16x32_bf16 v[160:163], a[128:131], a[40:43], v[160:163]
    buffer_load_dwordx4 a[232:235], v9, s[16:19], s41 offen offset:2048 sc1
    s_waitcnt vmcnt(27)
    v_mfma_f32_16x16x32_bf16 v[160:163], a[132:135], a[44:47], v[160:163]
    v_mov_b32 v7, 0xff800000
    ds_read_b64_tr_b16 a[78:79], v25 offset:9216
    v_mfma_f32_16x16x32_bf16 v[164:167], a[136:139], a[40:43], v[164:167]
    v_mov_b32 v6, v2
    v_xor_b32 v26, 0x10000, v26
    v_mfma_f32_16x16x32_bf16 v[164:167], a[140:143], a[44:47], v[164:167]
    buffer_load_dwordx4 v11, s[12:15], s3 offen offset:1024 lds
    v_mfma_f32_16x16x32_bf16 v[168:171], a[144:147], a[40:43], v[168:171]
    ds_read_b64_tr_b16 a[80:81], v26 offset:0
    ds_read_b64_tr_b16 a[82:83], v26 offset:1024
    v_mfma_f32_16x16x32_bf16 v[168:171], a[148:151], a[44:47], v[168:171]
    ds_read_b64_tr_b16 a[84:85], v26 offset:8192
    ds_read_b64_tr_b16 a[86:87], v26 offset:9216
    v_mfma_f32_16x16x32_bf16 v[172:175], a[152:155], a[40:43], v[172:175]
    v_xor_b32 v27, 0x10000, v27
    ds_read_b64_tr_b16 a[88:89], v27 offset:0
    v_mfma_f32_16x16x32_bf16 v[172:175], a[156:159], a[44:47], v[172:175]
    ds_read_b64_tr_b16 a[90:91], v27 offset:1024
    ds_read_b64_tr_b16 a[92:93], v27 offset:8192
    v_mfma_f32_16x16x32_bf16 v[176:179], a[160:163], a[40:43], v[176:179]
    buffer_store_dwordx4 v[88:91], v2, s[64:67], s71 offen offset:1024 sc1
    v_mfma_f32_16x16x32_bf16 v[176:179], a[164:167], a[44:47], v[176:179]
    buffer_load_dwordx4 a[236:239], v9, s[16:19], s41 offen offset:3072 sc1
    v_mfma_f32_16x16x32_bf16 v[180:183], a[168:171], a[40:43], v[180:183]
    ds_read_b64_tr_b16 a[94:95], v27 offset:9216
    v_xor_b32 v28, 0x10000, v28
    v_mfma_f32_16x16x32_bf16 v[180:183], a[172:175], a[44:47], v[180:183]
    ds_read_b64_tr_b16 a[96:97], v28 offset:0
    ds_read_b64_tr_b16 a[98:99], v28 offset:1024
    v_mfma_f32_16x16x32_bf16 v[184:187], a[176:179], a[40:43], v[184:187]
    ds_read_b64_tr_b16 a[100:101], v28 offset:8192
    ds_read_b64_tr_b16 a[102:103], v28 offset:9216
    v_mfma_f32_16x16x32_bf16 v[184:187], a[180:183], a[44:47], v[184:187]
    v_mfma_f32_16x16x32_bf16 v[188:191], a[184:187], a[40:43], v[188:191]
    v_xor_b32 v29, 0x10000, v29
    ds_read_b64_tr_b16 a[104:105], v29 offset:0
    v_mfma_f32_16x16x32_bf16 v[188:191], a[188:191], a[44:47], v[188:191]
    ds_read_b64_tr_b16 a[106:107], v29 offset:1024
    ds_read_b64_tr_b16 a[108:109], v29 offset:8192
    s_waitcnt vmcnt(28)
    v_mfma_f32_16x16x32_bf16 v[192:195], a[128:131], a[48:51], v[192:195]
    buffer_load_dwordx4 a[240:243], v9, s[16:19], s42 offen offset:2048 sc1
    s_waitcnt vmcnt(28)
    v_mfma_f32_16x16x32_bf16 v[192:195], a[132:135], a[52:55], v[192:195]
    ds_read_b64_tr_b16 a[110:111], v29 offset:9216
    v_mfma_f32_16x16x32_bf16 v[196:199], a[136:139], a[48:51], v[196:199]
    buffer_load_dwordx4 v12, s[12:15], s3 offen offset:2048 lds
    v_mfma_f32_16x16x32_bf16 v[196:199], a[140:143], a[52:55], v[196:199]
    v_mfma_f32_16x16x32_bf16 v[200:203], a[144:147], a[48:51], v[200:203]
    v_xor_b32 v30, 0x10000, v30
    ds_read_b64_tr_b16 a[112:113], v30 offset:0
    v_mfma_f32_16x16x32_bf16 v[200:203], a[148:151], a[52:55], v[200:203]
    ds_read_b64_tr_b16 a[114:115], v30 offset:1024
    ds_read_b64_tr_b16 a[116:117], v30 offset:8192
    v_mfma_f32_16x16x32_bf16 v[204:207], a[152:155], a[48:51], v[204:207]
    ds_read_b64_tr_b16 a[118:119], v30 offset:9216
    v_mfma_f32_16x16x32_bf16 v[204:207], a[156:159], a[52:55], v[204:207]
    v_mfma_f32_16x16x32_bf16 v[208:211], a[160:163], a[48:51], v[208:211]
    buffer_load_dwordx4 a[244:247], v9, s[16:19], s42 offen offset:3072 sc1
    v_mfma_f32_16x16x32_bf16 v[208:211], a[164:167], a[52:55], v[208:211]
    v_mfma_f32_16x16x32_bf16 v[212:215], a[168:171], a[48:51], v[212:215]
    v_xor_b32 v31, 0x10000, v31
    ds_read_b64_tr_b16 a[120:121], v31 offset:0
    v_mfma_f32_16x16x32_bf16 v[212:215], a[172:175], a[52:55], v[212:215]
    ds_read_b64_tr_b16 a[122:123], v31 offset:1024
    ds_read_b64_tr_b16 a[124:125], v31 offset:8192
    v_mfma_f32_16x16x32_bf16 v[216:219], a[176:179], a[48:51], v[216:219]
    buffer_store_dwordx4 v[92:95], v3, s[64:67], s71 offen offset:1024 sc1
    v_mfma_f32_16x16x32_bf16 v[216:219], a[180:183], a[52:55], v[216:219]
    ds_read_b64_tr_b16 a[126:127], v31 offset:9216
    v_mfma_f32_16x16x32_bf16 v[220:223], a[184:187], a[48:51], v[220:223]
    v_mfma_f32_16x16x32_bf16 v[220:223], a[188:191], a[52:55], v[220:223]
    s_waitcnt vmcnt(30)
    v_mfma_f32_16x16x32_bf16 v[224:227], a[128:131], a[56:59], v[224:227]
    buffer_load_dwordx4 a[248:251], v9, s[16:19], s43 offen offset:2048 sc1
    s_waitcnt vmcnt(29)
    v_mfma_f32_16x16x32_bf16 v[224:227], a[132:135], a[60:63], v[224:227]
    buffer_load_dwordx4 v13, s[12:15], s3 offen offset:3072 lds
    v_mfma_f32_16x16x32_bf16 v[228:231], a[136:139], a[56:59], v[228:231]
    v_mfma_f32_16x16x32_bf16 v[228:231], a[140:143], a[60:63], v[228:231]
    v_mfma_f32_16x16x32_bf16 v[232:235], a[144:147], a[56:59], v[232:235]
    v_mfma_f32_16x16x32_bf16 v[232:235], a[148:151], a[60:63], v[232:235]
    v_mfma_f32_16x16x32_bf16 v[236:239], a[152:155], a[56:59], v[236:239]
    s_and_b32 s4, s49, 0x8000
    s_lshr_b32 s5, s4, 1
    s_add_u32 s4, s4, s54
    s_add_u32 s4, s4, 16384
    v_mfma_f32_16x16x32_bf16 v[236:239], a[156:159], a[60:63], v[236:239]
    s_add_u32 s5, s5, 131072
    s_cmp_lt_u32 s32, 2
    s_cselect_b32 s4, s4, s5
    v_mfma_f32_16x16x32_bf16 v[240:243], a[160:163], a[56:59], v[240:243]
    buffer_load_dwordx4 a[252:255], v9, s[16:19], s43 offen offset:3072 sc1
    v_mfma_f32_16x16x32_bf16 v[240:243], a[164:167], a[60:63], v[240:243]
    s_movk_i32 s5, 0x4000
    s_cmp_lt_u32 s32, 2
    s_cselect_b32 s5, 0x8000, s5
    v_mfma_f32_16x16x32_bf16 v[244:247], a[168:171], a[56:59], v[244:247]
    v_add_u32 v14, s4, v2
    v_xor_b32 v15, s5, v14
    v_mfma_f32_16x16x32_bf16 v[244:247], a[172:175], a[60:63], v[244:247]
    s_add_u32 s4, s90, 131072
    v_add_u32 v17, s4, v2
    v_mfma_f32_16x16x32_bf16 v[248:251], a[176:179], a[56:59], v[248:251]
    v_xor_b32 v18, 0x2000, v17
    s_lshl_b32 s4, s32, 9
    s_add_u32 s4, s4, s54
    v_lshrrev_b32 v16, 2, v2
    v_add_u32 v16, s4, v16
    s_cmp_eq_u32 s98, 0
    s_cselect_b64 s[4:5], s[24:25], -1
    v_cndmask_b32_e64 v20, v7, 0, s[4:5]
    s_cmp_eq_u32 s98, 0
    s_cselect_b64 s[4:5], s[26:27], -1
    v_cndmask_b32_e64 v21, v7, 0, s[4:5]
    s_cmp_eq_u32 s98, 0
    s_cselect_b64 s[4:5], s[28:29], -1
    v_cndmask_b32_e64 v22, v7, 0, s[4:5]
    s_cmp_eq_u32 s98, 0
    s_cselect_b64 s[4:5], s[30:31], -1
    v_cndmask_b32_e64 v23, v7, 0, s[4:5]
    s_mov_b64 s[50:51], 0
    v_mfma_f32_16x16x32_bf16 v[248:251], a[180:183], a[60:63], v[248:251]
    v_mfma_f32_16x16x32_bf16 v[252:255], a[184:187], a[56:59], v[252:255]
    v_mfma_f32_16x16x32_bf16 v[252:255], a[188:191], a[60:63], v[252:255]
    v_add_u32 v9, 0x1000, v9
    v_and_b32 v9, 0x3fff, v9
    s_waitcnt vmcnt(30) lgkmcnt(0)
    v_mfma_f32_16x16x32_bf16 v[128:131], a[64:67], a[192:195], v[128:131]
    buffer_store_dwordx4 v[96:99], v4, s[64:67], s73 offen offset:0 sc1
    s_waitcnt vmcnt(29)
    v_mfma_f32_16x16x32_bf16 v[128:131], a[68:71], a[196:199], v[128:131]
    buffer_load_dwordx4 a[0:3], v9, s[16:19], s40 offen offset:0 sc1
    v_mfma_f32_16x16x32_bf16 v[132:135], a[72:75], a[192:195], v[132:135]
    ds_read_b64_tr_b16 a[128:129], v24 offset:16384
    ds_read_b64_tr_b16 a[130:131], v24 offset:17408
    v_mfma_f32_16x16x32_bf16 v[132:135], a[76:79], a[196:199], v[132:135]
    ds_read_b64_tr_b16 a[132:133], v24 offset:24576
    ds_read_b64_tr_b16 a[134:135], v24 offset:25600
    v_mfma_f32_16x16x32_bf16 v[136:139], a[80:83], a[192:195], v[136:139]
    v_mfma_f32_16x16x32_bf16 v[136:139], a[84:87], a[196:199], v[136:139]
    v_mfma_f32_16x16x32_bf16 v[140:143], a[88:91], a[192:195], v[140:143]
    ds_read_b64_tr_b16 a[136:137], v25 offset:16384
    ds_read_b64_tr_b16 a[138:139], v25 offset:17408
    v_mfma_f32_16x16x32_bf16 v[140:143], a[92:95], a[196:199], v[140:143]
    ds_read_b64_tr_b16 a[140:141], v25 offset:24576
    ds_read_b64_tr_b16 a[142:143], v25 offset:25600
    v_mfma_f32_16x16x32_bf16 v[144:147], a[96:99], a[192:195], v[144:147]
    buffer_load_dwordx4 a[4:7], v9, s[16:19], s40 offen offset:1024 sc1
    v_mfma_f32_16x16x32_bf16 v[144:147], a[100:103], a[196:199], v[144:147]
    v_mfma_f32_16x16x32_bf16 v[148:151], a[104:107], a[192:195], v[148:151]
    v_mfma_f32_16x16x32_bf16 v[148:151], a[108:111], a[196:199], v[148:151]
    v_mfma_f32_16x16x32_bf16 v[152:155], a[112:115], a[192:195], v[152:155]
    ds_read_b64_tr_b16 a[144:145], v26 offset:16384
    ds_read_b64_tr_b16 a[146:147], v26 offset:17408
    v_mfma_f32_16x16x32_bf16 v[152:155], a[116:119], a[196:199], v[152:155]
    ds_read_b64_tr_b16 a[148:149], v26 offset:24576
    ds_read_b64_tr_b16 a[150:151], v26 offset:25600
    v_mfma_f32_16x16x32_bf16 v[156:159], a[120:123], a[192:195], v[156:159]
    v_mfma_f32_16x16x32_bf16 v[156:159], a[124:127], a[196:199], v[156:159]
    s_waitcnt vmcnt(28)
    v_mfma_f32_16x16x32_bf16 v[160:163], a[64:67], a[200:203], v[160:163]
    s_waitcnt vmcnt(26)
    v_mfma_f32_16x16x32_bf16 v[160:163], a[68:71], a[204:207], v[160:163]
    buffer_load_dwordx4 a[8:11], v9, s[16:19], s41 offen offset:0 sc1
    v_mfma_f32_16x16x32_bf16 v[164:167], a[72:75], a[200:203], v[164:167]
    ds_read_b64_tr_b16 a[152:153], v27 offset:16384
    ds_read_b64_tr_b16 a[154:155], v27 offset:17408
    v_mfma_f32_16x16x32_bf16 v[164:167], a[76:79], a[204:207], v[164:167]
    ds_read_b64_tr_b16 a[156:157], v27 offset:24576
    ds_read_b64_tr_b16 a[158:159], v27 offset:25600
    v_mfma_f32_16x16x32_bf16 v[168:171], a[80:83], a[200:203], v[168:171]
    buffer_store_dwordx4 v[100:103], v4, s[64:67], s73 offen offset:1024 sc1
    v_mfma_f32_16x16x32_bf16 v[168:171], a[84:87], a[204:207], v[168:171]
    v_mfma_f32_16x16x32_bf16 v[172:175], a[88:91], a[200:203], v[172:175]
    v_mfma_f32_16x16x32_bf16 v[172:175], a[92:95], a[204:207], v[172:175]
    v_mfma_f32_16x16x32_bf16 v[176:179], a[96:99], a[200:203], v[176:179]
    v_and_b32 v35, 0x30, v2
    ds_read_b64_tr_b16 a[160:161], v28 offset:16384
    v_mfma_f32_16x16x32_bf16 v[176:179], a[100:103], a[204:207], v[176:179]
    s_and_b32 s4, s78, 0xffffff80
    s_add_u32 s4, s4, 0
    v_mfma_f32_16x16x32_bf16 v[180:183], a[104:107], a[200:203], v[180:183]
    buffer_load_dwordx4 a[12:15], v9, s[16:19], s41 offen offset:1024 sc1
    v_mfma_f32_16x16x32_bf16 v[180:183], a[108:111], a[204:207], v[180:183]
    v_add_u32 v35, s4, v35
    buffer_load_dwordx4 v[36:39], v35, s[20:23], 0 offen sc1
    v_mfma_f32_16x16x32_bf16 v[184:187], a[112:115], a[200:203], v[184:187]
    ds_read_b64_tr_b16 a[162:163], v28 offset:17408
    ds_read_b64_tr_b16 a[164:165], v28 offset:24576
    v_mfma_f32_16x16x32_bf16 v[184:187], a[116:119], a[204:207], v[184:187]
    ds_read_b64_tr_b16 a[166:167], v28 offset:25600
    v_mfma_f32_16x16x32_bf16 v[188:191], a[120:123], a[200:203], v[188:191]
    ds_read_b64_tr_b16 a[168:169], v29 offset:16384
    ds_read_b64_tr_b16 a[170:171], v29 offset:17408
    v_mfma_f32_16x16x32_bf16 v[188:191], a[124:127], a[204:207], v[188:191]
    ds_read_b64_tr_b16 a[172:173], v29 offset:24576
    ds_read_b64_tr_b16 a[174:175], v29 offset:25600
    s_waitcnt vmcnt(28)
    v_mfma_f32_16x16x32_bf16 v[192:195], a[64:67], a[208:211], v[192:195]
    s_waitcnt vmcnt(26)
    v_mfma_f32_16x16x32_bf16 v[192:195], a[68:71], a[212:215], v[192:195]
    v_mfma_f32_16x16x32_bf16 v[196:199], a[72:75], a[208:211], v[196:199]
    v_mfma_f32_16x16x32_bf16 v[196:199], a[76:79], a[212:215], v[196:199]
    buffer_load_dwordx4 a[16:19], v9, s[16:19], s42 offen offset:0 sc1
    v_mfma_f32_16x16x32_bf16 v[200:203], a[80:83], a[208:211], v[200:203]
    ds_read_b64_tr_b16 a[176:177], v30 offset:16384
    ds_read_b64_tr_b16 a[178:179], v30 offset:17408
    v_mfma_f32_16x16x32_bf16 v[200:203], a[84:87], a[212:215], v[200:203]
    ds_read_b64_tr_b16 a[180:181], v30 offset:24576
    ds_read_b64_tr_b16 a[182:183], v30 offset:25600
    v_mfma_f32_16x16x32_bf16 v[204:207], a[88:91], a[208:211], v[204:207]
    v_mfma_f32_16x16x32_bf16 v[204:207], a[92:95], a[212:215], v[204:207]
    v_mfma_f32_16x16x32_bf16 v[208:211], a[96:99], a[208:211], v[208:211]
    buffer_store_dwordx4 v[104:107], v4, s[64:67], s73 offen offset:2048 sc1
    v_mfma_f32_16x16x32_bf16 v[208:211], a[100:103], a[212:215], v[208:211]
    v_mfma_f32_16x16x32_bf16 v[212:215], a[104:107], a[208:211], v[212:215]
    ds_read_b64_tr_b16 a[184:185], v31 offset:16384
    ds_read_b64_tr_b16 a[186:187], v31 offset:17408
    v_mfma_f32_16x16x32_bf16 v[212:215], a[108:111], a[212:215], v[212:215]
    buffer_load_dwordx4 a[20:23], v9, s[16:19], s42 offen offset:1024 sc1
    v_mfma_f32_16x16x32_bf16 v[216:219], a[112:115], a[208:211], v[216:219]
    ds_read_b64_tr_b16 a[188:189], v31 offset:24576
    ds_read_b64_tr_b16 a[190:191], v31 offset:25600
    v_mfma_f32_16x16x32_bf16 v[216:219], a[116:119], a[212:215], v[216:219]
    v_mfma_f32_16x16x32_bf16 v[220:223], a[120:123], a[208:211], v[220:223]
    v_mfma_f32_16x16x32_bf16 v[220:223], a[124:127], a[212:215], v[220:223]
    s_waitcnt vmcnt(27)
    v_mfma_f32_16x16x32_bf16 v[224:227], a[64:67], a[216:219], v[224:227]
    s_waitcnt vmcnt(25)
    v_mfma_f32_16x16x32_bf16 v[224:227], a[68:71], a[220:223], v[224:227]
    v_mfma_f32_16x16x32_bf16 v[228:231], a[72:75], a[216:219], v[228:231]
    v_mfma_f32_16x16x32_bf16 v[228:231], a[76:79], a[220:223], v[228:231]
    v_mfma_f32_16x16x32_bf16 v[232:235], a[80:83], a[216:219], v[232:235]
    buffer_load_dwordx4 a[24:27], v9, s[16:19], s43 offen offset:0 sc1
    v_mfma_f32_16x16x32_bf16 v[232:235], a[84:87], a[220:223], v[232:235]
    v_mfma_f32_16x16x32_bf16 v[236:239], a[88:91], a[216:219], v[236:239]
    v_mfma_f32_16x16x32_bf16 v[236:239], a[92:95], a[220:223], v[236:239]
    v_mfma_f32_16x16x32_bf16 v[240:243], a[96:99], a[216:219], v[240:243]
    s_waitcnt vmcnt(4)
    v_cmp_eq_u64_e64 s[94:95], s[80:81], v[36:37]
    v_cmp_eq_u64 vcc, s[80:81], v[38:39]
    v_mfma_f32_16x16x32_bf16 v[240:243], a[100:103], a[220:223], v[240:243]
    s_and_b64 s[94:95], s[94:95], vcc
    v_mfma_f32_16x16x32_bf16 v[244:247], a[104:107], a[216:219], v[244:247]
    v_mfma_f32_16x16x32_bf16 v[244:247], a[108:111], a[220:223], v[244:247]
    v_mfma_f32_16x16x32_bf16 v[248:251], a[112:115], a[216:219], v[248:251]
    buffer_store_dwordx4 v[108:111], v4, s[64:67], s73 offen offset:3072 sc1
    v_mfma_f32_16x16x32_bf16 v[248:251], a[116:119], a[220:223], v[248:251]
    s_load_dwordx4 s[56:59], s[0:1], 64
    s_load_dwordx2 s[60:61], s[0:1], 80
    v_mfma_f32_16x16x32_bf16 v[252:255], a[120:123], a[216:219], v[252:255]
    buffer_load_dwordx4 a[28:31], v9, s[16:19], s43 offen offset:1024 sc1
    v_mfma_f32_16x16x32_bf16 v[252:255], a[124:127], a[220:223], v[252:255]
    s_cmp_eq_u64 s[94:95], -1
    s_cbranch_scc0 L_k0_retry
L_k0_back:
    s_waitcnt vmcnt(14) lgkmcnt(0)
    s_barrier
    v_mfma_f32_16x16x32_bf16 v[128:131], a[128:131], a[224:227], v[128:131]
    s_mov_b32 s37, s90
    s_mov_b32 s36, s90
    v_mfma_f32_16x16x32_bf16 v[128:131], a[132:135], a[228:231], v[128:131]
    s_mov_b32 m0, s37
    ds_read_b64_tr_b16 a[64:65], v24 offset:32768
    v_mfma_f32_16x16x32_bf16 v[132:135], a[136:139], a[224:227], v[132:135]
    buffer_load_dwordx4 v2, s[8:11], s36 offen offset:0 sc1 lds
    v_mfma_f32_16x16x32_bf16 v[132:135], a[140:143], a[228:231], v[132:135]
    s_lshr_b32 s62, s33, 3
    s_lshl_b32 s74, s62, 20
    s_lshl_b32 s63, s32, 14
    v_mfma_f32_16x16x32_bf16 v[136:139], a[144:147], a[224:227], v[136:139]
    s_add_u32 s74, s74, s63
    s_and_b32 s63, s33, 3
    s_lshl_b32 s89, s63, 8
    v_mfma_f32_16x16x32_bf16 v[136:139], a[148:151], a[228:231], v[136:139]
    s_add_u32 s74, s74, s89
    s_mov_b32 s63, s34
    v_mfma_f32_16x16x32_bf16 v[140:143], a[152:155], a[224:227], v[140:143]
    buffer_load_dwordx4 a[32:35], v9, s[16:19], s40 offen offset:2048 sc1
    v_mfma_f32_16x16x32_bf16 v[140:143], a[156:159], a[228:231], v[140:143]
    s_and_b32 s63, s63, 7
    s_lshl_b32 s76, s63, 17
    v_mfma_f32_16x16x32_bf16 v[144:147], a[160:163], a[224:227], v[144:147]
    s_lshl_b32 s77, s32, 12
    s_add_u32 s77, s77, s54
    v_mfma_f32_16x16x32_bf16 v[144:147], a[164:167], a[228:231], v[144:147]
    buffer_load_dwordx4 v2, s[8:11], s36 offen offset:1024 sc1 lds
    v_mfma_f32_16x16x32_bf16 v[148:151], a[168:171], a[224:227], v[148:151]
    s_lshl2_add_u32 s63, s33, s32
    s_lshl_b32 s75, s34, 10
    s_lshl3_add_u32 s75, s63, s75
    v_mfma_f32_16x16x32_bf16 v[148:151], a[172:175], a[228:231], v[148:151]
    v_accvgpr_write_b32 a192, v64
    v_accvgpr_write_b32 a193, v65
    v_mfma_f32_16x16x32_bf16 v[152:155], a[176:179], a[224:227], v[152:155]
    v_accvgpr_write_b32 a194, v66
    v_accvgpr_write_b32 a195, v67
    v_mfma_f32_16x16x32_bf16 v[152:155], a[180:183], a[228:231], v[152:155]
    v_accvgpr_write_b32 a196, v68
    v_accvgpr_write_b32 a197, v69
    v_mfma_f32_16x16x32_bf16 v[156:159], a[184:187], a[224:227], v[156:159]
    buffer_load_dwordx4 a[36:39], v9, s[16:19], s40 offen offset:3072 sc1
    v_mfma_f32_16x16x32_bf16 v[156:159], a[188:191], a[228:231], v[156:159]
    v_accvgpr_write_b32 a198, v70
    v_accvgpr_write_b32 a199, v71
    v_mfma_f32_16x16x32_bf16 v[160:163], a[128:131], a[232:235], v[160:163]
    buffer_store_dwordx4 v[112:115], v5, s[64:67], s73 offen offset:0 sc1
    v_mfma_f32_16x16x32_bf16 v[160:163], a[132:135], a[236:239], v[160:163]
    buffer_load_dwordx4 v2, s[8:11], s36 offen offset:2048 sc1 lds
    v_mfma_f32_16x16x32_bf16 v[164:167], a[136:139], a[232:235], v[164:167]
    v_accvgpr_write_b32 a200, v72
    v_accvgpr_write_b32 a201, v73
    v_mfma_f32_16x16x32_bf16 v[164:167], a[140:143], a[236:239], v[164:167]
    v_accvgpr_write_b32 a202, v74
    v_accvgpr_write_b32 a203, v75
    v_mfma_f32_16x16x32_bf16 v[168:171], a[144:147], a[232:235], v[168:171]
    v_accvgpr_write_b32 a204, v76
    v_accvgpr_write_b32 a205, v77
    v_mfma_f32_16x16x32_bf16 v[168:171], a[148:151], a[236:239], v[168:171]
    v_accvgpr_write_b32 a206, v78
    ds_read_b64_tr_b16 a[66:67], v24 offset:33792
    v_mfma_f32_16x16x32_bf16 v[172:175], a[152:155], a[232:235], v[172:175]
    ds_read_b64_tr_b16 a[68:69], v24 offset:40960
    ds_read_b64_tr_b16 a[70:71], v24 offset:41984
    v_mfma_f32_16x16x32_bf16 v[172:175], a[156:159], a[236:239], v[172:175]
    buffer_load_dwordx4 a[40:43], v9, s[16:19], s41 offen offset:2048 sc1
    v_mfma_f32_16x16x32_bf16 v[176:179], a[160:163], a[232:235], v[176:179]
    v_accvgpr_write_b32 a207, v79
    ds_read_b64_tr_b16 a[72:73], v25 offset:32768
    v_mfma_f32_16x16x32_bf16 v[176:179], a[164:167], a[236:239], v[176:179]
    buffer_load_dwordx4 v2, s[8:11], s36 offen offset:3072 sc1 lds
    v_mfma_f32_16x16x32_bf16 v[180:183], a[168:171], a[232:235], v[180:183]
    v_accvgpr_write_b32 a208, v80
    v_accvgpr_write_b32 a209, v81
    v_mfma_f32_16x16x32_bf16 v[180:183], a[172:175], a[236:239], v[180:183]
    ds_read_b64_tr_b16 a[74:75], v25 offset:33792
    ds_read_b64_tr_b16 a[76:77], v25 offset:40960
    v_mfma_f32_16x16x32_bf16 v[184:187], a[176:179], a[232:235], v[184:187]
    v_accvgpr_write_b32 a210, v82
    ds_read_b64_tr_b16 a[78:79], v25 offset:41984
    v_mfma_f32_16x16x32_bf16 v[184:187], a[180:183], a[236:239], v[184:187]
    ds_read_b64_tr_b16 a[80:81], v26 offset:32768
    ds_read_b64_tr_b16 a[82:83], v26 offset:33792
    v_mfma_f32_16x16x32_bf16 v[188:191], a[184:187], a[232:235], v[188:191]
    v_accvgpr_write_b32 a211, v83
    ds_read_b64_tr_b16 a[84:85], v26 offset:40960
    v_mfma_f32_16x16x32_bf16 v[188:191], a[188:191], a[236:239], v[188:191]
    ds_read_b64_tr_b16 a[86:87], v26 offset:41984
    ds_read_b64_tr_b16 a[88:89], v27 offset:32768
    v_mfma_f32_16x16x32_bf16 v[192:195], a[128:131], a[240:243], v[192:195]
    buffer_load_dwordx4 a[44:47], v9, s[16:19], s41 offen offset:3072 sc1
    v_mfma_f32_16x16x32_bf16 v[192:195], a[132:135], a[244:247], v[192:195]
    v_accvgpr_write_b32 a212, v84
    s_add_u32 m0, s37, 4096
    v_mfma_f32_16x16x32_bf16 v[196:199], a[136:139], a[240:243], v[196:199]
    buffer_load_dwordx4 v3, s[8:11], s36 offen offset:0 sc1 lds
    v_mfma_f32_16x16x32_bf16 v[196:199], a[140:143], a[244:247], v[196:199]
    v_accvgpr_write_b32 a213, v85
    v_accvgpr_write_b32 a214, v86
    v_mfma_f32_16x16x32_bf16 v[200:203], a[144:147], a[240:243], v[200:203]
    buffer_store_dwordx4 v[116:119], v5, s[64:67], s73 offen offset:1024 sc1
    v_mfma_f32_16x16x32_bf16 v[200:203], a[148:151], a[244:247], v[200:203]
    v_accvgpr_write_b32 a215, v87
    ds_read_b64_tr_b16 a[90:91], v27 offset:33792
    v_mfma_f32_16x16x32_bf16 v[204:207], a[152:155], a[240:243], v[204:207]
    ds_read_b64_tr_b16 a[92:93], v27 offset:40960
    ds_read_b64_tr_b16 a[94:95], v27 offset:41984
    v_mfma_f32_16x16x32_bf16 v[204:207], a[156:159], a[244:247], v[204:207]
    v_accvgpr_write_b32 a216, v88
    ds_read_b64_tr_b16 a[96:97], v28 offset:32768
    v_mfma_f32_16x16x32_bf16 v[208:211], a[160:163], a[240:243], v[208:211]
    ds_read_b64_tr_b16 a[98:99], v28 offset:33792
    ds_read_b64_tr_b16 a[100:101], v28 offset:40960
    v_mfma_f32_16x16x32_bf16 v[208:211], a[164:167], a[244:247], v[208:211]
    buffer_load_dwordx4 v3, s[8:11], s36 offen offset:1024 sc1 lds
    v_mfma_f32_16x16x32_bf16 v[212:215], a[168:171], a[240:243], v[212:215]
    buffer_load_dwordx4 a[48:51], v9, s[16:19], s42 offen offset:2048 sc1
    v_mfma_f32_16x16x32_bf16 v[212:215], a[172:175], a[244:247], v[212:215]
    v_accvgpr_write_b32 a217, v89
    ds_read_b64_tr_b16 a[102:103], v28 offset:41984
    v_mfma_f32_16x16x32_bf16 v[216:219], a[176:179], a[240:243], v[216:219]
    ds_read_b64_tr_b16 a[104:105], v29 offset:32768
    ds_read_b64_tr_b16 a[106:107], v29 offset:33792
    v_mfma_f32_16x16x32_bf16 v[216:219], a[180:183], a[244:247], v[216:219]
    ds_read_b64_tr_b16 a[108:109], v29 offset:40960
    ds_read_b64_tr_b16 a[110:111], v29 offset:41984
    v_mfma_f32_16x16x32_bf16 v[220:223], a[184:187], a[240:243], v[220:223]
    ds_read_b64_tr_b16 a[112:113], v30 offset:32768
    ds_read_b64_tr_b16 a[114:115], v30 offset:33792
    v_mfma_f32_16x16x32_bf16 v[220:223], a[188:191], a[244:247], v[220:223]
    ds_read_b64_tr_b16 a[116:117], v30 offset:40960
    ds_read_b64_tr_b16 a[118:119], v30 offset:41984
    v_mfma_f32_16x16x32_bf16 v[224:227], a[128:131], a[248:251], v[224:227]
    ds_read_b64_tr_b16 a[120:121], v31 offset:32768
    ds_read_b64_tr_b16 a[122:123], v31 offset:33792
    v_mfma_f32_16x16x32_bf16 v[224:227], a[132:135], a[252:255], v[224:227]
    buffer_load_dwordx4 v3, s[8:11], s36 offen offset:2048 sc1 lds
    v_mfma_f32_16x16x32_bf16 v[228:231], a[136:139], a[248:251], v[228:231]
    buffer_load_dwordx4 a[52:55], v9, s[16:19], s42 offen offset:3072 sc1
    v_mfma_f32_16x16x32_bf16 v[228:231], a[140:143], a[252:255], v[228:231]
    ds_read_b64_tr_b16 a[124:125], v31 offset:40960
    ds_read_b64_tr_b16 a[126:127], v31 offset:41984
    v_mfma_f32_16x16x32_bf16 v[232:235], a[144:147], a[248:251], v[232:235]
    v_accvgpr_write_b32 a218, v90
    v_accvgpr_write_b32 a219, v91
    v_mfma_f32_16x16x32_bf16 v[232:235], a[148:151], a[252:255], v[232:235]
    v_accvgpr_write_b32 a220, v92
    v_accvgpr_write_b32 a221, v93
    v_mfma_f32_16x16x32_bf16 v[236:239], a[152:155], a[248:251], v[236:239]
    v_accvgpr_write_b32 a222, v94
    v_accvgpr_write_b32 a223, v95
    v_mfma_f32_16x16x32_bf16 v[236:239], a[156:159], a[252:255], v[236:239]
    s_add_u32 s75, s75, 0xb000
    s_xor_b32 s63, s34, 7
    s_lshl2_add_u32 s63, s63, s62
    v_mfma_f32_16x16x32_bf16 v[240:243], a[160:163], a[248:251], v[240:243]
    buffer_store_dwordx4 v[120:123], v5, s[64:67], s73 offen offset:2048 sc1
    v_mfma_f32_16x16x32_bf16 v[240:243], a[164:167], a[252:255], v[240:243]
    buffer_load_dwordx4 v3, s[8:11], s36 offen offset:3072 sc1 lds
    s_add_u32 s36, s36, 32768
    v_mfma_f32_16x16x32_bf16 v[244:247], a[168:171], a[248:251], v[244:247]
    s_lshl_b32 s63, s63, 8
    s_add_u32 s63, s63, 0xb000
    v_mfma_f32_16x16x32_bf16 v[244:247], a[172:175], a[252:255], v[244:247]
    v_and_b32 v57, 0xf0, v2
    v_add_u32 v57, s63, v57
    v_mfma_f32_16x16x32_bf16 v[248:251], a[176:179], a[248:251], v[248:251]
    v_and_b32 v58, 0xf0, v2
    v_lshrrev_b32 v59, 8, v2
    v_lshl_or_b32 v58, v59, 12, v58
    v_and_b32 v59, 1, v59
    v_lshlrev_b32 v59, 7, v59
    v_xor_b32 v58, v58, v59
    v_xor_b32 v59, 32, v58
    v_xor_b32 v60, 64, v58
    v_xor_b32 v61, 96, v58
    s_xor_b32 s63, s34, 7
    s_bfe_u32 s89, s33, 0x10002
    s_lshl1_add_u32 s63, s63, s89
    s_lshl_b32 s63, s63, 18
    s_lshl_b32 s62, s62, 11
    s_add_u32 s63, s63, s62
    s_and_b32 s62, s33, 3
    s_lshl2_add_u32 s62, s62, s32
    s_lshl_b32 s62, s62, 7
    s_add_u32 s63, s63, s62
    s_add_u32 s55, s63, 0x4000000
    v_bfe_u32 v63, v2, 5, 3
    v_bfe_u32 v62, v2, 4, 1
    v_lshlrev_b32 v62, 6, v62
    v_lshl_or_b32 v63, v63, 13, v62
    v_bfe_u32 v62, v2, 8, 1
    v_lshl_or_b32 v63, v62, 5, v63
    v_bfe_u32 v62, v2, 9, 1
    v_lshl_or_b32 v63, v62, 4, v63
    v_mfma_f32_16x16x32_bf16 v[248:251], a[180:183], a[252:255], v[248:251]
    buffer_load_dwordx4 a[56:59], v9, s[16:19], s43 offen offset:2048 sc1
    v_mfma_f32_16x16x32_bf16 v[252:255], a[184:187], a[248:251], v[252:255]
    v_mfma_f32_16x16x32_bf16 v[252:255], a[188:191], a[252:255], v[252:255]
    s_waitcnt lgkmcnt(0)
    v_mfma_f32_16x16x32_bf16 v[128:131], a[64:67], a[0:3], v[128:131]
    ds_read_b64_tr_b16 a[128:129], v24 offset:49152
    ds_read_b64_tr_b16 a[130:131], v24 offset:50176
    v_mfma_f32_16x16x32_bf16 v[128:131], a[68:71], a[4:7], v[128:131]
    ds_read_b64_tr_b16 a[132:133], v24 offset:57344
    ds_read_b64_tr_b16 a[134:135], v24 offset:58368
    v_mfma_f32_16x16x32_bf16 v[132:135], a[72:75], a[0:3], v[132:135]
    v_accvgpr_write_b32 a224, v96
    s_add_u32 m0, s37, 32768
    v_mfma_f32_16x16x32_bf16 v[132:135], a[76:79], a[4:7], v[132:135]
    buffer_load_dwordx4 v2, s[8:11], s36 offen offset:0 sc1 lds
    v_mfma_f32_16x16x32_bf16 v[136:139], a[80:83], a[0:3], v[136:139]
    buffer_load_dwordx4 a[60:63], v9, s[16:19], s43 offen offset:3072 sc1
    v_mfma_f32_16x16x32_bf16 v[136:139], a[84:87], a[4:7], v[136:139]
    v_accvgpr_write_b32 a225, v97
    v_accvgpr_write_b32 a226, v98
    v_mfma_f32_16x16x32_bf16 v[140:143], a[88:91], a[0:3], v[140:143]
    v_accvgpr_write_b32 a227, v99
    v_accvgpr_write_b32 a228, v100
    v_mfma_f32_16x16x32_bf16 v[140:143], a[92:95], a[4:7], v[140:143]
    v_accvgpr_write_b32 a229, v101
    v_accvgpr_write_b32 a230, v102
    v_mfma_f32_16x16x32_bf16 v[144:147], a[96:99], a[0:3], v[144:147]
    v_accvgpr_write_b32 a231, v103
    v_accvgpr_write_b32 a232, v104
    v_mfma_f32_16x16x32_bf16 v[144:147], a[100:103], a[4:7], v[144:147]
    buffer_load_dwordx4 v2, s[8:11], s36 offen offset:1024 sc1 lds
    v_mfma_f32_16x16x32_bf16 v[148:151], a[104:107], a[0:3], v[148:151]
    v_accvgpr_write_b32 a233, v105
    v_accvgpr_write_b32 a234, v106
    v_mfma_f32_16x16x32_bf16 v[148:151], a[108:111], a[4:7], v[148:151]
    v_accvgpr_write_b32 a235, v107
    v_accvgpr_write_b32 a236, v108
    v_mfma_f32_16x16x32_bf16 v[152:155], a[112:115], a[0:3], v[152:155]
    buffer_store_dwordx4 v[124:127], v5, s[64:67], s73 offen offset:3072 sc1
    v_mfma_f32_16x16x32_bf16 v[152:155], a[116:119], a[4:7], v[152:155]
    v_accvgpr_write_b32 a237, v109
    v_accvgpr_write_b32 a238, v110
    v_mfma_f32_16x16x32_bf16 v[156:159], a[120:123], a[0:3], v[156:159]
    v_accvgpr_write_b32 a239, v111
    ds_read_b64_tr_b16 a[136:137], v25 offset:49152
    v_mfma_f32_16x16x32_bf16 v[156:159], a[124:127], a[4:7], v[156:159]
    ds_read_b64_tr_b16 a[138:139], v25 offset:50176
    ds_read_b64_tr_b16 a[140:141], v25 offset:57344
    v_mfma_f32_16x16x32_bf16 v[160:163], a[64:67], a[8:11], v[160:163]
    v_accvgpr_write_b32 a240, v112
    ds_read_b64_tr_b16 a[142:143], v25 offset:58368
    v_mfma_f32_16x16x32_bf16 v[160:163], a[68:71], a[12:15], v[160:163]
    buffer_load_dwordx4 v2, s[8:11], s36 offen offset:2048 sc1 lds
    v_mfma_f32_16x16x32_bf16 v[164:167], a[72:75], a[8:11], v[164:167]
    v_accvgpr_write_b32 a241, v113
    v_accvgpr_write_b32 a242, v114
    v_mfma_f32_16x16x32_bf16 v[164:167], a[76:79], a[12:15], v[164:167]
    v_accvgpr_write_b32 a243, v115
    ds_read_b64_tr_b16 a[144:145], v26 offset:49152
    v_mfma_f32_16x16x32_bf16 v[168:171], a[80:83], a[8:11], v[168:171]
    ds_read_b64_tr_b16 a[146:147], v26 offset:50176
    ds_read_b64_tr_b16 a[148:149], v26 offset:57344
    v_mfma_f32_16x16x32_bf16 v[168:171], a[84:87], a[12:15], v[168:171]
    v_accvgpr_write_b32 a244, v116
    ds_read_b64_tr_b16 a[150:151], v26 offset:58368
    v_mfma_f32_16x16x32_bf16 v[172:175], a[88:91], a[8:11], v[172:175]
    v_accvgpr_write_b32 a245, v117
    ds_read_b64_tr_b16 a[152:153], v27 offset:49152
    v_mfma_f32_16x16x32_bf16 v[172:175], a[92:95], a[12:15], v[172:175]
    v_accvgpr_write_b32 a246, v118
    ds_read_b64_tr_b16 a[154:155], v27 offset:50176
    v_mfma_f32_16x16x32_bf16 v[176:179], a[96:99], a[8:11], v[176:179]
    v_accvgpr_write_b32 a247, v119
    ds_read_b64_tr_b16 a[156:157], v27 offset:57344
    v_mfma_f32_16x16x32_bf16 v[176:179], a[100:103], a[12:15], v[176:179]
    buffer_load_dwordx4 v2, s[8:11], s36 offen offset:3072 sc1 lds
    v_mfma_f32_16x16x32_bf16 v[180:183], a[104:107], a[8:11], v[180:183]
    v_accvgpr_write_b32 a248, v120
    ds_read_b64_tr_b16 a[158:159], v27 offset:58368
    v_mfma_f32_16x16x32_bf16 v[180:183], a[108:111], a[12:15], v[180:183]
    v_accvgpr_write_b32 a249, v121
    ds_read_b64_tr_b16 a[160:161], v28 offset:49152
    v_mfma_f32_16x16x32_bf16 v[184:187], a[112:115], a[8:11], v[184:187]
    v_accvgpr_write_b32 a250, v122
    ds_read_b64_tr_b16 a[162:163], v28 offset:50176
    v_mfma_f32_16x16x32_bf16 v[184:187], a[116:119], a[12:15], v[184:187]
    v_accvgpr_write_b32 a251, v123
    ds_read_b64_tr_b16 a[164:165], v28 offset:57344
    v_mfma_f32_16x16x32_bf16 v[188:191], a[120:123], a[8:11], v[188:191]
    ds_read_b64_tr_b16 a[166:167], v28 offset:58368
    ds_read_b64_tr_b16 a[168:169], v29 offset:49152
    v_mfma_f32_16x16x32_bf16 v[188:191], a[124:127], a[12:15], v[188:191]
    v_accvgpr_write_b32 a252, v124
    ds_read_b64_tr_b16 a[170:171], v29 offset:50176
    s_waitcnt vmcnt(29)
    v_mfma_f32_16x16x32_bf16 v[192:195], a[64:67], a[16:19], v[192:195]
    v_accvgpr_write_b32 a253, v125
    ds_read_b64_tr_b16 a[172:173], v29 offset:57344
    s_waitcnt vmcnt(27)
    v_mfma_f32_16x16x32_bf16 v[192:195], a[68:71], a[20:23], v[192:195]
    v_accvgpr_write_b32 a254, v126
    s_add_u32 m0, s37, 36864
    v_mfma_f32_16x16x32_bf16 v[196:199], a[72:75], a[16:19], v[196:199]
    buffer_load_dwordx4 v3, s[8:11], s36 offen offset:0 sc1 lds
    v_mfma_f32_16x16x32_bf16 v[196:199], a[76:79], a[20:23], v[196:199]
    v_accvgpr_write_b32 a255, v127
    ds_read_b64_tr_b16 a[174:175], v29 offset:58368
    v_mfma_f32_16x16x32_bf16 v[200:203], a[80:83], a[16:19], v[200:203]
    ds_read_b64_tr_b16 a[176:177], v30 offset:49152
    ds_read_b64_tr_b16 a[178:179], v30 offset:50176
    v_mfma_f32_16x16x32_bf16 v[200:203], a[84:87], a[20:23], v[200:203]
    ds_read_b64_tr_b16 a[180:181], v30 offset:57344
    ds_read_b64_tr_b16 a[182:183], v30 offset:58368
    v_mfma_f32_16x16x32_bf16 v[204:207], a[88:91], a[16:19], v[204:207]
    v_mfma_f32_16x16x32_bf16 v[204:207], a[92:95], a[20:23], v[204:207]
    v_mfma_f32_16x16x32_bf16 v[208:211], a[96:99], a[16:19], v[208:211]
    buffer_load_dwordx4 v3, s[8:11], s36 offen offset:1024 sc1 lds
    v_mfma_f32_16x16x32_bf16 v[208:211], a[100:103], a[20:23], v[208:211]
    v_mfma_f32_16x16x32_bf16 v[212:215], a[104:107], a[16:19], v[212:215]
    ds_read_b64_tr_b16 a[184:185], v31 offset:49152
    ds_read_b64_tr_b16 a[186:187], v31 offset:50176
    v_mfma_f32_16x16x32_bf16 v[212:215], a[108:111], a[20:23], v[212:215]
    ds_read_b64_tr_b16 a[188:189], v31 offset:57344
    ds_read_b64_tr_b16 a[190:191], v31 offset:58368
    v_mfma_f32_16x16x32_bf16 v[216:219], a[112:115], a[16:19], v[216:219]
    v_mov_b32 v80, v7
    v_mov_b32 v81, v7
    v_mfma_f32_16x16x32_bf16 v[216:219], a[116:119], a[20:23], v[216:219]
    v_mov_b32 v82, v7
    v_mov_b32 v83, v7
    v_mfma_f32_16x16x32_bf16 v[220:223], a[120:123], a[16:19], v[220:223]
    v_mov_b32 v84, v7
    v_mov_b32 v85, v7
    v_mfma_f32_16x16x32_bf16 v[220:223], a[124:127], a[20:23], v[220:223]
    v_mov_b32 v86, v7
    s_waitcnt vmcnt(28)
    v_mfma_f32_16x16x32_bf16 v[224:227], a[64:67], a[24:27], v[224:227]
    buffer_load_dwordx4 v3, s[8:11], s36 offen offset:2048 sc1 lds
    s_waitcnt vmcnt(27)
    v_mfma_f32_16x16x32_bf16 v[224:227], a[68:71], a[28:31], v[224:227]
    v_mov_b32 v87, v7
    v_mfma_f32_16x16x32_bf16 v[228:231], a[72:75], a[24:27], v[228:231]
    v_mov_b32 v88, v7
    v_mfma_f32_16x16x32_bf16 v[228:231], a[76:79], a[28:31], v[228:231]
    v_mov_b32 v89, v7
    v_mfma_f32_16x16x32_bf16 v[232:235], a[80:83], a[24:27], v[232:235]
    v_mfma_f32_16x16x32_bf16 v[232:235], a[84:87], a[28:31], v[232:235]
    v_mov_b32 v90, v7
    v_mfma_f32_16x16x32_bf16 v[236:239], a[88:91], a[24:27], v[236:239]
    v_mov_b32 v91, v7
    v_mfma_f32_16x16x32_bf16 v[236:239], a[92:95], a[28:31], v[236:239]
    v_mfma_f32_16x16x32_bf16 v[240:243], a[96:99], a[24:27], v[240:243]
    buffer_load_dwordx4 v3, s[8:11], s36 offen offset:3072 sc1 lds
    s_add_u32 s36, s36, 32768
    v_mfma_f32_16x16x32_bf16 v[240:243], a[100:103], a[28:31], v[240:243]
    v_mov_b32 v92, v7
    v_mfma_f32_16x16x32_bf16 v[244:247], a[104:107], a[24:27], v[244:247]
    v_mov_b32 v93, v7
    v_mfma_f32_16x16x32_bf16 v[244:247], a[108:111], a[28:31], v[244:247]
    v_mov_b32 v94, v7
    v_mfma_f32_16x16x32_bf16 v[248:251], a[112:115], a[24:27], v[248:251]
    v_mfma_f32_16x16x32_bf16 v[248:251], a[116:119], a[28:31], v[248:251]
    v_mov_b32 v95, v7
    v_mfma_f32_16x16x32_bf16 v[252:255], a[120:123], a[24:27], v[252:255]
    v_mov_b64 v[96:97], 0
    v_mfma_f32_16x16x32_bf16 v[252:255], a[124:127], a[28:31], v[252:255]
    s_waitcnt vmcnt(11) lgkmcnt(0)
    s_barrier
    v_mfma_f32_16x16x32_bf16 v[128:131], a[128:131], a[32:35], v[128:131]
    ds_read_b128 a[64:67], v6 offset:0
    ds_read_b128 a[68:71], v6 offset:1024
    s_add_u32 m0, s37, 65536
    v_mfma_f32_16x16x32_bf16 v[128:131], a[132:135], a[36:39], v[128:131]
    ds_read_b128 a[72:75], v6 offset:2048
    ds_read_b128 a[76:79], v6 offset:3072
    buffer_load_dwordx4 v2, s[8:11], s36 offen offset:0 sc1 lds
    v_mfma_f32_16x16x32_bf16 v[132:135], a[136:139], a[32:35], v[132:135]
    ds_read_b128 a[80:83], v6 offset:4096
    ds_read_b128 a[84:87], v6 offset:5120
    ds_read_b128 a[88:91], v6 offset:6144
    v_mfma_f32_16x16x32_bf16 v[132:135], a[140:143], a[36:39], v[132:135]
    ds_read_b128 a[92:95], v6 offset:7168
    ds_read_b128 a[96:99], v6 offset:8192
    ds_read_b128 a[100:103], v6 offset:9216
    v_mfma_f32_16x16x32_bf16 v[136:139], a[144:147], a[32:35], v[136:139]
    ds_read_b128 a[104:107], v6 offset:10240
    ds_read_b128 a[108:111], v6 offset:11264
    ds_read_b128 a[112:115], v6 offset:12288
    v_mfma_f32_16x16x32_bf16 v[136:139], a[148:151], a[36:39], v[136:139]
    ds_read_b128 a[116:119], v6 offset:13312
    ds_read_b128 a[120:123], v6 offset:14336
    v_mov_b64 v[98:99], 0
    v_mfma_f32_16x16x32_bf16 v[140:143], a[152:155], a[32:35], v[140:143]
    v_mov_b64 v[100:101], 0
    v_mov_b64 v[102:103], 0
    v_mov_b64 v[8:9], 0
    v_mfma_f32_16x16x32_bf16 v[140:143], a[156:159], a[36:39], v[140:143]
    v_mov_b64 v[10:11], 0
    buffer_load_dwordx4 v2, s[8:11], s36 offen offset:1024 sc1 lds
    v_mfma_f32_16x16x32_bf16 v[144:147], a[160:163], a[32:35], v[144:147]
    s_add_u32 s38, s37, 0x18000
    s_min_u32 s35, s34, 6
    s_sub_u32 s83, s34, s35
    v_mfma_f32_16x16x32_bf16 v[144:147], a[164:167], a[36:39], v[144:147]
    ds_read_b128 a[124:127], v6 offset:15360
    v_and_b32 v56, 0x30, v2
    v_mfma_f32_16x16x32_bf16 v[148:151], a[168:171], a[32:35], v[148:151]
    v_cvt_pk_bf16_f32 v32, v128, v129
    v_cvt_pk_bf16_f32 v33, v130, v131
    s_and_b32 s4, s78, 0xffffff80
    s_add_u32 s4, s4, 64
    v_mfma_f32_16x16x32_bf16 v[148:151], a[172:175], a[36:39], v[148:151]
    v_cvt_pk_bf16_f32 v34, v132, v133
    v_cvt_pk_bf16_f32 v35, v134, v135
    ds_write_b128 v17, v[32:35] offset:0
    v_mfma_f32_16x16x32_bf16 v[152:155], a[176:179], a[32:35], v[152:155]
    v_accvgpr_write_b32 a0, v32
    v_accvgpr_write_b32 a1, v33
    v_accvgpr_write_b32 a2, v34
    v_mfma_f32_16x16x32_bf16 v[152:155], a[180:183], a[36:39], v[152:155]
    v_accvgpr_write_b32 a3, v35
    v_mov_b64 v[128:129], 0
    v_mov_b64 v[130:131], 0
    v_mfma_f32_16x16x32_bf16 v[156:159], a[184:187], a[32:35], v[156:159]
    v_mov_b64 v[132:133], 0
    v_mov_b64 v[134:135], 0
    buffer_load_dwordx4 v2, s[8:11], s36 offen offset:2048 sc1 lds
    v_mfma_f32_16x16x32_bf16 v[156:159], a[188:191], a[36:39], v[156:159]
    v_cvt_pk_bf16_f32 v36, v136, v137
    v_cvt_pk_bf16_f32 v37, v138, v139
    v_cvt_pk_bf16_f32 v38, v140, v141
    v_mfma_f32_16x16x32_bf16 v[160:163], a[128:131], a[40:43], v[160:163]
    v_cvt_pk_bf16_f32 v39, v142, v143
    ds_write_b128 v17, v[36:39] offset:1024
    v_accvgpr_write_b32 a4, v36
    v_mfma_f32_16x16x32_bf16 v[160:163], a[132:135], a[44:47], v[160:163]
    v_accvgpr_write_b32 a5, v37
    v_accvgpr_write_b32 a6, v38
    v_add_u32 v56, s4, v56
    v_mfma_f32_16x16x32_bf16 v[164:167], a[136:139], a[40:43], v[164:167]
    v_accvgpr_write_b32 a7, v39
    v_mov_b64 v[136:137], 0
    v_mov_b64 v[138:139], 0
    v_mfma_f32_16x16x32_bf16 v[164:167], a[140:143], a[44:47], v[164:167]
    v_mov_b64 v[140:141], 0
    v_mov_b64 v[142:143], 0
    v_cvt_pk_bf16_f32 v32, v144, v145
    v_mfma_f32_16x16x32_bf16 v[168:171], a[144:147], a[40:43], v[168:171]
    v_cvt_pk_bf16_f32 v33, v146, v147
    v_cvt_pk_bf16_f32 v34, v148, v149
    v_cvt_pk_bf16_f32 v35, v150, v151
    v_mfma_f32_16x16x32_bf16 v[168:171], a[148:151], a[44:47], v[168:171]
    ds_write_b128 v17, v[32:35] offset:2048
    v_accvgpr_write_b32 a8, v32
    buffer_load_dwordx4 v2, s[8:11], s36 offen offset:3072 sc1 lds
    v_mfma_f32_16x16x32_bf16 v[172:175], a[152:155], a[40:43], v[172:175]
    v_accvgpr_write_b32 a9, v33
    v_accvgpr_write_b32 a10, v34
    v_accvgpr_write_b32 a11, v35
    v_mfma_f32_16x16x32_bf16 v[172:175], a[156:159], a[44:47], v[172:175]
    v_mov_b64 v[144:145], 0
    v_mov_b64 v[146:147], 0
    v_mov_b64 v[148:149], 0
    v_mfma_f32_16x16x32_bf16 v[176:179], a[160:163], a[40:43], v[176:179]
    v_mov_b64 v[150:151], 0
    v_cvt_pk_bf16_f32 v36, v152, v153
    v_cvt_pk_bf16_f32 v37, v154, v155
    v_mfma_f32_16x16x32_bf16 v[176:179], a[164:167], a[44:47], v[176:179]
    v_cvt_pk_bf16_f32 v38, v156, v157
    v_cvt_pk_bf16_f32 v39, v158, v159
    ds_write_b128 v17, v[36:39] offset:3072
    v_mfma_f32_16x16x32_bf16 v[180:183], a[168:171], a[40:43], v[180:183]
    v_accvgpr_write_b32 a12, v36
    v_accvgpr_write_b32 a13, v37
    v_accvgpr_write_b32 a14, v38
    v_mfma_f32_16x16x32_bf16 v[180:183], a[172:175], a[44:47], v[180:183]
    v_accvgpr_write_b32 a15, v39
    v_mov_b64 v[152:153], 0
    v_mov_b64 v[154:155], 0
    v_mfma_f32_16x16x32_bf16 v[184:187], a[176:179], a[40:43], v[184:187]
    v_mov_b64 v[156:157], 0
    v_mov_b64 v[158:159], 0
    v_cvt_pk_bf16_f32 v32, v160, v161
    v_mfma_f32_16x16x32_bf16 v[184:187], a[180:183], a[44:47], v[184:187]
    v_cvt_pk_bf16_f32 v33, v162, v163
    v_cvt_pk_bf16_f32 v34, v164, v165
    s_add_u32 m0, s37, 69632
    v_mfma_f32_16x16x32_bf16 v[188:191], a[184:187], a[40:43], v[188:191]
    v_cvt_pk_bf16_f32 v35, v166, v167
    ds_write_b128 v17, v[32:35] offset:4096
    buffer_load_dwordx4 v3, s[8:11], s36 offen offset:0 sc1 lds
    v_mfma_f32_16x16x32_bf16 v[188:191], a[188:191], a[44:47], v[188:191]
    v_accvgpr_write_b32 a16, v32
    v_accvgpr_write_b32 a17, v33
    v_accvgpr_write_b32 a18, v34
    v_mfma_f32_16x16x32_bf16 v[192:195], a[128:131], a[48:51], v[192:195]
    v_accvgpr_write_b32 a19, v35
    v_mov_b64 v[160:161], 0
    v_mov_b64 v[162:163], 0
    v_mfma_f32_16x16x32_bf16 v[192:195], a[132:135], a[52:55], v[192:195]
    v_mov_b64 v[164:165], 0
    v_mov_b64 v[166:167], 0
    v_cvt_pk_bf16_f32 v36, v168, v169
    v_mfma_f32_16x16x32_bf16 v[196:199], a[136:139], a[48:51], v[196:199]
    v_cvt_pk_bf16_f32 v37, v170, v171
    v_cvt_pk_bf16_f32 v38, v172, v173
    v_cvt_pk_bf16_f32 v39, v174, v175
    v_mfma_f32_16x16x32_bf16 v[196:199], a[140:143], a[52:55], v[196:199]
    ds_write_b128 v17, v[36:39] offset:5120
    v_accvgpr_write_b32 a20, v36
    v_accvgpr_write_b32 a21, v37
    v_mfma_f32_16x16x32_bf16 v[200:203], a[144:147], a[48:51], v[200:203]
    v_accvgpr_write_b32 a22, v38
    v_accvgpr_write_b32 a23, v39
    buffer_load_dwordx4 v3, s[8:11], s36 offen offset:1024 sc1 lds
    v_mfma_f32_16x16x32_bf16 v[200:203], a[148:151], a[52:55], v[200:203]
    v_mov_b64 v[168:169], 0
    v_mov_b64 v[170:171], 0
    v_mov_b64 v[172:173], 0
    v_mfma_f32_16x16x32_bf16 v[204:207], a[152:155], a[48:51], v[204:207]
    v_mov_b64 v[174:175], 0
    v_cvt_pk_bf16_f32 v32, v176, v177
    v_cvt_pk_bf16_f32 v33, v178, v179
    v_mfma_f32_16x16x32_bf16 v[204:207], a[156:159], a[52:55], v[204:207]
    v_cvt_pk_bf16_f32 v34, v180, v181
    v_cvt_pk_bf16_f32 v35, v182, v183
    ds_write_b128 v17, v[32:35] offset:6144
    v_mfma_f32_16x16x32_bf16 v[208:211], a[160:163], a[48:51], v[208:211]
    v_accvgpr_write_b32 a24, v32
    v_accvgpr_write_b32 a25, v33
    v_accvgpr_write_b32 a26, v34
    v_mfma_f32_16x16x32_bf16 v[208:211], a[164:167], a[52:55], v[208:211]
    v_accvgpr_write_b32 a27, v35
    v_mov_b64 v[176:177], 0
    v_mov_b64 v[178:179], 0
    v_mfma_f32_16x16x32_bf16 v[212:215], a[168:171], a[48:51], v[212:215]
    v_mov_b64 v[180:181], 0
    v_mov_b64 v[182:183], 0
    v_cvt_pk_bf16_f32 v36, v184, v185
    v_mfma_f32_16x16x32_bf16 v[212:215], a[172:175], a[52:55], v[212:215]
    v_cvt_pk_bf16_f32 v37, v186, v187
    v_cvt_pk_bf16_f32 v38, v188, v189
    buffer_load_dwordx4 v3, s[8:11], s36 offen offset:2048 sc1 lds
    v_mfma_f32_16x16x32_bf16 v[216:219], a[176:179], a[48:51], v[216:219]
    v_cvt_pk_bf16_f32 v39, v190, v191
    ds_write_b128 v17, v[36:39] offset:7168
    v_accvgpr_write_b32 a28, v36
    v_mfma_f32_16x16x32_bf16 v[216:219], a[180:183], a[52:55], v[216:219]
    v_accvgpr_write_b32 a29, v37
    v_accvgpr_write_b32 a30, v38
    v_accvgpr_write_b32 a31, v39
    v_mfma_f32_16x16x32_bf16 v[220:223], a[184:187], a[48:51], v[220:223]
    v_mov_b64 v[184:185], 0
    v_mov_b64 v[186:187], 0
    v_mov_b64 v[188:189], 0
    v_mfma_f32_16x16x32_bf16 v[220:223], a[188:191], a[52:55], v[220:223]
    v_mov_b64 v[190:191], 0
    v_cvt_pk_bf16_f32 v32, v192, v193
    v_cvt_pk_bf16_f32 v33, v194, v195
    s_waitcnt vmcnt(17)
    v_mfma_f32_16x16x32_bf16 v[224:227], a[128:131], a[56:59], v[224:227]
    v_cvt_pk_bf16_f32 v34, v196, v197
    v_cvt_pk_bf16_f32 v35, v198, v199
    v_accvgpr_write_b32 a32, v32
    s_waitcnt vmcnt(15)
    v_mfma_f32_16x16x32_bf16 v[224:227], a[132:135], a[60:63], v[224:227]
    v_accvgpr_write_b32 a33, v33
    v_accvgpr_write_b32 a34, v34
    v_accvgpr_write_b32 a35, v35
    v_mfma_f32_16x16x32_bf16 v[228:231], a[136:139], a[56:59], v[228:231]
    v_mov_b64 v[192:193], 0
    buffer_load_dwordx4 v3, s[8:11], s36 offen offset:3072 sc1 lds
    s_add_u32 s36, s36, 32768
    v_mfma_f32_16x16x32_bf16 v[228:231], a[140:143], a[60:63], v[228:231]
    v_mov_b64 v[194:195], 0
    v_mov_b64 v[196:197], 0
    v_mov_b64 v[198:199], 0
    v_mfma_f32_16x16x32_bf16 v[232:235], a[144:147], a[56:59], v[232:235]
    v_cvt_pk_bf16_f32 v36, v200, v201
    v_cvt_pk_bf16_f32 v37, v202, v203
    v_cvt_pk_bf16_f32 v38, v204, v205
    v_mfma_f32_16x16x32_bf16 v[232:235], a[148:151], a[60:63], v[232:235]
    v_cvt_pk_bf16_f32 v39, v206, v207
    v_accvgpr_write_b32 a36, v36
    v_accvgpr_write_b32 a37, v37
    v_mfma_f32_16x16x32_bf16 v[236:239], a[152:155], a[56:59], v[236:239]
    v_accvgpr_write_b32 a38, v38
    v_accvgpr_write_b32 a39, v39
    v_mov_b64 v[200:201], 0
    v_mfma_f32_16x16x32_bf16 v[236:239], a[156:159], a[60:63], v[236:239]
    v_mov_b64 v[202:203], 0
    v_mov_b64 v[204:205], 0
    v_mov_b64 v[206:207], 0
    v_mfma_f32_16x16x32_bf16 v[240:243], a[160:163], a[56:59], v[240:243]
    v_cvt_pk_bf16_f32 v32, v208, v209
    v_cvt_pk_bf16_f32 v33, v210, v211
    v_cvt_pk_bf16_f32 v34, v212, v213
    v_mfma_f32_16x16x32_bf16 v[240:243], a[164:167], a[60:63], v[240:243]
    v_cvt_pk_bf16_f32 v35, v214, v215
    v_accvgpr_write_b32 a40, v32
    v_accvgpr_write_b32 a41, v33
    v_mfma_f32_16x16x32_bf16 v[244:247], a[168:171], a[56:59], v[244:247]
    v_accvgpr_write_b32 a42, v34
    v_accvgpr_write_b32 a43, v35
    v_mov_b64 v[208:209], 0
    v_mfma_f32_16x16x32_bf16 v[244:247], a[172:175], a[60:63], v[244:247]
    v_mov_b64 v[210:211], 0
    v_mov_b64 v[212:213], 0
    v_mov_b64 v[214:215], 0
    v_mfma_f32_16x16x32_bf16 v[248:251], a[176:179], a[56:59], v[248:251]
    v_cvt_pk_bf16_f32 v36, v216, v217
    v_cvt_pk_bf16_f32 v37, v218, v219
    v_cvt_pk_bf16_f32 v38, v220, v221
    v_mfma_f32_16x16x32_bf16 v[248:251], a[180:183], a[60:63], v[248:251]
    v_cvt_pk_bf16_f32 v39, v222, v223
    v_accvgpr_write_b32 a44, v36
    v_accvgpr_write_b32 a45, v37
    v_mfma_f32_16x16x32_bf16 v[252:255], a[184:187], a[56:59], v[252:255]
    v_accvgpr_write_b32 a46, v38
    v_accvgpr_write_b32 a47, v39
    v_mov_b64 v[216:217], 0
    v_mfma_f32_16x16x32_bf16 v[252:255], a[188:191], a[60:63], v[252:255]
    v_mov_b64 v[218:219], 0
    v_mov_b64 v[220:221], 0
    v_mov_b64 v[222:223], 0
    s_waitcnt lgkmcnt(0)
    s_barrier
    ds_read_b128 a[128:131], v18 offset:0
    ds_read_b128 a[132:135], v18 offset:1024
    ds_read_b128 a[136:139], v18 offset:2048
    ds_read_b128 a[140:143], v18 offset:3072
    ds_read_b128 a[144:147], v18 offset:4096
    ds_read_b128 a[148:151], v18 offset:5120
    ds_read_b128 a[152:155], v18 offset:6144
    ds_read_b128 a[156:159], v18 offset:7168
    v_lshlrev_b32 v48, 3, v2
    v_min_u32 v48, 2304, v48
    s_lshl2_add_u32 s3, s2, s32
    s_sub_u32 s3, s3, 256
    s_max_i32 s3, s3, 0
    s_mul_i32 s3, s3, 2432
    v_add_u32 v48, s3, v48
    v_min_u32 v48, 1834880, v48
    s_cmp_lt_u32 s34, 2
    s_cselect_b64 exec, 0, -1
    global_load_dword v62, v48, s[56:57]
    global_load_dword v62, v48, s[58:59]
    global_load_dword v62, v48, s[60:61]
    s_mov_b64 exec, -1
    v_mfma_f32_16x16x32_bf16 v[64:67], a[64:67], a[0:3], 0
    v_mfma_f32_16x16x32_bf16 v[64:67], a[68:71], a[4:7], v[64:67]
    v_cvt_pk_bf16_f32 v32, v224, v225
    v_cvt_pk_bf16_f32 v33, v226, v227
    v_cvt_pk_bf16_f32 v34, v228, v229
    v_mfma_f32_16x16x32_bf16 v[64:67], a[72:75], a[8:11], v[64:67]
    v_cvt_pk_bf16_f32 v35, v230, v231
    v_accvgpr_write_b32 a48, v32
    v_accvgpr_write_b32 a49, v33
    v_mfma_f32_16x16x32_bf16 v[64:67], a[76:79], a[12:15], v[64:67]
    v_accvgpr_write_b32 a50, v34
    v_accvgpr_write_b32 a51, v35
    v_mfma_f32_16x16x32_bf16 v[68:71], a[64:67], a[16:19], 0
    v_mov_b64 v[224:225], 0
    v_mov_b64 v[226:227], 0
    v_mfma_f32_16x16x32_bf16 v[68:71], a[68:71], a[20:23], v[68:71]
    v_mov_b64 v[228:229], 0
    v_mov_b64 v[230:231], 0
    v_mfma_f32_16x16x32_bf16 v[68:71], a[72:75], a[24:27], v[68:71]
    v_cvt_pk_bf16_f32 v36, v232, v233
    v_cvt_pk_bf16_f32 v37, v234, v235
    v_mfma_f32_16x16x32_bf16 v[68:71], a[76:79], a[28:31], v[68:71]
    v_cvt_pk_bf16_f32 v38, v236, v237
    v_cvt_pk_bf16_f32 v39, v238, v239
    v_mfma_f32_16x16x32_bf16 v[72:75], a[64:67], a[32:35], v[20:23]
    v_accvgpr_write_b32 a52, v36
    v_accvgpr_write_b32 a53, v37
    v_mfma_f32_16x16x32_bf16 v[72:75], a[68:71], a[36:39], v[72:75]
    v_accvgpr_write_b32 a54, v38
    v_accvgpr_write_b32 a55, v39
    v_mfma_f32_16x16x32_bf16 v[72:75], a[72:75], a[40:43], v[72:75]
    v_mov_b64 v[232:233], 0
    v_mov_b64 v[234:235], 0
    v_mfma_f32_16x16x32_bf16 v[72:75], a[76:79], a[44:47], v[72:75]
    v_mov_b64 v[236:237], 0
    v_mov_b64 v[238:239], 0
    s_waitcnt lgkmcnt(0)
    v_mfma_f32_16x16x32_bf16 v[40:43], a[64:67], a[128:131], 0
    v_cvt_pk_bf16_f32 v32, v240, v241
    v_cvt_pk_bf16_f32 v33, v242, v243
    v_mfma_f32_16x16x32_bf16 v[40:43], a[68:71], a[132:135], v[40:43]
    v_cvt_pk_bf16_f32 v34, v244, v245
    v_cvt_pk_bf16_f32 v35, v246, v247
    v_mfma_f32_16x16x32_bf16 v[40:43], a[72:75], a[136:139], v[40:43]
    v_accvgpr_write_b32 a56, v32
    v_accvgpr_write_b32 a57, v33
    v_mfma_f32_16x16x32_bf16 v[40:43], a[76:79], a[140:143], v[40:43]
    v_accvgpr_write_b32 a58, v34
    v_accvgpr_write_b32 a59, v35
    v_mfma_f32_16x16x32_bf16 v[44:47], a[64:67], a[144:147], 0
    v_mov_b64 v[240:241], 0
    v_mov_b64 v[242:243], 0
    v_mfma_f32_16x16x32_bf16 v[44:47], a[68:71], a[148:151], v[44:47]
    v_mov_b64 v[244:245], 0
    v_mov_b64 v[246:247], 0
    v_mfma_f32_16x16x32_bf16 v[44:47], a[72:75], a[152:155], v[44:47]
    v_cvt_pk_bf16_f32 v36, v248, v249
    v_cvt_pk_bf16_f32 v37, v250, v251
    v_cvt_pk_bf16_f32 v38, v252, v253
    v_cvt_pk_bf16_f32 v39, v254, v255
    v_accvgpr_write_b32 a60, v36
    v_accvgpr_write_b32 a61, v37
    v_accvgpr_write_b32 a62, v38
    v_accvgpr_write_b32 a63, v39
    v_mov_b64 v[248:249], 0
    v_mov_b64 v[250:251], 0
    v_mov_b64 v[252:253], 0
    v_mov_b64 v[254:255], 0
    v_mfma_f32_16x16x32_bf16 v[44:47], a[76:79], a[156:159], v[44:47]
    v_mfma_f32_16x16x32_bf16 v[76:79], a[64:67], a[48:51], 0
    v_mfma_f32_16x16x32_bf16 v[76:79], a[68:71], a[52:55], v[76:79]
    v_mfma_f32_16x16x32_bf16 v[76:79], a[72:75], a[56:59], v[76:79]
    v_mfma_f32_16x16x32_bf16 v[76:79], a[76:79], a[60:63], v[76:79]
    v_max3_f32 v64, v64, v65, v66
    v_max3_f32 v68, v68, v69, v70
    v_max3_f32 v72, v72, v73, v74
    v_max3_f32 v40, v40, v41, v42
    v_max3_f32 v44, v44, v45, v46
    s_nop 2
    v_max3_f32 v76, v76, v77, v78
    v_max_f32 v64, v64, v67
    v_max_f32 v68, v68, v71
    v_max_f32 v72, v72, v75
    v_max_f32 v40, v40, v43
    v_max_f32 v44, v44, v47
    v_max_f32 v76, v76, v79
    v_mov_b32 v65, v64
    v_mov_b32 v69, v68
    v_mov_b32 v73, v72
    v_mov_b32 v41, v40
    v_mov_b32 v45, v44
    v_mov_b32 v77, v76
    v_permlane16_swap_b32 v64, v65
    v_permlane16_swap_b32 v68, v69
    v_permlane16_swap_b32 v72, v73
    v_permlane16_swap_b32 v40, v41
    v_permlane16_swap_b32 v44, v45
    v_permlane16_swap_b32 v76, v77
    v_max_f32 v64, v64, v65
    v_max_f32 v68, v68, v69
    v_max_f32 v72, v72, v73
    v_max_f32 v40, v40, v41
    v_max_f32 v44, v44, v45
    v_max_f32 v76, v76, v77
    v_mov_b32 v65, v64
    v_mov_b32 v69, v68
    v_mov_b32 v73, v72
    v_mov_b32 v41, v40
    v_mov_b32 v45, v44
    v_mov_b32 v77, v76
    v_permlane32_swap_b32 v64, v65
    v_permlane32_swap_b32 v68, v69
    v_permlane32_swap_b32 v72, v73
    v_permlane32_swap_b32 v40, v41
    v_permlane32_swap_b32 v44, v45
    v_permlane32_swap_b32 v76, v77
    v_max_f32 v64, v64, v65
    v_max_f32 v68, v68, v69
    v_max_f32 v72, v72, v73
    v_max_f32 v40, v40, v41
    v_max_f32 v44, v44, v45
    v_max_f32 v76, v76, v77
    v_sub_f32 v112, 0, v64
    v_sub_f32 v113, 0, v64
    v_sub_f32 v114, 0, v64
    v_sub_f32 v115, 0, v64
    v_sub_f32 v116, 0, v68
    v_sub_f32 v117, 0, v68
    v_sub_f32 v118, 0, v68
    v_sub_f32 v119, 0, v68
    v_sub_f32 v120, 0, v72
    v_sub_f32 v121, 0, v72
    v_sub_f32 v122, 0, v72
    v_sub_f32 v123, 0, v72
    v_sub_f32 v12, 0, v40
    v_sub_f32 v13, 0, v44
    v_sub_f32 v124, 0, v76
    v_sub_f32 v125, 0, v76
    v_sub_f32 v126, 0, v76
    v_sub_f32 v127, 0, v76
    s_cmp_le_u32 s34, 1
    s_cselect_b32 s3, 0, 0x80000000
    v_or_b32 v34, s3, v0
    v_mov_b32 v32, s80
    v_mov_b32 v33, s81
    s_mov_b32 s66, s68
    s_waitcnt vmcnt(17)
    s_barrier
    buffer_store_dwordx2 v[32:33], v34, s[20:23], s78 offen sc1
    s_cmp_lg_u32 s48, 0
    s_cbranch_scc1 L_slow
L_go2:
    v_mov_b32 v50, s80
    v_mov_b32 v51, s81
    v_bfrev_b32 v52, 1
    s_cmp_eq_u32 s35, 0
    s_cbranch_scc1 L_d1
    s_lshl_b32 s3, s34, 1
    s_lshr_b32 s3, 0x5554, s3
    s_and_b32 s3, s3, 3
    s_sub_u32 s88, s35, s3
    s_cmp_lg_u32 s3, 0
    s_cbranch_scc1 L_p1
L_p0:
    s_mov_b32 s88, 0
    s_waitcnt lgkmcnt(0)
    v_mfma_f32_16x16x32_bf16 v[64:67], a[64:67], a[0:3], v[112:115]
    ds_read_b128 a[124:127], v6 offset:15360
    ds_read_b128 a[120:123], v6 offset:14336
    ds_read_b128 a[116:119], v6 offset:13312
    v_mfma_f32_16x16x32_bf16 v[64:67], a[68:71], a[4:7], v[64:67]
    ds_read_b128 a[112:115], v6 offset:12288
    buffer_store_dwordx4 a[192:195], v2, s[64:67], s70 offen offset:0 sc1
    v_mfma_f32_16x16x32_bf16 v[64:67], a[72:75], a[8:11], v[64:67]
    v_exp_f32 v80, v80
    v_exp_f32 v81, v81
    v_mfma_f32_16x16x32_bf16 v[64:67], a[76:79], a[12:15], v[64:67]
    v_add_f32 v11, v11, v80
    v_add_f32 v11, v11, v81
    v_exp_f32 v82, v82
    v_mfma_f32_16x16x32_bf16 v[68:71], a[92:95], a[12:15], v[112:115]
    s_mov_b32 m0, s38
    v_exp_f32 v83, v83
    v_mfma_f32_16x16x32_bf16 v[68:71], a[88:91], a[8:11], v[68:71]
    buffer_load_dwordx4 v2, s[8:11], s36 offen offset:0 sc1 lds
    v_mfma_f32_16x16x32_bf16 v[68:71], a[84:87], a[4:7], v[68:71]
    v_cvt_pk_bf16_f32 v104, v80, v81
    v_add_f32 v11, v11, v82
    v_mfma_f32_16x16x32_bf16 v[68:71], a[80:83], a[0:3], v[68:71]
    v_add_f32 v11, v11, v83
    v_cvt_pk_bf16_f32 v105, v82, v83
    v_mfma_f32_16x16x32_bf16 v[72:75], a[96:99], a[0:3], v[112:115]
    v_exp_f32 v84, v84
    v_mfma_f32_16x16x32_bf16 v[72:75], a[100:103], a[4:7], v[72:75]
    v_exp_f32 v85, v85
    v_mfma_f32_16x16x32_bf16 v[72:75], a[104:107], a[8:11], v[72:75]
    v_add_f32 v11, v11, v84
    v_add_f32 v11, v11, v85
    v_mfma_f32_16x16x32_bf16 v[72:75], a[108:111], a[12:15], v[72:75]
    v_exp_f32 v86, v86
    s_waitcnt lgkmcnt(0)
    v_mfma_f32_16x16x32_bf16 v[76:79], a[124:127], a[12:15], v[112:115]
    v_exp_f32 v87, v87
    v_mfma_f32_16x16x32_bf16 v[76:79], a[120:123], a[8:11], v[76:79]
    v_cvt_pk_bf16_f32 v106, v84, v85
    v_add_f32 v11, v11, v86
    v_mfma_f32_16x16x32_bf16 v[76:79], a[116:119], a[4:7], v[76:79]
    buffer_load_dwordx4 v2, s[8:11], s36 offen offset:1024 sc1 lds
    v_mfma_f32_16x16x32_bf16 v[76:79], a[112:115], a[0:3], v[76:79]
    buffer_store_dwordx4 a[196:199], v3, s[64:67], s70 offen offset:0 sc1
    v_mfma_f32_16x16x32_bf16 v[192:195], a[128:131], v[96:99], v[192:195]
    v_add_f32 v11, v11, v87
    v_cvt_pk_bf16_f32 v107, v86, v87
    v_mfma_f32_16x16x32_bf16 v[192:195], a[132:135], v[100:103], v[192:195]
    v_exp_f32 v88, v88
    v_mfma_f32_16x16x32_bf16 v[196:199], a[140:143], v[100:103], v[196:199]
    v_exp_f32 v89, v89
    v_mfma_f32_16x16x32_bf16 v[196:199], a[136:139], v[96:99], v[196:199]
    v_add_f32 v11, v11, v88
    v_add_f32 v11, v11, v89
    v_mfma_f32_16x16x32_bf16 v[200:203], a[144:147], v[96:99], v[200:203]
    v_exp_f32 v90, v90
    v_mfma_f32_16x16x32_bf16 v[200:203], a[148:151], v[100:103], v[200:203]
    v_exp_f32 v91, v91
    v_mfma_f32_16x16x32_bf16 v[204:207], a[156:159], v[100:103], v[204:207]
    buffer_load_dwordx4 v2, s[8:11], s36 offen offset:2048 sc1 lds
    v_mfma_f32_16x16x32_bf16 v[204:207], a[152:155], v[96:99], v[204:207]
    v_cvt_pk_bf16_f32 v108, v88, v89
    v_add_f32 v11, v11, v90
    v_mfma_f32_16x16x32_bf16 v[208:211], a[160:163], v[96:99], v[208:211]
    v_add_f32 v11, v11, v91
    v_cvt_pk_bf16_f32 v109, v90, v91
    v_mfma_f32_16x16x32_bf16 v[208:211], a[164:167], v[100:103], v[208:211]
    v_exp_f32 v92, v92
    v_mfma_f32_16x16x32_bf16 v[212:215], a[172:175], v[100:103], v[212:215]
    v_exp_f32 v93, v93
    v_mfma_f32_16x16x32_bf16 v[212:215], a[168:171], v[96:99], v[212:215]
    v_add_f32 v11, v11, v92
    v_add_f32 v11, v11, v93
    v_mfma_f32_16x16x32_bf16 v[216:219], a[176:179], v[96:99], v[216:219]
    v_exp_f32 v94, v94
    v_mfma_f32_16x16x32_bf16 v[216:219], a[180:183], v[100:103], v[216:219]
    v_exp_f32 v95, v95
    v_mfma_f32_16x16x32_bf16 v[220:223], a[188:191], v[100:103], v[220:223]
    v_cvt_pk_bf16_f32 v110, v92, v93
    v_add_f32 v11, v11, v94
    v_mfma_f32_16x16x32_bf16 v[220:223], a[184:187], v[96:99], v[220:223]
    v_add_f32 v11, v11, v95
    v_cvt_pk_bf16_f32 v111, v94, v95
    v_mfma_f32_16x16x32_bf16 v[80:83], a[64:67], a[16:19], v[116:119]
    v_exp_f32 v64, v64
    v_exp_f32 v65, v65
    v_mfma_f32_16x16x32_bf16 v[80:83], a[68:71], a[20:23], v[80:83]
    v_add_f32 v8, v8, v64
    buffer_store_dwordx4 a[200:203], v2, s[64:67], s71 offen offset:0 sc1
    v_mfma_f32_16x16x32_bf16 v[80:83], a[72:75], a[24:27], v[80:83]
    v_add_f32 v8, v8, v65
    v_exp_f32 v66, v66
    v_mfma_f32_16x16x32_bf16 v[80:83], a[76:79], a[28:31], v[80:83]
    v_exp_f32 v67, v67
    v_cvt_pk_bf16_f32 v96, v64, v65
    v_mfma_f32_16x16x32_bf16 v[84:87], a[92:95], a[28:31], v[116:119]
    v_add_f32 v8, v8, v66
    v_add_f32 v8, v8, v67
    v_cvt_pk_bf16_f32 v97, v66, v67
    v_mfma_f32_16x16x32_bf16 v[84:87], a[88:91], a[24:27], v[84:87]
    v_exp_f32 v68, v68
    v_exp_f32 v69, v69
    v_mfma_f32_16x16x32_bf16 v[84:87], a[84:87], a[20:23], v[84:87]
    v_add_f32 v8, v8, v68
    v_add_f32 v8, v8, v69
    buffer_load_dwordx4 v2, s[8:11], s36 offen offset:3072 sc1 lds
    v_mfma_f32_16x16x32_bf16 v[84:87], a[80:83], a[16:19], v[84:87]
    v_exp_f32 v70, v70
    v_mfma_f32_16x16x32_bf16 v[88:91], a[96:99], a[16:19], v[116:119]
    v_exp_f32 v71, v71
    v_mfma_f32_16x16x32_bf16 v[88:91], a[100:103], a[20:23], v[88:91]
    v_cvt_pk_bf16_f32 v98, v68, v69
    v_add_f32 v8, v8, v70
    v_mfma_f32_16x16x32_bf16 v[88:91], a[104:107], a[24:27], v[88:91]
    v_add_f32 v8, v8, v71
    v_cvt_pk_bf16_f32 v99, v70, v71
    v_mfma_f32_16x16x32_bf16 v[88:91], a[108:111], a[28:31], v[88:91]
    v_exp_f32 v72, v72
    v_mfma_f32_16x16x32_bf16 v[92:95], a[124:127], a[28:31], v[116:119]
    s_add_u32 m0, s38, 4096
    v_exp_f32 v73, v73
    v_mfma_f32_16x16x32_bf16 v[92:95], a[120:123], a[24:27], v[92:95]
    v_add_f32 v8, v8, v72
    v_add_f32 v8, v8, v73
    v_mfma_f32_16x16x32_bf16 v[92:95], a[116:119], a[20:23], v[92:95]
    buffer_load_dwordx4 v3, s[8:11], s36 offen offset:0 sc1 lds
    v_mfma_f32_16x16x32_bf16 v[92:95], a[112:115], a[16:19], v[92:95]
    buffer_store_dwordx4 a[204:207], v3, s[64:67], s71 offen offset:0 sc1
    v_mfma_f32_16x16x32_bf16 v[224:227], a[128:131], v[104:107], v[224:227]
    v_exp_f32 v74, v74
    v_mfma_f32_16x16x32_bf16 v[224:227], a[132:135], v[108:111], v[224:227]
    ds_read_b128 a[128:131], v6 offset:16384
    ds_read_b128 a[132:135], v6 offset:17408
    v_mfma_f32_16x16x32_bf16 v[228:231], a[140:143], v[108:111], v[228:231]
    v_exp_f32 v75, v75
    v_mfma_f32_16x16x32_bf16 v[228:231], a[136:139], v[104:107], v[228:231]
    ds_read_b128 a[140:143], v6 offset:19456
    ds_read_b128 a[136:139], v6 offset:18432
    v_mfma_f32_16x16x32_bf16 v[232:235], a[144:147], v[104:107], v[232:235]
    ds_read_b128 a[144:147], v6 offset:20480
    v_cvt_pk_bf16_f32 v100, v72, v73
    v_mfma_f32_16x16x32_bf16 v[232:235], a[148:151], v[108:111], v[232:235]
    ds_read_b128 a[148:151], v6 offset:21504
    v_add_f32 v8, v8, v74
    v_mfma_f32_16x16x32_bf16 v[236:239], a[156:159], v[108:111], v[236:239]
    buffer_load_dwordx4 v3, s[8:11], s36 offen offset:1024 sc1 lds
    v_mfma_f32_16x16x32_bf16 v[236:239], a[152:155], v[104:107], v[236:239]
    ds_read_b128 a[156:159], v6 offset:23552
    ds_read_b128 a[152:155], v6 offset:22528
    v_mfma_f32_16x16x32_bf16 v[240:243], a[160:163], v[104:107], v[240:243]
    v_add_f32 v8, v8, v75
    v_cvt_pk_bf16_f32 v101, v74, v75
    v_mfma_f32_16x16x32_bf16 v[240:243], a[164:167], v[108:111], v[240:243]
    v_exp_f32 v76, v76
    v_mfma_f32_16x16x32_bf16 v[244:247], a[172:175], v[108:111], v[244:247]
    v_exp_f32 v77, v77
    v_mfma_f32_16x16x32_bf16 v[244:247], a[168:171], v[104:107], v[244:247]
    v_add_f32 v8, v8, v76
    v_add_f32 v8, v8, v77
    v_mfma_f32_16x16x32_bf16 v[248:251], a[176:179], v[104:107], v[248:251]
    v_exp_f32 v78, v78
    v_mfma_f32_16x16x32_bf16 v[248:251], a[180:183], v[108:111], v[248:251]
    v_exp_f32 v79, v79
    v_mfma_f32_16x16x32_bf16 v[252:255], a[188:191], v[108:111], v[252:255]
    v_cvt_pk_bf16_f32 v102, v76, v77
    v_add_f32 v8, v8, v78
    v_mfma_f32_16x16x32_bf16 v[252:255], a[184:187], v[104:107], v[252:255]
    v_add_f32 v8, v8, v79
    v_cvt_pk_bf16_f32 v103, v78, v79
    v_mfma_f32_16x16x32_bf16 v[64:67], a[64:67], a[32:35], v[120:123]
    ds_read_b128 a[160:163], v6 offset:24576
    ds_read_b128 a[164:167], v6 offset:25600
    v_exp_f32 v80, v80
    v_mfma_f32_16x16x32_bf16 v[64:67], a[68:71], a[36:39], v[64:67]
    ds_read_b128 a[172:175], v6 offset:27648
    buffer_store_dwordx4 a[208:211], v2, s[64:67], s70 offen offset:1024 sc1
    v_mfma_f32_16x16x32_bf16 v[64:67], a[72:75], a[40:43], v[64:67]
    ds_read_b128 a[168:171], v6 offset:26624
    ds_read_b128 a[176:179], v6 offset:28672
    v_exp_f32 v81, v81
    v_mfma_f32_16x16x32_bf16 v[64:67], a[76:79], a[44:47], v[64:67]
    v_add_f32 v9, v9, v80
    v_add_f32 v9, v9, v81
    v_exp_f32 v82, v82
    v_mfma_f32_16x16x32_bf16 v[68:71], a[92:95], a[44:47], v[120:123]
    ds_read_b128 a[180:183], v6 offset:29696
    ds_read_b128 a[188:191], v6 offset:31744
    ds_read_b128 a[184:187], v6 offset:30720
    v_mfma_f32_16x16x32_bf16 v[68:71], a[88:91], a[40:43], v[68:71]
    v_exp_f32 v83, v83
    v_mfma_f32_16x16x32_bf16 v[68:71], a[84:87], a[36:39], v[68:71]
    v_cvt_pk_bf16_f32 v104, v80, v81
    v_add_f32 v9, v9, v82
    v_mfma_f32_16x16x32_bf16 v[68:71], a[80:83], a[32:35], v[68:71]
    buffer_load_dwordx4 v3, s[8:11], s36 offen offset:2048 sc1 lds
    v_mfma_f32_16x16x32_bf16 v[72:75], a[96:99], a[32:35], v[120:123]
    v_add_f32 v9, v9, v83
    v_cvt_pk_bf16_f32 v105, v82, v83
    v_mfma_f32_16x16x32_bf16 v[72:75], a[100:103], a[36:39], v[72:75]
    v_exp_f32 v84, v84
    v_mfma_f32_16x16x32_bf16 v[72:75], a[104:107], a[40:43], v[72:75]
    v_exp_f32 v85, v85
    v_mfma_f32_16x16x32_bf16 v[72:75], a[108:111], a[44:47], v[72:75]
    v_add_f32 v9, v9, v84
    v_add_f32 v9, v9, v85
    v_mfma_f32_16x16x32_bf16 v[76:79], a[124:127], a[44:47], v[120:123]
    v_exp_f32 v86, v86
    v_mfma_f32_16x16x32_bf16 v[76:79], a[120:123], a[40:43], v[76:79]
    v_exp_f32 v87, v87
    v_mfma_f32_16x16x32_bf16 v[76:79], a[116:119], a[36:39], v[76:79]
    v_cvt_pk_bf16_f32 v106, v84, v85
    v_add_f32 v9, v9, v86
    v_mfma_f32_16x16x32_bf16 v[76:79], a[112:115], a[32:35], v[76:79]
    buffer_store_dwordx4 a[212:215], v3, s[64:67], s70 offen offset:1024 sc1
    s_waitcnt lgkmcnt(0)
    v_mfma_f32_16x16x32_bf16 v[128:131], a[128:131], v[96:99], v[128:131]
    v_add_f32 v9, v9, v87
    v_cvt_pk_bf16_f32 v107, v86, v87
    v_mfma_f32_16x16x32_bf16 v[128:131], a[132:135], v[100:103], v[128:131]
    v_exp_f32 v88, v88
    v_mfma_f32_16x16x32_bf16 v[132:135], a[140:143], v[100:103], v[132:135]
    v_exp_f32 v89, v89
    v_mfma_f32_16x16x32_bf16 v[132:135], a[136:139], v[96:99], v[132:135]
    v_add_f32 v9, v9, v88
    v_add_f32 v9, v9, v89
    v_mfma_f32_16x16x32_bf16 v[136:139], a[144:147], v[96:99], v[136:139]
    buffer_load_dwordx4 v3, s[8:11], s36 offen offset:3072 sc1 lds
    s_add_u32 s36, s36, 32768
    s_xor_b32 s38, s38, 0x10000
    v_mfma_f32_16x16x32_bf16 v[136:139], a[148:151], v[100:103], v[136:139]
    v_exp_f32 v90, v90
    v_mfma_f32_16x16x32_bf16 v[140:143], a[156:159], v[100:103], v[140:143]
    v_exp_f32 v91, v91
    v_mfma_f32_16x16x32_bf16 v[140:143], a[152:155], v[96:99], v[140:143]
    v_cvt_pk_bf16_f32 v108, v88, v89
    v_add_f32 v9, v9, v90
    v_mfma_f32_16x16x32_bf16 v[144:147], a[160:163], v[96:99], v[144:147]
    v_add_f32 v9, v9, v91
    v_cvt_pk_bf16_f32 v109, v90, v91
    v_mfma_f32_16x16x32_bf16 v[144:147], a[164:167], v[100:103], v[144:147]
    v_exp_f32 v92, v92
    v_mfma_f32_16x16x32_bf16 v[148:151], a[172:175], v[100:103], v[148:151]
    v_exp_f32 v93, v93
    v_mfma_f32_16x16x32_bf16 v[148:151], a[168:171], v[96:99], v[148:151]
    v_add_f32 v9, v9, v92
    v_add_f32 v9, v9, v93
    v_mfma_f32_16x16x32_bf16 v[152:155], a[176:179], v[96:99], v[152:155]
    v_exp_f32 v94, v94
    v_mfma_f32_16x16x32_bf16 v[152:155], a[180:183], v[100:103], v[152:155]
    v_exp_f32 v95, v95
    v_mfma_f32_16x16x32_bf16 v[156:159], a[188:191], v[100:103], v[156:159]
    v_cvt_pk_bf16_f32 v110, v92, v93
    v_add_f32 v9, v9, v94
    v_mfma_f32_16x16x32_bf16 v[156:159], a[184:187], v[96:99], v[156:159]
    v_add_f32 v9, v9, v95
    v_cvt_pk_bf16_f32 v111, v94, v95
    s_waitcnt vmcnt(24)
    s_barrier
    v_mfma_f32_16x16x32_bf16 v[80:83], a[64:67], a[48:51], v[124:127]
    v_exp_f32 v64, v64
    v_exp_f32 v65, v65
    v_mfma_f32_16x16x32_bf16 v[80:83], a[68:71], a[52:55], v[80:83]
    ds_read_b128 a[64:67], v6 offset:32768
    buffer_store_dwordx4 a[216:219], v2, s[64:67], s71 offen offset:1024 sc1
    v_mfma_f32_16x16x32_bf16 v[80:83], a[72:75], a[56:59], v[80:83]
    v_add_f32 v10, v10, v64
    v_add_f32 v10, v10, v65
    v_exp_f32 v66, v66
    v_mfma_f32_16x16x32_bf16 v[80:83], a[76:79], a[60:63], v[80:83]
    ds_read_b128 a[68:71], v6 offset:33792
    ds_read_b128 a[72:75], v6 offset:34816
    v_exp_f32 v67, v67
    v_mfma_f32_16x16x32_bf16 v[84:87], a[92:95], a[60:63], v[124:127]
    ds_read_b128 a[76:79], v6 offset:35840
    v_cvt_pk_bf16_f32 v96, v64, v65
    v_add_f32 v10, v10, v66
    v_mfma_f32_16x16x32_bf16 v[84:87], a[88:91], a[56:59], v[84:87]
    v_add_f32 v10, v10, v67
    v_cvt_pk_bf16_f32 v97, v66, v67
    v_exp_f32 v68, v68
    v_mfma_f32_16x16x32_bf16 v[84:87], a[84:87], a[52:55], v[84:87]
    ds_read_b128 a[92:95], v6 offset:39936
    ds_read_b128 a[88:91], v6 offset:38912
    v_exp_f32 v69, v69
    v_mfma_f32_16x16x32_bf16 v[84:87], a[80:83], a[48:51], v[84:87]
    v_add_f32 v10, v10, v68
    v_add_f32 v10, v10, v69
    v_mfma_f32_16x16x32_bf16 v[88:91], a[96:99], a[48:51], v[124:127]
    buffer_store_dwordx4 a[220:223], v3, s[64:67], s71 offen offset:1024 sc1
    v_mfma_f32_16x16x32_bf16 v[88:91], a[100:103], a[52:55], v[88:91]
    v_exp_f32 v70, v70
    v_mfma_f32_16x16x32_bf16 v[88:91], a[104:107], a[56:59], v[88:91]
    ds_read_b128 a[84:87], v6 offset:37888
    ds_read_b128 a[80:83], v6 offset:36864
    v_mfma_f32_16x16x32_bf16 v[88:91], a[108:111], a[60:63], v[88:91]
    ds_read_b128 a[96:99], v6 offset:40960
    ds_read_b128 a[100:103], v6 offset:41984
    v_mfma_f32_16x16x32_bf16 v[92:95], a[124:127], a[60:63], v[124:127]
    ds_read_b128 a[104:107], v6 offset:43008
    ds_read_b128 a[108:111], v6 offset:44032
    v_mfma_f32_16x16x32_bf16 v[92:95], a[120:123], a[56:59], v[92:95]
    v_exp_f32 v71, v71
    v_mfma_f32_16x16x32_bf16 v[92:95], a[116:119], a[52:55], v[92:95]
    v_cvt_pk_bf16_f32 v98, v68, v69
    v_add_f32 v10, v10, v70
    v_mfma_f32_16x16x32_bf16 v[92:95], a[112:115], a[48:51], v[92:95]
    buffer_store_dwordx4 a[224:227], v4, s[64:67], s73 offen offset:0 sc1
    v_mfma_f32_16x16x32_bf16 v[160:163], a[128:131], v[104:107], v[160:163]
    v_add_f32 v10, v10, v71
    v_cvt_pk_bf16_f32 v99, v70, v71
    v_mfma_f32_16x16x32_bf16 v[160:163], a[132:135], v[108:111], v[160:163]
    v_exp_f32 v72, v72
    v_mfma_f32_16x16x32_bf16 v[164:167], a[140:143], v[108:111], v[164:167]
    v_exp_f32 v73, v73
    v_mfma_f32_16x16x32_bf16 v[164:167], a[136:139], v[104:107], v[164:167]
    v_add_f32 v10, v10, v72
    v_add_f32 v10, v10, v73
    v_mfma_f32_16x16x32_bf16 v[168:171], a[144:147], v[104:107], v[168:171]
    v_exp_f32 v74, v74
    v_mfma_f32_16x16x32_bf16 v[168:171], a[148:151], v[108:111], v[168:171]
    v_exp_f32 v75, v75
    v_mfma_f32_16x16x32_bf16 v[172:175], a[156:159], v[108:111], v[172:175]
    buffer_store_dwordx4 a[228:231], v4, s[64:67], s73 offen offset:1024 sc1
    v_mfma_f32_16x16x32_bf16 v[172:175], a[152:155], v[104:107], v[172:175]
    v_cvt_pk_bf16_f32 v100, v72, v73
    v_add_f32 v10, v10, v74
    v_mfma_f32_16x16x32_bf16 v[176:179], a[160:163], v[104:107], v[176:179]
    v_add_f32 v10, v10, v75
    v_cvt_pk_bf16_f32 v101, v74, v75
    v_mfma_f32_16x16x32_bf16 v[176:179], a[164:167], v[108:111], v[176:179]
    v_exp_f32 v76, v76
    v_mfma_f32_16x16x32_bf16 v[180:183], a[172:175], v[108:111], v[180:183]
    v_exp_f32 v77, v77
    v_mfma_f32_16x16x32_bf16 v[180:183], a[168:171], v[104:107], v[180:183]
    v_add_f32 v10, v10, v76
    v_add_f32 v10, v10, v77
    v_mfma_f32_16x16x32_bf16 v[184:187], a[176:179], v[104:107], v[184:187]
    v_exp_f32 v78, v78
    v_mfma_f32_16x16x32_bf16 v[184:187], a[180:183], v[108:111], v[184:187]
    v_exp_f32 v79, v79
    v_mfma_f32_16x16x32_bf16 v[188:191], a[188:191], v[108:111], v[188:191]
    v_cvt_pk_bf16_f32 v102, v76, v77
    v_add_f32 v10, v10, v78
    v_mfma_f32_16x16x32_bf16 v[188:191], a[184:187], v[104:107], v[188:191]
    v_add_f32 v10, v10, v79
    v_cvt_pk_bf16_f32 v103, v78, v79
    s_waitcnt lgkmcnt(0)
    v_mfma_f32_16x16x32_bf16 v[64:67], a[64:67], a[0:3], v[112:115]
    ds_read_b128 a[124:127], v6 offset:48128
    ds_read_b128 a[120:123], v6 offset:47104
    s_waitcnt vmcnt(27)
    buffer_load_dwordx4 v[44:47], v56, s[20:23], 0 offen sc1
    v_mfma_f32_16x16x32_bf16 v[64:67], a[68:71], a[4:7], v[64:67]
    ds_read_b128 a[116:119], v6 offset:46080
    buffer_store_dwordx4 a[232:235], v4, s[64:67], s73 offen offset:2048 sc1
    v_mfma_f32_16x16x32_bf16 v[64:67], a[72:75], a[8:11], v[64:67]
    ds_read_b128 a[112:115], v6 offset:45056
    v_exp_f32 v80, v80
    v_mfma_f32_16x16x32_bf16 v[64:67], a[76:79], a[12:15], v[64:67]
    v_exp_f32 v81, v81
    v_add_f32 v11, v11, v80
    v_mfma_f32_16x16x32_bf16 v[68:71], a[92:95], a[12:15], v[112:115]
    s_mov_b32 m0, s37
    v_add_f32 v11, v11, v81
    v_exp_f32 v82, v82
    v_mfma_f32_16x16x32_bf16 v[68:71], a[88:91], a[8:11], v[68:71]
    buffer_load_dwordx4 v2, s[8:11], s36 offen offset:0 sc1 lds
    v_exp_f32 v83, v83
    v_mfma_f32_16x16x32_bf16 v[68:71], a[84:87], a[4:7], v[68:71]
    v_cvt_pk_bf16_f32 v104, v80, v81
    v_add_f32 v11, v11, v82
    v_mfma_f32_16x16x32_bf16 v[68:71], a[80:83], a[0:3], v[68:71]
    v_add_f32 v11, v11, v83
    v_cvt_pk_bf16_f32 v105, v82, v83
    v_mfma_f32_16x16x32_bf16 v[72:75], a[96:99], a[0:3], v[112:115]
    v_exp_f32 v84, v84
    v_mfma_f32_16x16x32_bf16 v[72:75], a[100:103], a[4:7], v[72:75]
    v_exp_f32 v85, v85
    v_mfma_f32_16x16x32_bf16 v[72:75], a[104:107], a[8:11], v[72:75]
    v_add_f32 v11, v11, v84
    v_add_f32 v11, v11, v85
    v_mfma_f32_16x16x32_bf16 v[72:75], a[108:111], a[12:15], v[72:75]
    v_exp_f32 v86, v86
    s_waitcnt lgkmcnt(0)
    v_mfma_f32_16x16x32_bf16 v[76:79], a[124:127], a[12:15], v[112:115]
    v_exp_f32 v87, v87
    v_mfma_f32_16x16x32_bf16 v[76:79], a[120:123], a[8:11], v[76:79]
    v_cvt_pk_bf16_f32 v106, v84, v85
    v_add_f32 v11, v11, v86
    v_mfma_f32_16x16x32_bf16 v[76:79], a[116:119], a[4:7], v[76:79]
    buffer_load_dwordx4 v2, s[8:11], s36 offen offset:1024 sc1 lds
    v_mfma_f32_16x16x32_bf16 v[76:79], a[112:115], a[0:3], v[76:79]
    buffer_store_dwordx4 a[236:239], v4, s[64:67], s73 offen offset:3072 sc1
    v_mfma_f32_16x16x32_bf16 v[192:195], a[128:131], v[96:99], v[192:195]
    v_add_f32 v11, v11, v87
    v_cvt_pk_bf16_f32 v107, v86, v87
    v_mfma_f32_16x16x32_bf16 v[192:195], a[132:135], v[100:103], v[192:195]
    v_exp_f32 v88, v88
    v_mfma_f32_16x16x32_bf16 v[196:199], a[140:143], v[100:103], v[196:199]
    v_exp_f32 v89, v89
    v_mfma_f32_16x16x32_bf16 v[196:199], a[136:139], v[96:99], v[196:199]
    v_add_f32 v11, v11, v88
    v_add_f32 v11, v11, v89
    v_mfma_f32_16x16x32_bf16 v[200:203], a[144:147], v[96:99], v[200:203]
    v_exp_f32 v90, v90
    v_mfma_f32_16x16x32_bf16 v[200:203], a[148:151], v[100:103], v[200:203]
    v_exp_f32 v91, v91
    v_mfma_f32_16x16x32_bf16 v[204:207], a[156:159], v[100:103], v[204:207]
    buffer_load_dwordx4 v2, s[8:11], s36 offen offset:2048 sc1 lds
    v_mfma_f32_16x16x32_bf16 v[204:207], a[152:155], v[96:99], v[204:207]
    v_cvt_pk_bf16_f32 v108, v88, v89
    v_add_f32 v11, v11, v90
    v_mfma_f32_16x16x32_bf16 v[208:211], a[160:163], v[96:99], v[208:211]
    v_add_f32 v11, v11, v91
    v_cvt_pk_bf16_f32 v109, v90, v91
    v_mfma_f32_16x16x32_bf16 v[208:211], a[164:167], v[100:103], v[208:211]
    v_exp_f32 v92, v92
    v_mfma_f32_16x16x32_bf16 v[212:215], a[172:175], v[100:103], v[212:215]
    v_exp_f32 v93, v93
    v_mfma_f32_16x16x32_bf16 v[212:215], a[168:171], v[96:99], v[212:215]
    v_add_f32 v11, v11, v92
    v_add_f32 v11, v11, v93
    v_mfma_f32_16x16x32_bf16 v[216:219], a[176:179], v[96:99], v[216:219]
    v_exp_f32 v94, v94
    v_mfma_f32_16x16x32_bf16 v[216:219], a[180:183], v[100:103], v[216:219]
    v_exp_f32 v95, v95
    v_mfma_f32_16x16x32_bf16 v[220:223], a[188:191], v[100:103], v[220:223]
    v_cvt_pk_bf16_f32 v110, v92, v93
    v_add_f32 v11, v11, v94
    v_mfma_f32_16x16x32_bf16 v[220:223], a[184:187], v[96:99], v[220:223]
    v_add_f32 v11, v11, v95
    v_cvt_pk_bf16_f32 v111, v94, v95
    v_mfma_f32_16x16x32_bf16 v[80:83], a[64:67], a[16:19], v[116:119]
    v_exp_f32 v64, v64
    v_exp_f32 v65, v65
    v_mfma_f32_16x16x32_bf16 v[80:83], a[68:71], a[20:23], v[80:83]
    v_add_f32 v8, v8, v64
    buffer_store_dwordx4 a[240:243], v5, s[64:67], s73 offen offset:0 sc1
    v_mfma_f32_16x16x32_bf16 v[80:83], a[72:75], a[24:27], v[80:83]
    v_add_f32 v8, v8, v65
    v_exp_f32 v66, v66
    v_mfma_f32_16x16x32_bf16 v[80:83], a[76:79], a[28:31], v[80:83]
    v_exp_f32 v67, v67
    v_cvt_pk_bf16_f32 v96, v64, v65
    v_mfma_f32_16x16x32_bf16 v[84:87], a[92:95], a[28:31], v[116:119]
    v_add_f32 v8, v8, v66
    v_add_f32 v8, v8, v67
    v_cvt_pk_bf16_f32 v97, v66, v67
    v_mfma_f32_16x16x32_bf16 v[84:87], a[88:91], a[24:27], v[84:87]
    v_exp_f32 v68, v68
    v_exp_f32 v69, v69
    v_mfma_f32_16x16x32_bf16 v[84:87], a[84:87], a[20:23], v[84:87]
    v_add_f32 v8, v8, v68
    v_add_f32 v8, v8, v69
    buffer_load_dwordx4 v2, s[8:11], s36 offen offset:3072 sc1 lds
    v_mfma_f32_16x16x32_bf16 v[84:87], a[80:83], a[16:19], v[84:87]
    v_exp_f32 v70, v70
    v_exp_f32 v71, v71
    v_mfma_f32_16x16x32_bf16 v[88:91], a[96:99], a[16:19], v[116:119]
    v_cvt_pk_bf16_f32 v98, v68, v69
    v_add_f32 v8, v8, v70
    v_mfma_f32_16x16x32_bf16 v[88:91], a[100:103], a[20:23], v[88:91]
    v_add_f32 v8, v8, v71
    v_cvt_pk_bf16_f32 v99, v70, v71
    v_mfma_f32_16x16x32_bf16 v[88:91], a[104:107], a[24:27], v[88:91]
    buffer_store_dwordx4 a[244:247], v5, s[64:67], s73 offen offset:1024 sc1
    v_mfma_f32_16x16x32_bf16 v[88:91], a[108:111], a[28:31], v[88:91]
    v_exp_f32 v72, v72
    v_mfma_f32_16x16x32_bf16 v[92:95], a[124:127], a[28:31], v[116:119]
    s_add_u32 m0, s37, 4096
    v_exp_f32 v73, v73
    v_mfma_f32_16x16x32_bf16 v[92:95], a[120:123], a[24:27], v[92:95]
    v_add_f32 v8, v8, v72
    v_add_f32 v8, v8, v73
    v_mfma_f32_16x16x32_bf16 v[92:95], a[116:119], a[20:23], v[92:95]
    v_exp_f32 v74, v74
    v_mfma_f32_16x16x32_bf16 v[92:95], a[112:115], a[16:19], v[92:95]
    v_exp_f32 v75, v75
    v_mfma_f32_16x16x32_bf16 v[224:227], a[128:131], v[104:107], v[224:227]
    buffer_load_dwordx4 v3, s[8:11], s36 offen offset:0 sc1 lds
    v_mfma_f32_16x16x32_bf16 v[224:227], a[132:135], v[108:111], v[224:227]
    ds_read_b128 a[128:131], v6 offset:49152
    v_cvt_pk_bf16_f32 v100, v72, v73
    v_mfma_f32_16x16x32_bf16 v[228:231], a[140:143], v[108:111], v[228:231]
    ds_read_b128 a[132:135], v6 offset:50176
    ds_read_b128 a[140:143], v6 offset:52224
    v_mfma_f32_16x16x32_bf16 v[228:231], a[136:139], v[104:107], v[228:231]
    ds_read_b128 a[136:139], v6 offset:51200
    v_add_f32 v8, v8, v74
    v_mfma_f32_16x16x32_bf16 v[232:235], a[144:147], v[104:107], v[232:235]
    buffer_store_dwordx4 a[248:251], v5, s[64:67], s73 offen offset:2048 sc1
    v_mfma_f32_16x16x32_bf16 v[232:235], a[148:151], v[108:111], v[232:235]
    ds_read_b128 a[144:147], v6 offset:53248
    ds_read_b128 a[148:151], v6 offset:54272
    v_mfma_f32_16x16x32_bf16 v[236:239], a[156:159], v[108:111], v[236:239]
    buffer_load_dwordx4 v3, s[8:11], s36 offen offset:1024 sc1 lds
    v_mfma_f32_16x16x32_bf16 v[236:239], a[152:155], v[104:107], v[236:239]
    ds_read_b128 a[156:159], v6 offset:56320
    ds_read_b128 a[152:155], v6 offset:55296
    v_mfma_f32_16x16x32_bf16 v[240:243], a[160:163], v[104:107], v[240:243]
    v_add_f32 v8, v8, v75
    v_cvt_pk_bf16_f32 v101, v74, v75
    v_mfma_f32_16x16x32_bf16 v[240:243], a[164:167], v[108:111], v[240:243]
    v_exp_f32 v76, v76
    v_mfma_f32_16x16x32_bf16 v[244:247], a[172:175], v[108:111], v[244:247]
    v_exp_f32 v77, v77
    v_mfma_f32_16x16x32_bf16 v[244:247], a[168:171], v[104:107], v[244:247]
    v_add_f32 v8, v8, v76
    v_add_f32 v8, v8, v77
    v_mfma_f32_16x16x32_bf16 v[248:251], a[176:179], v[104:107], v[248:251]
    v_exp_f32 v78, v78
    v_mfma_f32_16x16x32_bf16 v[248:251], a[180:183], v[108:111], v[248:251]
    v_exp_f32 v79, v79
    v_mfma_f32_16x16x32_bf16 v[252:255], a[188:191], v[108:111], v[252:255]
    v_cvt_pk_bf16_f32 v102, v76, v77
    v_add_f32 v8, v8, v78
    v_mfma_f32_16x16x32_bf16 v[252:255], a[184:187], v[104:107], v[252:255]
    v_add_f32 v8, v8, v79
    v_cvt_pk_bf16_f32 v103, v78, v79
    v_mfma_f32_16x16x32_bf16 v[64:67], a[64:67], a[32:35], v[120:123]
    ds_read_b128 a[160:163], v6 offset:57344
    ds_read_b128 a[164:167], v6 offset:58368
    v_exp_f32 v80, v80
    v_mfma_f32_16x16x32_bf16 v[64:67], a[68:71], a[36:39], v[64:67]
    ds_read_b128 a[172:175], v6 offset:60416
    buffer_store_dwordx4 a[252:255], v5, s[64:67], s73 offen offset:3072 sc1
    v_mfma_f32_16x16x32_bf16 v[64:67], a[72:75], a[40:43], v[64:67]
    ds_read_b128 a[168:171], v6 offset:59392
    ds_read_b128 a[176:179], v6 offset:61440
    v_exp_f32 v81, v81
    v_mfma_f32_16x16x32_bf16 v[64:67], a[76:79], a[44:47], v[64:67]
    ds_read_b128 a[180:183], v6 offset:62464
    v_add_f32 v9, v9, v80
    v_add_f32 v9, v9, v81
    v_mfma_f32_16x16x32_bf16 v[68:71], a[92:95], a[44:47], v[120:123]
    v_exp_f32 v82, v82
    v_mfma_f32_16x16x32_bf16 v[68:71], a[88:91], a[40:43], v[68:71]
    ds_read_b128 a[188:191], v6 offset:64512
    ds_read_b128 a[184:187], v6 offset:63488
    v_mfma_f32_16x16x32_bf16 v[68:71], a[84:87], a[36:39], v[68:71]
    v_exp_f32 v83, v83
    v_mfma_f32_16x16x32_bf16 v[68:71], a[80:83], a[32:35], v[68:71]
    buffer_load_dwordx4 v3, s[8:11], s36 offen offset:2048 sc1 lds
    v_mfma_f32_16x16x32_bf16 v[72:75], a[96:99], a[32:35], v[120:123]
    v_cvt_pk_bf16_f32 v104, v80, v81
    v_add_f32 v9, v9, v82
    v_mfma_f32_16x16x32_bf16 v[72:75], a[100:103], a[36:39], v[72:75]
    v_add_f32 v9, v9, v83
    v_cvt_pk_bf16_f32 v105, v82, v83
    v_mfma_f32_16x16x32_bf16 v[72:75], a[104:107], a[40:43], v[72:75]
    v_exp_f32 v84, v84
    v_mfma_f32_16x16x32_bf16 v[72:75], a[108:111], a[44:47], v[72:75]
    v_exp_f32 v85, v85
    v_mfma_f32_16x16x32_bf16 v[76:79], a[124:127], a[44:47], v[120:123]
    v_add_f32 v9, v9, v84
    v_add_f32 v9, v9, v85
    v_mfma_f32_16x16x32_bf16 v[76:79], a[120:123], a[40:43], v[76:79]
    v_exp_f32 v86, v86
    v_mfma_f32_16x16x32_bf16 v[76:79], a[116:119], a[36:39], v[76:79]
    v_exp_f32 v87, v87
    v_mfma_f32_16x16x32_bf16 v[76:79], a[112:115], a[32:35], v[76:79]
    v_cvt_pk_bf16_f32 v106, v84, v85
    v_add_f32 v9, v9, v86
    s_waitcnt lgkmcnt(0)
    v_mfma_f32_16x16x32_bf16 v[128:131], a[128:131], v[96:99], v[128:131]
    v_add_f32 v9, v9, v87
    v_cvt_pk_bf16_f32 v107, v86, v87
    v_mfma_f32_16x16x32_bf16 v[128:131], a[132:135], v[100:103], v[128:131]
    v_exp_f32 v88, v88
    v_mfma_f32_16x16x32_bf16 v[132:135], a[140:143], v[100:103], v[132:135]
    v_exp_f32 v89, v89
    v_mfma_f32_16x16x32_bf16 v[132:135], a[136:139], v[96:99], v[132:135]
    v_add_f32 v9, v9, v88
    v_add_f32 v9, v9, v89
    v_mfma_f32_16x16x32_bf16 v[136:139], a[144:147], v[96:99], v[136:139]
    buffer_load_dwordx4 v3, s[8:11], s36 offen offset:3072 sc1 lds
    s_add_u32 s36, s36, 32768
    s_xor_b32 s37, s37, 0x10000
    v_mfma_f32_16x16x32_bf16 v[136:139], a[148:151], v[100:103], v[136:139]
    v_exp_f32 v90, v90
    v_mfma_f32_16x16x32_bf16 v[140:143], a[156:159], v[100:103], v[140:143]
    v_exp_f32 v91, v91
    v_mfma_f32_16x16x32_bf16 v[140:143], a[152:155], v[96:99], v[140:143]
    v_cvt_pk_bf16_f32 v108, v88, v89
    v_add_f32 v9, v9, v90
    v_mfma_f32_16x16x32_bf16 v[144:147], a[160:163], v[96:99], v[144:147]
    v_add_f32 v9, v9, v91
    v_cvt_pk_bf16_f32 v109, v90, v91
    v_mfma_f32_16x16x32_bf16 v[144:147], a[164:167], v[100:103], v[144:147]
    v_exp_f32 v92, v92
    v_mfma_f32_16x16x32_bf16 v[148:151], a[172:175], v[100:103], v[148:151]
    v_exp_f32 v93, v93
    v_mfma_f32_16x16x32_bf16 v[148:151], a[168:171], v[96:99], v[148:151]
    v_add_f32 v9, v9, v92
    v_add_f32 v9, v9, v93
    v_mfma_f32_16x16x32_bf16 v[152:155], a[176:179], v[96:99], v[152:155]
    v_exp_f32 v94, v94
    v_mfma_f32_16x16x32_bf16 v[152:155], a[180:183], v[100:103], v[152:155]
    v_exp_f32 v95, v95
    v_mfma_f32_16x16x32_bf16 v[156:159], a[188:191], v[100:103], v[156:159]
    v_cvt_pk_bf16_f32 v110, v92, v93
    v_add_f32 v9, v9, v94
    v_mfma_f32_16x16x32_bf16 v[156:159], a[184:187], v[96:99], v[156:159]
    v_add_f32 v9, v9, v95
    v_cvt_pk_bf16_f32 v111, v94, v95
    s_waitcnt vmcnt(34)
    s_barrier
    v_xor_b32 v6, 0x10000, v6
    v_mfma_f32_16x16x32_bf16 v[80:83], a[64:67], a[48:51], v[124:127]
    v_exp_f32 v64, v64
    v_exp_f32 v65, v65
    v_mfma_f32_16x16x32_bf16 v[80:83], a[68:71], a[52:55], v[80:83]
    v_add_f32 v10, v10, v64
    v_add_f32 v10, v10, v65
    v_exp_f32 v66, v66
    v_mfma_f32_16x16x32_bf16 v[80:83], a[72:75], a[56:59], v[80:83]
    v_mov_b32 v52, v0
    ds_read_b128 a[64:67], v6 offset:0
    v_exp_f32 v67, v67
    v_mfma_f32_16x16x32_bf16 v[80:83], a[76:79], a[60:63], v[80:83]
    ds_read_b128 a[68:71], v6 offset:1024
    ds_read_b128 a[72:75], v6 offset:2048
    ds_read_b128 a[76:79], v6 offset:3072
    v_mfma_f32_16x16x32_bf16 v[84:87], a[92:95], a[60:63], v[124:127]
    ds_read_b128 a[92:95], v6 offset:7168
    v_cvt_pk_bf16_f32 v96, v64, v65
    v_mfma_f32_16x16x32_bf16 v[84:87], a[88:91], a[56:59], v[84:87]
    ds_read_b128 a[88:91], v6 offset:6144
    v_add_f32 v10, v10, v66
    v_mfma_f32_16x16x32_bf16 v[84:87], a[84:87], a[52:55], v[84:87]
    ds_read_b128 a[84:87], v6 offset:5120
    v_add_f32 v10, v10, v67
    v_mfma_f32_16x16x32_bf16 v[84:87], a[80:83], a[48:51], v[84:87]
    ds_read_b128 a[80:83], v6 offset:4096
    v_cvt_pk_bf16_f32 v97, v66, v67
    v_mfma_f32_16x16x32_bf16 v[88:91], a[96:99], a[48:51], v[124:127]
    v_exp_f32 v68, v68
    v_mfma_f32_16x16x32_bf16 v[88:91], a[100:103], a[52:55], v[88:91]
    ds_read_b128 a[96:99], v6 offset:8192
    ds_read_b128 a[100:103], v6 offset:9216
    v_mfma_f32_16x16x32_bf16 v[88:91], a[104:107], a[56:59], v[88:91]
    v_exp_f32 v69, v69
    v_mfma_f32_16x16x32_bf16 v[88:91], a[108:111], a[60:63], v[88:91]
    ds_read_b128 a[104:107], v6 offset:10240
    ds_read_b128 a[108:111], v6 offset:11264
    v_mfma_f32_16x16x32_bf16 v[92:95], a[124:127], a[60:63], v[124:127]
    v_add_f32 v10, v10, v68
    v_add_f32 v10, v10, v69
    v_mfma_f32_16x16x32_bf16 v[92:95], a[120:123], a[56:59], v[92:95]
    v_exp_f32 v70, v70
    v_mfma_f32_16x16x32_bf16 v[92:95], a[116:119], a[52:55], v[92:95]
    v_exp_f32 v71, v71
    v_mfma_f32_16x16x32_bf16 v[92:95], a[112:115], a[48:51], v[92:95]
    v_cvt_pk_bf16_f32 v98, v68, v69
    v_add_f32 v10, v10, v70
    v_mfma_f32_16x16x32_bf16 v[160:163], a[128:131], v[104:107], v[160:163]
    v_add_f32 v10, v10, v71
    v_cvt_pk_bf16_f32 v99, v70, v71
    v_mfma_f32_16x16x32_bf16 v[160:163], a[132:135], v[108:111], v[160:163]
    v_exp_f32 v72, v72
    v_mfma_f32_16x16x32_bf16 v[164:167], a[140:143], v[108:111], v[164:167]
    v_exp_f32 v73, v73
    v_mfma_f32_16x16x32_bf16 v[164:167], a[136:139], v[104:107], v[164:167]
    v_add_f32 v10, v10, v72
    v_add_f32 v10, v10, v73
    v_mfma_f32_16x16x32_bf16 v[168:171], a[144:147], v[104:107], v[168:171]
    s_sub_u32 s35, s35, 1
    s_cmp_lg_u32 s35, s88
    v_mfma_f32_16x16x32_bf16 v[168:171], a[148:151], v[108:111], v[168:171]
    v_exp_f32 v74, v74
    v_mfma_f32_16x16x32_bf16 v[172:175], a[156:159], v[108:111], v[172:175]
    v_exp_f32 v75, v75
    v_mfma_f32_16x16x32_bf16 v[172:175], a[152:155], v[104:107], v[172:175]
    v_cvt_pk_bf16_f32 v100, v72, v73
    v_add_f32 v10, v10, v74
    v_mfma_f32_16x16x32_bf16 v[176:179], a[160:163], v[104:107], v[176:179]
    v_add_f32 v10, v10, v75
    v_cvt_pk_bf16_f32 v101, v74, v75
    v_mfma_f32_16x16x32_bf16 v[176:179], a[164:167], v[108:111], v[176:179]
    v_exp_f32 v76, v76
    v_mfma_f32_16x16x32_bf16 v[180:183], a[172:175], v[108:111], v[180:183]
    v_exp_f32 v77, v77
    v_mfma_f32_16x16x32_bf16 v[180:183], a[168:171], v[104:107], v[180:183]
    v_add_f32 v10, v10, v76
    v_add_f32 v10, v10, v77
    v_mfma_f32_16x16x32_bf16 v[184:187], a[176:179], v[104:107], v[184:187]
    v_exp_f32 v78, v78
    v_mfma_f32_16x16x32_bf16 v[184:187], a[180:183], v[108:111], v[184:187]
    v_exp_f32 v79, v79
    v_mfma_f32_16x16x32_bf16 v[188:191], a[188:191], v[108:111], v[188:191]
    v_cvt_pk_bf16_f32 v102, v76, v77
    v_add_f32 v10, v10, v78
    v_mfma_f32_16x16x32_bf16 v[188:191], a[184:187], v[104:107], v[188:191]
    v_add_f32 v10, v10, v79
    v_cvt_pk_bf16_f32 v103, v78, v79
    s_cbranch_scc0 L_chka
L_p1:
    s_waitcnt lgkmcnt(0)
    v_mfma_f32_16x16x32_bf16 v[64:67], a[64:67], a[0:3], v[112:115]
    ds_read_b128 a[124:127], v6 offset:15360
    ds_read_b128 a[120:123], v6 offset:14336
    v_exp_f32 v80, v80
    v_mfma_f32_16x16x32_bf16 v[64:67], a[68:71], a[4:7], v[64:67]
    ds_read_b128 a[116:119], v6 offset:13312
    ds_read_b128 a[112:115], v6 offset:12288
    v_mfma_f32_16x16x32_bf16 v[64:67], a[72:75], a[8:11], v[64:67]
    v_exp_f32 v81, v81
    v_mfma_f32_16x16x32_bf16 v[64:67], a[76:79], a[12:15], v[64:67]
    v_add_f32 v11, v11, v80
    v_add_f32 v11, v11, v81
    v_mfma_f32_16x16x32_bf16 v[68:71], a[92:95], a[12:15], v[112:115]
    s_mov_b32 m0, s38
    v_exp_f32 v82, v82
    v_mfma_f32_16x16x32_bf16 v[68:71], a[88:91], a[8:11], v[68:71]
    buffer_load_dwordx4 v2, s[8:11], s36 offen offset:0 sc1 lds
    v_mfma_f32_16x16x32_bf16 v[68:71], a[84:87], a[4:7], v[68:71]
    v_exp_f32 v83, v83
    v_mfma_f32_16x16x32_bf16 v[68:71], a[80:83], a[0:3], v[68:71]
    v_cvt_pk_bf16_f32 v104, v80, v81
    v_add_f32 v11, v11, v82
    v_mfma_f32_16x16x32_bf16 v[72:75], a[96:99], a[0:3], v[112:115]
    v_add_f32 v11, v11, v83
    v_cvt_pk_bf16_f32 v105, v82, v83
    v_mfma_f32_16x16x32_bf16 v[72:75], a[100:103], a[4:7], v[72:75]
    v_exp_f32 v84, v84
    v_mfma_f32_16x16x32_bf16 v[72:75], a[104:107], a[8:11], v[72:75]
    v_exp_f32 v85, v85
    v_mfma_f32_16x16x32_bf16 v[72:75], a[108:111], a[12:15], v[72:75]
    v_add_f32 v11, v11, v84
    v_add_f32 v11, v11, v85
    s_waitcnt lgkmcnt(0)
    v_mfma_f32_16x16x32_bf16 v[76:79], a[124:127], a[12:15], v[112:115]
    v_exp_f32 v86, v86
    v_mfma_f32_16x16x32_bf16 v[76:79], a[120:123], a[8:11], v[76:79]
    buffer_load_dwordx4 v2, s[8:11], s36 offen offset:1024 sc1 lds
    v_mfma_f32_16x16x32_bf16 v[76:79], a[116:119], a[4:7], v[76:79]
    v_exp_f32 v87, v87
    v_mfma_f32_16x16x32_bf16 v[76:79], a[112:115], a[0:3], v[76:79]
    v_cvt_pk_bf16_f32 v106, v84, v85
    v_add_f32 v11, v11, v86
    v_mfma_f32_16x16x32_bf16 v[192:195], a[128:131], v[96:99], v[192:195]
    v_add_f32 v11, v11, v87
    v_cvt_pk_bf16_f32 v107, v86, v87
    v_mfma_f32_16x16x32_bf16 v[192:195], a[132:135], v[100:103], v[192:195]
    v_exp_f32 v88, v88
    v_mfma_f32_16x16x32_bf16 v[196:199], a[140:143], v[100:103], v[196:199]
    v_exp_f32 v89, v89
    v_mfma_f32_16x16x32_bf16 v[196:199], a[136:139], v[96:99], v[196:199]
    v_add_f32 v11, v11, v88
    v_add_f32 v11, v11, v89
    v_mfma_f32_16x16x32_bf16 v[200:203], a[144:147], v[96:99], v[200:203]
    v_exp_f32 v90, v90
    v_mfma_f32_16x16x32_bf16 v[200:203], a[148:151], v[100:103], v[200:203]
    v_exp_f32 v91, v91
    v_mfma_f32_16x16x32_bf16 v[204:207], a[156:159], v[100:103], v[204:207]
    buffer_load_dwordx4 v2, s[8:11], s36 offen offset:2048 sc1 lds
    v_mfma_f32_16x16x32_bf16 v[204:207], a[152:155], v[96:99], v[204:207]
    v_cvt_pk_bf16_f32 v108, v88, v89
    v_add_f32 v11, v11, v90
    v_mfma_f32_16x16x32_bf16 v[208:211], a[160:163], v[96:99], v[208:211]
    v_add_f32 v11, v11, v91
    v_cvt_pk_bf16_f32 v109, v90, v91
    v_mfma_f32_16x16x32_bf16 v[208:211], a[164:167], v[100:103], v[208:211]
    v_exp_f32 v92, v92
    v_mfma_f32_16x16x32_bf16 v[212:215], a[172:175], v[100:103], v[212:215]
    v_exp_f32 v93, v93
    v_mfma_f32_16x16x32_bf16 v[212:215], a[168:171], v[96:99], v[212:215]
    v_add_f32 v11, v11, v92
    v_add_f32 v11, v11, v93
    v_mfma_f32_16x16x32_bf16 v[216:219], a[176:179], v[96:99], v[216:219]
    v_exp_f32 v94, v94
    v_mfma_f32_16x16x32_bf16 v[216:219], a[180:183], v[100:103], v[216:219]
    v_exp_f32 v95, v95
    v_mfma_f32_16x16x32_bf16 v[220:223], a[188:191], v[100:103], v[220:223]
    v_cvt_pk_bf16_f32 v110, v92, v93
    v_add_f32 v11, v11, v94
    v_mfma_f32_16x16x32_bf16 v[220:223], a[184:187], v[96:99], v[220:223]
    v_add_f32 v11, v11, v95
    v_cvt_pk_bf16_f32 v111, v94, v95
    v_mfma_f32_16x16x32_bf16 v[80:83], a[64:67], a[16:19], v[116:119]
    v_exp_f32 v64, v64
    v_exp_f32 v65, v65
    v_mfma_f32_16x16x32_bf16 v[80:83], a[68:71], a[20:23], v[80:83]
    v_add_f32 v8, v8, v64
    v_add_f32 v8, v8, v65
    v_exp_f32 v66, v66
    v_mfma_f32_16x16x32_bf16 v[80:83], a[72:75], a[24:27], v[80:83]
    v_exp_f32 v67, v67
    v_cvt_pk_bf16_f32 v96, v64, v65
    v_mfma_f32_16x16x32_bf16 v[80:83], a[76:79], a[28:31], v[80:83]
    v_add_f32 v8, v8, v66
    v_add_f32 v8, v8, v67
    v_cvt_pk_bf16_f32 v97, v66, v67
    v_mfma_f32_16x16x32_bf16 v[84:87], a[92:95], a[28:31], v[116:119]
    v_exp_f32 v68, v68
    v_mfma_f32_16x16x32_bf16 v[84:87], a[88:91], a[24:27], v[84:87]
    v_exp_f32 v69, v69
    v_mfma_f32_16x16x32_bf16 v[84:87], a[84:87], a[20:23], v[84:87]
    v_add_f32 v8, v8, v68
    v_add_f32 v8, v8, v69
    v_mfma_f32_16x16x32_bf16 v[84:87], a[80:83], a[16:19], v[84:87]
    buffer_load_dwordx4 v2, s[8:11], s36 offen offset:3072 sc1 lds
    v_mfma_f32_16x16x32_bf16 v[88:91], a[96:99], a[16:19], v[116:119]
    v_exp_f32 v70, v70
    v_mfma_f32_16x16x32_bf16 v[88:91], a[100:103], a[20:23], v[88:91]
    v_exp_f32 v71, v71
    v_mfma_f32_16x16x32_bf16 v[88:91], a[104:107], a[24:27], v[88:91]
    v_cvt_pk_bf16_f32 v98, v68, v69
    v_add_f32 v8, v8, v70
    v_mfma_f32_16x16x32_bf16 v[88:91], a[108:111], a[28:31], v[88:91]
    v_add_f32 v8, v8, v71
    v_cvt_pk_bf16_f32 v99, v70, v71
    v_mfma_f32_16x16x32_bf16 v[92:95], a[124:127], a[28:31], v[116:119]
    s_add_u32 m0, s38, 4096
    v_exp_f32 v72, v72
    v_mfma_f32_16x16x32_bf16 v[92:95], a[120:123], a[24:27], v[92:95]
    buffer_load_dwordx4 v3, s[8:11], s36 offen offset:0 sc1 lds
    v_mfma_f32_16x16x32_bf16 v[92:95], a[116:119], a[20:23], v[92:95]
    v_exp_f32 v73, v73
    v_mfma_f32_16x16x32_bf16 v[92:95], a[112:115], a[16:19], v[92:95]
    v_add_f32 v8, v8, v72
    v_add_f32 v8, v8, v73
    v_mfma_f32_16x16x32_bf16 v[224:227], a[128:131], v[104:107], v[224:227]
    v_exp_f32 v74, v74
    v_mfma_f32_16x16x32_bf16 v[224:227], a[132:135], v[108:111], v[224:227]
    ds_read_b128 a[128:131], v6 offset:16384
    ds_read_b128 a[132:135], v6 offset:17408
    v_mfma_f32_16x16x32_bf16 v[228:231], a[140:143], v[108:111], v[228:231]
    v_exp_f32 v75, v75
    v_mfma_f32_16x16x32_bf16 v[228:231], a[136:139], v[104:107], v[228:231]
    ds_read_b128 a[140:143], v6 offset:19456
    ds_read_b128 a[136:139], v6 offset:18432
    v_mfma_f32_16x16x32_bf16 v[232:235], a[144:147], v[104:107], v[232:235]
    ds_read_b128 a[144:147], v6 offset:20480
    v_cvt_pk_bf16_f32 v100, v72, v73
    v_mfma_f32_16x16x32_bf16 v[232:235], a[148:151], v[108:111], v[232:235]
    ds_read_b128 a[148:151], v6 offset:21504
    v_add_f32 v8, v8, v74
    v_mfma_f32_16x16x32_bf16 v[236:239], a[156:159], v[108:111], v[236:239]
    buffer_load_dwordx4 v3, s[8:11], s36 offen offset:1024 sc1 lds
    v_mfma_f32_16x16x32_bf16 v[236:239], a[152:155], v[104:107], v[236:239]
    ds_read_b128 a[156:159], v6 offset:23552
    ds_read_b128 a[152:155], v6 offset:22528
    v_mfma_f32_16x16x32_bf16 v[240:243], a[160:163], v[104:107], v[240:243]
    v_add_f32 v8, v8, v75
    v_cvt_pk_bf16_f32 v101, v74, v75
    v_mfma_f32_16x16x32_bf16 v[240:243], a[164:167], v[108:111], v[240:243]
    v_exp_f32 v76, v76
    v_mfma_f32_16x16x32_bf16 v[244:247], a[172:175], v[108:111], v[244:247]
    v_exp_f32 v77, v77
    v_mfma_f32_16x16x32_bf16 v[244:247], a[168:171], v[104:107], v[244:247]
    v_add_f32 v8, v8, v76
    v_add_f32 v8, v8, v77
    v_mfma_f32_16x16x32_bf16 v[248:251], a[176:179], v[104:107], v[248:251]
    v_exp_f32 v78, v78
    v_mfma_f32_16x16x32_bf16 v[248:251], a[180:183], v[108:111], v[248:251]
    v_exp_f32 v79, v79
    v_mfma_f32_16x16x32_bf16 v[252:255], a[188:191], v[108:111], v[252:255]
    v_cvt_pk_bf16_f32 v102, v76, v77
    v_add_f32 v8, v8, v78
    v_mfma_f32_16x16x32_bf16 v[252:255], a[184:187], v[104:107], v[252:255]
    v_add_f32 v8, v8, v79
    v_cvt_pk_bf16_f32 v103, v78, v79
    v_mfma_f32_16x16x32_bf16 v[64:67], a[64:67], a[32:35], v[120:123]
    ds_read_b128 a[160:163], v6 offset:24576
    ds_read_b128 a[164:167], v6 offset:25600
    v_exp_f32 v80, v80
    v_mfma_f32_16x16x32_bf16 v[64:67], a[68:71], a[36:39], v[64:67]
    ds_read_b128 a[172:175], v6 offset:27648
    ds_read_b128 a[168:171], v6 offset:26624
    v_exp_f32 v81, v81
    v_mfma_f32_16x16x32_bf16 v[64:67], a[72:75], a[40:43], v[64:67]
    v_add_f32 v9, v9, v80
    v_add_f32 v9, v9, v81
    v_mfma_f32_16x16x32_bf16 v[64:67], a[76:79], a[44:47], v[64:67]
    v_exp_f32 v82, v82
    v_mfma_f32_16x16x32_bf16 v[68:71], a[92:95], a[44:47], v[120:123]
    ds_read_b128 a[176:179], v6 offset:28672
    ds_read_b128 a[180:183], v6 offset:29696
    v_mfma_f32_16x16x32_bf16 v[68:71], a[88:91], a[40:43], v[68:71]
    ds_read_b128 a[188:191], v6 offset:31744
    ds_read_b128 a[184:187], v6 offset:30720
    v_mfma_f32_16x16x32_bf16 v[68:71], a[84:87], a[36:39], v[68:71]
    v_exp_f32 v83, v83
    v_mfma_f32_16x16x32_bf16 v[68:71], a[80:83], a[32:35], v[68:71]
    buffer_load_dwordx4 v3, s[8:11], s36 offen offset:2048 sc1 lds
    v_mfma_f32_16x16x32_bf16 v[72:75], a[96:99], a[32:35], v[120:123]
    v_cvt_pk_bf16_f32 v104, v80, v81
    v_add_f32 v9, v9, v82
    v_mfma_f32_16x16x32_bf16 v[72:75], a[100:103], a[36:39], v[72:75]
    v_add_f32 v9, v9, v83
    v_cvt_pk_bf16_f32 v105, v82, v83
    v_mfma_f32_16x16x32_bf16 v[72:75], a[104:107], a[40:43], v[72:75]
    v_exp_f32 v84, v84
    v_mfma_f32_16x16x32_bf16 v[72:75], a[108:111], a[44:47], v[72:75]
    v_exp_f32 v85, v85
    v_mfma_f32_16x16x32_bf16 v[76:79], a[124:127], a[44:47], v[120:123]
    v_add_f32 v9, v9, v84
    v_add_f32 v9, v9, v85
    v_mfma_f32_16x16x32_bf16 v[76:79], a[120:123], a[40:43], v[76:79]
    v_exp_f32 v86, v86
    v_mfma_f32_16x16x32_bf16 v[76:79], a[116:119], a[36:39], v[76:79]
    v_exp_f32 v87, v87
    v_mfma_f32_16x16x32_bf16 v[76:79], a[112:115], a[32:35], v[76:79]
    v_cvt_pk_bf16_f32 v106, v84, v85
    v_add_f32 v9, v9, v86
    s_waitcnt lgkmcnt(0)
    v_mfma_f32_16x16x32_bf16 v[128:131], a[128:131], v[96:99], v[128:131]
    v_add_f32 v9, v9, v87
    v_cvt_pk_bf16_f32 v107, v86, v87
    v_mfma_f32_16x16x32_bf16 v[128:131], a[132:135], v[100:103], v[128:131]
    v_exp_f32 v88, v88
    v_mfma_f32_16x16x32_bf16 v[132:135], a[140:143], v[100:103], v[132:135]
    v_exp_f32 v89, v89
    v_mfma_f32_16x16x32_bf16 v[132:135], a[136:139], v[96:99], v[132:135]
    v_add_f32 v9, v9, v88
    v_add_f32 v9, v9, v89
    v_mfma_f32_16x16x32_bf16 v[136:139], a[144:147], v[96:99], v[136:139]
    buffer_load_dwordx4 v3, s[8:11], s36 offen offset:3072 sc1 lds
    s_add_u32 s36, s36, 32768
    s_xor_b32 s38, s38, 0x10000
    v_mfma_f32_16x16x32_bf16 v[136:139], a[148:151], v[100:103], v[136:139]
    v_exp_f32 v90, v90
    v_mfma_f32_16x16x32_bf16 v[140:143], a[156:159], v[100:103], v[140:143]
    v_exp_f32 v91, v91
    v_mfma_f32_16x16x32_bf16 v[140:143], a[152:155], v[96:99], v[140:143]
    v_cvt_pk_bf16_f32 v108, v88, v89
    v_add_f32 v9, v9, v90
    v_mfma_f32_16x16x32_bf16 v[144:147], a[160:163], v[96:99], v[144:147]
    v_add_f32 v9, v9, v91
    v_cvt_pk_bf16_f32 v109, v90, v91
    v_mfma_f32_16x16x32_bf16 v[144:147], a[164:167], v[100:103], v[144:147]
    v_exp_f32 v92, v92
    v_mfma_f32_16x16x32_bf16 v[148:151], a[172:175], v[100:103], v[148:151]
    v_exp_f32 v93, v93
    v_mfma_f32_16x16x32_bf16 v[148:151], a[168:171], v[96:99], v[148:151]
    v_add_f32 v9, v9, v92
    v_add_f32 v9, v9, v93
    v_mfma_f32_16x16x32_bf16 v[152:155], a[176:179], v[96:99], v[152:155]
    v_exp_f32 v94, v94
    v_mfma_f32_16x16x32_bf16 v[152:155], a[180:183], v[100:103], v[152:155]
    v_exp_f32 v95, v95
    v_mfma_f32_16x16x32_bf16 v[156:159], a[188:191], v[100:103], v[156:159]
    v_cvt_pk_bf16_f32 v110, v92, v93
    v_add_f32 v9, v9, v94
    v_mfma_f32_16x16x32_bf16 v[156:159], a[184:187], v[96:99], v[156:159]
    v_add_f32 v9, v9, v95
    v_cvt_pk_bf16_f32 v111, v94, v95
    s_waitcnt vmcnt(18)
    s_barrier
    v_mfma_f32_16x16x32_bf16 v[80:83], a[64:67], a[48:51], v[124:127]
    v_exp_f32 v64, v64
    v_exp_f32 v65, v65
    v_mfma_f32_16x16x32_bf16 v[80:83], a[68:71], a[52:55], v[80:83]
    v_add_f32 v10, v10, v64
    v_add_f32 v10, v10, v65
    v_exp_f32 v66, v66
    v_mfma_f32_16x16x32_bf16 v[80:83], a[72:75], a[56:59], v[80:83]
    ds_read_b128 a[64:67], v6 offset:32768
    ds_read_b128 a[68:71], v6 offset:33792
    v_mfma_f32_16x16x32_bf16 v[80:83], a[76:79], a[60:63], v[80:83]
    ds_read_b128 a[72:75], v6 offset:34816
    ds_read_b128 a[76:79], v6 offset:35840
    v_mfma_f32_16x16x32_bf16 v[84:87], a[92:95], a[60:63], v[124:127]
    v_exp_f32 v67, v67
    v_mfma_f32_16x16x32_bf16 v[84:87], a[88:91], a[56:59], v[84:87]
    ds_read_b128 a[92:95], v6 offset:39936
    ds_read_b128 a[88:91], v6 offset:38912
    v_mfma_f32_16x16x32_bf16 v[84:87], a[84:87], a[52:55], v[84:87]
    ds_read_b128 a[84:87], v6 offset:37888
    v_cvt_pk_bf16_f32 v96, v64, v65
    v_mfma_f32_16x16x32_bf16 v[84:87], a[80:83], a[48:51], v[84:87]
    ds_read_b128 a[80:83], v6 offset:36864
    v_add_f32 v10, v10, v66
    v_mfma_f32_16x16x32_bf16 v[88:91], a[96:99], a[48:51], v[124:127]
    ds_read_b128 a[96:99], v6 offset:40960
    v_add_f32 v10, v10, v67
    v_mfma_f32_16x16x32_bf16 v[88:91], a[100:103], a[52:55], v[88:91]
    ds_read_b128 a[100:103], v6 offset:41984
    v_cvt_pk_bf16_f32 v97, v66, v67
    v_mfma_f32_16x16x32_bf16 v[88:91], a[104:107], a[56:59], v[88:91]
    v_exp_f32 v68, v68
    v_mfma_f32_16x16x32_bf16 v[88:91], a[108:111], a[60:63], v[88:91]
    ds_read_b128 a[104:107], v6 offset:43008
    ds_read_b128 a[108:111], v6 offset:44032
    v_mfma_f32_16x16x32_bf16 v[92:95], a[124:127], a[60:63], v[124:127]
    v_exp_f32 v69, v69
    v_mfma_f32_16x16x32_bf16 v[92:95], a[120:123], a[56:59], v[92:95]
    v_add_f32 v10, v10, v68
    v_add_f32 v10, v10, v69
    v_mfma_f32_16x16x32_bf16 v[92:95], a[116:119], a[52:55], v[92:95]
    v_exp_f32 v70, v70
    v_mfma_f32_16x16x32_bf16 v[92:95], a[112:115], a[48:51], v[92:95]
    v_exp_f32 v71, v71
    v_mfma_f32_16x16x32_bf16 v[160:163], a[128:131], v[104:107], v[160:163]
    v_cvt_pk_bf16_f32 v98, v68, v69
    v_add_f32 v10, v10, v70
    v_mfma_f32_16x16x32_bf16 v[160:163], a[132:135], v[108:111], v[160:163]
    v_add_f32 v10, v10, v71
    v_cvt_pk_bf16_f32 v99, v70, v71
    v_mfma_f32_16x16x32_bf16 v[164:167], a[140:143], v[108:111], v[164:167]
    v_exp_f32 v72, v72
    v_mfma_f32_16x16x32_bf16 v[164:167], a[136:139], v[104:107], v[164:167]
    v_exp_f32 v73, v73
    v_mfma_f32_16x16x32_bf16 v[168:171], a[144:147], v[104:107], v[168:171]
    v_add_f32 v10, v10, v72
    v_add_f32 v10, v10, v73
    v_mfma_f32_16x16x32_bf16 v[168:171], a[148:151], v[108:111], v[168:171]
    v_exp_f32 v74, v74
    v_mfma_f32_16x16x32_bf16 v[172:175], a[156:159], v[108:111], v[172:175]
    v_exp_f32 v75, v75
    v_mfma_f32_16x16x32_bf16 v[172:175], a[152:155], v[104:107], v[172:175]
    v_cvt_pk_bf16_f32 v100, v72, v73
    v_add_f32 v10, v10, v74
    v_mfma_f32_16x16x32_bf16 v[176:179], a[160:163], v[104:107], v[176:179]
    v_add_f32 v10, v10, v75
    v_cvt_pk_bf16_f32 v101, v74, v75
    v_mfma_f32_16x16x32_bf16 v[176:179], a[164:167], v[108:111], v[176:179]
    v_exp_f32 v76, v76
    v_mfma_f32_16x16x32_bf16 v[180:183], a[172:175], v[108:111], v[180:183]
    v_exp_f32 v77, v77
    v_mfma_f32_16x16x32_bf16 v[180:183], a[168:171], v[104:107], v[180:183]
    v_add_f32 v10, v10, v76
    v_add_f32 v10, v10, v77
    v_mfma_f32_16x16x32_bf16 v[184:187], a[176:179], v[104:107], v[184:187]
    v_exp_f32 v78, v78
    v_mfma_f32_16x16x32_bf16 v[184:187], a[180:183], v[108:111], v[184:187]
    v_exp_f32 v79, v79
    v_mfma_f32_16x16x32_bf16 v[188:191], a[188:191], v[108:111], v[188:191]
    v_cvt_pk_bf16_f32 v102, v76, v77
    v_add_f32 v10, v10, v78
    v_mfma_f32_16x16x32_bf16 v[188:191], a[184:187], v[104:107], v[188:191]
    v_add_f32 v10, v10, v79
    v_cvt_pk_bf16_f32 v103, v78, v79
    s_waitcnt lgkmcnt(0)
    v_mfma_f32_16x16x32_bf16 v[64:67], a[64:67], a[0:3], v[112:115]
    ds_read_b128 a[124:127], v6 offset:48128
    ds_read_b128 a[120:123], v6 offset:47104
    s_waitcnt vmcnt(17)
    buffer_load_dwordx4 v[44:47], v56, s[20:23], 0 offen sc1
    v_mfma_f32_16x16x32_bf16 v[64:67], a[68:71], a[4:7], v[64:67]
    ds_read_b128 a[116:119], v6 offset:46080
    ds_read_b128 a[112:115], v6 offset:45056
    v_exp_f32 v80, v80
    v_mfma_f32_16x16x32_bf16 v[64:67], a[72:75], a[8:11], v[64:67]
    v_exp_f32 v81, v81
    v_mfma_f32_16x16x32_bf16 v[64:67], a[76:79], a[12:15], v[64:67]
    v_add_f32 v11, v11, v80
    v_add_f32 v11, v11, v81
    v_mfma_f32_16x16x32_bf16 v[68:71], a[92:95], a[12:15], v[112:115]
    s_mov_b32 m0, s37
    v_exp_f32 v82, v82
    v_mfma_f32_16x16x32_bf16 v[68:71], a[88:91], a[8:11], v[68:71]
    buffer_load_dwordx4 v2, s[8:11], s36 offen offset:0 sc1 lds
    v_mfma_f32_16x16x32_bf16 v[68:71], a[84:87], a[4:7], v[68:71]
    v_exp_f32 v83, v83
    v_mfma_f32_16x16x32_bf16 v[68:71], a[80:83], a[0:3], v[68:71]
    v_cvt_pk_bf16_f32 v104, v80, v81
    v_add_f32 v11, v11, v82
    v_mfma_f32_16x16x32_bf16 v[72:75], a[96:99], a[0:3], v[112:115]
    v_add_f32 v11, v11, v83
    v_cvt_pk_bf16_f32 v105, v82, v83
    v_mfma_f32_16x16x32_bf16 v[72:75], a[100:103], a[4:7], v[72:75]
    v_exp_f32 v84, v84
    v_mfma_f32_16x16x32_bf16 v[72:75], a[104:107], a[8:11], v[72:75]
    v_exp_f32 v85, v85
    v_mfma_f32_16x16x32_bf16 v[72:75], a[108:111], a[12:15], v[72:75]
    v_add_f32 v11, v11, v84
    v_add_f32 v11, v11, v85
    s_waitcnt lgkmcnt(0)
    v_mfma_f32_16x16x32_bf16 v[76:79], a[124:127], a[12:15], v[112:115]
    v_exp_f32 v86, v86
    v_mfma_f32_16x16x32_bf16 v[76:79], a[120:123], a[8:11], v[76:79]
    buffer_load_dwordx4 v2, s[8:11], s36 offen offset:1024 sc1 lds
    v_mfma_f32_16x16x32_bf16 v[76:79], a[116:119], a[4:7], v[76:79]
    v_exp_f32 v87, v87
    v_mfma_f32_16x16x32_bf16 v[76:79], a[112:115], a[0:3], v[76:79]
    v_cvt_pk_bf16_f32 v106, v84, v85
    v_add_f32 v11, v11, v86
    v_mfma_f32_16x16x32_bf16 v[192:195], a[128:131], v[96:99], v[192:195]
    v_add_f32 v11, v11, v87
    v_cvt_pk_bf16_f32 v107, v86, v87
    v_mfma_f32_16x16x32_bf16 v[192:195], a[132:135], v[100:103], v[192:195]
    v_exp_f32 v88, v88
    v_mfma_f32_16x16x32_bf16 v[196:199], a[140:143], v[100:103], v[196:199]
    v_exp_f32 v89, v89
    v_mfma_f32_16x16x32_bf16 v[196:199], a[136:139], v[96:99], v[196:199]
    v_add_f32 v11, v11, v88
    v_add_f32 v11, v11, v89
    v_mfma_f32_16x16x32_bf16 v[200:203], a[144:147], v[96:99], v[200:203]
    v_exp_f32 v90, v90
    v_mfma_f32_16x16x32_bf16 v[200:203], a[148:151], v[100:103], v[200:203]
    v_exp_f32 v91, v91
    v_mfma_f32_16x16x32_bf16 v[204:207], a[156:159], v[100:103], v[204:207]
    buffer_load_dwordx4 v2, s[8:11], s36 offen offset:2048 sc1 lds
    v_mfma_f32_16x16x32_bf16 v[204:207], a[152:155], v[96:99], v[204:207]
    v_cvt_pk_bf16_f32 v108, v88, v89
    v_add_f32 v11, v11, v90
    v_mfma_f32_16x16x32_bf16 v[208:211], a[160:163], v[96:99], v[208:211]
    v_add_f32 v11, v11, v91
    v_cvt_pk_bf16_f32 v109, v90, v91
    v_mfma_f32_16x16x32_bf16 v[208:211], a[164:167], v[100:103], v[208:211]
    v_exp_f32 v92, v92
    v_mfma_f32_16x16x32_bf16 v[212:215], a[172:175], v[100:103], v[212:215]
    v_exp_f32 v93, v93
    v_mfma_f32_16x16x32_bf16 v[212:215], a[168:171], v[96:99], v[212:215]
    v_add_f32 v11, v11, v92
    v_add_f32 v11, v11, v93
    v_mfma_f32_16x16x32_bf16 v[216:219], a[176:179], v[96:99], v[216:219]
    v_exp_f32 v94, v94
    v_mfma_f32_16x16x32_bf16 v[216:219], a[180:183], v[100:103], v[216:219]
    v_exp_f32 v95, v95
    v_mfma_f32_16x16x32_bf16 v[220:223], a[188:191], v[100:103], v[220:223]
    v_cvt_pk_bf16_f32 v110, v92, v93
    v_add_f32 v11, v11, v94
    v_mfma_f32_16x16x32_bf16 v[220:223], a[184:187], v[96:99], v[220:223]
    v_add_f32 v11, v11, v95
    v_cvt_pk_bf16_f32 v111, v94, v95
    v_mfma_f32_16x16x32_bf16 v[80:83], a[64:67], a[16:19], v[116:119]
    v_exp_f32 v64, v64
    v_exp_f32 v65, v65
    v_mfma_f32_16x16x32_bf16 v[80:83], a[68:71], a[20:23], v[80:83]
    v_add_f32 v8, v8, v64
    v_add_f32 v8, v8, v65
    v_exp_f32 v66, v66
    v_mfma_f32_16x16x32_bf16 v[80:83], a[72:75], a[24:27], v[80:83]
    v_exp_f32 v67, v67
    v_cvt_pk_bf16_f32 v96, v64, v65
    v_mfma_f32_16x16x32_bf16 v[80:83], a[76:79], a[28:31], v[80:83]
    v_add_f32 v8, v8, v66
    v_add_f32 v8, v8, v67
    v_cvt_pk_bf16_f32 v97, v66, v67
    v_mfma_f32_16x16x32_bf16 v[84:87], a[92:95], a[28:31], v[116:119]
    v_exp_f32 v68, v68
    v_mfma_f32_16x16x32_bf16 v[84:87], a[88:91], a[24:27], v[84:87]
    v_exp_f32 v69, v69
    v_mfma_f32_16x16x32_bf16 v[84:87], a[84:87], a[20:23], v[84:87]
    v_add_f32 v8, v8, v68
    v_add_f32 v8, v8, v69
    v_mfma_f32_16x16x32_bf16 v[84:87], a[80:83], a[16:19], v[84:87]
    buffer_load_dwordx4 v2, s[8:11], s36 offen offset:3072 sc1 lds
    v_mfma_f32_16x16x32_bf16 v[88:91], a[96:99], a[16:19], v[116:119]
    v_exp_f32 v70, v70
    v_mfma_f32_16x16x32_bf16 v[88:91], a[100:103], a[20:23], v[88:91]
    v_exp_f32 v71, v71
    v_mfma_f32_16x16x32_bf16 v[88:91], a[104:107], a[24:27], v[88:91]
    v_cvt_pk_bf16_f32 v98, v68, v69
    v_add_f32 v8, v8, v70
    v_mfma_f32_16x16x32_bf16 v[88:91], a[108:111], a[28:31], v[88:91]
    v_add_f32 v8, v8, v71
    v_cvt_pk_bf16_f32 v99, v70, v71
    v_mfma_f32_16x16x32_bf16 v[92:95], a[124:127], a[28:31], v[116:119]
    s_add_u32 m0, s37, 4096
    v_exp_f32 v72, v72
    v_mfma_f32_16x16x32_bf16 v[92:95], a[120:123], a[24:27], v[92:95]
    buffer_load_dwordx4 v3, s[8:11], s36 offen offset:0 sc1 lds
    v_mfma_f32_16x16x32_bf16 v[92:95], a[116:119], a[20:23], v[92:95]
    v_exp_f32 v73, v73
    v_mfma_f32_16x16x32_bf16 v[92:95], a[112:115], a[16:19], v[92:95]
    v_add_f32 v8, v8, v72
    v_add_f32 v8, v8, v73
    v_mfma_f32_16x16x32_bf16 v[224:227], a[128:131], v[104:107], v[224:227]
    v_exp_f32 v74, v74
    v_mfma_f32_16x16x32_bf16 v[224:227], a[132:135], v[108:111], v[224:227]
    ds_read_b128 a[128:131], v6 offset:49152
    ds_read_b128 a[132:135], v6 offset:50176
    v_mfma_f32_16x16x32_bf16 v[228:231], a[140:143], v[108:111], v[228:231]
    v_exp_f32 v75, v75
    v_mfma_f32_16x16x32_bf16 v[228:231], a[136:139], v[104:107], v[228:231]
    ds_read_b128 a[140:143], v6 offset:52224
    ds_read_b128 a[136:139], v6 offset:51200
    v_mfma_f32_16x16x32_bf16 v[232:235], a[144:147], v[104:107], v[232:235]
    ds_read_b128 a[144:147], v6 offset:53248
    v_cvt_pk_bf16_f32 v100, v72, v73
    v_mfma_f32_16x16x32_bf16 v[232:235], a[148:151], v[108:111], v[232:235]
    ds_read_b128 a[148:151], v6 offset:54272
    v_add_f32 v8, v8, v74
    v_mfma_f32_16x16x32_bf16 v[236:239], a[156:159], v[108:111], v[236:239]
    buffer_load_dwordx4 v3, s[8:11], s36 offen offset:1024 sc1 lds
    v_mfma_f32_16x16x32_bf16 v[236:239], a[152:155], v[104:107], v[236:239]
    ds_read_b128 a[156:159], v6 offset:56320
    ds_read_b128 a[152:155], v6 offset:55296
    v_mfma_f32_16x16x32_bf16 v[240:243], a[160:163], v[104:107], v[240:243]
    v_add_f32 v8, v8, v75
    v_cvt_pk_bf16_f32 v101, v74, v75
    v_mfma_f32_16x16x32_bf16 v[240:243], a[164:167], v[108:111], v[240:243]
    v_exp_f32 v76, v76
    v_mfma_f32_16x16x32_bf16 v[244:247], a[172:175], v[108:111], v[244:247]
    v_exp_f32 v77, v77
    v_mfma_f32_16x16x32_bf16 v[244:247], a[168:171], v[104:107], v[244:247]
    v_add_f32 v8, v8, v76
    v_add_f32 v8, v8, v77
    v_mfma_f32_16x16x32_bf16 v[248:251], a[176:179], v[104:107], v[248:251]
    v_exp_f32 v78, v78
    v_mfma_f32_16x16x32_bf16 v[248:251], a[180:183], v[108:111], v[248:251]
    v_exp_f32 v79, v79
    v_mfma_f32_16x16x32_bf16 v[252:255], a[188:191], v[108:111], v[252:255]
    v_cvt_pk_bf16_f32 v102, v76, v77
    v_add_f32 v8, v8, v78
    v_mfma_f32_16x16x32_bf16 v[252:255], a[184:187], v[104:107], v[252:255]
    v_add_f32 v8, v8, v79
    v_cvt_pk_bf16_f32 v103, v78, v79
    v_mfma_f32_16x16x32_bf16 v[64:67], a[64:67], a[32:35], v[120:123]
    ds_read_b128 a[160:163], v6 offset:57344
    ds_read_b128 a[164:167], v6 offset:58368
    v_exp_f32 v80, v80
    v_mfma_f32_16x16x32_bf16 v[64:67], a[68:71], a[36:39], v[64:67]
    ds_read_b128 a[172:175], v6 offset:60416
    ds_read_b128 a[168:171], v6 offset:59392
    v_exp_f32 v81, v81
    v_mfma_f32_16x16x32_bf16 v[64:67], a[72:75], a[40:43], v[64:67]
    v_add_f32 v9, v9, v80
    v_add_f32 v9, v9, v81
    v_mfma_f32_16x16x32_bf16 v[64:67], a[76:79], a[44:47], v[64:67]
    v_exp_f32 v82, v82
    v_mfma_f32_16x16x32_bf16 v[68:71], a[92:95], a[44:47], v[120:123]
    ds_read_b128 a[176:179], v6 offset:61440
    ds_read_b128 a[180:183], v6 offset:62464
    v_mfma_f32_16x16x32_bf16 v[68:71], a[88:91], a[40:43], v[68:71]
    ds_read_b128 a[188:191], v6 offset:64512
    ds_read_b128 a[184:187], v6 offset:63488
    v_mfma_f32_16x16x32_bf16 v[68:71], a[84:87], a[36:39], v[68:71]
    v_exp_f32 v83, v83
    v_mfma_f32_16x16x32_bf16 v[68:71], a[80:83], a[32:35], v[68:71]
    buffer_load_dwordx4 v3, s[8:11], s36 offen offset:2048 sc1 lds
    v_mfma_f32_16x16x32_bf16 v[72:75], a[96:99], a[32:35], v[120:123]
    v_cvt_pk_bf16_f32 v104, v80, v81
    v_add_f32 v9, v9, v82
    v_mfma_f32_16x16x32_bf16 v[72:75], a[100:103], a[36:39], v[72:75]
    v_add_f32 v9, v9, v83
    v_cvt_pk_bf16_f32 v105, v82, v83
    v_mfma_f32_16x16x32_bf16 v[72:75], a[104:107], a[40:43], v[72:75]
    v_exp_f32 v84, v84
    v_mfma_f32_16x16x32_bf16 v[72:75], a[108:111], a[44:47], v[72:75]
    v_exp_f32 v85, v85
    v_mfma_f32_16x16x32_bf16 v[76:79], a[124:127], a[44:47], v[120:123]
    v_add_f32 v9, v9, v84
    v_add_f32 v9, v9, v85
    v_mfma_f32_16x16x32_bf16 v[76:79], a[120:123], a[40:43], v[76:79]
    v_exp_f32 v86, v86
    v_mfma_f32_16x16x32_bf16 v[76:79], a[116:119], a[36:39], v[76:79]
    v_exp_f32 v87, v87
    v_mfma_f32_16x16x32_bf16 v[76:79], a[112:115], a[32:35], v[76:79]
    v_cvt_pk_bf16_f32 v106, v84, v85
    v_add_f32 v9, v9, v86
    s_waitcnt lgkmcnt(0)
    v_mfma_f32_16x16x32_bf16 v[128:131], a[128:131], v[96:99], v[128:131]
    v_add_f32 v9, v9, v87
    v_cvt_pk_bf16_f32 v107, v86, v87
    v_mfma_f32_16x16x32_bf16 v[128:131], a[132:135], v[100:103], v[128:131]
    v_exp_f32 v88, v88
    v_mfma_f32_16x16x32_bf16 v[132:135], a[140:143], v[100:103], v[132:135]
    v_exp_f32 v89, v89
    v_mfma_f32_16x16x32_bf16 v[132:135], a[136:139], v[96:99], v[132:135]
    v_add_f32 v9, v9, v88
    v_add_f32 v9, v9, v89
    v_mfma_f32_16x16x32_bf16 v[136:139], a[144:147], v[96:99], v[136:139]
    buffer_load_dwordx4 v3, s[8:11], s36 offen offset:3072 sc1 lds
    s_add_u32 s36, s36, 32768
    s_xor_b32 s37, s37, 0x10000
    v_mfma_f32_16x16x32_bf16 v[136:139], a[148:151], v[100:103], v[136:139]
    v_exp_f32 v90, v90
    v_mfma_f32_16x16x32_bf16 v[140:143], a[156:159], v[100:103], v[140:143]
    v_exp_f32 v91, v91
    v_mfma_f32_16x16x32_bf16 v[140:143], a[152:155], v[96:99], v[140:143]
    v_cvt_pk_bf16_f32 v108, v88, v89
    v_add_f32 v9, v9, v90
    v_mfma_f32_16x16x32_bf16 v[144:147], a[160:163], v[96:99], v[144:147]
    v_add_f32 v9, v9, v91
    v_cvt_pk_bf16_f32 v109, v90, v91
    v_mfma_f32_16x16x32_bf16 v[144:147], a[164:167], v[100:103], v[144:147]
    v_exp_f32 v92, v92
    v_mfma_f32_16x16x32_bf16 v[148:151], a[172:175], v[100:103], v[148:151]
    v_exp_f32 v93, v93
    v_mfma_f32_16x16x32_bf16 v[148:151], a[168:171], v[96:99], v[148:151]
    v_add_f32 v9, v9, v92
    v_add_f32 v9, v9, v93
    v_mfma_f32_16x16x32_bf16 v[152:155], a[176:179], v[96:99], v[152:155]
    v_exp_f32 v94, v94
    v_mfma_f32_16x16x32_bf16 v[152:155], a[180:183], v[100:103], v[152:155]
    v_exp_f32 v95, v95
    v_mfma_f32_16x16x32_bf16 v[156:159], a[188:191], v[100:103], v[156:159]
    v_cvt_pk_bf16_f32 v110, v92, v93
    v_add_f32 v9, v9, v94
    v_mfma_f32_16x16x32_bf16 v[156:159], a[184:187], v[96:99], v[156:159]
    v_add_f32 v9, v9, v95
    v_cvt_pk_bf16_f32 v111, v94, v95
    s_waitcnt vmcnt(17)
    s_barrier
    v_xor_b32 v6, 0x10000, v6
    v_mfma_f32_16x16x32_bf16 v[80:83], a[64:67], a[48:51], v[124:127]
    v_exp_f32 v64, v64
    v_exp_f32 v65, v65
    v_mfma_f32_16x16x32_bf16 v[80:83], a[68:71], a[52:55], v[80:83]
    v_add_f32 v10, v10, v64
    v_add_f32 v10, v10, v65
    v_exp_f32 v66, v66
    v_mfma_f32_16x16x32_bf16 v[80:83], a[72:75], a[56:59], v[80:83]
    ds_read_b128 a[64:67], v6 offset:0
    ds_read_b128 a[68:71], v6 offset:1024
    buffer_store_dwordx2 v[50:51], v52, s[20:23], s78 offen sc1
    v_mfma_f32_16x16x32_bf16 v[80:83], a[76:79], a[60:63], v[80:83]
    ds_read_b128 a[72:75], v6 offset:2048
    ds_read_b128 a[76:79], v6 offset:3072
    v_exp_f32 v67, v67
    v_mfma_f32_16x16x32_bf16 v[84:87], a[92:95], a[60:63], v[124:127]
    ds_read_b128 a[92:95], v6 offset:7168
    v_cvt_pk_bf16_f32 v96, v64, v65
    v_mfma_f32_16x16x32_bf16 v[84:87], a[88:91], a[56:59], v[84:87]
    ds_read_b128 a[88:91], v6 offset:6144
    v_add_f32 v10, v10, v66
    v_mfma_f32_16x16x32_bf16 v[84:87], a[84:87], a[52:55], v[84:87]
    ds_read_b128 a[84:87], v6 offset:5120
    v_add_f32 v10, v10, v67
    v_mfma_f32_16x16x32_bf16 v[84:87], a[80:83], a[48:51], v[84:87]
    ds_read_b128 a[80:83], v6 offset:4096
    v_cvt_pk_bf16_f32 v97, v66, v67
    v_mfma_f32_16x16x32_bf16 v[88:91], a[96:99], a[48:51], v[124:127]
    v_exp_f32 v68, v68
    v_mfma_f32_16x16x32_bf16 v[88:91], a[100:103], a[52:55], v[88:91]
    ds_read_b128 a[96:99], v6 offset:8192
    ds_read_b128 a[100:103], v6 offset:9216
    v_mfma_f32_16x16x32_bf16 v[88:91], a[104:107], a[56:59], v[88:91]
    v_exp_f32 v69, v69
    v_mfma_f32_16x16x32_bf16 v[88:91], a[108:111], a[60:63], v[88:91]
    ds_read_b128 a[104:107], v6 offset:10240
    ds_read_b128 a[108:111], v6 offset:11264
    v_mfma_f32_16x16x32_bf16 v[92:95], a[124:127], a[60:63], v[124:127]
    v_add_f32 v10, v10, v68
    v_add_f32 v10, v10, v69
    v_mfma_f32_16x16x32_bf16 v[92:95], a[120:123], a[56:59], v[92:95]
    v_exp_f32 v70, v70
    v_mfma_f32_16x16x32_bf16 v[92:95], a[116:119], a[52:55], v[92:95]
    v_exp_f32 v71, v71
    v_mfma_f32_16x16x32_bf16 v[92:95], a[112:115], a[48:51], v[92:95]
    v_cvt_pk_bf16_f32 v98, v68, v69
    v_add_f32 v10, v10, v70
    v_mfma_f32_16x16x32_bf16 v[160:163], a[128:131], v[104:107], v[160:163]
    v_add_f32 v10, v10, v71
    v_cvt_pk_bf16_f32 v99, v70, v71
    v_mfma_f32_16x16x32_bf16 v[160:163], a[132:135], v[108:111], v[160:163]
    v_exp_f32 v72, v72
    v_mfma_f32_16x16x32_bf16 v[164:167], a[140:143], v[108:111], v[164:167]
    v_exp_f32 v73, v73
    v_mfma_f32_16x16x32_bf16 v[164:167], a[136:139], v[104:107], v[164:167]
    v_add_f32 v10, v10, v72
    v_add_f32 v10, v10, v73
    v_mfma_f32_16x16x32_bf16 v[168:171], a[144:147], v[104:107], v[168:171]
    s_sub_u32 s35, s35, 1
    s_cmp_lg_u32 s35, s88
    v_mfma_f32_16x16x32_bf16 v[168:171], a[148:151], v[108:111], v[168:171]
    v_exp_f32 v74, v74
    v_mfma_f32_16x16x32_bf16 v[172:175], a[156:159], v[108:111], v[172:175]
    v_exp_f32 v75, v75
    v_mfma_f32_16x16x32_bf16 v[172:175], a[152:155], v[104:107], v[172:175]
    v_cvt_pk_bf16_f32 v100, v72, v73
    v_add_f32 v10, v10, v74
    v_mfma_f32_16x16x32_bf16 v[176:179], a[160:163], v[104:107], v[176:179]
    v_add_f32 v10, v10, v75
    v_cvt_pk_bf16_f32 v101, v74, v75
    v_mfma_f32_16x16x32_bf16 v[176:179], a[164:167], v[108:111], v[176:179]
    v_exp_f32 v76, v76
    v_mfma_f32_16x16x32_bf16 v[180:183], a[172:175], v[108:111], v[180:183]
    v_exp_f32 v77, v77
    v_mfma_f32_16x16x32_bf16 v[180:183], a[168:171], v[104:107], v[180:183]
    v_add_f32 v10, v10, v76
    v_add_f32 v10, v10, v77
    v_mfma_f32_16x16x32_bf16 v[184:187], a[176:179], v[104:107], v[184:187]
    v_exp_f32 v78, v78
    v_mfma_f32_16x16x32_bf16 v[184:187], a[180:183], v[108:111], v[184:187]
    v_exp_f32 v79, v79
    v_mfma_f32_16x16x32_bf16 v[188:191], a[188:191], v[108:111], v[188:191]
    v_cvt_pk_bf16_f32 v102, v76, v77
    v_add_f32 v10, v10, v78
    v_mfma_f32_16x16x32_bf16 v[188:191], a[184:187], v[104:107], v[188:191]
    v_add_f32 v10, v10, v79
    v_cvt_pk_bf16_f32 v103, v78, v79
    s_cbranch_scc1 L_p1
L_chka:
    s_cmp_lg_u32 s88, 0
    s_cbranch_scc1 L_p0
    s_cmp_lt_u32 s34, 5
    s_cbranch_scc1 L_d1
    s_waitcnt vmcnt(9)
    v_cmp_eq_u64_e64 s[4:5], s[80:81], v[44:45]
    v_cmp_eq_u64 vcc, s[80:81], v[46:47]
    s_and_b64 s[4:5], s[4:5], vcc
    s_cmp_eq_u64 s[4:5], -1
    s_cbranch_scc0 L_ka_retry
L_ka_back:
    s_mov_b32 s35, s83
    s_mov_b32 s83, 0
    s_cmp_lg_u32 s35, 0
    s_cbranch_scc1 L_p1
L_d1:
    s_lshl_b32 s52, s34, 1
    s_sub_u32 s52, 14, s52
    s_cmp_eq_u32 s52, 0
    s_cselect_b32 s39, 0x10000, s49
    s_lshr_b32 s53, s32, 1
    s_lshl_b32 s53, s53, 14
    s_add_u32 s37, s37, s53
    s_add_u32 s53, s53, 32768
    s_sub_u32 s88, s52, 2
    s_sub_u32 s3, 9, s34
    s_cmp_lt_u32 s34, 5
    s_cselect_b32 s88, s3, s88
    s_mov_b32 s83, 1
    s_cmp_eq_u32 s32, 1
    s_cbranch_scc1 L_d1_1
    s_cmp_eq_u32 s32, 2
    s_cbranch_scc1 L_d1_2
    s_cmp_eq_u32 s32, 3
    s_cbranch_scc1 L_d1_3
L_d1_0:
    s_waitcnt lgkmcnt(0)
    v_mfma_f32_16x16x32_bf16 v[64:67], a[64:67], a[0:3], v[112:115]
    ds_read_b128 a[124:127], v6 offset:15360
    ds_read_b128 a[120:123], v6 offset:14336
    v_exp_f32 v80, v80
    v_mfma_f32_16x16x32_bf16 v[64:67], a[68:71], a[4:7], v[64:67]
    ds_read_b128 a[116:119], v6 offset:13312
    ds_read_b128 a[112:115], v6 offset:12288
    v_exp_f32 v81, v81
    v_mfma_f32_16x16x32_bf16 v[64:67], a[72:75], a[8:11], v[64:67]
    v_add_f32 v11, v11, v80
    v_add_f32 v11, v11, v81
    v_mfma_f32_16x16x32_bf16 v[64:67], a[76:79], a[12:15], v[64:67]
    v_exp_f32 v82, v82
    v_mfma_f32_16x16x32_bf16 v[68:71], a[92:95], a[12:15], v[112:115]
    v_exp_f32 v83, v83
    v_cvt_pk_bf16_f32 v104, v80, v81
    v_mfma_f32_16x16x32_bf16 v[68:71], a[88:91], a[8:11], v[68:71]
    s_mov_b32 m0, s38
    v_add_f32 v11, v11, v82
    v_mfma_f32_16x16x32_bf16 v[68:71], a[84:87], a[4:7], v[68:71]
    v_add_f32 v11, v11, v83
    v_cvt_pk_bf16_f32 v105, v82, v83
    v_mfma_f32_16x16x32_bf16 v[68:71], a[80:83], a[0:3], v[68:71]
    buffer_load_dwordx4 v2, s[8:11], s36 offen offset:0 sc1 lds
    v_mfma_f32_16x16x32_bf16 v[72:75], a[96:99], a[0:3], v[112:115]
    v_exp_f32 v84, v84
    v_mfma_f32_16x16x32_bf16 v[72:75], a[100:103], a[4:7], v[72:75]
    v_exp_f32 v85, v85
    v_mfma_f32_16x16x32_bf16 v[72:75], a[104:107], a[8:11], v[72:75]
    v_add_f32 v11, v11, v84
    v_add_f32 v11, v11, v85
    v_mfma_f32_16x16x32_bf16 v[72:75], a[108:111], a[12:15], v[72:75]
    v_exp_f32 v86, v86
    s_waitcnt lgkmcnt(0)
    v_mfma_f32_16x16x32_bf16 v[76:79], a[124:127], a[12:15], v[112:115]
    v_exp_f32 v87, v87
    v_mfma_f32_16x16x32_bf16 v[76:79], a[120:123], a[8:11], v[76:79]
    v_cvt_pk_bf16_f32 v106, v84, v85
    v_add_f32 v11, v11, v86
    v_mfma_f32_16x16x32_bf16 v[76:79], a[116:119], a[4:7], v[76:79]
    v_add_f32 v11, v11, v87
    v_cvt_pk_bf16_f32 v107, v86, v87
    v_mfma_f32_16x16x32_bf16 v[76:79], a[112:115], a[0:3], v[76:79]
    v_exp_f32 v88, v88
    v_mfma_f32_16x16x32_bf16 v[192:195], a[128:131], v[96:99], v[192:195]
    buffer_load_dwordx4 v2, s[8:11], s36 offen offset:1024 sc1 lds
    v_mfma_f32_16x16x32_bf16 v[192:195], a[132:135], v[100:103], v[192:195]
    v_exp_f32 v89, v89
    v_mfma_f32_16x16x32_bf16 v[196:199], a[140:143], v[100:103], v[196:199]
    v_add_f32 v11, v11, v88
    v_add_f32 v11, v11, v89
    v_mfma_f32_16x16x32_bf16 v[196:199], a[136:139], v[96:99], v[196:199]
    v_exp_f32 v90, v90
    v_mfma_f32_16x16x32_bf16 v[200:203], a[144:147], v[96:99], v[200:203]
    v_exp_f32 v91, v91
    v_mfma_f32_16x16x32_bf16 v[200:203], a[148:151], v[100:103], v[200:203]
    v_cvt_pk_bf16_f32 v108, v88, v89
    v_add_f32 v11, v11, v90
    v_mfma_f32_16x16x32_bf16 v[204:207], a[156:159], v[100:103], v[204:207]
    v_add_f32 v11, v11, v91
    v_cvt_pk_bf16_f32 v109, v90, v91
    v_mfma_f32_16x16x32_bf16 v[204:207], a[152:155], v[96:99], v[204:207]
    v_exp_f32 v92, v92
    v_mfma_f32_16x16x32_bf16 v[208:211], a[160:163], v[96:99], v[208:211]
    v_exp_f32 v93, v93
    v_mfma_f32_16x16x32_bf16 v[208:211], a[164:167], v[100:103], v[208:211]
    buffer_load_dwordx4 v2, s[8:11], s36 offen offset:2048 sc1 lds
    v_mfma_f32_16x16x32_bf16 v[212:215], a[172:175], v[100:103], v[212:215]
    v_add_f32 v11, v11, v92
    v_add_f32 v11, v11, v93
    v_mfma_f32_16x16x32_bf16 v[212:215], a[168:171], v[96:99], v[212:215]
    v_exp_f32 v94, v94
    v_mfma_f32_16x16x32_bf16 v[216:219], a[176:179], v[96:99], v[216:219]
    v_exp_f32 v95, v95
    v_mfma_f32_16x16x32_bf16 v[216:219], a[180:183], v[100:103], v[216:219]
    v_cvt_pk_bf16_f32 v110, v92, v93
    v_add_f32 v11, v11, v94
    v_mfma_f32_16x16x32_bf16 v[220:223], a[188:191], v[100:103], v[220:223]
    v_add_f32 v11, v11, v95
    v_cvt_pk_bf16_f32 v111, v94, v95
    v_mfma_f32_16x16x32_bf16 v[220:223], a[184:187], v[96:99], v[220:223]
    s_and_b32 s4, s2, 7
    s_mul_i32 s4, s4, 28
    s_lshr_b32 s5, s2, 3
    s_add_u32 s4, s4, s5
    s_sub_u32 s4, s4, 4
    s_cmp_ge_u32 s5, 4
    s_cselect_b32 s4, s4, 0
    s_cselect_b32 s5, 7168, 0
    v_lshrrev_b32 v49, 24, v0
    v_mul_u32_u24 v48, s5, v49
    v_lshl_add_u32 v48, s4, 4, v48
    v_and_b32 v49, 127, v49
    s_lshl_b32 s4, s4, 13
    s_add_u32 s4, s4, 4096
    v_lshl_add_u32 v49, v49, 3, s4
    v_mfma_f32_16x16x32_bf16 v[80:83], a[64:67], a[16:19], v[116:119]
    v_exp_f32 v64, v64
    v_exp_f32 v65, v65
    v_mfma_f32_16x16x32_bf16 v[80:83], a[68:71], a[20:23], v[80:83]
    v_add_f32 v8, v8, v64
    v_add_f32 v8, v8, v65
    v_exp_f32 v66, v66
    v_mfma_f32_16x16x32_bf16 v[80:83], a[72:75], a[24:27], v[80:83]
    s_waitcnt vmcnt(12)
    v_mov_b64 v[44:45], -1
    v_mov_b64 v[46:47], -1
    v_exp_f32 v67, v67
    v_mfma_f32_16x16x32_bf16 v[80:83], a[76:79], a[28:31], v[80:83]
    v_cvt_pk_bf16_f32 v96, v64, v65
    v_add_f32 v8, v8, v66
    v_add_f32 v8, v8, v67
    v_mfma_f32_16x16x32_bf16 v[84:87], a[92:95], a[28:31], v[116:119]
    v_cndmask_b32_e64 v20, v7, v120, s[24:25]
    v_cvt_pk_bf16_f32 v97, v66, v67
    buffer_load_dwordx4 v2, s[8:11], s36 offen offset:3072 sc1 lds
    v_mfma_f32_16x16x32_bf16 v[84:87], a[88:91], a[24:27], v[84:87]
    v_exp_f32 v68, v68
    v_exp_f32 v69, v69
    v_mfma_f32_16x16x32_bf16 v[84:87], a[84:87], a[20:23], v[84:87]
    v_add_f32 v8, v8, v68
    v_add_f32 v8, v8, v69
    v_exp_f32 v70, v70
    v_mfma_f32_16x16x32_bf16 v[84:87], a[80:83], a[16:19], v[84:87]
    v_cndmask_b32_e64 v21, v7, v120, s[26:27]
    v_cndmask_b32_e64 v22, v7, v120, s[28:29]
    v_mfma_f32_16x16x32_bf16 v[88:91], a[96:99], a[16:19], v[116:119]
    v_exp_f32 v71, v71
    v_mfma_f32_16x16x32_bf16 v[88:91], a[100:103], a[20:23], v[88:91]
    v_cvt_pk_bf16_f32 v98, v68, v69
    v_add_f32 v8, v8, v70
    v_mfma_f32_16x16x32_bf16 v[88:91], a[104:107], a[24:27], v[88:91]
    v_add_f32 v8, v8, v71
    v_cvt_pk_bf16_f32 v99, v70, v71
    v_mfma_f32_16x16x32_bf16 v[88:91], a[108:111], a[28:31], v[88:91]
    v_exp_f32 v72, v72
    v_mfma_f32_16x16x32_bf16 v[92:95], a[124:127], a[28:31], v[116:119]
    v_cndmask_b32_e64 v23, v7, v120, s[30:31]
    s_add_u32 m0, s38, 4096
    v_mfma_f32_16x16x32_bf16 v[92:95], a[120:123], a[24:27], v[92:95]
    buffer_load_dwordx4 v3, s[8:11], s36 offen offset:0 sc1 lds
    v_mfma_f32_16x16x32_bf16 v[92:95], a[116:119], a[20:23], v[92:95]
    v_exp_f32 v73, v73
    v_mfma_f32_16x16x32_bf16 v[92:95], a[112:115], a[16:19], v[92:95]
    v_add_f32 v8, v8, v72
    v_add_f32 v8, v8, v73
    v_mfma_f32_16x16x32_bf16 v[224:227], a[128:131], v[104:107], v[224:227]
    v_exp_f32 v74, v74
    v_mfma_f32_16x16x32_bf16 v[224:227], a[132:135], v[108:111], v[224:227]
    ds_read_b128 a[128:131], v6 offset:16384
    ds_read_b128 a[132:135], v6 offset:17408
    v_mfma_f32_16x16x32_bf16 v[228:231], a[140:143], v[108:111], v[228:231]
    v_exp_f32 v75, v75
    v_mfma_f32_16x16x32_bf16 v[228:231], a[136:139], v[104:107], v[228:231]
    ds_read_b128 a[140:143], v6 offset:19456
    ds_read_b128 a[136:139], v6 offset:18432
    v_mfma_f32_16x16x32_bf16 v[232:235], a[144:147], v[104:107], v[232:235]
    ds_read_b128 a[144:147], v6 offset:20480
    v_cvt_pk_bf16_f32 v100, v72, v73
    v_mfma_f32_16x16x32_bf16 v[232:235], a[148:151], v[108:111], v[232:235]
    ds_read_b128 a[148:151], v6 offset:21504
    v_add_f32 v8, v8, v74
    v_mfma_f32_16x16x32_bf16 v[236:239], a[156:159], v[108:111], v[236:239]
    buffer_load_dwordx4 v3, s[8:11], s36 offen offset:1024 sc1 lds
    v_mfma_f32_16x16x32_bf16 v[236:239], a[152:155], v[104:107], v[236:239]
    ds_read_b128 a[156:159], v6 offset:23552
    ds_read_b128 a[152:155], v6 offset:22528
    v_mfma_f32_16x16x32_bf16 v[240:243], a[160:163], v[104:107], v[240:243]
    v_add_f32 v8, v8, v75
    v_cvt_pk_bf16_f32 v101, v74, v75
    v_mfma_f32_16x16x32_bf16 v[240:243], a[164:167], v[108:111], v[240:243]
    v_exp_f32 v76, v76
    v_mfma_f32_16x16x32_bf16 v[244:247], a[172:175], v[108:111], v[244:247]
    v_exp_f32 v77, v77
    v_mfma_f32_16x16x32_bf16 v[244:247], a[168:171], v[104:107], v[244:247]
    v_add_f32 v8, v8, v76
    v_add_f32 v8, v8, v77
    v_mfma_f32_16x16x32_bf16 v[248:251], a[176:179], v[104:107], v[248:251]
    v_exp_f32 v78, v78
    v_mfma_f32_16x16x32_bf16 v[248:251], a[180:183], v[108:111], v[248:251]
    v_exp_f32 v79, v79
    v_mfma_f32_16x16x32_bf16 v[252:255], a[188:191], v[108:111], v[252:255]
    v_cvt_pk_bf16_f32 v102, v76, v77
    v_add_f32 v8, v8, v78
    v_mfma_f32_16x16x32_bf16 v[252:255], a[184:187], v[104:107], v[252:255]
    v_add_f32 v8, v8, v79
    v_cvt_pk_bf16_f32 v103, v78, v79
    v_mfma_f32_16x16x32_bf16 v[64:67], a[64:67], a[32:35], v[20:23]
    ds_read_b128 a[160:163], v6 offset:24576
    ds_read_b128 a[164:167], v6 offset:25600
    buffer_load_dwordx4 v3, s[8:11], s36 offen offset:2048 sc1 lds
    v_mfma_f32_16x16x32_bf16 v[64:67], a[68:71], a[36:39], v[64:67]
    ds_read_b128 a[172:175], v6 offset:27648
    ds_read_b128 a[168:171], v6 offset:26624
    v_exp_f32 v80, v80
    v_mfma_f32_16x16x32_bf16 v[64:67], a[72:75], a[40:43], v[64:67]
    ds_read_b128 a[176:179], v6 offset:28672
    ds_read_b128 a[180:183], v6 offset:29696
    v_exp_f32 v81, v81
    v_mfma_f32_16x16x32_bf16 v[64:67], a[76:79], a[44:47], v[64:67]
    v_add_f32 v9, v9, v80
    v_add_f32 v9, v9, v81
    v_exp_f32 v82, v82
    s_waitcnt lgkmcnt(6)
    v_mfma_f32_16x16x32_bf16 v[128:131], a[128:131], v[96:99], v[128:131]
    ds_read_b128 a[188:191], v6 offset:31744
    ds_read_b128 a[184:187], v6 offset:30720
    v_exp_f32 v83, v83
    v_mfma_f32_16x16x32_bf16 v[128:131], a[132:135], v[100:103], v[128:131]
    v_cvt_pk_bf16_f32 v104, v80, v81
    buffer_load_dwordx4 v3, s[8:11], s36 offen offset:3072 sc1 lds
    s_add_u32 s36, s36, s53
    v_mfma_f32_16x16x32_bf16 v[132:135], a[140:143], v[100:103], v[132:135]
    v_add_f32 v9, v9, v82
    v_add_f32 v9, v9, v83
    v_cvt_pk_bf16_f32 v105, v82, v83
    v_mfma_f32_16x16x32_bf16 v[132:135], a[136:139], v[96:99], v[132:135]
    v_exp_f32 v84, v84
    v_exp_f32 v85, v85
    v_mfma_f32_16x16x32_bf16 v[136:139], a[144:147], v[96:99], v[136:139]
    v_add_f32 v9, v9, v84
    v_add_f32 v9, v9, v85
    v_exp_f32 v86, v86
    v_mfma_f32_16x16x32_bf16 v[136:139], a[148:151], v[100:103], v[136:139]
    v_exp_f32 v87, v87
    v_cvt_pk_bf16_f32 v106, v84, v85
    v_mfma_f32_16x16x32_bf16 v[140:143], a[156:159], v[100:103], v[140:143]
    v_add_f32 v9, v9, v86
    v_add_f32 v9, v9, v87
    v_cvt_pk_bf16_f32 v107, v86, v87
    v_mfma_f32_16x16x32_bf16 v[140:143], a[152:155], v[96:99], v[140:143]
    v_exp_f32 v88, v88
    v_exp_f32 v89, v89
    s_waitcnt lgkmcnt(0)
    v_mfma_f32_16x16x32_bf16 v[144:147], a[160:163], v[96:99], v[144:147]
    global_load_dwordx4 a[224:227], v48, s[56:57] offset:0
    v_mfma_f32_16x16x32_bf16 v[144:147], a[164:167], v[100:103], v[144:147]
    v_add_f32 v9, v9, v88
    v_add_f32 v9, v9, v89
    v_exp_f32 v90, v90
    v_mfma_f32_16x16x32_bf16 v[148:151], a[172:175], v[100:103], v[148:151]
    v_exp_f32 v91, v91
    v_cvt_pk_bf16_f32 v108, v88, v89
    v_mfma_f32_16x16x32_bf16 v[148:151], a[168:171], v[96:99], v[148:151]
    v_add_f32 v9, v9, v90
    v_add_f32 v9, v9, v91
    v_cvt_pk_bf16_f32 v109, v90, v91
    v_mfma_f32_16x16x32_bf16 v[152:155], a[176:179], v[96:99], v[152:155]
    v_exp_f32 v92, v92
    v_exp_f32 v93, v93
    v_mfma_f32_16x16x32_bf16 v[152:155], a[180:183], v[100:103], v[152:155]
    v_add_f32 v9, v9, v92
    v_add_f32 v9, v9, v93
    v_exp_f32 v94, v94
    v_mfma_f32_16x16x32_bf16 v[156:159], a[188:191], v[100:103], v[156:159]
    v_exp_f32 v95, v95
    v_cvt_pk_bf16_f32 v110, v92, v93
    v_mfma_f32_16x16x32_bf16 v[156:159], a[184:187], v[96:99], v[156:159]
    v_add_f32 v9, v9, v94
    v_add_f32 v9, v9, v95
    v_cvt_pk_bf16_f32 v111, v94, v95
    s_waitcnt vmcnt(19)
    s_barrier
    v_mfma_f32_16x16x32_bf16 v[80:83], a[64:67], a[48:51], v[124:127]
    v_exp_f32 v64, v64
    v_mfma_f32_16x16x32_bf16 v[80:83], a[68:71], a[52:55], v[80:83]
    v_exp_f32 v65, v65
    v_mfma_f32_16x16x32_bf16 v[80:83], a[72:75], a[56:59], v[80:83]
    global_load_dwordx2 a[240:241], v49, s[60:61] offset:-4096
    v_mfma_f32_16x16x32_bf16 v[80:83], a[76:79], a[60:63], v[80:83]
    ds_read_b128 a[64:67], v6 offset:32768
    ds_read_b128 a[68:71], v6 offset:33792
    v_mfma_f32_16x16x32_bf16 v[84:87], a[92:95], a[60:63], v[124:127]
    global_load_dwordx2 a[242:243], v49, s[60:61] offset:-3072
    v_mfma_f32_16x16x32_bf16 v[84:87], a[88:91], a[56:59], v[84:87]
    ds_read_b128 a[32:35], v18 offset:0
    ds_read_b128 a[72:75], v6 offset:34816
    v_mfma_f32_16x16x32_bf16 v[84:87], a[84:87], a[52:55], v[84:87]
    ds_read_b128 a[36:39], v18 offset:1024
    ds_read_b128 a[40:43], v18 offset:2048
    v_mfma_f32_16x16x32_bf16 v[84:87], a[80:83], a[48:51], v[84:87]
    global_load_dwordx2 a[244:245], v49, s[60:61] offset:-2048
    v_mfma_f32_16x16x32_bf16 v[88:91], a[96:99], a[48:51], v[124:127]
    ds_read_b128 a[44:47], v18 offset:3072
    v_mov_b32 v120, v12
    v_mfma_f32_16x16x32_bf16 v[88:91], a[100:103], a[52:55], v[88:91]
    v_mov_b32 v121, v12
    v_mov_b32 v122, v12
    v_mfma_f32_16x16x32_bf16 v[88:91], a[104:107], a[56:59], v[88:91]
    v_mov_b32 v123, v12
    v_cndmask_b32_e64 v20, v7, v124, s[24:25]
    v_mfma_f32_16x16x32_bf16 v[88:91], a[108:111], a[60:63], v[88:91]
    v_cndmask_b32_e64 v21, v7, v124, s[26:27]
    v_cndmask_b32_e64 v22, v7, v124, s[28:29]
    v_mfma_f32_16x16x32_bf16 v[92:95], a[124:127], a[60:63], v[124:127]
    global_load_dwordx2 a[246:247], v49, s[60:61] offset:-1024
    v_mfma_f32_16x16x32_bf16 v[92:95], a[120:123], a[56:59], v[92:95]
    v_cndmask_b32_e64 v23, v7, v124, s[30:31]
    ds_read_b128 a[76:79], v6 offset:35840
    v_mfma_f32_16x16x32_bf16 v[92:95], a[116:119], a[52:55], v[92:95]
    ds_read_b128 a[92:95], v6 offset:39936
    ds_read_b128 a[88:91], v6 offset:38912
    v_mfma_f32_16x16x32_bf16 v[92:95], a[112:115], a[48:51], v[92:95]
    global_load_dwordx2 a[248:249], v49, s[60:61] offset:0
    v_mfma_f32_16x16x32_bf16 v[160:163], a[128:131], v[104:107], v[160:163]
    ds_read_b128 a[84:87], v6 offset:37888
    ds_read_b128 a[80:83], v6 offset:36864
    v_mfma_f32_16x16x32_bf16 v[160:163], a[132:135], v[108:111], v[160:163]
    global_load_dwordx2 a[250:251], v49, s[60:61] offset:1024
    v_mfma_f32_16x16x32_bf16 v[164:167], a[140:143], v[108:111], v[164:167]
    ds_read_b128 a[96:99], v6 offset:40960
    ds_read_b128 a[100:103], v6 offset:41984
    v_mfma_f32_16x16x32_bf16 v[164:167], a[136:139], v[104:107], v[164:167]
    ds_read_b128 a[104:107], v6 offset:43008
    ds_read_b128 a[108:111], v6 offset:44032
    v_mfma_f32_16x16x32_bf16 v[168:171], a[144:147], v[104:107], v[168:171]
    global_load_dwordx2 a[252:253], v49, s[60:61] offset:2048
    v_mfma_f32_16x16x32_bf16 v[168:171], a[148:151], v[108:111], v[168:171]
    v_add_f32 v10, v10, v64
    v_add_f32 v10, v10, v65
    v_mfma_f32_16x16x32_bf16 v[172:175], a[156:159], v[108:111], v[172:175]
    global_load_dwordx2 a[254:255], v49, s[60:61] offset:3072
    v_mfma_f32_16x16x32_bf16 v[172:175], a[152:155], v[104:107], v[172:175]
    v_exp_f32 v66, v66
    v_mfma_f32_16x16x32_bf16 v[176:179], a[160:163], v[104:107], v[176:179]
    v_exp_f32 v67, v67
    v_mfma_f32_16x16x32_bf16 v[176:179], a[164:167], v[108:111], v[176:179]
    v_cvt_pk_bf16_f32 v96, v64, v65
    v_add_f32 v10, v10, v66
    v_mfma_f32_16x16x32_bf16 v[180:183], a[172:175], v[108:111], v[180:183]
    v_add_f32 v10, v10, v67
    v_cvt_pk_bf16_f32 v97, v66, v67
    v_mfma_f32_16x16x32_bf16 v[180:183], a[168:171], v[104:107], v[180:183]
    v_mov_b64 v[98:99], 0
    v_mfma_f32_16x16x32_bf16 v[184:187], a[176:179], v[104:107], v[184:187]
    global_load_dwordx4 a[228:231], v48, s[56:57] offset:3584
    v_mfma_f32_16x16x32_bf16 v[184:187], a[180:183], v[108:111], v[184:187]
    v_mfma_f32_16x16x32_bf16 v[188:191], a[188:191], v[108:111], v[188:191]
    v_mfma_f32_16x16x32_bf16 v[188:191], a[184:187], v[104:107], v[188:191]
    s_waitcnt lgkmcnt(0)
    v_mfma_f32_16x16x32_bf16 v[64:67], a[64:67], a[48:51], v[124:127]
    ds_read_b128 a[124:127], v6 offset:48128
    ds_read_b128 a[120:123], v6 offset:47104
    v_exp_f32 v80, v80
    v_mfma_f32_16x16x32_bf16 v[64:67], a[68:71], a[52:55], v[64:67]
    ds_read_b128 a[116:119], v6 offset:46080
    ds_read_b128 a[112:115], v6 offset:45056
    v_exp_f32 v81, v81
    v_mfma_f32_16x16x32_bf16 v[64:67], a[72:75], a[56:59], v[64:67]
    v_mov_b32 v41, v10
    s_mov_b32 s3, s55
    buffer_store_dwordx4 v[44:47], v63, s[16:19], s3 offen sc1
    v_mfma_f32_16x16x32_bf16 v[64:67], a[76:79], a[60:63], v[64:67]
    v_add_f32 v11, v11, v80
    v_add_f32 v11, v11, v81
    v_exp_f32 v82, v82
    v_mfma_f32_16x16x32_bf16 v[68:71], a[92:95], a[60:63], v[124:127]
    s_nop 1
    v_permlane16_swap_b32 v10, v41
    v_exp_f32 v83, v83
    v_mfma_f32_16x16x32_bf16 v[68:71], a[88:91], a[56:59], v[68:71]
    v_cvt_pk_bf16_f32 v104, v80, v81
    s_xor_b32 s3, s55, 0x10000
    buffer_store_dwordx4 v[44:47], v63, s[16:19], s3 offen sc1
    v_mfma_f32_16x16x32_bf16 v[68:71], a[84:87], a[52:55], v[68:71]
    v_add_f32 v11, v11, v82
    v_add_f32 v11, v11, v83
    v_cvt_pk_bf16_f32 v105, v82, v83
    v_mfma_f32_16x16x32_bf16 v[68:71], a[80:83], a[48:51], v[68:71]
    v_exp_f32 v84, v84
    v_exp_f32 v85, v85
    v_mfma_f32_16x16x32_bf16 v[72:75], a[96:99], a[48:51], v[124:127]
    v_add_f32 v10, v10, v41
    s_xor_b32 s3, s55, 0x20000
    buffer_store_dwordx4 v[44:47], v63, s[16:19], s3 offen sc1
    v_mfma_f32_16x16x32_bf16 v[72:75], a[100:103], a[52:55], v[72:75]
    v_add_f32 v11, v11, v84
    v_add_f32 v11, v11, v85
    v_exp_f32 v86, v86
    v_mfma_f32_16x16x32_bf16 v[72:75], a[104:107], a[56:59], v[72:75]
    v_mov_b32 v41, v10
    s_nop 1
    v_exp_f32 v87, v87
    v_mfma_f32_16x16x32_bf16 v[72:75], a[108:111], a[60:63], v[72:75]
    v_cvt_pk_bf16_f32 v106, v84, v85
    s_xor_b32 s3, s55, 0x30000
    buffer_store_dwordx4 v[44:47], v63, s[16:19], s3 offen sc1
    s_waitcnt lgkmcnt(0)
    v_mfma_f32_16x16x32_bf16 v[76:79], a[124:127], a[60:63], v[20:23]
    v_add_f32 v11, v11, v86
    v_add_f32 v11, v11, v87
    v_cvt_pk_bf16_f32 v107, v86, v87
    v_mfma_f32_16x16x32_bf16 v[76:79], a[120:123], a[56:59], v[76:79]
    v_exp_f32 v88, v88
    v_exp_f32 v89, v89
    v_mfma_f32_16x16x32_bf16 v[76:79], a[116:119], a[52:55], v[76:79]
    v_add_f32 v11, v11, v88
    v_add_f32 v11, v11, v89
    v_exp_f32 v90, v90
    v_mfma_f32_16x16x32_bf16 v[76:79], a[112:115], a[48:51], v[76:79]
    v_permlane32_swap_b32 v10, v41
    v_add_f32 v10, v10, v41
    v_exp_f32 v91, v91
    v_mfma_f32_16x16x32_bf16 v[192:195], a[128:131], v[96:99], v[192:195]
    global_load_dwordx4 a[232:235], v48, s[58:59] offset:0
    v_mfma_f32_16x16x32_bf16 v[196:199], a[136:139], v[96:99], v[196:199]
    v_cvt_pk_bf16_f32 v108, v88, v89
    v_add_f32 v11, v11, v90
    v_rcp_f32 v40, v10
    v_mfma_f32_16x16x32_bf16 v[200:203], a[144:147], v[96:99], v[200:203]
    v_add_f32 v11, v11, v91
    v_cvt_pk_bf16_f32 v109, v90, v91
    v_exp_f32 v92, v92
    v_mfma_f32_16x16x32_bf16 v[204:207], a[152:155], v[96:99], v[204:207]
    v_cmp_nge_f32 vcc, 0x5f800000, v10
    s_or_b64 s[50:51], s[50:51], vcc
    v_exp_f32 v93, v93
    v_mfma_f32_16x16x32_bf16 v[208:211], a[160:163], v[96:99], v[208:211]
    v_add_f32 v11, v11, v92
    v_add_f32 v11, v11, v93
    v_exp_f32 v94, v94
    v_mfma_f32_16x16x32_bf16 v[212:215], a[168:171], v[96:99], v[212:215]
    v_exp_f32 v95, v95
    v_mfma_f32_16x16x32_bf16 v[216:219], a[176:179], v[96:99], v[216:219]
    v_cvt_pk_bf16_f32 v110, v92, v93
    v_add_f32 v11, v11, v94
    v_mfma_f32_16x16x32_bf16 v[220:223], a[184:187], v[96:99], v[220:223]
    v_add_f32 v11, v11, v95
    v_cvt_pk_bf16_f32 v111, v94, v95
    v_mfma_f32_16x16x32_bf16 v[80:83], a[64:67], a[0:3], v[112:115]
    v_exp_f32 v64, v64
    v_exp_f32 v65, v65
    v_mfma_f32_16x16x32_bf16 v[80:83], a[68:71], a[4:7], v[80:83]
    v_add_f32 v11, v11, v64
    v_add_f32 v11, v11, v65
    v_exp_f32 v66, v66
    v_mfma_f32_16x16x32_bf16 v[80:83], a[72:75], a[8:11], v[80:83]
    ds_read_b128 a[48:51], v18 offset:4096
    s_xor_b32 s3, s55, 0x780000
    buffer_store_dwordx4 v[44:47], v63, s[16:19], s3 offen sc1
    v_mfma_f32_16x16x32_bf16 v[80:83], a[76:79], a[12:15], v[80:83]
    ds_read_b128 a[52:55], v18 offset:5120
    ds_read_b128 a[56:59], v18 offset:6144
    v_exp_f32 v67, v67
    v_mfma_f32_16x16x32_bf16 v[84:87], a[92:95], a[12:15], v[112:115]
    ds_read_b128 a[60:63], v18 offset:7168
    v_cvt_pk_bf16_f32 v96, v64, v65
    v_add_f32 v11, v11, v66
    v_mfma_f32_16x16x32_bf16 v[84:87], a[88:91], a[8:11], v[84:87]
    v_add_f32 v11, v11, v67
    v_cvt_pk_bf16_f32 v97, v66, v67
    v_exp_f32 v68, v68
    v_mfma_f32_16x16x32_bf16 v[84:87], a[84:87], a[4:7], v[84:87]
    v_mul_f32 v192, v192, v40
    s_xor_b32 s3, s55, 0x790000
    buffer_store_dwordx4 v[44:47], v63, s[16:19], s3 offen sc1
    v_mfma_f32_16x16x32_bf16 v[84:87], a[80:83], a[0:3], v[84:87]
    v_mul_f32 v193, v193, v40
    v_mul_f32 v194, v194, v40
    v_exp_f32 v69, v69
    v_mfma_f32_16x16x32_bf16 v[88:91], a[96:99], a[0:3], v[112:115]
    v_add_f32 v11, v11, v68
    v_add_f32 v11, v11, v69
    v_exp_f32 v70, v70
    v_mfma_f32_16x16x32_bf16 v[88:91], a[100:103], a[4:7], v[88:91]
    v_mul_f32 v195, v195, v40
    v_mul_f32 v196, v196, v40
    v_exp_f32 v71, v71
    v_mfma_f32_16x16x32_bf16 v[88:91], a[104:107], a[8:11], v[88:91]
    v_mul_f32 v197, v197, v40
    v_mul_f32 v198, v198, v40
    v_cvt_pk_bf16_f32 v98, v68, v69
    v_mfma_f32_16x16x32_bf16 v[88:91], a[108:111], a[12:15], v[88:91]
    v_add_f32 v11, v11, v70
    s_xor_b32 s3, s55, 0x7a0000
    buffer_store_dwordx4 v[44:47], v63, s[16:19], s3 offen sc1
    v_mfma_f32_16x16x32_bf16 v[92:95], a[124:127], a[12:15], v[112:115]
    v_add_f32 v11, v11, v71
    v_cvt_pk_bf16_f32 v99, v70, v71
    v_exp_f32 v72, v72
    v_mfma_f32_16x16x32_bf16 v[92:95], a[120:123], a[8:11], v[92:95]
    v_mul_f32 v199, v199, v40
    v_cvt_pk_bf16_f32 v32, v192, v193
    v_exp_f32 v73, v73
    v_mfma_f32_16x16x32_bf16 v[92:95], a[116:119], a[4:7], v[92:95]
    v_add_f32 v11, v11, v72
    v_add_f32 v11, v11, v73
    v_exp_f32 v74, v74
    v_mfma_f32_16x16x32_bf16 v[92:95], a[112:115], a[0:3], v[92:95]
    v_cvt_pk_bf16_f32 v33, v194, v195
    s_xor_b32 s3, s55, 0x7b0000
    buffer_store_dwordx4 v[44:47], v63, s[16:19], s3 offen sc1
    v_mfma_f32_16x16x32_bf16 v[224:227], a[128:131], v[104:107], v[224:227]
    v_cvt_pk_bf16_f32 v34, v196, v197
    v_cvt_pk_bf16_f32 v35, v198, v199
    v_exp_f32 v75, v75
    v_mfma_f32_16x16x32_bf16 v[224:227], a[132:135], v[108:111], v[224:227]
    buffer_store_dwordx4 v[32:35], v2, s[16:19], s46 offen offset:0 sc1
    v_cvt_pk_bf16_f32 v100, v72, v73
    v_add_f32 v11, v11, v74
    v_mfma_f32_16x16x32_bf16 v[228:231], a[140:143], v[108:111], v[228:231]
    v_add_f32 v11, v11, v75
    v_cvt_pk_bf16_f32 v101, v74, v75
    v_exp_f32 v76, v76
    v_mfma_f32_16x16x32_bf16 v[228:231], a[136:139], v[104:107], v[228:231]
    ds_read_b128 a[128:131], v6 offset:49152
    ds_read_b128 a[132:135], v6 offset:50176
    v_exp_f32 v77, v77
    v_mfma_f32_16x16x32_bf16 v[232:235], a[144:147], v[104:107], v[232:235]
    v_add_f32 v11, v11, v76
    v_add_f32 v11, v11, v77
    v_exp_f32 v78, v78
    v_mfma_f32_16x16x32_bf16 v[232:235], a[148:151], v[108:111], v[232:235]
    ds_read_b128 a[140:143], v6 offset:52224
    ds_read_b128 a[136:139], v6 offset:51200
    v_exp_f32 v79, v79
    v_mfma_f32_16x16x32_bf16 v[236:239], a[156:159], v[108:111], v[236:239]
    global_load_dwordx4 a[236:239], v48, s[58:59] offset:3584
    v_mfma_f32_16x16x32_bf16 v[236:239], a[152:155], v[104:107], v[236:239]
    v_mov_b64 v[192:193], 0
    v_mov_b64 v[194:195], 0
    ds_read_b128 a[144:147], v6 offset:53248
    v_mfma_f32_16x16x32_bf16 v[240:243], a[160:163], v[104:107], v[240:243]
    v_mov_b64 v[196:197], 0
    v_mov_b64 v[198:199], 0
    ds_read_b128 a[148:151], v6 offset:54272
    v_mfma_f32_16x16x32_bf16 v[240:243], a[164:167], v[108:111], v[240:243]
    v_mul_f32 v200, v200, v40
    v_mul_f32 v201, v201, v40
    ds_read_b128 a[156:159], v6 offset:56320
    v_mfma_f32_16x16x32_bf16 v[244:247], a[172:175], v[108:111], v[244:247]
    v_mov_b32 v124, v13
    v_mov_b32 v125, v13
    ds_read_b128 a[152:155], v6 offset:55296
    v_mfma_f32_16x16x32_bf16 v[244:247], a[168:171], v[104:107], v[244:247]
    v_mov_b32 v126, v13
    v_mov_b32 v127, v13
    v_cvt_pk_bf16_f32 v102, v76, v77
    v_mfma_f32_16x16x32_bf16 v[248:251], a[176:179], v[104:107], v[248:251]
    v_add_f32 v11, v11, v78
    v_add_f32 v11, v11, v79
    v_cvt_pk_bf16_f32 v103, v78, v79
    v_mfma_f32_16x16x32_bf16 v[248:251], a[180:183], v[108:111], v[248:251]
    v_mul_f32 v202, v202, v40
    v_mul_f32 v203, v203, v40
    v_mul_f32 v204, v204, v40
    v_mfma_f32_16x16x32_bf16 v[252:255], a[188:191], v[108:111], v[252:255]
    v_mul_f32 v205, v205, v40
    v_mul_f32 v206, v206, v40
    v_mul_f32 v207, v207, v40
    v_mfma_f32_16x16x32_bf16 v[252:255], a[184:187], v[104:107], v[252:255]
    v_cvt_pk_bf16_f32 v36, v200, v201
    v_cvt_pk_bf16_f32 v37, v202, v203
    v_cvt_pk_bf16_f32 v38, v204, v205
    v_cvt_pk_bf16_f32 v39, v206, v207
    buffer_store_dwordx4 v[36:39], v2, s[16:19], s46 offen offset:1024 sc1
    v_mov_b64 v[200:201], 0
    v_mov_b64 v[202:203], 0
    v_mov_b64 v[204:205], 0
    v_mov_b64 v[206:207], 0
    s_waitcnt vmcnt(22)
    s_barrier
    v_xor_b32 v19, s39, v6
    v_mfma_f32_16x16x32_bf16 v[64:67], a[64:67], a[16:19], v[116:119]
    v_mul_f32 v208, v208, v40
    v_mul_f32 v209, v209, v40
    buffer_store_dwordx2 v[50:51], v52, s[20:23], s78 offen sc1
    v_mfma_f32_16x16x32_bf16 v[64:67], a[68:71], a[20:23], v[64:67]
    v_mul_f32 v210, v210, v40
    v_mul_f32 v211, v211, v40
    v_exp_f32 v80, v80
    v_mfma_f32_16x16x32_bf16 v[64:67], a[72:75], a[24:27], v[64:67]
    v_cndmask_b32_e64 v20, v7, v112, s[24:25]
    v_cndmask_b32_e64 v21, v7, v112, s[26:27]
    v_exp_f32 v81, v81
    v_mfma_f32_16x16x32_bf16 v[64:67], a[76:79], a[28:31], v[64:67]
    v_cndmask_b32_e64 v22, v7, v112, s[28:29]
    s_mov_b32 m0, s37
    s_nop 0
    buffer_load_dwordx4 v2, s[8:11], s36 offen offset:0 sc1 lds
    v_mfma_f32_16x16x32_bf16 v[68:71], a[92:95], a[28:31], v[116:119]
    v_cndmask_b32_e64 v23, v7, v112, s[30:31]
    v_mov_b32 v43, v11
    buffer_load_dwordx4 v2, s[8:11], s36 offen offset:1024 sc1 lds
    v_mfma_f32_16x16x32_bf16 v[68:71], a[88:91], a[24:27], v[68:71]
    v_add_f32 v8, v8, v80
    v_add_f32 v8, v8, v81
    v_exp_f32 v82, v82
    v_mfma_f32_16x16x32_bf16 v[68:71], a[84:87], a[20:23], v[68:71]
    s_nop 1
    v_permlane16_swap_b32 v11, v43
    buffer_load_dwordx4 v2, s[8:11], s36 offen offset:2048 sc1 lds
    v_mfma_f32_16x16x32_bf16 v[68:71], a[80:83], a[16:19], v[68:71]
    v_add_f32 v11, v11, v43
    v_mov_b32 v43, v11
    v_exp_f32 v83, v83
    v_mfma_f32_16x16x32_bf16 v[72:75], a[96:99], a[16:19], v[116:119]
    v_cvt_pk_bf16_f32 v104, v80, v81
    v_add_f32 v8, v8, v82
    buffer_load_dwordx4 v2, s[8:11], s36 offen offset:3072 sc1 lds
    v_mfma_f32_16x16x32_bf16 v[72:75], a[100:103], a[20:23], v[72:75]
    v_add_f32 v8, v8, v83
    v_cvt_pk_bf16_f32 v105, v82, v83
    v_exp_f32 v84, v84
    v_mfma_f32_16x16x32_bf16 v[72:75], a[104:107], a[24:27], v[72:75]
    ds_read_b128 a[160:163], v6 offset:57344
    ds_read_b128 a[164:167], v6 offset:58368
    v_exp_f32 v85, v85
    v_mfma_f32_16x16x32_bf16 v[72:75], a[108:111], a[28:31], v[72:75]
    v_add_f32 v8, v8, v84
    v_add_f32 v8, v8, v85
    v_exp_f32 v86, v86
    v_mfma_f32_16x16x32_bf16 v[76:79], a[124:127], a[28:31], v[116:119]
    s_add_u32 m0, s37, 4096
    ds_read_b128 a[172:175], v6 offset:60416
    buffer_load_dwordx4 v3, s[8:11], s36 offen offset:0 sc1 lds
    v_mfma_f32_16x16x32_bf16 v[76:79], a[120:123], a[24:27], v[76:79]
    ds_read_b128 a[168:171], v6 offset:59392
    ds_read_b128 a[176:179], v6 offset:61440
    buffer_load_dwordx4 v3, s[8:11], s36 offen offset:1024 sc1 lds
    v_mfma_f32_16x16x32_bf16 v[76:79], a[116:119], a[20:23], v[76:79]
    ds_read_b128 a[180:183], v6 offset:62464
    ds_read_b128 a[188:191], v6 offset:64512
    v_exp_f32 v87, v87
    v_mfma_f32_16x16x32_bf16 v[76:79], a[112:115], a[16:19], v[76:79]
    v_cvt_pk_bf16_f32 v106, v84, v85
    v_add_f32 v8, v8, v86
    buffer_load_dwordx4 v3, s[8:11], s36 offen offset:2048 sc1 lds
    s_waitcnt lgkmcnt(5)
    v_mfma_f32_16x16x32_bf16 v[224:227], a[128:131], v[96:99], v[224:227]
    v_add_f32 v8, v8, v87
    v_cvt_pk_bf16_f32 v107, v86, v87
    v_exp_f32 v88, v88
    v_mfma_f32_16x16x32_bf16 v[224:227], a[132:135], v[100:103], v[224:227]
    ds_read_b128 a[184:187], v6 offset:63488
    ds_read_b128 a[64:67], v19 offset:0
    buffer_load_dwordx4 v3, s[8:11], s36 offen offset:3072 sc1 lds
    v_mfma_f32_16x16x32_bf16 v[228:231], a[140:143], v[100:103], v[228:231]
    ds_read_b128 a[68:71], v19 offset:1024
    ds_read_b128 a[72:75], v19 offset:2048
    v_exp_f32 v89, v89
    v_mfma_f32_16x16x32_bf16 v[228:231], a[136:139], v[96:99], v[228:231]
    v_add_f32 v8, v8, v88
    v_add_f32 v8, v8, v89
    v_exp_f32 v90, v90
    v_mfma_f32_16x16x32_bf16 v[232:235], a[144:147], v[96:99], v[232:235]
    ds_read_b128 a[76:79], v19 offset:3072
    ds_read_b128 a[92:95], v19 offset:7168
    v_exp_f32 v91, v91
    v_mfma_f32_16x16x32_bf16 v[232:235], a[148:151], v[100:103], v[232:235]
    ds_read_b128 a[88:91], v19 offset:6144
    v_cvt_pk_bf16_f32 v108, v88, v89
    v_add_f32 v8, v8, v90
    v_mfma_f32_16x16x32_bf16 v[236:239], a[156:159], v[100:103], v[236:239]
    v_add_f32 v8, v8, v91
    v_cvt_pk_bf16_f32 v109, v90, v91
    v_exp_f32 v92, v92
    v_mfma_f32_16x16x32_bf16 v[236:239], a[152:155], v[96:99], v[236:239]
    ds_read_b128 a[84:87], v19 offset:5120
    ds_read_b128 a[80:83], v19 offset:4096
    v_exp_f32 v93, v93
    v_mfma_f32_16x16x32_bf16 v[240:243], a[160:163], v[96:99], v[240:243]
    v_add_f32 v8, v8, v92
    v_add_f32 v8, v8, v93
    v_exp_f32 v94, v94
    v_mfma_f32_16x16x32_bf16 v[240:243], a[164:167], v[100:103], v[240:243]
    s_nop 1
    ds_read_b128 a[96:99], v19 offset:8192
    v_exp_f32 v95, v95
    s_waitcnt lgkmcnt(4)
    v_mfma_f32_16x16x32_bf16 v[244:247], a[172:175], v[100:103], v[244:247]
    v_permlane32_swap_b32 v11, v43
    v_add_f32 v11, v11, v43
    ds_read_b128 a[100:103], v19 offset:9216
    v_mfma_f32_16x16x32_bf16 v[244:247], a[168:171], v[96:99], v[244:247]
    ds_read_b128 a[104:107], v19 offset:10240
    ds_read_b128 a[108:111], v19 offset:11264
    v_rcp_f32 v42, v11
    v_mfma_f32_16x16x32_bf16 v[248:251], a[176:179], v[96:99], v[248:251]
    v_cmp_nge_f32 vcc, 0x5f800000, v11
    s_or_b64 s[50:51], s[50:51], vcc
    v_cvt_pk_bf16_f32 v110, v92, v93
    v_mfma_f32_16x16x32_bf16 v[248:251], a[180:183], v[100:103], v[248:251]
    v_add_f32 v8, v8, v94
    v_add_f32 v8, v8, v95
    v_cvt_pk_bf16_f32 v111, v94, v95
    v_mfma_f32_16x16x32_bf16 v[252:255], a[188:191], v[100:103], v[252:255]
    v_mul_f32 v212, v212, v40
    v_mul_f32 v213, v213, v40
    v_mul_f32 v214, v214, v40
    v_mfma_f32_16x16x32_bf16 v[252:255], a[184:187], v[96:99], v[252:255]
    v_mul_f32 v215, v215, v40
    v_cvt_pk_bf16_f32 v32, v208, v209
    v_cvt_pk_bf16_f32 v33, v210, v211
    v_cvt_pk_bf16_f32 v34, v212, v213
    v_cvt_pk_bf16_f32 v35, v214, v215
    buffer_store_dwordx4 v[32:35], v2, s[16:19], s46 offen offset:2048 sc1
    v_mov_b64 v[208:209], 0
    v_mov_b64 v[210:211], 0
    v_mov_b64 v[212:213], 0
    v_mov_b64 v[214:215], 0
    v_mul_f32 v216, v216, v40
    v_mul_f32 v217, v217, v40
    v_mul_f32 v218, v218, v40
    v_mul_f32 v219, v219, v40
    v_mul_f32 v220, v220, v40
    v_mul_f32 v221, v221, v40
    v_mul_f32 v222, v222, v40
    v_mul_f32 v223, v223, v40
    v_cvt_pk_bf16_f32 v36, v216, v217
    v_cvt_pk_bf16_f32 v37, v218, v219
    v_cvt_pk_bf16_f32 v38, v220, v221
    v_cvt_pk_bf16_f32 v39, v222, v223
    buffer_store_dwordx4 v[36:39], v2, s[16:19], s46 offen offset:3072 sc1
    v_mov_b64 v[216:217], 0
    v_mov_b64 v[218:219], 0
    v_mov_b64 v[220:221], 0
    v_mov_b64 v[222:223], 0
    v_mov_b32 v6, v19
    v_mov_b64 v[10:11], 0
    s_mov_b32 s35, s52
    s_nop 3
    v_pk_mul_f32 v[224:225], v[224:225], v[42:43] op_sel_hi:[1,0]
    v_pk_mul_f32 v[226:227], v[226:227], v[42:43] op_sel_hi:[1,0]
    v_pk_mul_f32 v[228:229], v[228:229], v[42:43] op_sel_hi:[1,0]
    v_pk_mul_f32 v[230:231], v[230:231], v[42:43] op_sel_hi:[1,0]
    v_cvt_pk_bf16_f32 v32, v224, v225
    v_cvt_pk_bf16_f32 v33, v226, v227
    v_cvt_pk_bf16_f32 v34, v228, v229
    v_cvt_pk_bf16_f32 v35, v230, v231
    buffer_store_dwordx4 v[32:35], v2, s[16:19], s47 offen offset:0 sc1
    v_mov_b64 v[224:225], 0
    v_mov_b64 v[226:227], 0
    v_mov_b64 v[228:229], 0
    v_mov_b64 v[230:231], 0
    v_pk_mul_f32 v[232:233], v[232:233], v[42:43] op_sel_hi:[1,0]
    v_pk_mul_f32 v[234:235], v[234:235], v[42:43] op_sel_hi:[1,0]
    v_pk_mul_f32 v[236:237], v[236:237], v[42:43] op_sel_hi:[1,0]
    v_pk_mul_f32 v[238:239], v[238:239], v[42:43] op_sel_hi:[1,0]
    v_cvt_pk_bf16_f32 v36, v232, v233
    v_cvt_pk_bf16_f32 v37, v234, v235
    v_cvt_pk_bf16_f32 v38, v236, v237
    v_cvt_pk_bf16_f32 v39, v238, v239
    buffer_store_dwordx4 v[36:39], v2, s[16:19], s47 offen offset:1024 sc1
    v_mov_b64 v[232:233], 0
    v_mov_b64 v[234:235], 0
    v_mov_b64 v[236:237], 0
    v_mov_b64 v[238:239], 0
    v_pk_mul_f32 v[240:241], v[240:241], v[42:43] op_sel_hi:[1,0]
    v_pk_mul_f32 v[242:243], v[242:243], v[42:43] op_sel_hi:[1,0]
    v_pk_mul_f32 v[244:245], v[244:245], v[42:43] op_sel_hi:[1,0]
    v_pk_mul_f32 v[246:247], v[246:247], v[42:43] op_sel_hi:[1,0]
    v_cvt_pk_bf16_f32 v32, v240, v241
    v_cvt_pk_bf16_f32 v33, v242, v243
    v_cvt_pk_bf16_f32 v34, v244, v245
    v_cvt_pk_bf16_f32 v35, v246, v247
    buffer_store_dwordx4 v[32:35], v2, s[16:19], s47 offen offset:2048 sc1
    v_mov_b64 v[240:241], 0
    v_mov_b64 v[242:243], 0
    v_mov_b64 v[244:245], 0
    v_mov_b64 v[246:247], 0
    v_pk_mul_f32 v[248:249], v[248:249], v[42:43] op_sel_hi:[1,0]
    v_pk_mul_f32 v[250:251], v[250:251], v[42:43] op_sel_hi:[1,0]
    v_pk_mul_f32 v[252:253], v[252:253], v[42:43] op_sel_hi:[1,0]
    v_pk_mul_f32 v[254:255], v[254:255], v[42:43] op_sel_hi:[1,0]
    v_cvt_pk_bf16_f32 v36, v248, v249
    v_cvt_pk_bf16_f32 v37, v250, v251
    v_cvt_pk_bf16_f32 v38, v252, v253
    v_cvt_pk_bf16_f32 v39, v254, v255
    buffer_store_dwordx4 v[36:39], v2, s[16:19], s47 offen offset:3072 sc1
    v_mov_b64 v[248:249], 0
    v_mov_b64 v[250:251], 0
    v_mov_b64 v[252:253], 0
    v_mov_b64 v[254:255], 0
    s_waitcnt lgkmcnt(0)
    s_barrier
    s_cmp_lg_u32 s35, 0
    s_cbranch_scc1 L_p2
    s_branch L_d2_0
L_d1_1:
    s_waitcnt lgkmcnt(0)
    v_mfma_f32_16x16x32_bf16 v[64:67], a[64:67], a[0:3], v[112:115]
    ds_read_b128 a[124:127], v6 offset:15360
    ds_read_b128 a[120:123], v6 offset:14336
    v_exp_f32 v80, v80
    v_mfma_f32_16x16x32_bf16 v[64:67], a[68:71], a[4:7], v[64:67]
    ds_read_b128 a[116:119], v6 offset:13312
    ds_read_b128 a[112:115], v6 offset:12288
    v_exp_f32 v81, v81
    v_mfma_f32_16x16x32_bf16 v[64:67], a[72:75], a[8:11], v[64:67]
    v_add_f32 v11, v11, v80
    v_add_f32 v11, v11, v81
    v_mfma_f32_16x16x32_bf16 v[64:67], a[76:79], a[12:15], v[64:67]
    v_exp_f32 v82, v82
    v_mfma_f32_16x16x32_bf16 v[68:71], a[92:95], a[12:15], v[112:115]
    v_exp_f32 v83, v83
    v_cvt_pk_bf16_f32 v104, v80, v81
    v_mfma_f32_16x16x32_bf16 v[68:71], a[88:91], a[8:11], v[68:71]
    s_mov_b32 m0, s38
    v_add_f32 v11, v11, v82
    v_mfma_f32_16x16x32_bf16 v[68:71], a[84:87], a[4:7], v[68:71]
    v_add_f32 v11, v11, v83
    v_cvt_pk_bf16_f32 v105, v82, v83
    v_mfma_f32_16x16x32_bf16 v[68:71], a[80:83], a[0:3], v[68:71]
    buffer_load_dwordx4 v2, s[8:11], s36 offen offset:0 sc1 lds
    v_mfma_f32_16x16x32_bf16 v[72:75], a[96:99], a[0:3], v[112:115]
    v_exp_f32 v84, v84
    v_mfma_f32_16x16x32_bf16 v[72:75], a[100:103], a[4:7], v[72:75]
    v_exp_f32 v85, v85
    v_mfma_f32_16x16x32_bf16 v[72:75], a[104:107], a[8:11], v[72:75]
    v_add_f32 v11, v11, v84
    v_add_f32 v11, v11, v85
    v_mfma_f32_16x16x32_bf16 v[72:75], a[108:111], a[12:15], v[72:75]
    v_exp_f32 v86, v86
    s_waitcnt lgkmcnt(0)
    v_mfma_f32_16x16x32_bf16 v[76:79], a[124:127], a[12:15], v[112:115]
    v_exp_f32 v87, v87
    v_mfma_f32_16x16x32_bf16 v[76:79], a[120:123], a[8:11], v[76:79]
    v_cvt_pk_bf16_f32 v106, v84, v85
    v_add_f32 v11, v11, v86
    v_mfma_f32_16x16x32_bf16 v[76:79], a[116:119], a[4:7], v[76:79]
    v_add_f32 v11, v11, v87
    v_cvt_pk_bf16_f32 v107, v86, v87
    v_mfma_f32_16x16x32_bf16 v[76:79], a[112:115], a[0:3], v[76:79]
    v_exp_f32 v88, v88
    v_mfma_f32_16x16x32_bf16 v[192:195], a[128:131], v[96:99], v[192:195]
    buffer_load_dwordx4 v2, s[8:11], s36 offen offset:1024 sc1 lds
    v_mfma_f32_16x16x32_bf16 v[192:195], a[132:135], v[100:103], v[192:195]
    v_exp_f32 v89, v89
    v_mfma_f32_16x16x32_bf16 v[196:199], a[140:143], v[100:103], v[196:199]
    v_add_f32 v11, v11, v88
    v_add_f32 v11, v11, v89
    v_mfma_f32_16x16x32_bf16 v[196:199], a[136:139], v[96:99], v[196:199]
    v_exp_f32 v90, v90
    v_mfma_f32_16x16x32_bf16 v[200:203], a[144:147], v[96:99], v[200:203]
    v_exp_f32 v91, v91
    v_mfma_f32_16x16x32_bf16 v[200:203], a[148:151], v[100:103], v[200:203]
    v_cvt_pk_bf16_f32 v108, v88, v89
    v_add_f32 v11, v11, v90
    v_mfma_f32_16x16x32_bf16 v[204:207], a[156:159], v[100:103], v[204:207]
    v_add_f32 v11, v11, v91
    v_cvt_pk_bf16_f32 v109, v90, v91
    v_mfma_f32_16x16x32_bf16 v[204:207], a[152:155], v[96:99], v[204:207]
    v_exp_f32 v92, v92
    v_mfma_f32_16x16x32_bf16 v[208:211], a[160:163], v[96:99], v[208:211]
    v_exp_f32 v93, v93
    v_mfma_f32_16x16x32_bf16 v[208:211], a[164:167], v[100:103], v[208:211]
    buffer_load_dwordx4 v2, s[8:11], s36 offen offset:2048 sc1 lds
    v_mfma_f32_16x16x32_bf16 v[212:215], a[172:175], v[100:103], v[212:215]
    v_add_f32 v11, v11, v92
    v_add_f32 v11, v11, v93
    v_mfma_f32_16x16x32_bf16 v[212:215], a[168:171], v[96:99], v[212:215]
    v_exp_f32 v94, v94
    v_mfma_f32_16x16x32_bf16 v[216:219], a[176:179], v[96:99], v[216:219]
    v_exp_f32 v95, v95
    v_mfma_f32_16x16x32_bf16 v[216:219], a[180:183], v[100:103], v[216:219]
    v_cvt_pk_bf16_f32 v110, v92, v93
    v_add_f32 v11, v11, v94
    v_mfma_f32_16x16x32_bf16 v[220:223], a[188:191], v[100:103], v[220:223]
    v_add_f32 v11, v11, v95
    v_cvt_pk_bf16_f32 v111, v94, v95
    v_mfma_f32_16x16x32_bf16 v[220:223], a[184:187], v[96:99], v[220:223]
    s_and_b32 s4, s2, 7
    s_mul_i32 s4, s4, 28
    s_lshr_b32 s5, s2, 3
    s_add_u32 s4, s4, s5
    s_sub_u32 s4, s4, 4
    s_cmp_ge_u32 s5, 4
    s_cselect_b32 s4, s4, 0
    s_cselect_b32 s5, 7168, 0
    v_lshrrev_b32 v49, 24, v0
    v_mul_u32_u24 v48, s5, v49
    v_lshl_add_u32 v48, s4, 4, v48
    v_and_b32 v49, 127, v49
    s_lshl_b32 s4, s4, 13
    s_add_u32 s4, s4, 4096
    v_lshl_add_u32 v49, v49, 3, s4
    v_mfma_f32_16x16x32_bf16 v[80:83], a[64:67], a[16:19], v[116:119]
    v_exp_f32 v64, v64
    v_exp_f32 v65, v65
    v_mfma_f32_16x16x32_bf16 v[80:83], a[68:71], a[20:23], v[80:83]
    v_add_f32 v8, v8, v64
    v_add_f32 v8, v8, v65
    v_exp_f32 v66, v66
    v_mfma_f32_16x16x32_bf16 v[80:83], a[72:75], a[24:27], v[80:83]
    s_waitcnt vmcnt(12)
    v_mov_b64 v[44:45], -1
    v_mov_b64 v[46:47], -1
    v_exp_f32 v67, v67
    v_mfma_f32_16x16x32_bf16 v[80:83], a[76:79], a[28:31], v[80:83]
    v_cvt_pk_bf16_f32 v96, v64, v65
    v_add_f32 v8, v8, v66
    v_add_f32 v8, v8, v67
    v_mfma_f32_16x16x32_bf16 v[84:87], a[92:95], a[28:31], v[116:119]
    v_cndmask_b32_e64 v20, v7, v120, s[24:25]
    v_cvt_pk_bf16_f32 v97, v66, v67
    buffer_load_dwordx4 v2, s[8:11], s36 offen offset:3072 sc1 lds
    v_mfma_f32_16x16x32_bf16 v[84:87], a[88:91], a[24:27], v[84:87]
    v_exp_f32 v68, v68
    v_exp_f32 v69, v69
    v_mfma_f32_16x16x32_bf16 v[84:87], a[84:87], a[20:23], v[84:87]
    v_add_f32 v8, v8, v68
    v_add_f32 v8, v8, v69
    v_exp_f32 v70, v70
    v_mfma_f32_16x16x32_bf16 v[84:87], a[80:83], a[16:19], v[84:87]
    v_cndmask_b32_e64 v21, v7, v120, s[26:27]
    v_cndmask_b32_e64 v22, v7, v120, s[28:29]
    v_mfma_f32_16x16x32_bf16 v[88:91], a[96:99], a[16:19], v[116:119]
    v_exp_f32 v71, v71
    v_mfma_f32_16x16x32_bf16 v[88:91], a[100:103], a[20:23], v[88:91]
    v_cvt_pk_bf16_f32 v98, v68, v69
    v_add_f32 v8, v8, v70
    v_mfma_f32_16x16x32_bf16 v[88:91], a[104:107], a[24:27], v[88:91]
    v_add_f32 v8, v8, v71
    v_cvt_pk_bf16_f32 v99, v70, v71
    v_mfma_f32_16x16x32_bf16 v[88:91], a[108:111], a[28:31], v[88:91]
    v_exp_f32 v72, v72
    v_mfma_f32_16x16x32_bf16 v[92:95], a[124:127], a[28:31], v[116:119]
    v_cndmask_b32_e64 v23, v7, v120, s[30:31]
    s_add_u32 m0, s38, 4096
    v_mfma_f32_16x16x32_bf16 v[92:95], a[120:123], a[24:27], v[92:95]
    buffer_load_dwordx4 v3, s[8:11], s36 offen offset:0 sc1 lds
    v_mfma_f32_16x16x32_bf16 v[92:95], a[116:119], a[20:23], v[92:95]
    v_exp_f32 v73, v73
    v_mfma_f32_16x16x32_bf16 v[92:95], a[112:115], a[16:19], v[92:95]
    v_add_f32 v8, v8, v72
    v_add_f32 v8, v8, v73
    v_mfma_f32_16x16x32_bf16 v[224:227], a[128:131], v[104:107], v[224:227]
    v_exp_f32 v74, v74
    v_mfma_f32_16x16x32_bf16 v[224:227], a[132:135], v[108:111], v[224:227]
    ds_read_b128 a[128:131], v6 offset:16384
    ds_read_b128 a[132:135], v6 offset:17408
    v_mfma_f32_16x16x32_bf16 v[228:231], a[140:143], v[108:111], v[228:231]
    v_exp_f32 v75, v75
    v_mfma_f32_16x16x32_bf16 v[228:231], a[136:139], v[104:107], v[228:231]
    ds_read_b128 a[140:143], v6 offset:19456
    ds_read_b128 a[136:139], v6 offset:18432
    v_mfma_f32_16x16x32_bf16 v[232:235], a[144:147], v[104:107], v[232:235]
    ds_read_b128 a[144:147], v6 offset:20480
    v_cvt_pk_bf16_f32 v100, v72, v73
    v_mfma_f32_16x16x32_bf16 v[232:235], a[148:151], v[108:111], v[232:235]
    ds_read_b128 a[148:151], v6 offset:21504
    v_add_f32 v8, v8, v74
    v_mfma_f32_16x16x32_bf16 v[236:239], a[156:159], v[108:111], v[236:239]
    buffer_load_dwordx4 v3, s[8:11], s36 offen offset:1024 sc1 lds
    v_mfma_f32_16x16x32_bf16 v[236:239], a[152:155], v[104:107], v[236:239]
    ds_read_b128 a[156:159], v6 offset:23552
    ds_read_b128 a[152:155], v6 offset:22528
    v_mfma_f32_16x16x32_bf16 v[240:243], a[160:163], v[104:107], v[240:243]
    v_add_f32 v8, v8, v75
    v_cvt_pk_bf16_f32 v101, v74, v75
    v_mfma_f32_16x16x32_bf16 v[240:243], a[164:167], v[108:111], v[240:243]
    v_exp_f32 v76, v76
    v_mfma_f32_16x16x32_bf16 v[244:247], a[172:175], v[108:111], v[244:247]
    v_exp_f32 v77, v77
    v_mfma_f32_16x16x32_bf16 v[244:247], a[168:171], v[104:107], v[244:247]
    v_add_f32 v8, v8, v76
    v_add_f32 v8, v8, v77
    v_mfma_f32_16x16x32_bf16 v[248:251], a[176:179], v[104:107], v[248:251]
    v_exp_f32 v78, v78
    v_mfma_f32_16x16x32_bf16 v[248:251], a[180:183], v[108:111], v[248:251]
    v_exp_f32 v79, v79
    v_mfma_f32_16x16x32_bf16 v[252:255], a[188:191], v[108:111], v[252:255]
    v_cvt_pk_bf16_f32 v102, v76, v77
    v_add_f32 v8, v8, v78
    v_mfma_f32_16x16x32_bf16 v[252:255], a[184:187], v[104:107], v[252:255]
    v_add_f32 v8, v8, v79
    v_cvt_pk_bf16_f32 v103, v78, v79
    v_mfma_f32_16x16x32_bf16 v[64:67], a[64:67], a[32:35], v[120:123]
    v_exp_f32 v80, v80
    v_exp_f32 v81, v81
    v_mfma_f32_16x16x32_bf16 v[64:67], a[68:71], a[36:39], v[64:67]
    v_add_f32 v9, v9, v80
    v_add_f32 v9, v9, v81
    v_exp_f32 v82, v82
    v_mfma_f32_16x16x32_bf16 v[64:67], a[72:75], a[40:43], v[64:67]
    ds_read_b128 a[160:163], v6 offset:24576
    ds_read_b128 a[164:167], v6 offset:25600
    v_exp_f32 v83, v83
    v_mfma_f32_16x16x32_bf16 v[64:67], a[76:79], a[44:47], v[64:67]
    v_cvt_pk_bf16_f32 v104, v80, v81
    v_add_f32 v9, v9, v82
    buffer_load_dwordx4 v3, s[8:11], s36 offen offset:2048 sc1 lds
    v_mfma_f32_16x16x32_bf16 v[68:71], a[92:95], a[44:47], v[20:23]
    v_add_f32 v9, v9, v83
    v_cvt_pk_bf16_f32 v105, v82, v83
    v_exp_f32 v84, v84
    v_mfma_f32_16x16x32_bf16 v[68:71], a[88:91], a[40:43], v[68:71]
    ds_read_b128 a[172:175], v6 offset:27648
    ds_read_b128 a[168:171], v6 offset:26624
    v_exp_f32 v85, v85
    v_mfma_f32_16x16x32_bf16 v[68:71], a[84:87], a[36:39], v[68:71]
    v_add_f32 v9, v9, v84
    v_add_f32 v9, v9, v85
    v_exp_f32 v86, v86
    v_mfma_f32_16x16x32_bf16 v[68:71], a[80:83], a[32:35], v[68:71]
    ds_read_b128 a[176:179], v6 offset:28672
    ds_read_b128 a[180:183], v6 offset:29696
    v_exp_f32 v87, v87
    s_waitcnt lgkmcnt(4)
    v_mfma_f32_16x16x32_bf16 v[128:131], a[128:131], v[96:99], v[128:131]
    ds_read_b128 a[188:191], v6 offset:31744
    buffer_load_dwordx4 v3, s[8:11], s36 offen offset:3072 sc1 lds
    s_add_u32 s36, s36, s53
    v_mfma_f32_16x16x32_bf16 v[128:131], a[132:135], v[100:103], v[128:131]
    ds_read_b128 a[184:187], v6 offset:30720
    v_cvt_pk_bf16_f32 v106, v84, v85
    v_add_f32 v9, v9, v86
    v_mfma_f32_16x16x32_bf16 v[132:135], a[140:143], v[100:103], v[132:135]
    v_add_f32 v9, v9, v87
    v_cvt_pk_bf16_f32 v107, v86, v87
    v_exp_f32 v88, v88
    v_mfma_f32_16x16x32_bf16 v[132:135], a[136:139], v[96:99], v[132:135]
    v_exp_f32 v89, v89
    v_add_f32 v9, v9, v88
    v_mfma_f32_16x16x32_bf16 v[136:139], a[144:147], v[96:99], v[136:139]
    global_load_dwordx4 a[224:227], v48, s[56:57] offset:0
    v_mfma_f32_16x16x32_bf16 v[136:139], a[148:151], v[100:103], v[136:139]
    v_add_f32 v9, v9, v89
    v_exp_f32 v90, v90
    v_mfma_f32_16x16x32_bf16 v[140:143], a[156:159], v[100:103], v[140:143]
    v_exp_f32 v91, v91
    v_mfma_f32_16x16x32_bf16 v[140:143], a[152:155], v[96:99], v[140:143]
    v_cvt_pk_bf16_f32 v108, v88, v89
    v_add_f32 v9, v9, v90
    v_mfma_f32_16x16x32_bf16 v[144:147], a[160:163], v[96:99], v[144:147]
    v_add_f32 v9, v9, v91
    v_cvt_pk_bf16_f32 v109, v90, v91
    v_mfma_f32_16x16x32_bf16 v[144:147], a[164:167], v[100:103], v[144:147]
    v_exp_f32 v92, v92
    s_waitcnt lgkmcnt(0)
    v_mfma_f32_16x16x32_bf16 v[148:151], a[172:175], v[100:103], v[148:151]
    v_exp_f32 v93, v93
    v_mfma_f32_16x16x32_bf16 v[148:151], a[168:171], v[96:99], v[148:151]
    v_add_f32 v9, v9, v92
    v_add_f32 v9, v9, v93
    v_mfma_f32_16x16x32_bf16 v[152:155], a[176:179], v[96:99], v[152:155]
    v_exp_f32 v94, v94
    v_mfma_f32_16x16x32_bf16 v[152:155], a[180:183], v[100:103], v[152:155]
    v_exp_f32 v95, v95
    v_mfma_f32_16x16x32_bf16 v[156:159], a[188:191], v[100:103], v[156:159]
    v_cvt_pk_bf16_f32 v110, v92, v93
    v_add_f32 v9, v9, v94
    v_mfma_f32_16x16x32_bf16 v[156:159], a[184:187], v[96:99], v[156:159]
    v_add_f32 v9, v9, v95
    v_cvt_pk_bf16_f32 v111, v94, v95
    s_waitcnt vmcnt(19)
    s_barrier
    v_mfma_f32_16x16x32_bf16 v[80:83], a[64:67], a[48:51], v[124:127]
    v_exp_f32 v64, v64
    v_exp_f32 v65, v65
    v_mfma_f32_16x16x32_bf16 v[80:83], a[68:71], a[52:55], v[80:83]
    v_add_f32 v10, v10, v64
    v_add_f32 v10, v10, v65
    v_exp_f32 v66, v66
    v_mfma_f32_16x16x32_bf16 v[80:83], a[72:75], a[56:59], v[80:83]
    ds_read_b128 a[64:67], v6 offset:32768
    global_load_dwordx2 a[240:241], v49, s[60:61] offset:-4096
    v_mfma_f32_16x16x32_bf16 v[80:83], a[76:79], a[60:63], v[80:83]
    ds_read_b128 a[68:71], v6 offset:33792
    ds_read_b128 a[72:75], v6 offset:34816
    v_exp_f32 v67, v67
    v_mfma_f32_16x16x32_bf16 v[84:87], a[92:95], a[60:63], v[124:127]
    ds_read_b128 a[32:35], v18 offset:0
    global_load_dwordx2 a[242:243], v49, s[60:61] offset:-3072
    v_mfma_f32_16x16x32_bf16 v[84:87], a[88:91], a[56:59], v[84:87]
    ds_read_b128 a[36:39], v18 offset:1024
    v_cvt_pk_bf16_f32 v96, v64, v65
    v_add_f32 v10, v10, v66
    v_mfma_f32_16x16x32_bf16 v[84:87], a[84:87], a[52:55], v[84:87]
    v_add_f32 v10, v10, v67
    v_cvt_pk_bf16_f32 v97, v66, v67
    v_exp_f32 v68, v68
    v_mfma_f32_16x16x32_bf16 v[84:87], a[80:83], a[48:51], v[84:87]
    ds_read_b128 a[40:43], v18 offset:2048
    global_load_dwordx2 a[244:245], v49, s[60:61] offset:-2048
    v_mfma_f32_16x16x32_bf16 v[88:91], a[96:99], a[48:51], v[124:127]
    ds_read_b128 a[44:47], v18 offset:3072
    v_mov_b32 v120, v12
    v_mfma_f32_16x16x32_bf16 v[88:91], a[100:103], a[52:55], v[88:91]
    global_load_dwordx2 a[246:247], v49, s[60:61] offset:-1024
    v_mfma_f32_16x16x32_bf16 v[88:91], a[104:107], a[56:59], v[88:91]
    v_mov_b32 v121, v12
    v_mov_b32 v122, v12
    v_mfma_f32_16x16x32_bf16 v[88:91], a[108:111], a[60:63], v[88:91]
    v_mov_b32 v123, v12
    v_cndmask_b32_e64 v20, v7, v124, s[24:25]
    v_mfma_f32_16x16x32_bf16 v[92:95], a[124:127], a[60:63], v[124:127]
    v_cndmask_b32_e64 v21, v7, v124, s[26:27]
    v_cndmask_b32_e64 v22, v7, v124, s[28:29]
    v_mfma_f32_16x16x32_bf16 v[92:95], a[120:123], a[56:59], v[92:95]
    v_cndmask_b32_e64 v23, v7, v124, s[30:31]
    ds_read_b128 a[76:79], v6 offset:35840
    v_mfma_f32_16x16x32_bf16 v[92:95], a[116:119], a[52:55], v[92:95]
    ds_read_b128 a[92:95], v6 offset:39936
    ds_read_b128 a[88:91], v6 offset:38912
    v_mfma_f32_16x16x32_bf16 v[92:95], a[112:115], a[48:51], v[92:95]
    global_load_dwordx2 a[248:249], v49, s[60:61] offset:0
    v_mfma_f32_16x16x32_bf16 v[160:163], a[128:131], v[104:107], v[160:163]
    ds_read_b128 a[84:87], v6 offset:37888
    ds_read_b128 a[80:83], v6 offset:36864
    v_mfma_f32_16x16x32_bf16 v[160:163], a[132:135], v[108:111], v[160:163]
    global_load_dwordx2 a[250:251], v49, s[60:61] offset:1024
    v_mfma_f32_16x16x32_bf16 v[164:167], a[140:143], v[108:111], v[164:167]
    ds_read_b128 a[96:99], v6 offset:40960
    ds_read_b128 a[100:103], v6 offset:41984
    v_mfma_f32_16x16x32_bf16 v[164:167], a[136:139], v[104:107], v[164:167]
    ds_read_b128 a[104:107], v6 offset:43008
    ds_read_b128 a[108:111], v6 offset:44032
    v_mfma_f32_16x16x32_bf16 v[168:171], a[144:147], v[104:107], v[168:171]
    global_load_dwordx2 a[252:253], v49, s[60:61] offset:2048
    v_mfma_f32_16x16x32_bf16 v[168:171], a[148:151], v[108:111], v[168:171]
    v_exp_f32 v69, v69
    v_mfma_f32_16x16x32_bf16 v[172:175], a[156:159], v[108:111], v[172:175]
    global_load_dwordx2 a[254:255], v49, s[60:61] offset:3072
    v_mfma_f32_16x16x32_bf16 v[172:175], a[152:155], v[104:107], v[172:175]
    v_add_f32 v10, v10, v68
    v_add_f32 v10, v10, v69
    v_mfma_f32_16x16x32_bf16 v[176:179], a[160:163], v[104:107], v[176:179]
    v_exp_f32 v70, v70
    v_mfma_f32_16x16x32_bf16 v[176:179], a[164:167], v[108:111], v[176:179]
    v_exp_f32 v71, v71
    v_mfma_f32_16x16x32_bf16 v[180:183], a[172:175], v[108:111], v[180:183]
    v_cvt_pk_bf16_f32 v98, v68, v69
    v_add_f32 v10, v10, v70
    v_mfma_f32_16x16x32_bf16 v[180:183], a[168:171], v[104:107], v[180:183]
    v_add_f32 v10, v10, v71
    v_cvt_pk_bf16_f32 v99, v70, v71
    v_mfma_f32_16x16x32_bf16 v[184:187], a[176:179], v[104:107], v[184:187]
    global_load_dwordx4 a[228:231], v48, s[56:57] offset:3584
    v_mfma_f32_16x16x32_bf16 v[184:187], a[180:183], v[108:111], v[184:187]
    v_mfma_f32_16x16x32_bf16 v[188:191], a[188:191], v[108:111], v[188:191]
    v_mfma_f32_16x16x32_bf16 v[188:191], a[184:187], v[104:107], v[188:191]
    s_waitcnt lgkmcnt(0)
    v_mfma_f32_16x16x32_bf16 v[64:67], a[64:67], a[48:51], v[124:127]
    ds_read_b128 a[124:127], v6 offset:48128
    ds_read_b128 a[120:123], v6 offset:47104
    v_exp_f32 v80, v80
    v_mfma_f32_16x16x32_bf16 v[64:67], a[68:71], a[52:55], v[64:67]
    ds_read_b128 a[116:119], v6 offset:46080
    ds_read_b128 a[112:115], v6 offset:45056
    v_exp_f32 v81, v81
    v_mfma_f32_16x16x32_bf16 v[64:67], a[72:75], a[56:59], v[64:67]
    v_mov_b32 v41, v10
    s_mov_b32 s3, s55
    buffer_store_dwordx4 v[44:47], v63, s[16:19], s3 offen sc1
    v_mfma_f32_16x16x32_bf16 v[64:67], a[76:79], a[60:63], v[64:67]
    v_add_f32 v11, v11, v80
    v_add_f32 v11, v11, v81
    v_exp_f32 v82, v82
    v_mfma_f32_16x16x32_bf16 v[68:71], a[92:95], a[60:63], v[124:127]
    s_nop 1
    v_permlane16_swap_b32 v10, v41
    v_exp_f32 v83, v83
    v_mfma_f32_16x16x32_bf16 v[68:71], a[88:91], a[56:59], v[68:71]
    v_add_f32 v10, v10, v41
    s_xor_b32 s3, s55, 0x10000
    buffer_store_dwordx4 v[44:47], v63, s[16:19], s3 offen sc1
    v_mfma_f32_16x16x32_bf16 v[68:71], a[84:87], a[52:55], v[68:71]
    v_mov_b32 v41, v10
    v_cvt_pk_bf16_f32 v104, v80, v81
    v_add_f32 v11, v11, v82
    v_mfma_f32_16x16x32_bf16 v[68:71], a[80:83], a[48:51], v[68:71]
    v_add_f32 v11, v11, v83
    v_cvt_pk_bf16_f32 v105, v82, v83
    v_exp_f32 v84, v84
    v_mfma_f32_16x16x32_bf16 v[72:75], a[96:99], a[48:51], v[20:23]
    s_nop 1
    s_xor_b32 s3, s55, 0x20000
    buffer_store_dwordx4 v[44:47], v63, s[16:19], s3 offen sc1
    v_mfma_f32_16x16x32_bf16 v[72:75], a[100:103], a[52:55], v[72:75]
    v_permlane32_swap_b32 v10, v41
    v_add_f32 v10, v10, v41
    v_exp_f32 v85, v85
    v_mfma_f32_16x16x32_bf16 v[72:75], a[104:107], a[56:59], v[72:75]
    v_add_f32 v11, v11, v84
    v_add_f32 v11, v11, v85
    v_rcp_f32 v40, v10
    v_mfma_f32_16x16x32_bf16 v[72:75], a[108:111], a[60:63], v[72:75]
    v_cmp_nge_f32 vcc, 0x5f800000, v10
    s_xor_b32 s3, s55, 0x30000
    buffer_store_dwordx4 v[44:47], v63, s[16:19], s3 offen sc1
    v_mfma_f32_16x16x32_bf16 v[192:195], a[128:131], v[96:99], v[192:195]
    v_exp_f32 v86, v86
    v_exp_f32 v87, v87
    v_mfma_f32_16x16x32_bf16 v[196:199], a[136:139], v[96:99], v[196:199]
    s_or_b64 s[50:51], s[50:51], vcc
    v_cvt_pk_bf16_f32 v106, v84, v85
    v_add_f32 v11, v11, v86
    v_mfma_f32_16x16x32_bf16 v[200:203], a[144:147], v[96:99], v[200:203]
    v_add_f32 v11, v11, v87
    v_cvt_pk_bf16_f32 v107, v86, v87
    v_exp_f32 v88, v88
    v_mfma_f32_16x16x32_bf16 v[204:207], a[152:155], v[96:99], v[204:207]
    v_exp_f32 v89, v89
    v_add_f32 v11, v11, v88
    v_mfma_f32_16x16x32_bf16 v[208:211], a[160:163], v[96:99], v[208:211]
    global_load_dwordx4 a[232:235], v48, s[58:59] offset:0
    v_mfma_f32_16x16x32_bf16 v[212:215], a[168:171], v[96:99], v[212:215]
    v_add_f32 v11, v11, v89
    v_exp_f32 v90, v90
    v_mfma_f32_16x16x32_bf16 v[216:219], a[176:179], v[96:99], v[216:219]
    v_exp_f32 v91, v91
    v_cvt_pk_bf16_f32 v108, v88, v89
    v_mfma_f32_16x16x32_bf16 v[220:223], a[184:187], v[96:99], v[220:223]
    v_add_f32 v11, v11, v90
    v_add_f32 v11, v11, v91
    v_cvt_pk_bf16_f32 v109, v90, v91
    v_exp_f32 v92, v92
    v_exp_f32 v93, v93
    v_add_f32 v11, v11, v92
    v_add_f32 v11, v11, v93
    v_exp_f32 v94, v94
    v_exp_f32 v95, v95
    v_cvt_pk_bf16_f32 v110, v92, v93
    v_add_f32 v11, v11, v94
    v_add_f32 v11, v11, v95
    v_cvt_pk_bf16_f32 v111, v94, v95
    v_mfma_f32_16x16x32_bf16 v[80:83], a[64:67], a[0:3], v[112:115]
    v_exp_f32 v64, v64
    v_exp_f32 v65, v65
    v_mfma_f32_16x16x32_bf16 v[80:83], a[68:71], a[4:7], v[80:83]
    v_add_f32 v11, v11, v64
    v_add_f32 v11, v11, v65
    v_exp_f32 v66, v66
    v_mfma_f32_16x16x32_bf16 v[80:83], a[72:75], a[8:11], v[80:83]
    ds_read_b128 a[48:51], v18 offset:4096
    s_xor_b32 s3, s55, 0x780000
    buffer_store_dwordx4 v[44:47], v63, s[16:19], s3 offen sc1
    v_mfma_f32_16x16x32_bf16 v[80:83], a[76:79], a[12:15], v[80:83]
    ds_read_b128 a[52:55], v18 offset:5120
    ds_read_b128 a[56:59], v18 offset:6144
    v_exp_f32 v67, v67
    v_mfma_f32_16x16x32_bf16 v[84:87], a[92:95], a[12:15], v[112:115]
    ds_read_b128 a[60:63], v18 offset:7168
    v_cvt_pk_bf16_f32 v96, v64, v65
    v_add_f32 v11, v11, v66
    v_mfma_f32_16x16x32_bf16 v[84:87], a[88:91], a[8:11], v[84:87]
    v_add_f32 v11, v11, v67
    v_cvt_pk_bf16_f32 v97, v66, v67
    v_exp_f32 v68, v68
    v_mfma_f32_16x16x32_bf16 v[84:87], a[84:87], a[4:7], v[84:87]
    v_mul_f32 v192, v192, v40
    s_xor_b32 s3, s55, 0x790000
    buffer_store_dwordx4 v[44:47], v63, s[16:19], s3 offen sc1
    v_mfma_f32_16x16x32_bf16 v[84:87], a[80:83], a[0:3], v[84:87]
    v_mul_f32 v193, v193, v40
    v_mul_f32 v194, v194, v40
    v_exp_f32 v69, v69
    v_mfma_f32_16x16x32_bf16 v[88:91], a[96:99], a[0:3], v[112:115]
    v_add_f32 v11, v11, v68
    v_add_f32 v11, v11, v69
    v_exp_f32 v70, v70
    v_mfma_f32_16x16x32_bf16 v[88:91], a[100:103], a[4:7], v[88:91]
    v_mul_f32 v195, v195, v40
    v_mul_f32 v196, v196, v40
    v_exp_f32 v71, v71
    v_mfma_f32_16x16x32_bf16 v[88:91], a[104:107], a[8:11], v[88:91]
    v_mul_f32 v197, v197, v40
    v_mul_f32 v198, v198, v40
    v_cvt_pk_bf16_f32 v98, v68, v69
    v_mfma_f32_16x16x32_bf16 v[88:91], a[108:111], a[12:15], v[88:91]
    v_add_f32 v11, v11, v70
    s_xor_b32 s3, s55, 0x7a0000
    buffer_store_dwordx4 v[44:47], v63, s[16:19], s3 offen sc1
    s_waitcnt lgkmcnt(0)
    v_mfma_f32_16x16x32_bf16 v[92:95], a[124:127], a[12:15], v[112:115]
    v_add_f32 v11, v11, v71
    v_cvt_pk_bf16_f32 v99, v70, v71
    v_exp_f32 v72, v72
    v_mfma_f32_16x16x32_bf16 v[92:95], a[120:123], a[8:11], v[92:95]
    v_mul_f32 v199, v199, v40
    v_cvt_pk_bf16_f32 v32, v192, v193
    v_exp_f32 v73, v73
    v_mfma_f32_16x16x32_bf16 v[92:95], a[116:119], a[4:7], v[92:95]
    v_add_f32 v11, v11, v72
    v_add_f32 v11, v11, v73
    v_exp_f32 v74, v74
    v_mfma_f32_16x16x32_bf16 v[92:95], a[112:115], a[0:3], v[92:95]
    v_cvt_pk_bf16_f32 v33, v194, v195
    s_xor_b32 s3, s55, 0x7b0000
    buffer_store_dwordx4 v[44:47], v63, s[16:19], s3 offen sc1
    v_mfma_f32_16x16x32_bf16 v[224:227], a[128:131], v[104:107], v[224:227]
    v_cvt_pk_bf16_f32 v34, v196, v197
    v_cvt_pk_bf16_f32 v35, v198, v199
    v_exp_f32 v75, v75
    v_mfma_f32_16x16x32_bf16 v[224:227], a[132:135], v[108:111], v[224:227]
    buffer_store_dwordx4 v[32:35], v2, s[16:19], s46 offen offset:0 sc1
    v_mov_b64 v[192:193], 0
    v_mov_b64 v[194:195], 0
    v_mfma_f32_16x16x32_bf16 v[228:231], a[140:143], v[108:111], v[228:231]
    v_mov_b64 v[196:197], 0
    v_mov_b64 v[198:199], 0
    v_mul_f32 v200, v200, v40
    v_mfma_f32_16x16x32_bf16 v[228:231], a[136:139], v[104:107], v[228:231]
    v_mul_f32 v201, v201, v40
    v_mul_f32 v202, v202, v40
    ds_read_b128 a[128:131], v6 offset:49152
    v_mfma_f32_16x16x32_bf16 v[232:235], a[144:147], v[104:107], v[232:235]
    v_mul_f32 v203, v203, v40
    v_mul_f32 v204, v204, v40
    ds_read_b128 a[132:135], v6 offset:50176
    v_mfma_f32_16x16x32_bf16 v[232:235], a[148:151], v[108:111], v[232:235]
    v_mul_f32 v205, v205, v40
    ds_read_b128 a[140:143], v6 offset:52224
    ds_read_b128 a[136:139], v6 offset:51200
    v_mfma_f32_16x16x32_bf16 v[236:239], a[156:159], v[108:111], v[236:239]
    global_load_dwordx4 a[236:239], v48, s[58:59] offset:3584
    v_mfma_f32_16x16x32_bf16 v[236:239], a[152:155], v[104:107], v[236:239]
    v_mul_f32 v206, v206, v40
    v_mul_f32 v207, v207, v40
    ds_read_b128 a[144:147], v6 offset:53248
    v_mfma_f32_16x16x32_bf16 v[240:243], a[160:163], v[104:107], v[240:243]
    v_cvt_pk_bf16_f32 v36, v200, v201
    v_cvt_pk_bf16_f32 v37, v202, v203
    ds_read_b128 a[148:151], v6 offset:54272
    v_mfma_f32_16x16x32_bf16 v[240:243], a[164:167], v[108:111], v[240:243]
    v_cvt_pk_bf16_f32 v38, v204, v205
    v_mov_b32 v124, v13
    ds_read_b128 a[156:159], v6 offset:56320
    v_mfma_f32_16x16x32_bf16 v[244:247], a[172:175], v[108:111], v[244:247]
    v_mov_b32 v125, v13
    v_mov_b32 v126, v13
    ds_read_b128 a[152:155], v6 offset:55296
    v_mfma_f32_16x16x32_bf16 v[244:247], a[168:171], v[104:107], v[244:247]
    v_mov_b32 v127, v13
    v_cvt_pk_bf16_f32 v100, v72, v73
    v_add_f32 v11, v11, v74
    v_mfma_f32_16x16x32_bf16 v[248:251], a[176:179], v[104:107], v[248:251]
    v_add_f32 v11, v11, v75
    v_cvt_pk_bf16_f32 v101, v74, v75
    v_mov_b64 v[102:103], 0
    v_mfma_f32_16x16x32_bf16 v[248:251], a[180:183], v[108:111], v[248:251]
    v_cvt_pk_bf16_f32 v39, v206, v207
    buffer_store_dwordx4 v[36:39], v2, s[16:19], s46 offen offset:1024 sc1
    v_mfma_f32_16x16x32_bf16 v[252:255], a[188:191], v[108:111], v[252:255]
    v_mov_b64 v[200:201], 0
    v_mov_b64 v[202:203], 0
    v_mfma_f32_16x16x32_bf16 v[252:255], a[184:187], v[104:107], v[252:255]
    v_mov_b64 v[204:205], 0
    v_mov_b64 v[206:207], 0
    s_waitcnt vmcnt(22)
    s_barrier
    v_xor_b32 v19, s39, v6
    v_mfma_f32_16x16x32_bf16 v[64:67], a[64:67], a[16:19], v[116:119]
    v_mul_f32 v208, v208, v40
    v_mul_f32 v209, v209, v40
    buffer_store_dwordx2 v[50:51], v52, s[20:23], s78 offen sc1
    v_mfma_f32_16x16x32_bf16 v[64:67], a[68:71], a[20:23], v[64:67]
    v_mul_f32 v210, v210, v40
    v_mul_f32 v211, v211, v40
    v_exp_f32 v80, v80
    v_mfma_f32_16x16x32_bf16 v[64:67], a[72:75], a[24:27], v[64:67]
    v_cndmask_b32_e64 v20, v7, v112, s[24:25]
    v_cndmask_b32_e64 v21, v7, v112, s[26:27]
    v_exp_f32 v81, v81
    v_mfma_f32_16x16x32_bf16 v[64:67], a[76:79], a[28:31], v[64:67]
    v_cndmask_b32_e64 v22, v7, v112, s[28:29]
    s_mov_b32 m0, s37
    s_nop 0
    buffer_load_dwordx4 v2, s[8:11], s36 offen offset:0 sc1 lds
    v_mfma_f32_16x16x32_bf16 v[68:71], a[92:95], a[28:31], v[116:119]
    v_cndmask_b32_e64 v23, v7, v112, s[30:31]
    v_mov_b32 v43, v11
    buffer_load_dwordx4 v2, s[8:11], s36 offen offset:1024 sc1 lds
    v_mfma_f32_16x16x32_bf16 v[68:71], a[88:91], a[24:27], v[68:71]
    v_add_f32 v8, v8, v80
    v_add_f32 v8, v8, v81
    v_exp_f32 v82, v82
    v_mfma_f32_16x16x32_bf16 v[68:71], a[84:87], a[20:23], v[68:71]
    s_nop 1
    v_permlane16_swap_b32 v11, v43
    buffer_load_dwordx4 v2, s[8:11], s36 offen offset:2048 sc1 lds
    v_mfma_f32_16x16x32_bf16 v[68:71], a[80:83], a[16:19], v[68:71]
    v_add_f32 v11, v11, v43
    v_mov_b32 v43, v11
    v_exp_f32 v83, v83
    v_mfma_f32_16x16x32_bf16 v[72:75], a[96:99], a[16:19], v[116:119]
    v_cvt_pk_bf16_f32 v104, v80, v81
    v_add_f32 v8, v8, v82
    buffer_load_dwordx4 v2, s[8:11], s36 offen offset:3072 sc1 lds
    v_mfma_f32_16x16x32_bf16 v[72:75], a[100:103], a[20:23], v[72:75]
    v_add_f32 v8, v8, v83
    v_cvt_pk_bf16_f32 v105, v82, v83
    v_exp_f32 v84, v84
    v_mfma_f32_16x16x32_bf16 v[72:75], a[104:107], a[24:27], v[72:75]
    ds_read_b128 a[160:163], v6 offset:57344
    ds_read_b128 a[164:167], v6 offset:58368
    v_exp_f32 v85, v85
    v_mfma_f32_16x16x32_bf16 v[72:75], a[108:111], a[28:31], v[72:75]
    v_add_f32 v8, v8, v84
    v_add_f32 v8, v8, v85
    v_exp_f32 v86, v86
    v_mfma_f32_16x16x32_bf16 v[76:79], a[124:127], a[28:31], v[116:119]
    s_add_u32 m0, s37, 4096
    ds_read_b128 a[172:175], v6 offset:60416
    buffer_load_dwordx4 v3, s[8:11], s36 offen offset:0 sc1 lds
    v_mfma_f32_16x16x32_bf16 v[76:79], a[120:123], a[24:27], v[76:79]
    ds_read_b128 a[168:171], v6 offset:59392
    ds_read_b128 a[176:179], v6 offset:61440
    buffer_load_dwordx4 v3, s[8:11], s36 offen offset:1024 sc1 lds
    v_mfma_f32_16x16x32_bf16 v[76:79], a[116:119], a[20:23], v[76:79]
    ds_read_b128 a[180:183], v6 offset:62464
    ds_read_b128 a[188:191], v6 offset:64512
    v_exp_f32 v87, v87
    v_mfma_f32_16x16x32_bf16 v[76:79], a[112:115], a[16:19], v[76:79]
    v_cvt_pk_bf16_f32 v106, v84, v85
    v_add_f32 v8, v8, v86
    buffer_load_dwordx4 v3, s[8:11], s36 offen offset:2048 sc1 lds
    s_waitcnt lgkmcnt(5)
    v_mfma_f32_16x16x32_bf16 v[224:227], a[128:131], v[96:99], v[224:227]
    v_add_f32 v8, v8, v87
    v_cvt_pk_bf16_f32 v107, v86, v87
    v_exp_f32 v88, v88
    v_mfma_f32_16x16x32_bf16 v[224:227], a[132:135], v[100:103], v[224:227]
    ds_read_b128 a[184:187], v6 offset:63488
    ds_read_b128 a[64:67], v19 offset:0
    buffer_load_dwordx4 v3, s[8:11], s36 offen offset:3072 sc1 lds
    v_mfma_f32_16x16x32_bf16 v[228:231], a[140:143], v[100:103], v[228:231]
    ds_read_b128 a[68:71], v19 offset:1024
    ds_read_b128 a[72:75], v19 offset:2048
    v_exp_f32 v89, v89
    v_mfma_f32_16x16x32_bf16 v[228:231], a[136:139], v[96:99], v[228:231]
    v_add_f32 v8, v8, v88
    v_add_f32 v8, v8, v89
    v_exp_f32 v90, v90
    v_mfma_f32_16x16x32_bf16 v[232:235], a[144:147], v[96:99], v[232:235]
    ds_read_b128 a[76:79], v19 offset:3072
    ds_read_b128 a[92:95], v19 offset:7168
    v_exp_f32 v91, v91
    v_mfma_f32_16x16x32_bf16 v[232:235], a[148:151], v[100:103], v[232:235]
    ds_read_b128 a[88:91], v19 offset:6144
    v_cvt_pk_bf16_f32 v108, v88, v89
    v_add_f32 v8, v8, v90
    v_mfma_f32_16x16x32_bf16 v[236:239], a[156:159], v[100:103], v[236:239]
    v_add_f32 v8, v8, v91
    v_cvt_pk_bf16_f32 v109, v90, v91
    v_exp_f32 v92, v92
    v_mfma_f32_16x16x32_bf16 v[236:239], a[152:155], v[96:99], v[236:239]
    ds_read_b128 a[84:87], v19 offset:5120
    ds_read_b128 a[80:83], v19 offset:4096
    v_exp_f32 v93, v93
    v_mfma_f32_16x16x32_bf16 v[240:243], a[160:163], v[96:99], v[240:243]
    v_add_f32 v8, v8, v92
    v_add_f32 v8, v8, v93
    v_exp_f32 v94, v94
    v_mfma_f32_16x16x32_bf16 v[240:243], a[164:167], v[100:103], v[240:243]
    s_nop 1
    ds_read_b128 a[96:99], v19 offset:8192
    v_exp_f32 v95, v95
    s_waitcnt lgkmcnt(4)
    v_mfma_f32_16x16x32_bf16 v[244:247], a[172:175], v[100:103], v[244:247]
    v_permlane32_swap_b32 v11, v43
    v_add_f32 v11, v11, v43
    ds_read_b128 a[100:103], v19 offset:9216
    v_mfma_f32_16x16x32_bf16 v[244:247], a[168:171], v[96:99], v[244:247]
    ds_read_b128 a[104:107], v19 offset:10240
    ds_read_b128 a[108:111], v19 offset:11264
    v_rcp_f32 v42, v11
    v_mfma_f32_16x16x32_bf16 v[248:251], a[176:179], v[96:99], v[248:251]
    v_cmp_nge_f32 vcc, 0x5f800000, v11
    s_or_b64 s[50:51], s[50:51], vcc
    v_cvt_pk_bf16_f32 v110, v92, v93
    v_mfma_f32_16x16x32_bf16 v[248:251], a[180:183], v[100:103], v[248:251]
    v_add_f32 v8, v8, v94
    v_add_f32 v8, v8, v95
    v_cvt_pk_bf16_f32 v111, v94, v95
    v_mfma_f32_16x16x32_bf16 v[252:255], a[188:191], v[100:103], v[252:255]
    v_mul_f32 v212, v212, v40
    v_mul_f32 v213, v213, v40
    v_mul_f32 v214, v214, v40
    v_mfma_f32_16x16x32_bf16 v[252:255], a[184:187], v[96:99], v[252:255]
    v_mul_f32 v215, v215, v40
    v_cvt_pk_bf16_f32 v32, v208, v209
    v_cvt_pk_bf16_f32 v33, v210, v211
    v_cvt_pk_bf16_f32 v34, v212, v213
    v_cvt_pk_bf16_f32 v35, v214, v215
    buffer_store_dwordx4 v[32:35], v2, s[16:19], s46 offen offset:2048 sc1
    v_mov_b64 v[208:209], 0
    v_mov_b64 v[210:211], 0
    v_mov_b64 v[212:213], 0
    v_mov_b64 v[214:215], 0
    v_mul_f32 v216, v216, v40
    v_mul_f32 v217, v217, v40
    v_mul_f32 v218, v218, v40
    v_mul_f32 v219, v219, v40
    v_mul_f32 v220, v220, v40
    v_mul_f32 v221, v221, v40
    v_mul_f32 v222, v222, v40
    v_mul_f32 v223, v223, v40
    v_cvt_pk_bf16_f32 v36, v216, v217
    v_cvt_pk_bf16_f32 v37, v218, v219
    v_cvt_pk_bf16_f32 v38, v220, v221
    v_cvt_pk_bf16_f32 v39, v222, v223
    buffer_store_dwordx4 v[36:39], v2, s[16:19], s46 offen offset:3072 sc1
    v_mov_b64 v[216:217], 0
    v_mov_b64 v[218:219], 0
    v_mov_b64 v[220:221], 0
    v_mov_b64 v[222:223], 0
    v_mov_b32 v6, v19
    v_mov_b64 v[10:11], 0
    s_mov_b32 s35, s52
    s_nop 3
    v_pk_mul_f32 v[224:225], v[224:225], v[42:43] op_sel_hi:[1,0]
    v_pk_mul_f32 v[226:227], v[226:227], v[42:43] op_sel_hi:[1,0]
    v_pk_mul_f32 v[228:229], v[228:229], v[42:43] op_sel_hi:[1,0]
    v_pk_mul_f32 v[230:231], v[230:231], v[42:43] op_sel_hi:[1,0]
    v_cvt_pk_bf16_f32 v32, v224, v225
    v_cvt_pk_bf16_f32 v33, v226, v227
    v_cvt_pk_bf16_f32 v34, v228, v229
    v_cvt_pk_bf16_f32 v35, v230, v231
    buffer_store_dwordx4 v[32:35], v2, s[16:19], s47 offen offset:0 sc1
    v_mov_b64 v[224:225], 0
    v_mov_b64 v[226:227], 0
    v_mov_b64 v[228:229], 0
    v_mov_b64 v[230:231], 0
    v_pk_mul_f32 v[232:233], v[232:233], v[42:43] op_sel_hi:[1,0]
    v_pk_mul_f32 v[234:235], v[234:235], v[42:43] op_sel_hi:[1,0]
    v_pk_mul_f32 v[236:237], v[236:237], v[42:43] op_sel_hi:[1,0]
    v_pk_mul_f32 v[238:239], v[238:239], v[42:43] op_sel_hi:[1,0]
    v_cvt_pk_bf16_f32 v36, v232, v233
    v_cvt_pk_bf16_f32 v37, v234, v235
    v_cvt_pk_bf16_f32 v38, v236, v237
    v_cvt_pk_bf16_f32 v39, v238, v239
    buffer_store_dwordx4 v[36:39], v2, s[16:19], s47 offen offset:1024 sc1
    v_mov_b64 v[232:233], 0
    v_mov_b64 v[234:235], 0
    v_mov_b64 v[236:237], 0
    v_mov_b64 v[238:239], 0
    v_pk_mul_f32 v[240:241], v[240:241], v[42:43] op_sel_hi:[1,0]
    v_pk_mul_f32 v[242:243], v[242:243], v[42:43] op_sel_hi:[1,0]
    v_pk_mul_f32 v[244:245], v[244:245], v[42:43] op_sel_hi:[1,0]
    v_pk_mul_f32 v[246:247], v[246:247], v[42:43] op_sel_hi:[1,0]
    v_cvt_pk_bf16_f32 v32, v240, v241
    v_cvt_pk_bf16_f32 v33, v242, v243
    v_cvt_pk_bf16_f32 v34, v244, v245
    v_cvt_pk_bf16_f32 v35, v246, v247
    buffer_store_dwordx4 v[32:35], v2, s[16:19], s47 offen offset:2048 sc1
    v_mov_b64 v[240:241], 0
    v_mov_b64 v[242:243], 0
    v_mov_b64 v[244:245], 0
    v_mov_b64 v[246:247], 0
    v_pk_mul_f32 v[248:249], v[248:249], v[42:43] op_sel_hi:[1,0]
    v_pk_mul_f32 v[250:251], v[250:251], v[42:43] op_sel_hi:[1,0]
    v_pk_mul_f32 v[252:253], v[252:253], v[42:43] op_sel_hi:[1,0]
    v_pk_mul_f32 v[254:255], v[254:255], v[42:43] op_sel_hi:[1,0]
    v_cvt_pk_bf16_f32 v36, v248, v249
    v_cvt_pk_bf16_f32 v37, v250, v251
    v_cvt_pk_bf16_f32 v38, v252, v253
    v_cvt_pk_bf16_f32 v39, v254, v255
    buffer_store_dwordx4 v[36:39], v2, s[16:19], s47 offen offset:3072 sc1
    v_mov_b64 v[248:249], 0
    v_mov_b64 v[250:251], 0
    v_mov_b64 v[252:253], 0
    v_mov_b64 v[254:255], 0
    s_waitcnt lgkmcnt(0)
    s_barrier
    s_cmp_lg_u32 s35, 0
    s_cbranch_scc1 L_p2
    s_branch L_d2_1
L_d1_2:
    s_waitcnt lgkmcnt(0)
    v_mfma_f32_16x16x32_bf16 v[64:67], a[64:67], a[0:3], v[112:115]
    ds_read_b128 a[124:127], v6 offset:15360
    ds_read_b128 a[120:123], v6 offset:14336
    v_exp_f32 v80, v80
    v_mfma_f32_16x16x32_bf16 v[64:67], a[68:71], a[4:7], v[64:67]
    ds_read_b128 a[116:119], v6 offset:13312
    ds_read_b128 a[112:115], v6 offset:12288
    v_exp_f32 v81, v81
    v_mfma_f32_16x16x32_bf16 v[64:67], a[72:75], a[8:11], v[64:67]
    v_add_f32 v11, v11, v80
    v_add_f32 v11, v11, v81
    v_mfma_f32_16x16x32_bf16 v[64:67], a[76:79], a[12:15], v[64:67]
    v_exp_f32 v82, v82
    v_mfma_f32_16x16x32_bf16 v[68:71], a[92:95], a[12:15], v[112:115]
    v_exp_f32 v83, v83
    v_cvt_pk_bf16_f32 v104, v80, v81
    v_mfma_f32_16x16x32_bf16 v[68:71], a[88:91], a[8:11], v[68:71]
    s_mov_b32 m0, s38
    v_add_f32 v11, v11, v82
    v_mfma_f32_16x16x32_bf16 v[68:71], a[84:87], a[4:7], v[68:71]
    v_add_f32 v11, v11, v83
    v_cvt_pk_bf16_f32 v105, v82, v83
    v_mfma_f32_16x16x32_bf16 v[68:71], a[80:83], a[0:3], v[68:71]
    buffer_load_dwordx4 v2, s[8:11], s36 offen offset:0 sc1 lds
    v_mfma_f32_16x16x32_bf16 v[72:75], a[96:99], a[0:3], v[112:115]
    v_exp_f32 v84, v84
    v_mfma_f32_16x16x32_bf16 v[72:75], a[100:103], a[4:7], v[72:75]
    v_exp_f32 v85, v85
    v_mfma_f32_16x16x32_bf16 v[72:75], a[104:107], a[8:11], v[72:75]
    v_add_f32 v11, v11, v84
    v_add_f32 v11, v11, v85
    v_mfma_f32_16x16x32_bf16 v[72:75], a[108:111], a[12:15], v[72:75]
    v_exp_f32 v86, v86
    s_waitcnt lgkmcnt(0)
    v_mfma_f32_16x16x32_bf16 v[76:79], a[124:127], a[12:15], v[112:115]
    v_exp_f32 v87, v87
    v_mfma_f32_16x16x32_bf16 v[76:79], a[120:123], a[8:11], v[76:79]
    v_cvt_pk_bf16_f32 v106, v84, v85
    v_add_f32 v11, v11, v86
    v_mfma_f32_16x16x32_bf16 v[76:79], a[116:119], a[4:7], v[76:79]
    v_add_f32 v11, v11, v87
    v_cvt_pk_bf16_f32 v107, v86, v87
    v_mfma_f32_16x16x32_bf16 v[76:79], a[112:115], a[0:3], v[76:79]
    v_exp_f32 v88, v88
    v_mfma_f32_16x16x32_bf16 v[192:195], a[128:131], v[96:99], v[192:195]
    buffer_load_dwordx4 v2, s[8:11], s36 offen offset:1024 sc1 lds
    v_mfma_f32_16x16x32_bf16 v[192:195], a[132:135], v[100:103], v[192:195]
    v_exp_f32 v89, v89
    v_mfma_f32_16x16x32_bf16 v[196:199], a[140:143], v[100:103], v[196:199]
    v_add_f32 v11, v11, v88
    v_add_f32 v11, v11, v89
    v_mfma_f32_16x16x32_bf16 v[196:199], a[136:139], v[96:99], v[196:199]
    v_exp_f32 v90, v90
    v_mfma_f32_16x16x32_bf16 v[200:203], a[144:147], v[96:99], v[200:203]
    v_exp_f32 v91, v91
    v_mfma_f32_16x16x32_bf16 v[200:203], a[148:151], v[100:103], v[200:203]
    v_cvt_pk_bf16_f32 v108, v88, v89
    v_add_f32 v11, v11, v90
    v_mfma_f32_16x16x32_bf16 v[204:207], a[156:159], v[100:103], v[204:207]
    v_add_f32 v11, v11, v91
    v_cvt_pk_bf16_f32 v109, v90, v91
    v_mfma_f32_16x16x32_bf16 v[204:207], a[152:155], v[96:99], v[204:207]
    v_exp_f32 v92, v92
    v_mfma_f32_16x16x32_bf16 v[208:211], a[160:163], v[96:99], v[208:211]
    v_exp_f32 v93, v93
    v_mfma_f32_16x16x32_bf16 v[208:211], a[164:167], v[100:103], v[208:211]
    buffer_load_dwordx4 v2, s[8:11], s36 offen offset:2048 sc1 lds
    v_mfma_f32_16x16x32_bf16 v[212:215], a[172:175], v[100:103], v[212:215]
    v_add_f32 v11, v11, v92
    v_add_f32 v11, v11, v93
    v_mfma_f32_16x16x32_bf16 v[212:215], a[168:171], v[96:99], v[212:215]
    v_exp_f32 v94, v94
    v_mfma_f32_16x16x32_bf16 v[216:219], a[176:179], v[96:99], v[216:219]
    v_exp_f32 v95, v95
    v_mfma_f32_16x16x32_bf16 v[216:219], a[180:183], v[100:103], v[216:219]
    v_cvt_pk_bf16_f32 v110, v92, v93
    v_add_f32 v11, v11, v94
    v_mfma_f32_16x16x32_bf16 v[220:223], a[188:191], v[100:103], v[220:223]
    v_add_f32 v11, v11, v95
    v_cvt_pk_bf16_f32 v111, v94, v95
    v_mfma_f32_16x16x32_bf16 v[220:223], a[184:187], v[96:99], v[220:223]
    s_and_b32 s4, s2, 7
    s_mul_i32 s4, s4, 28
    s_lshr_b32 s5, s2, 3
    s_add_u32 s4, s4, s5
    s_sub_u32 s4, s4, 4
    s_cmp_ge_u32 s5, 4
    s_cselect_b32 s4, s4, 0
    s_cselect_b32 s5, 7168, 0
    v_lshrrev_b32 v49, 24, v0
    v_mul_u32_u24 v48, s5, v49
    v_lshl_add_u32 v48, s4, 4, v48
    v_and_b32 v49, 127, v49
    s_lshl_b32 s4, s4, 13
    s_add_u32 s4, s4, 4096
    v_lshl_add_u32 v49, v49, 3, s4
    v_mfma_f32_16x16x32_bf16 v[80:83], a[64:67], a[16:19], v[116:119]
    v_exp_f32 v64, v64
    v_exp_f32 v65, v65
    v_mfma_f32_16x16x32_bf16 v[80:83], a[68:71], a[20:23], v[80:83]
    v_add_f32 v8, v8, v64
    v_add_f32 v8, v8, v65
    v_exp_f32 v66, v66
    v_mfma_f32_16x16x32_bf16 v[80:83], a[72:75], a[24:27], v[80:83]
    s_waitcnt vmcnt(12)
    v_mov_b64 v[44:45], -1
    v_mov_b64 v[46:47], -1
    v_exp_f32 v67, v67
    v_mfma_f32_16x16x32_bf16 v[80:83], a[76:79], a[28:31], v[80:83]
    v_cvt_pk_bf16_f32 v96, v64, v65
    v_add_f32 v8, v8, v66
    v_add_f32 v8, v8, v67
    v_mfma_f32_16x16x32_bf16 v[84:87], a[92:95], a[28:31], v[116:119]
    v_cndmask_b32_e64 v20, v7, v120, s[24:25]
    v_cvt_pk_bf16_f32 v97, v66, v67
    buffer_load_dwordx4 v2, s[8:11], s36 offen offset:3072 sc1 lds
    v_mfma_f32_16x16x32_bf16 v[84:87], a[88:91], a[24:27], v[84:87]
    v_exp_f32 v68, v68
    v_exp_f32 v69, v69
    v_mfma_f32_16x16x32_bf16 v[84:87], a[84:87], a[20:23], v[84:87]
    v_add_f32 v8, v8, v68
    v_add_f32 v8, v8, v69
    v_exp_f32 v70, v70
    v_mfma_f32_16x16x32_bf16 v[84:87], a[80:83], a[16:19], v[84:87]
    v_cndmask_b32_e64 v21, v7, v120, s[26:27]
    v_cndmask_b32_e64 v22, v7, v120, s[28:29]
    v_mfma_f32_16x16x32_bf16 v[88:91], a[96:99], a[16:19], v[116:119]
    v_exp_f32 v71, v71
    v_mfma_f32_16x16x32_bf16 v[88:91], a[100:103], a[20:23], v[88:91]
    v_cvt_pk_bf16_f32 v98, v68, v69
    v_add_f32 v8, v8, v70
    v_mfma_f32_16x16x32_bf16 v[88:91], a[104:107], a[24:27], v[88:91]
    v_add_f32 v8, v8, v71
    v_cvt_pk_bf16_f32 v99, v70, v71
    v_mfma_f32_16x16x32_bf16 v[88:91], a[108:111], a[28:31], v[88:91]
    v_exp_f32 v72, v72
    v_mfma_f32_16x16x32_bf16 v[92:95], a[124:127], a[28:31], v[116:119]
    v_cndmask_b32_e64 v23, v7, v120, s[30:31]
    s_add_u32 m0, s38, 4096
    v_mfma_f32_16x16x32_bf16 v[92:95], a[120:123], a[24:27], v[92:95]
    buffer_load_dwordx4 v3, s[8:11], s36 offen offset:0 sc1 lds
    v_mfma_f32_16x16x32_bf16 v[92:95], a[116:119], a[20:23], v[92:95]
    v_exp_f32 v73, v73
    v_mfma_f32_16x16x32_bf16 v[92:95], a[112:115], a[16:19], v[92:95]
    v_add_f32 v8, v8, v72
    v_add_f32 v8, v8, v73
    v_mfma_f32_16x16x32_bf16 v[224:227], a[128:131], v[104:107], v[224:227]
    v_exp_f32 v74, v74
    v_mfma_f32_16x16x32_bf16 v[224:227], a[132:135], v[108:111], v[224:227]
    ds_read_b128 a[128:131], v6 offset:16384
    ds_read_b128 a[132:135], v6 offset:17408
    v_mfma_f32_16x16x32_bf16 v[228:231], a[140:143], v[108:111], v[228:231]
    v_exp_f32 v75, v75
    v_mfma_f32_16x16x32_bf16 v[228:231], a[136:139], v[104:107], v[228:231]
    ds_read_b128 a[140:143], v6 offset:19456
    ds_read_b128 a[136:139], v6 offset:18432
    v_mfma_f32_16x16x32_bf16 v[232:235], a[144:147], v[104:107], v[232:235]
    ds_read_b128 a[144:147], v6 offset:20480
    v_cvt_pk_bf16_f32 v100, v72, v73
    v_mfma_f32_16x16x32_bf16 v[232:235], a[148:151], v[108:111], v[232:235]
    ds_read_b128 a[148:151], v6 offset:21504
    v_add_f32 v8, v8, v74
    v_mfma_f32_16x16x32_bf16 v[236:239], a[156:159], v[108:111], v[236:239]
    buffer_load_dwordx4 v3, s[8:11], s36 offen offset:1024 sc1 lds
    v_mfma_f32_16x16x32_bf16 v[236:239], a[152:155], v[104:107], v[236:239]
    ds_read_b128 a[156:159], v6 offset:23552
    ds_read_b128 a[152:155], v6 offset:22528
    v_mfma_f32_16x16x32_bf16 v[240:243], a[160:163], v[104:107], v[240:243]
    v_add_f32 v8, v8, v75
    v_cvt_pk_bf16_f32 v101, v74, v75
    v_mfma_f32_16x16x32_bf16 v[240:243], a[164:167], v[108:111], v[240:243]
    v_exp_f32 v76, v76
    v_mfma_f32_16x16x32_bf16 v[244:247], a[172:175], v[108:111], v[244:247]
    v_exp_f32 v77, v77
    v_mfma_f32_16x16x32_bf16 v[244:247], a[168:171], v[104:107], v[244:247]
    v_add_f32 v8, v8, v76
    v_add_f32 v8, v8, v77
    v_mfma_f32_16x16x32_bf16 v[248:251], a[176:179], v[104:107], v[248:251]
    v_exp_f32 v78, v78
    v_mfma_f32_16x16x32_bf16 v[248:251], a[180:183], v[108:111], v[248:251]
    v_exp_f32 v79, v79
    v_mfma_f32_16x16x32_bf16 v[252:255], a[188:191], v[108:111], v[252:255]
    v_cvt_pk_bf16_f32 v102, v76, v77
    v_add_f32 v8, v8, v78
    v_mfma_f32_16x16x32_bf16 v[252:255], a[184:187], v[104:107], v[252:255]
    v_add_f32 v8, v8, v79
    v_cvt_pk_bf16_f32 v103, v78, v79
    v_mfma_f32_16x16x32_bf16 v[64:67], a[64:67], a[32:35], v[120:123]
    ds_read_b128 a[160:163], v6 offset:24576
    ds_read_b128 a[164:167], v6 offset:25600
    v_exp_f32 v80, v80
    v_mfma_f32_16x16x32_bf16 v[64:67], a[68:71], a[36:39], v[64:67]
    ds_read_b128 a[172:175], v6 offset:27648
    ds_read_b128 a[168:171], v6 offset:26624
    v_exp_f32 v81, v81
    v_mfma_f32_16x16x32_bf16 v[64:67], a[72:75], a[40:43], v[64:67]
    v_add_f32 v9, v9, v80
    v_add_f32 v9, v9, v81
    v_exp_f32 v82, v82
    v_mfma_f32_16x16x32_bf16 v[64:67], a[76:79], a[44:47], v[64:67]
    ds_read_b128 a[176:179], v6 offset:28672
    ds_read_b128 a[180:183], v6 offset:29696
    v_exp_f32 v83, v83
    v_mfma_f32_16x16x32_bf16 v[68:71], a[92:95], a[44:47], v[120:123]
    ds_read_b128 a[188:191], v6 offset:31744
    v_cvt_pk_bf16_f32 v104, v80, v81
    buffer_load_dwordx4 v3, s[8:11], s36 offen offset:2048 sc1 lds
    v_mfma_f32_16x16x32_bf16 v[68:71], a[88:91], a[40:43], v[68:71]
    v_add_f32 v9, v9, v82
    buffer_load_dwordx4 v3, s[8:11], s36 offen offset:3072 sc1 lds
    s_add_u32 s36, s36, s53
    v_mfma_f32_16x16x32_bf16 v[68:71], a[84:87], a[36:39], v[68:71]
    v_add_f32 v9, v9, v83
    v_cvt_pk_bf16_f32 v105, v82, v83
    v_exp_f32 v84, v84
    v_mfma_f32_16x16x32_bf16 v[68:71], a[80:83], a[32:35], v[68:71]
    ds_read_b128 a[184:187], v6 offset:30720
    v_exp_f32 v85, v85
    v_mfma_f32_16x16x32_bf16 v[72:75], a[96:99], a[32:35], v[20:23]
    v_add_f32 v9, v9, v84
    v_add_f32 v9, v9, v85
    v_mfma_f32_16x16x32_bf16 v[72:75], a[100:103], a[36:39], v[72:75]
    v_exp_f32 v86, v86
    v_mfma_f32_16x16x32_bf16 v[72:75], a[104:107], a[40:43], v[72:75]
    v_exp_f32 v87, v87
    v_mfma_f32_16x16x32_bf16 v[72:75], a[108:111], a[44:47], v[72:75]
    v_cvt_pk_bf16_f32 v106, v84, v85
    v_add_f32 v9, v9, v86
    s_waitcnt lgkmcnt(1)
    v_mfma_f32_16x16x32_bf16 v[128:131], a[128:131], v[96:99], v[128:131]
    global_load_dwordx4 a[224:227], v48, s[56:57] offset:0
    v_mfma_f32_16x16x32_bf16 v[128:131], a[132:135], v[100:103], v[128:131]
    v_add_f32 v9, v9, v87
    v_cvt_pk_bf16_f32 v107, v86, v87
    v_mfma_f32_16x16x32_bf16 v[132:135], a[140:143], v[100:103], v[132:135]
    v_exp_f32 v88, v88
    v_mfma_f32_16x16x32_bf16 v[132:135], a[136:139], v[96:99], v[132:135]
    v_exp_f32 v89, v89
    v_mfma_f32_16x16x32_bf16 v[136:139], a[144:147], v[96:99], v[136:139]
    v_add_f32 v9, v9, v88
    v_add_f32 v9, v9, v89
    v_mfma_f32_16x16x32_bf16 v[136:139], a[148:151], v[100:103], v[136:139]
    v_exp_f32 v90, v90
    v_mfma_f32_16x16x32_bf16 v[140:143], a[156:159], v[100:103], v[140:143]
    v_exp_f32 v91, v91
    v_mfma_f32_16x16x32_bf16 v[140:143], a[152:155], v[96:99], v[140:143]
    v_cvt_pk_bf16_f32 v108, v88, v89
    v_add_f32 v9, v9, v90
    v_mfma_f32_16x16x32_bf16 v[144:147], a[160:163], v[96:99], v[144:147]
    v_add_f32 v9, v9, v91
    v_cvt_pk_bf16_f32 v109, v90, v91
    v_mfma_f32_16x16x32_bf16 v[144:147], a[164:167], v[100:103], v[144:147]
    v_exp_f32 v92, v92
    v_mfma_f32_16x16x32_bf16 v[148:151], a[172:175], v[100:103], v[148:151]
    v_exp_f32 v93, v93
    v_mfma_f32_16x16x32_bf16 v[148:151], a[168:171], v[96:99], v[148:151]
    v_add_f32 v9, v9, v92
    v_add_f32 v9, v9, v93
    v_mfma_f32_16x16x32_bf16 v[152:155], a[176:179], v[96:99], v[152:155]
    v_exp_f32 v94, v94
    v_mfma_f32_16x16x32_bf16 v[152:155], a[180:183], v[100:103], v[152:155]
    v_exp_f32 v95, v95
    v_mfma_f32_16x16x32_bf16 v[156:159], a[188:191], v[100:103], v[156:159]
    v_cvt_pk_bf16_f32 v110, v92, v93
    v_add_f32 v9, v9, v94
    s_waitcnt lgkmcnt(0)
    v_mfma_f32_16x16x32_bf16 v[156:159], a[184:187], v[96:99], v[156:159]
    v_add_f32 v9, v9, v95
    v_cvt_pk_bf16_f32 v111, v94, v95
    s_waitcnt vmcnt(19)
    s_barrier
    v_mfma_f32_16x16x32_bf16 v[80:83], a[64:67], a[48:51], v[124:127]
    v_exp_f32 v64, v64
    v_exp_f32 v65, v65
    v_mfma_f32_16x16x32_bf16 v[80:83], a[68:71], a[52:55], v[80:83]
    v_add_f32 v10, v10, v64
    v_add_f32 v10, v10, v65
    v_exp_f32 v66, v66
    v_mfma_f32_16x16x32_bf16 v[80:83], a[72:75], a[56:59], v[80:83]
    ds_read_b128 a[64:67], v6 offset:32768
    global_load_dwordx2 a[240:241], v49, s[60:61] offset:-4096
    v_mfma_f32_16x16x32_bf16 v[80:83], a[76:79], a[60:63], v[80:83]
    ds_read_b128 a[68:71], v6 offset:33792
    ds_read_b128 a[72:75], v6 offset:34816
    v_exp_f32 v67, v67
    v_mfma_f32_16x16x32_bf16 v[84:87], a[92:95], a[60:63], v[124:127]
    ds_read_b128 a[32:35], v18 offset:0
    global_load_dwordx2 a[242:243], v49, s[60:61] offset:-3072
    v_mfma_f32_16x16x32_bf16 v[84:87], a[88:91], a[56:59], v[84:87]
    ds_read_b128 a[36:39], v18 offset:1024
    v_cvt_pk_bf16_f32 v96, v64, v65
    v_add_f32 v10, v10, v66
    v_mfma_f32_16x16x32_bf16 v[84:87], a[84:87], a[52:55], v[84:87]
    v_add_f32 v10, v10, v67
    v_cvt_pk_bf16_f32 v97, v66, v67
    v_exp_f32 v68, v68
    v_mfma_f32_16x16x32_bf16 v[84:87], a[80:83], a[48:51], v[84:87]
    ds_read_b128 a[40:43], v18 offset:2048
    global_load_dwordx2 a[244:245], v49, s[60:61] offset:-2048
    v_mfma_f32_16x16x32_bf16 v[88:91], a[96:99], a[48:51], v[124:127]
    ds_read_b128 a[44:47], v18 offset:3072
    v_mov_b32 v120, v12
    v_exp_f32 v69, v69
    v_mfma_f32_16x16x32_bf16 v[88:91], a[100:103], a[52:55], v[88:91]
    v_mov_b32 v121, v12
    global_load_dwordx2 a[246:247], v49, s[60:61] offset:-1024
    v_mfma_f32_16x16x32_bf16 v[88:91], a[104:107], a[56:59], v[88:91]
    v_add_f32 v10, v10, v68
    v_add_f32 v10, v10, v69
    v_exp_f32 v70, v70
    v_mfma_f32_16x16x32_bf16 v[88:91], a[108:111], a[60:63], v[88:91]
    v_mov_b32 v122, v12
    v_mov_b32 v123, v12
    v_exp_f32 v71, v71
    v_mfma_f32_16x16x32_bf16 v[92:95], a[124:127], a[60:63], v[124:127]
    v_cndmask_b32_e64 v20, v7, v124, s[24:25]
    global_load_dwordx2 a[248:249], v49, s[60:61] offset:0
    v_mfma_f32_16x16x32_bf16 v[92:95], a[120:123], a[56:59], v[92:95]
    v_cndmask_b32_e64 v21, v7, v124, s[26:27]
    v_cndmask_b32_e64 v22, v7, v124, s[28:29]
    v_cvt_pk_bf16_f32 v98, v68, v69
    v_mfma_f32_16x16x32_bf16 v[92:95], a[116:119], a[52:55], v[92:95]
    v_add_f32 v10, v10, v70
    global_load_dwordx2 a[250:251], v49, s[60:61] offset:1024
    v_mfma_f32_16x16x32_bf16 v[92:95], a[112:115], a[48:51], v[92:95]
    v_add_f32 v10, v10, v71
    v_cvt_pk_bf16_f32 v99, v70, v71
    v_exp_f32 v72, v72
    v_mfma_f32_16x16x32_bf16 v[160:163], a[128:131], v[104:107], v[160:163]
    v_cndmask_b32_e64 v23, v7, v124, s[30:31]
    ds_read_b128 a[76:79], v6 offset:35840
    v_mfma_f32_16x16x32_bf16 v[160:163], a[132:135], v[108:111], v[160:163]
    global_load_dwordx2 a[252:253], v49, s[60:61] offset:2048
    v_mfma_f32_16x16x32_bf16 v[164:167], a[140:143], v[108:111], v[164:167]
    ds_read_b128 a[92:95], v6 offset:39936
    ds_read_b128 a[88:91], v6 offset:38912
    v_mfma_f32_16x16x32_bf16 v[164:167], a[136:139], v[104:107], v[164:167]
    ds_read_b128 a[84:87], v6 offset:37888
    ds_read_b128 a[80:83], v6 offset:36864
    v_mfma_f32_16x16x32_bf16 v[168:171], a[144:147], v[104:107], v[168:171]
    global_load_dwordx2 a[254:255], v49, s[60:61] offset:3072
    v_mfma_f32_16x16x32_bf16 v[168:171], a[148:151], v[108:111], v[168:171]
    ds_read_b128 a[96:99], v6 offset:40960
    ds_read_b128 a[100:103], v6 offset:41984
    v_mfma_f32_16x16x32_bf16 v[172:175], a[156:159], v[108:111], v[172:175]
    ds_read_b128 a[104:107], v6 offset:43008
    ds_read_b128 a[108:111], v6 offset:44032
    v_mfma_f32_16x16x32_bf16 v[172:175], a[152:155], v[104:107], v[172:175]
    v_exp_f32 v73, v73
    v_mfma_f32_16x16x32_bf16 v[176:179], a[160:163], v[104:107], v[176:179]
    v_add_f32 v10, v10, v72
    v_add_f32 v10, v10, v73
    v_mfma_f32_16x16x32_bf16 v[176:179], a[164:167], v[108:111], v[176:179]
    v_exp_f32 v74, v74
    v_mfma_f32_16x16x32_bf16 v[180:183], a[172:175], v[108:111], v[180:183]
    v_exp_f32 v75, v75
    v_mfma_f32_16x16x32_bf16 v[180:183], a[168:171], v[104:107], v[180:183]
    v_cvt_pk_bf16_f32 v100, v72, v73
    v_add_f32 v10, v10, v74
    v_mfma_f32_16x16x32_bf16 v[184:187], a[176:179], v[104:107], v[184:187]
    global_load_dwordx4 a[228:231], v48, s[56:57] offset:3584
    v_mfma_f32_16x16x32_bf16 v[184:187], a[180:183], v[108:111], v[184:187]
    v_add_f32 v10, v10, v75
    v_cvt_pk_bf16_f32 v101, v74, v75
    v_mfma_f32_16x16x32_bf16 v[188:191], a[188:191], v[108:111], v[188:191]
    v_mov_b64 v[102:103], 0
    v_mfma_f32_16x16x32_bf16 v[188:191], a[184:187], v[104:107], v[188:191]
    s_waitcnt lgkmcnt(0)
    v_mfma_f32_16x16x32_bf16 v[64:67], a[64:67], a[48:51], v[124:127]
    ds_read_b128 a[124:127], v6 offset:48128
    ds_read_b128 a[120:123], v6 offset:47104
    v_exp_f32 v80, v80
    v_mfma_f32_16x16x32_bf16 v[64:67], a[68:71], a[52:55], v[64:67]
    ds_read_b128 a[116:119], v6 offset:46080
    ds_read_b128 a[112:115], v6 offset:45056
    v_exp_f32 v81, v81
    v_mfma_f32_16x16x32_bf16 v[64:67], a[72:75], a[56:59], v[64:67]
    v_mov_b32 v41, v10
    s_mov_b32 s3, s55
    buffer_store_dwordx4 v[44:47], v63, s[16:19], s3 offen sc1
    v_mfma_f32_16x16x32_bf16 v[64:67], a[76:79], a[60:63], v[64:67]
    v_add_f32 v11, v11, v80
    v_add_f32 v11, v11, v81
    v_exp_f32 v82, v82
    v_mfma_f32_16x16x32_bf16 v[68:71], a[92:95], a[60:63], v[20:23]
    s_nop 1
    v_permlane16_swap_b32 v10, v41
    v_exp_f32 v83, v83
    v_mfma_f32_16x16x32_bf16 v[68:71], a[88:91], a[56:59], v[68:71]
    v_cvt_pk_bf16_f32 v104, v80, v81
    s_xor_b32 s3, s55, 0x10000
    buffer_store_dwordx4 v[44:47], v63, s[16:19], s3 offen sc1
    v_mfma_f32_16x16x32_bf16 v[68:71], a[84:87], a[52:55], v[68:71]
    v_add_f32 v11, v11, v82
    v_add_f32 v11, v11, v83
    v_cvt_pk_bf16_f32 v105, v82, v83
    v_mfma_f32_16x16x32_bf16 v[68:71], a[80:83], a[48:51], v[68:71]
    v_exp_f32 v84, v84
    v_exp_f32 v85, v85
    v_mfma_f32_16x16x32_bf16 v[192:195], a[128:131], v[96:99], v[192:195]
    v_add_f32 v10, v10, v41
    s_xor_b32 s3, s55, 0x20000
    buffer_store_dwordx4 v[44:47], v63, s[16:19], s3 offen sc1
    v_mfma_f32_16x16x32_bf16 v[192:195], a[132:135], v[100:103], v[192:195]
    v_add_f32 v11, v11, v84
    v_add_f32 v11, v11, v85
    v_exp_f32 v86, v86
    v_mfma_f32_16x16x32_bf16 v[196:199], a[140:143], v[100:103], v[196:199]
    v_mov_b32 v41, v10
    s_nop 1
    v_exp_f32 v87, v87
    v_mfma_f32_16x16x32_bf16 v[196:199], a[136:139], v[96:99], v[196:199]
    v_cvt_pk_bf16_f32 v106, v84, v85
    s_xor_b32 s3, s55, 0x30000
    buffer_store_dwordx4 v[44:47], v63, s[16:19], s3 offen sc1
    v_mfma_f32_16x16x32_bf16 v[200:203], a[144:147], v[96:99], v[200:203]
    v_add_f32 v11, v11, v86
    v_add_f32 v11, v11, v87
    v_cvt_pk_bf16_f32 v107, v86, v87
    v_mfma_f32_16x16x32_bf16 v[200:203], a[148:151], v[100:103], v[200:203]
    v_exp_f32 v88, v88
    v_exp_f32 v89, v89
    v_mfma_f32_16x16x32_bf16 v[204:207], a[156:159], v[100:103], v[204:207]
    v_add_f32 v11, v11, v88
    v_add_f32 v11, v11, v89
    v_exp_f32 v90, v90
    v_mfma_f32_16x16x32_bf16 v[204:207], a[152:155], v[96:99], v[204:207]
    v_permlane32_swap_b32 v10, v41
    v_add_f32 v10, v10, v41
    v_exp_f32 v91, v91
    v_mfma_f32_16x16x32_bf16 v[208:211], a[160:163], v[96:99], v[208:211]
    global_load_dwordx4 a[232:235], v48, s[58:59] offset:0
    v_mfma_f32_16x16x32_bf16 v[208:211], a[164:167], v[100:103], v[208:211]
    v_cvt_pk_bf16_f32 v108, v88, v89
    v_add_f32 v11, v11, v90
    v_rcp_f32 v40, v10
    v_mfma_f32_16x16x32_bf16 v[212:215], a[172:175], v[100:103], v[212:215]
    v_add_f32 v11, v11, v91
    v_cvt_pk_bf16_f32 v109, v90, v91
    v_exp_f32 v92, v92
    v_mfma_f32_16x16x32_bf16 v[212:215], a[168:171], v[96:99], v[212:215]
    v_cmp_nge_f32 vcc, 0x5f800000, v10
    s_or_b64 s[50:51], s[50:51], vcc
    v_exp_f32 v93, v93
    v_mfma_f32_16x16x32_bf16 v[216:219], a[176:179], v[96:99], v[216:219]
    v_add_f32 v11, v11, v92
    v_add_f32 v11, v11, v93
    v_exp_f32 v94, v94
    v_mfma_f32_16x16x32_bf16 v[216:219], a[180:183], v[100:103], v[216:219]
    v_exp_f32 v95, v95
    v_mfma_f32_16x16x32_bf16 v[220:223], a[188:191], v[100:103], v[220:223]
    v_cvt_pk_bf16_f32 v110, v92, v93
    v_add_f32 v11, v11, v94
    v_mfma_f32_16x16x32_bf16 v[220:223], a[184:187], v[96:99], v[220:223]
    v_add_f32 v11, v11, v95
    v_cvt_pk_bf16_f32 v111, v94, v95
    v_mfma_f32_16x16x32_bf16 v[80:83], a[64:67], a[0:3], v[112:115]
    v_exp_f32 v64, v64
    v_exp_f32 v65, v65
    v_mfma_f32_16x16x32_bf16 v[80:83], a[68:71], a[4:7], v[80:83]
    v_add_f32 v11, v11, v64
    v_add_f32 v11, v11, v65
    v_exp_f32 v66, v66
    v_mfma_f32_16x16x32_bf16 v[80:83], a[72:75], a[8:11], v[80:83]
    ds_read_b128 a[48:51], v18 offset:4096
    s_xor_b32 s3, s55, 0x780000
    buffer_store_dwordx4 v[44:47], v63, s[16:19], s3 offen sc1
    v_mfma_f32_16x16x32_bf16 v[80:83], a[76:79], a[12:15], v[80:83]
    ds_read_b128 a[52:55], v18 offset:5120
    ds_read_b128 a[56:59], v18 offset:6144
    v_exp_f32 v67, v67
    v_mfma_f32_16x16x32_bf16 v[84:87], a[92:95], a[12:15], v[112:115]
    v_cvt_pk_bf16_f32 v96, v64, v65
    v_add_f32 v11, v11, v66
    v_add_f32 v11, v11, v67
    v_mfma_f32_16x16x32_bf16 v[84:87], a[88:91], a[8:11], v[84:87]
    v_mul_f32 v192, v192, v40
    v_cvt_pk_bf16_f32 v97, v66, v67
    v_exp_f32 v68, v68
    v_mfma_f32_16x16x32_bf16 v[84:87], a[84:87], a[4:7], v[84:87]
    v_mul_f32 v193, v193, v40
    s_xor_b32 s3, s55, 0x790000
    buffer_store_dwordx4 v[44:47], v63, s[16:19], s3 offen sc1
    v_mfma_f32_16x16x32_bf16 v[84:87], a[80:83], a[0:3], v[84:87]
    v_mul_f32 v194, v194, v40
    v_mul_f32 v195, v195, v40
    v_exp_f32 v69, v69
    v_mfma_f32_16x16x32_bf16 v[88:91], a[96:99], a[0:3], v[112:115]
    v_add_f32 v11, v11, v68
    v_add_f32 v11, v11, v69
    v_exp_f32 v70, v70
    v_mfma_f32_16x16x32_bf16 v[88:91], a[100:103], a[4:7], v[88:91]
    v_mul_f32 v196, v196, v40
    v_mul_f32 v197, v197, v40
    v_exp_f32 v71, v71
    v_mfma_f32_16x16x32_bf16 v[88:91], a[104:107], a[8:11], v[88:91]
    v_mul_f32 v198, v198, v40
    v_mul_f32 v199, v199, v40
    v_cvt_pk_bf16_f32 v32, v192, v193
    v_mfma_f32_16x16x32_bf16 v[88:91], a[108:111], a[12:15], v[88:91]
    v_cvt_pk_bf16_f32 v33, v194, v195
    s_xor_b32 s3, s55, 0x7a0000
    buffer_store_dwordx4 v[44:47], v63, s[16:19], s3 offen sc1
    s_waitcnt lgkmcnt(0)
    v_mfma_f32_16x16x32_bf16 v[92:95], a[124:127], a[12:15], v[112:115]
    v_cvt_pk_bf16_f32 v34, v196, v197
    v_cvt_pk_bf16_f32 v35, v198, v199
    buffer_store_dwordx4 v[32:35], v2, s[16:19], s46 offen offset:0 sc1
    v_mfma_f32_16x16x32_bf16 v[92:95], a[120:123], a[8:11], v[92:95]
    v_mov_b64 v[192:193], 0
    v_mov_b64 v[194:195], 0
    v_mov_b64 v[196:197], 0
    v_mfma_f32_16x16x32_bf16 v[92:95], a[116:119], a[4:7], v[92:95]
    v_mov_b64 v[198:199], 0
    v_mul_f32 v200, v200, v40
    v_mul_f32 v201, v201, v40
    v_mfma_f32_16x16x32_bf16 v[92:95], a[112:115], a[0:3], v[92:95]
    v_mul_f32 v202, v202, v40
    s_xor_b32 s3, s55, 0x7b0000
    buffer_store_dwordx4 v[44:47], v63, s[16:19], s3 offen sc1
    v_mfma_f32_16x16x32_bf16 v[224:227], a[128:131], v[104:107], v[224:227]
    v_mul_f32 v203, v203, v40
    v_mul_f32 v204, v204, v40
    v_mul_f32 v205, v205, v40
    v_mfma_f32_16x16x32_bf16 v[224:227], a[132:135], v[108:111], v[224:227]
    v_mul_f32 v206, v206, v40
    v_mul_f32 v207, v207, v40
    v_cvt_pk_bf16_f32 v36, v200, v201
    v_mfma_f32_16x16x32_bf16 v[228:231], a[140:143], v[108:111], v[228:231]
    v_cvt_pk_bf16_f32 v37, v202, v203
    v_cvt_pk_bf16_f32 v38, v204, v205
    v_mfma_f32_16x16x32_bf16 v[228:231], a[136:139], v[104:107], v[228:231]
    v_cvt_pk_bf16_f32 v39, v206, v207
    ds_read_b128 a[128:131], v6 offset:49152
    v_mfma_f32_16x16x32_bf16 v[232:235], a[144:147], v[104:107], v[232:235]
    buffer_store_dwordx4 v[36:39], v2, s[16:19], s46 offen offset:1024 sc1
    ds_read_b128 a[132:135], v6 offset:50176
    v_mfma_f32_16x16x32_bf16 v[232:235], a[148:151], v[108:111], v[232:235]
    v_mov_b64 v[200:201], 0
    ds_read_b128 a[140:143], v6 offset:52224
    v_mfma_f32_16x16x32_bf16 v[236:239], a[156:159], v[108:111], v[236:239]
    v_mov_b64 v[202:203], 0
    ds_read_b128 a[136:139], v6 offset:51200
    v_mfma_f32_16x16x32_bf16 v[236:239], a[152:155], v[104:107], v[236:239]
    v_mov_b64 v[204:205], 0
    ds_read_b128 a[144:147], v6 offset:53248
    v_mfma_f32_16x16x32_bf16 v[240:243], a[160:163], v[104:107], v[240:243]
    v_mov_b64 v[206:207], 0
    ds_read_b128 a[148:151], v6 offset:54272
    v_mfma_f32_16x16x32_bf16 v[240:243], a[164:167], v[108:111], v[240:243]
    ds_read_b128 a[156:159], v6 offset:56320
    ds_read_b128 a[152:155], v6 offset:55296
    v_mfma_f32_16x16x32_bf16 v[244:247], a[172:175], v[108:111], v[244:247]
    v_cvt_pk_bf16_f32 v98, v68, v69
    v_add_f32 v11, v11, v70
    v_mfma_f32_16x16x32_bf16 v[244:247], a[168:171], v[104:107], v[244:247]
    v_add_f32 v11, v11, v71
    v_cvt_pk_bf16_f32 v99, v70, v71
    v_mfma_f32_16x16x32_bf16 v[248:251], a[176:179], v[104:107], v[248:251]
    global_load_dwordx4 a[236:239], v48, s[58:59] offset:3584
    v_mfma_f32_16x16x32_bf16 v[248:251], a[180:183], v[108:111], v[248:251]
    ds_read_b128 a[60:63], v18 offset:7168
    v_mov_b32 v124, v13
    v_mfma_f32_16x16x32_bf16 v[252:255], a[188:191], v[108:111], v[252:255]
    v_mov_b32 v125, v13
    v_mov_b32 v126, v13
    v_mfma_f32_16x16x32_bf16 v[252:255], a[184:187], v[104:107], v[252:255]
    v_mov_b32 v127, v13
    s_waitcnt vmcnt(22)
    s_barrier
    v_xor_b32 v19, s39, v6
    v_mfma_f32_16x16x32_bf16 v[64:67], a[64:67], a[16:19], v[116:119]
    v_mul_f32 v208, v208, v40
    v_mul_f32 v209, v209, v40
    buffer_store_dwordx2 v[50:51], v52, s[20:23], s78 offen sc1
    v_mfma_f32_16x16x32_bf16 v[64:67], a[68:71], a[20:23], v[64:67]
    v_mul_f32 v210, v210, v40
    v_mul_f32 v211, v211, v40
    v_exp_f32 v80, v80
    v_mfma_f32_16x16x32_bf16 v[64:67], a[72:75], a[24:27], v[64:67]
    v_cndmask_b32_e64 v20, v7, v112, s[24:25]
    v_cndmask_b32_e64 v21, v7, v112, s[26:27]
    v_exp_f32 v81, v81
    v_mfma_f32_16x16x32_bf16 v[64:67], a[76:79], a[28:31], v[64:67]
    s_mov_b32 m0, s37
    ds_read_b128 a[160:163], v6 offset:57344
    buffer_load_dwordx4 v2, s[8:11], s36 offen offset:0 sc1 lds
    v_mfma_f32_16x16x32_bf16 v[68:71], a[92:95], a[28:31], v[116:119]
    ds_read_b128 a[164:167], v6 offset:58368
    ds_read_b128 a[168:171], v6 offset:59392
    buffer_load_dwordx4 v2, s[8:11], s36 offen offset:1024 sc1 lds
    v_mfma_f32_16x16x32_bf16 v[68:71], a[88:91], a[24:27], v[68:71]
    v_add_f32 v8, v8, v80
    v_add_f32 v8, v8, v81
    v_exp_f32 v82, v82
    v_mfma_f32_16x16x32_bf16 v[68:71], a[84:87], a[20:23], v[68:71]
    ds_read_b128 a[172:175], v6 offset:60416
    ds_read_b128 a[176:179], v6 offset:61440
    buffer_load_dwordx4 v2, s[8:11], s36 offen offset:2048 sc1 lds
    v_mfma_f32_16x16x32_bf16 v[68:71], a[80:83], a[16:19], v[68:71]
    ds_read_b128 a[180:183], v6 offset:62464
    ds_read_b128 a[64:67], v19 offset:0
    v_exp_f32 v83, v83
    v_mfma_f32_16x16x32_bf16 v[72:75], a[96:99], a[16:19], v[116:119]
    v_cvt_pk_bf16_f32 v104, v80, v81
    v_add_f32 v8, v8, v82
    buffer_load_dwordx4 v2, s[8:11], s36 offen offset:3072 sc1 lds
    v_mfma_f32_16x16x32_bf16 v[72:75], a[100:103], a[20:23], v[72:75]
    v_add_f32 v8, v8, v83
    v_cvt_pk_bf16_f32 v105, v82, v83
    v_exp_f32 v84, v84
    v_mfma_f32_16x16x32_bf16 v[72:75], a[104:107], a[24:27], v[72:75]
    ds_read_b128 a[184:187], v6 offset:63488
    ds_read_b128 a[188:191], v6 offset:64512
    ds_read_b128 a[68:71], v19 offset:1024
    v_mfma_f32_16x16x32_bf16 v[72:75], a[108:111], a[28:31], v[72:75]
    v_cndmask_b32_e64 v22, v7, v112, s[28:29]
    ds_read_b128 a[72:75], v19 offset:2048
    v_exp_f32 v85, v85
    v_mfma_f32_16x16x32_bf16 v[76:79], a[124:127], a[28:31], v[116:119]
    s_add_u32 m0, s37, 4096
    ds_read_b128 a[76:79], v19 offset:3072
    buffer_load_dwordx4 v3, s[8:11], s36 offen offset:0 sc1 lds
    v_mfma_f32_16x16x32_bf16 v[76:79], a[120:123], a[24:27], v[76:79]
    ds_read_b128 a[92:95], v19 offset:7168
    ds_read_b128 a[88:91], v19 offset:6144
    buffer_load_dwordx4 v3, s[8:11], s36 offen offset:1024 sc1 lds
    v_mfma_f32_16x16x32_bf16 v[76:79], a[116:119], a[20:23], v[76:79]
    v_add_f32 v8, v8, v84
    v_add_f32 v8, v8, v85
    v_exp_f32 v86, v86
    v_mfma_f32_16x16x32_bf16 v[76:79], a[112:115], a[16:19], v[76:79]
    v_cndmask_b32_e64 v23, v7, v112, s[30:31]
    ds_read_b128 a[84:87], v19 offset:5120
    buffer_load_dwordx4 v3, s[8:11], s36 offen offset:2048 sc1 lds
    s_waitcnt lgkmcnt(5)
    v_mfma_f32_16x16x32_bf16 v[224:227], a[128:131], v[96:99], v[224:227]
    v_mov_b32 v43, v11
    ds_read_b128 a[80:83], v19 offset:4096
    v_exp_f32 v87, v87
    v_mfma_f32_16x16x32_bf16 v[228:231], a[136:139], v[96:99], v[228:231]
    s_nop 1
    ds_read_b128 a[96:99], v19 offset:8192
    buffer_load_dwordx4 v3, s[8:11], s36 offen offset:3072 sc1 lds
    v_mfma_f32_16x16x32_bf16 v[232:235], a[144:147], v[96:99], v[232:235]
    v_permlane16_swap_b32 v11, v43
    v_add_f32 v11, v11, v43
    ds_read_b128 a[100:103], v19 offset:9216
    v_mfma_f32_16x16x32_bf16 v[236:239], a[152:155], v[96:99], v[236:239]
    v_mov_b32 v43, v11
    s_nop 1
    ds_read_b128 a[104:107], v19 offset:10240
    v_mfma_f32_16x16x32_bf16 v[240:243], a[160:163], v[96:99], v[240:243]
    v_permlane32_swap_b32 v11, v43
    v_add_f32 v11, v11, v43
    ds_read_b128 a[108:111], v19 offset:11264
    v_mfma_f32_16x16x32_bf16 v[244:247], a[168:171], v[96:99], v[244:247]
    v_mul_f32 v212, v212, v40
    v_mul_f32 v213, v213, v40
    v_rcp_f32 v42, v11
    v_mfma_f32_16x16x32_bf16 v[248:251], a[176:179], v[96:99], v[248:251]
    v_cmp_nge_f32 vcc, 0x5f800000, v11
    s_or_b64 s[50:51], s[50:51], vcc
    v_mul_f32 v214, v214, v40
    v_mfma_f32_16x16x32_bf16 v[252:255], a[184:187], v[96:99], v[252:255]
    v_cvt_pk_bf16_f32 v106, v84, v85
    v_add_f32 v8, v8, v86
    v_add_f32 v8, v8, v87
    v_cvt_pk_bf16_f32 v107, v86, v87
    v_exp_f32 v88, v88
    v_exp_f32 v89, v89
    v_add_f32 v8, v8, v88
    v_add_f32 v8, v8, v89
    v_exp_f32 v90, v90
    v_exp_f32 v91, v91
    v_cvt_pk_bf16_f32 v108, v88, v89
    v_add_f32 v8, v8, v90
    v_add_f32 v8, v8, v91
    v_cvt_pk_bf16_f32 v109, v90, v91
    v_exp_f32 v92, v92
    v_exp_f32 v93, v93
    v_add_f32 v8, v8, v92
    v_add_f32 v8, v8, v93
    v_exp_f32 v94, v94
    v_exp_f32 v95, v95
    v_cvt_pk_bf16_f32 v110, v92, v93
    v_add_f32 v8, v8, v94
    v_add_f32 v8, v8, v95
    v_cvt_pk_bf16_f32 v111, v94, v95
    v_mul_f32 v215, v215, v40
    v_cvt_pk_bf16_f32 v32, v208, v209
    v_cvt_pk_bf16_f32 v33, v210, v211
    v_cvt_pk_bf16_f32 v34, v212, v213
    v_cvt_pk_bf16_f32 v35, v214, v215
    buffer_store_dwordx4 v[32:35], v2, s[16:19], s46 offen offset:2048 sc1
    v_mov_b64 v[208:209], 0
    v_mov_b64 v[210:211], 0
    v_mov_b64 v[212:213], 0
    v_mov_b64 v[214:215], 0
    v_mul_f32 v216, v216, v40
    v_mul_f32 v217, v217, v40
    v_mul_f32 v218, v218, v40
    v_mul_f32 v219, v219, v40
    v_mul_f32 v220, v220, v40
    v_mul_f32 v221, v221, v40
    v_mul_f32 v222, v222, v40
    v_mul_f32 v223, v223, v40
    v_cvt_pk_bf16_f32 v36, v216, v217
    v_cvt_pk_bf16_f32 v37, v218, v219
    v_cvt_pk_bf16_f32 v38, v220, v221
    v_cvt_pk_bf16_f32 v39, v222, v223
    buffer_store_dwordx4 v[36:39], v2, s[16:19], s46 offen offset:3072 sc1
    v_mov_b64 v[216:217], 0
    v_mov_b64 v[218:219], 0
    v_mov_b64 v[220:221], 0
    v_mov_b64 v[222:223], 0
    v_mov_b32 v6, v19
    v_mov_b64 v[10:11], 0
    s_mov_b32 s35, s52
    s_nop 3
    v_pk_mul_f32 v[224:225], v[224:225], v[42:43] op_sel_hi:[1,0]
    v_pk_mul_f32 v[226:227], v[226:227], v[42:43] op_sel_hi:[1,0]
    v_pk_mul_f32 v[228:229], v[228:229], v[42:43] op_sel_hi:[1,0]
    v_pk_mul_f32 v[230:231], v[230:231], v[42:43] op_sel_hi:[1,0]
    v_cvt_pk_bf16_f32 v32, v224, v225
    v_cvt_pk_bf16_f32 v33, v226, v227
    v_cvt_pk_bf16_f32 v34, v228, v229
    v_cvt_pk_bf16_f32 v35, v230, v231
    buffer_store_dwordx4 v[32:35], v2, s[16:19], s47 offen offset:0 sc1
    v_mov_b64 v[224:225], 0
    v_mov_b64 v[226:227], 0
    v_mov_b64 v[228:229], 0
    v_mov_b64 v[230:231], 0
    v_pk_mul_f32 v[232:233], v[232:233], v[42:43] op_sel_hi:[1,0]
    v_pk_mul_f32 v[234:235], v[234:235], v[42:43] op_sel_hi:[1,0]
    v_pk_mul_f32 v[236:237], v[236:237], v[42:43] op_sel_hi:[1,0]
    v_pk_mul_f32 v[238:239], v[238:239], v[42:43] op_sel_hi:[1,0]
    v_cvt_pk_bf16_f32 v36, v232, v233
    v_cvt_pk_bf16_f32 v37, v234, v235
    v_cvt_pk_bf16_f32 v38, v236, v237
    v_cvt_pk_bf16_f32 v39, v238, v239
    buffer_store_dwordx4 v[36:39], v2, s[16:19], s47 offen offset:1024 sc1
    v_mov_b64 v[232:233], 0
    v_mov_b64 v[234:235], 0
    v_mov_b64 v[236:237], 0
    v_mov_b64 v[238:239], 0
    v_pk_mul_f32 v[240:241], v[240:241], v[42:43] op_sel_hi:[1,0]
    v_pk_mul_f32 v[242:243], v[242:243], v[42:43] op_sel_hi:[1,0]
    v_pk_mul_f32 v[244:245], v[244:245], v[42:43] op_sel_hi:[1,0]
    v_pk_mul_f32 v[246:247], v[246:247], v[42:43] op_sel_hi:[1,0]
    v_cvt_pk_bf16_f32 v32, v240, v241
    v_cvt_pk_bf16_f32 v33, v242, v243
    v_cvt_pk_bf16_f32 v34, v244, v245
    v_cvt_pk_bf16_f32 v35, v246, v247
    buffer_store_dwordx4 v[32:35], v2, s[16:19], s47 offen offset:2048 sc1
    v_mov_b64 v[240:241], 0
    v_mov_b64 v[242:243], 0
    v_mov_b64 v[244:245], 0
    v_mov_b64 v[246:247], 0
    v_pk_mul_f32 v[248:249], v[248:249], v[42:43] op_sel_hi:[1,0]
    v_pk_mul_f32 v[250:251], v[250:251], v[42:43] op_sel_hi:[1,0]
    v_pk_mul_f32 v[252:253], v[252:253], v[42:43] op_sel_hi:[1,0]
    v_pk_mul_f32 v[254:255], v[254:255], v[42:43] op_sel_hi:[1,0]
    v_cvt_pk_bf16_f32 v36, v248, v249
    v_cvt_pk_bf16_f32 v37, v250, v251
    v_cvt_pk_bf16_f32 v38, v252, v253
    v_cvt_pk_bf16_f32 v39, v254, v255
    buffer_store_dwordx4 v[36:39], v2, s[16:19], s47 offen offset:3072 sc1
    v_mov_b64 v[248:249], 0
    v_mov_b64 v[250:251], 0
    v_mov_b64 v[252:253], 0
    v_mov_b64 v[254:255], 0
    s_waitcnt lgkmcnt(0)
    s_barrier
    s_cmp_lg_u32 s35, 0
    s_cbranch_scc1 L_p2
    s_branch L_d2_2
L_d1_3:
    s_waitcnt lgkmcnt(0)
    v_mfma_f32_16x16x32_bf16 v[64:67], a[64:67], a[0:3], v[112:115]
    ds_read_b128 a[124:127], v6 offset:15360
    ds_read_b128 a[120:123], v6 offset:14336
    v_exp_f32 v80, v80
    v_mfma_f32_16x16x32_bf16 v[64:67], a[68:71], a[4:7], v[64:67]
    ds_read_b128 a[116:119], v6 offset:13312
    ds_read_b128 a[112:115], v6 offset:12288
    v_exp_f32 v81, v81
    v_mfma_f32_16x16x32_bf16 v[64:67], a[72:75], a[8:11], v[64:67]
    v_add_f32 v11, v11, v80
    v_add_f32 v11, v11, v81
    v_mfma_f32_16x16x32_bf16 v[64:67], a[76:79], a[12:15], v[64:67]
    v_exp_f32 v82, v82
    v_mfma_f32_16x16x32_bf16 v[68:71], a[92:95], a[12:15], v[112:115]
    v_exp_f32 v83, v83
    v_cvt_pk_bf16_f32 v104, v80, v81
    v_mfma_f32_16x16x32_bf16 v[68:71], a[88:91], a[8:11], v[68:71]
    s_mov_b32 m0, s38
    v_add_f32 v11, v11, v82
    v_mfma_f32_16x16x32_bf16 v[68:71], a[84:87], a[4:7], v[68:71]
    v_add_f32 v11, v11, v83
    v_cvt_pk_bf16_f32 v105, v82, v83
    v_mfma_f32_16x16x32_bf16 v[68:71], a[80:83], a[0:3], v[68:71]
    buffer_load_dwordx4 v2, s[8:11], s36 offen offset:0 sc1 lds
    v_mfma_f32_16x16x32_bf16 v[72:75], a[96:99], a[0:3], v[112:115]
    v_exp_f32 v84, v84
    v_mfma_f32_16x16x32_bf16 v[72:75], a[100:103], a[4:7], v[72:75]
    v_exp_f32 v85, v85
    v_mfma_f32_16x16x32_bf16 v[72:75], a[104:107], a[8:11], v[72:75]
    v_add_f32 v11, v11, v84
    v_add_f32 v11, v11, v85
    v_mfma_f32_16x16x32_bf16 v[72:75], a[108:111], a[12:15], v[72:75]
    v_exp_f32 v86, v86
    s_waitcnt lgkmcnt(0)
    v_mfma_f32_16x16x32_bf16 v[76:79], a[124:127], a[12:15], v[112:115]
    v_exp_f32 v87, v87
    v_mfma_f32_16x16x32_bf16 v[76:79], a[120:123], a[8:11], v[76:79]
    v_cvt_pk_bf16_f32 v106, v84, v85
    v_add_f32 v11, v11, v86
    v_mfma_f32_16x16x32_bf16 v[76:79], a[116:119], a[4:7], v[76:79]
    v_add_f32 v11, v11, v87
    v_cvt_pk_bf16_f32 v107, v86, v87
    v_mfma_f32_16x16x32_bf16 v[76:79], a[112:115], a[0:3], v[76:79]
    v_exp_f32 v88, v88
    v_mfma_f32_16x16x32_bf16 v[192:195], a[128:131], v[96:99], v[192:195]
    buffer_load_dwordx4 v2, s[8:11], s36 offen offset:1024 sc1 lds
    v_mfma_f32_16x16x32_bf16 v[192:195], a[132:135], v[100:103], v[192:195]
    v_exp_f32 v89, v89
    v_mfma_f32_16x16x32_bf16 v[196:199], a[140:143], v[100:103], v[196:199]
    v_add_f32 v11, v11, v88
    v_add_f32 v11, v11, v89
    v_mfma_f32_16x16x32_bf16 v[196:199], a[136:139], v[96:99], v[196:199]
    v_exp_f32 v90, v90
    v_mfma_f32_16x16x32_bf16 v[200:203], a[144:147], v[96:99], v[200:203]
    v_exp_f32 v91, v91
    v_mfma_f32_16x16x32_bf16 v[200:203], a[148:151], v[100:103], v[200:203]
    v_cvt_pk_bf16_f32 v108, v88, v89
    v_add_f32 v11, v11, v90
    v_mfma_f32_16x16x32_bf16 v[204:207], a[156:159], v[100:103], v[204:207]
    v_add_f32 v11, v11, v91
    v_cvt_pk_bf16_f32 v109, v90, v91
    v_mfma_f32_16x16x32_bf16 v[204:207], a[152:155], v[96:99], v[204:207]
    v_exp_f32 v92, v92
    v_mfma_f32_16x16x32_bf16 v[208:211], a[160:163], v[96:99], v[208:211]
    v_exp_f32 v93, v93
    v_mfma_f32_16x16x32_bf16 v[208:211], a[164:167], v[100:103], v[208:211]
    buffer_load_dwordx4 v2, s[8:11], s36 offen offset:2048 sc1 lds
    v_mfma_f32_16x16x32_bf16 v[212:215], a[172:175], v[100:103], v[212:215]
    v_add_f32 v11, v11, v92
    v_add_f32 v11, v11, v93
    v_mfma_f32_16x16x32_bf16 v[212:215], a[168:171], v[96:99], v[212:215]
    v_exp_f32 v94, v94
    v_mfma_f32_16x16x32_bf16 v[216:219], a[176:179], v[96:99], v[216:219]
    v_exp_f32 v95, v95
    v_mfma_f32_16x16x32_bf16 v[216:219], a[180:183], v[100:103], v[216:219]
    v_cvt_pk_bf16_f32 v110, v92, v93
    v_add_f32 v11, v11, v94
    v_mfma_f32_16x16x32_bf16 v[220:223], a[188:191], v[100:103], v[220:223]
    v_add_f32 v11, v11, v95
    v_cvt_pk_bf16_f32 v111, v94, v95
    v_mfma_f32_16x16x32_bf16 v[220:223], a[184:187], v[96:99], v[220:223]
    s_and_b32 s4, s2, 7
    s_mul_i32 s4, s4, 28
    s_lshr_b32 s5, s2, 3
    s_add_u32 s4, s4, s5
    s_sub_u32 s4, s4, 4
    s_cmp_ge_u32 s5, 4
    s_cselect_b32 s4, s4, 0
    s_cselect_b32 s5, 7168, 0
    v_lshrrev_b32 v49, 24, v0
    v_mul_u32_u24 v48, s5, v49
    v_lshl_add_u32 v48, s4, 4, v48
    v_and_b32 v49, 127, v49
    s_lshl_b32 s4, s4, 13
    s_add_u32 s4, s4, 4096
    v_lshl_add_u32 v49, v49, 3, s4
    v_mfma_f32_16x16x32_bf16 v[80:83], a[64:67], a[16:19], v[116:119]
    v_exp_f32 v64, v64
    v_exp_f32 v65, v65
    v_mfma_f32_16x16x32_bf16 v[80:83], a[68:71], a[20:23], v[80:83]
    v_add_f32 v8, v8, v64
    v_add_f32 v8, v8, v65
    v_exp_f32 v66, v66
    v_mfma_f32_16x16x32_bf16 v[80:83], a[72:75], a[24:27], v[80:83]
    s_waitcnt vmcnt(12)
    v_mov_b64 v[44:45], -1
    v_mov_b64 v[46:47], -1
    v_exp_f32 v67, v67
    v_mfma_f32_16x16x32_bf16 v[80:83], a[76:79], a[28:31], v[80:83]
    v_cvt_pk_bf16_f32 v96, v64, v65
    v_add_f32 v8, v8, v66
    v_add_f32 v8, v8, v67
    v_mfma_f32_16x16x32_bf16 v[84:87], a[92:95], a[28:31], v[116:119]
    v_cndmask_b32_e64 v20, v7, v120, s[24:25]
    v_cvt_pk_bf16_f32 v97, v66, v67
    buffer_load_dwordx4 v2, s[8:11], s36 offen offset:3072 sc1 lds
    v_mfma_f32_16x16x32_bf16 v[84:87], a[88:91], a[24:27], v[84:87]
    v_exp_f32 v68, v68
    v_exp_f32 v69, v69
    v_mfma_f32_16x16x32_bf16 v[84:87], a[84:87], a[20:23], v[84:87]
    v_add_f32 v8, v8, v68
    v_add_f32 v8, v8, v69
    v_exp_f32 v70, v70
    v_mfma_f32_16x16x32_bf16 v[84:87], a[80:83], a[16:19], v[84:87]
    v_cndmask_b32_e64 v21, v7, v120, s[26:27]
    v_cndmask_b32_e64 v22, v7, v120, s[28:29]
    v_mfma_f32_16x16x32_bf16 v[88:91], a[96:99], a[16:19], v[116:119]
    v_exp_f32 v71, v71
    v_mfma_f32_16x16x32_bf16 v[88:91], a[100:103], a[20:23], v[88:91]
    v_cvt_pk_bf16_f32 v98, v68, v69
    v_add_f32 v8, v8, v70
    v_mfma_f32_16x16x32_bf16 v[88:91], a[104:107], a[24:27], v[88:91]
    v_add_f32 v8, v8, v71
    v_cvt_pk_bf16_f32 v99, v70, v71
    v_mfma_f32_16x16x32_bf16 v[88:91], a[108:111], a[28:31], v[88:91]
    v_exp_f32 v72, v72
    v_mfma_f32_16x16x32_bf16 v[92:95], a[124:127], a[28:31], v[116:119]
    v_cndmask_b32_e64 v23, v7, v120, s[30:31]
    s_add_u32 m0, s38, 4096
    v_mfma_f32_16x16x32_bf16 v[92:95], a[120:123], a[24:27], v[92:95]
    buffer_load_dwordx4 v3, s[8:11], s36 offen offset:0 sc1 lds
    v_mfma_f32_16x16x32_bf16 v[92:95], a[116:119], a[20:23], v[92:95]
    v_exp_f32 v73, v73
    v_mfma_f32_16x16x32_bf16 v[92:95], a[112:115], a[16:19], v[92:95]
    v_add_f32 v8, v8, v72
    v_add_f32 v8, v8, v73
    v_mfma_f32_16x16x32_bf16 v[224:227], a[128:131], v[104:107], v[224:227]
    v_exp_f32 v74, v74
    v_mfma_f32_16x16x32_bf16 v[224:227], a[132:135], v[108:111], v[224:227]
    ds_read_b128 a[128:131], v6 offset:16384
    ds_read_b128 a[132:135], v6 offset:17408
    v_mfma_f32_16x16x32_bf16 v[228:231], a[140:143], v[108:111], v[228:231]
    v_exp_f32 v75, v75
    v_mfma_f32_16x16x32_bf16 v[228:231], a[136:139], v[104:107], v[228:231]
    ds_read_b128 a[140:143], v6 offset:19456
    ds_read_b128 a[136:139], v6 offset:18432
    v_mfma_f32_16x16x32_bf16 v[232:235], a[144:147], v[104:107], v[232:235]
    ds_read_b128 a[144:147], v6 offset:20480
    v_cvt_pk_bf16_f32 v100, v72, v73
    v_mfma_f32_16x16x32_bf16 v[232:235], a[148:151], v[108:111], v[232:235]
    ds_read_b128 a[148:151], v6 offset:21504
    v_add_f32 v8, v8, v74
    v_mfma_f32_16x16x32_bf16 v[236:239], a[156:159], v[108:111], v[236:239]
    buffer_load_dwordx4 v3, s[8:11], s36 offen offset:1024 sc1 lds
    v_mfma_f32_16x16x32_bf16 v[236:239], a[152:155], v[104:107], v[236:239]
    ds_read_b128 a[156:159], v6 offset:23552
    ds_read_b128 a[152:155], v6 offset:22528
    v_mfma_f32_16x16x32_bf16 v[240:243], a[160:163], v[104:107], v[240:243]
    v_add_f32 v8, v8, v75
    v_cvt_pk_bf16_f32 v101, v74, v75
    v_mfma_f32_16x16x32_bf16 v[240:243], a[164:167], v[108:111], v[240:243]
    v_exp_f32 v76, v76
    v_mfma_f32_16x16x32_bf16 v[244:247], a[172:175], v[108:111], v[244:247]
    v_exp_f32 v77, v77
    v_mfma_f32_16x16x32_bf16 v[244:247], a[168:171], v[104:107], v[244:247]
    v_add_f32 v8, v8, v76
    v_add_f32 v8, v8, v77
    v_mfma_f32_16x16x32_bf16 v[248:251], a[176:179], v[104:107], v[248:251]
    v_exp_f32 v78, v78
    v_mfma_f32_16x16x32_bf16 v[248:251], a[180:183], v[108:111], v[248:251]
    v_exp_f32 v79, v79
    v_mfma_f32_16x16x32_bf16 v[252:255], a[188:191], v[108:111], v[252:255]
    v_cvt_pk_bf16_f32 v102, v76, v77
    v_add_f32 v8, v8, v78
    v_mfma_f32_16x16x32_bf16 v[252:255], a[184:187], v[104:107], v[252:255]
    v_add_f32 v8, v8, v79
    v_cvt_pk_bf16_f32 v103, v78, v79
    v_mfma_f32_16x16x32_bf16 v[64:67], a[64:67], a[32:35], v[120:123]
    buffer_load_dwordx4 v3, s[8:11], s36 offen offset:2048 sc1 lds
    v_exp_f32 v80, v80
    v_mfma_f32_16x16x32_bf16 v[64:67], a[68:71], a[36:39], v[64:67]
    ds_read_b128 a[160:163], v6 offset:24576
    buffer_load_dwordx4 v3, s[8:11], s36 offen offset:3072 sc1 lds
    s_add_u32 s36, s36, s53
    v_mfma_f32_16x16x32_bf16 v[64:67], a[72:75], a[40:43], v[64:67]
    ds_read_b128 a[164:167], v6 offset:25600
    ds_read_b128 a[172:175], v6 offset:27648
    v_exp_f32 v81, v81
    v_mfma_f32_16x16x32_bf16 v[64:67], a[76:79], a[44:47], v[64:67]
    ds_read_b128 a[168:171], v6 offset:26624
    v_add_f32 v9, v9, v80
    v_add_f32 v9, v9, v81
    v_mfma_f32_16x16x32_bf16 v[68:71], a[92:95], a[44:47], v[120:123]
    v_exp_f32 v82, v82
    v_mfma_f32_16x16x32_bf16 v[68:71], a[88:91], a[40:43], v[68:71]
    ds_read_b128 a[176:179], v6 offset:28672
    ds_read_b128 a[180:183], v6 offset:29696
    v_mfma_f32_16x16x32_bf16 v[68:71], a[84:87], a[36:39], v[68:71]
    ds_read_b128 a[188:191], v6 offset:31744
    ds_read_b128 a[184:187], v6 offset:30720
    v_mfma_f32_16x16x32_bf16 v[68:71], a[80:83], a[32:35], v[68:71]
    v_exp_f32 v83, v83
    v_mfma_f32_16x16x32_bf16 v[72:75], a[96:99], a[32:35], v[120:123]
    v_cvt_pk_bf16_f32 v104, v80, v81
    v_add_f32 v9, v9, v82
    v_mfma_f32_16x16x32_bf16 v[72:75], a[100:103], a[36:39], v[72:75]
    v_add_f32 v9, v9, v83
    v_cvt_pk_bf16_f32 v105, v82, v83
    v_mfma_f32_16x16x32_bf16 v[72:75], a[104:107], a[40:43], v[72:75]
    v_exp_f32 v84, v84
    v_mfma_f32_16x16x32_bf16 v[72:75], a[108:111], a[44:47], v[72:75]
    v_exp_f32 v85, v85
    v_mfma_f32_16x16x32_bf16 v[76:79], a[124:127], a[44:47], v[20:23]
    global_load_dwordx4 a[224:227], v48, s[56:57] offset:0
    v_mfma_f32_16x16x32_bf16 v[76:79], a[120:123], a[40:43], v[76:79]
    v_add_f32 v9, v9, v84
    v_add_f32 v9, v9, v85
    v_mfma_f32_16x16x32_bf16 v[76:79], a[116:119], a[36:39], v[76:79]
    v_exp_f32 v86, v86
    v_mfma_f32_16x16x32_bf16 v[76:79], a[112:115], a[32:35], v[76:79]
    v_exp_f32 v87, v87
    s_waitcnt lgkmcnt(0)
    v_mfma_f32_16x16x32_bf16 v[128:131], a[128:131], v[96:99], v[128:131]
    v_cvt_pk_bf16_f32 v106, v84, v85
    v_add_f32 v9, v9, v86
    v_mfma_f32_16x16x32_bf16 v[128:131], a[132:135], v[100:103], v[128:131]
    v_add_f32 v9, v9, v87
    v_cvt_pk_bf16_f32 v107, v86, v87
    v_mfma_f32_16x16x32_bf16 v[132:135], a[140:143], v[100:103], v[132:135]
    v_exp_f32 v88, v88
    v_mfma_f32_16x16x32_bf16 v[132:135], a[136:139], v[96:99], v[132:135]
    v_exp_f32 v89, v89
    v_mfma_f32_16x16x32_bf16 v[136:139], a[144:147], v[96:99], v[136:139]
    v_add_f32 v9, v9, v88
    v_add_f32 v9, v9, v89
    v_mfma_f32_16x16x32_bf16 v[136:139], a[148:151], v[100:103], v[136:139]
    v_exp_f32 v90, v90
    v_mfma_f32_16x16x32_bf16 v[140:143], a[156:159], v[100:103], v[140:143]
    v_exp_f32 v91, v91
    v_mfma_f32_16x16x32_bf16 v[140:143], a[152:155], v[96:99], v[140:143]
    v_cvt_pk_bf16_f32 v108, v88, v89
    v_add_f32 v9, v9, v90
    v_mfma_f32_16x16x32_bf16 v[144:147], a[160:163], v[96:99], v[144:147]
    v_add_f32 v9, v9, v91
    v_cvt_pk_bf16_f32 v109, v90, v91
    v_mfma_f32_16x16x32_bf16 v[144:147], a[164:167], v[100:103], v[144:147]
    v_exp_f32 v92, v92
    v_mfma_f32_16x16x32_bf16 v[148:151], a[172:175], v[100:103], v[148:151]
    v_exp_f32 v93, v93
    v_mfma_f32_16x16x32_bf16 v[148:151], a[168:171], v[96:99], v[148:151]
    v_add_f32 v9, v9, v92
    v_add_f32 v9, v9, v93
    v_mfma_f32_16x16x32_bf16 v[152:155], a[176:179], v[96:99], v[152:155]
    v_exp_f32 v94, v94
    v_mfma_f32_16x16x32_bf16 v[152:155], a[180:183], v[100:103], v[152:155]
    v_exp_f32 v95, v95
    v_mfma_f32_16x16x32_bf16 v[156:159], a[188:191], v[100:103], v[156:159]
    v_cvt_pk_bf16_f32 v110, v92, v93
    v_add_f32 v9, v9, v94
    v_mfma_f32_16x16x32_bf16 v[156:159], a[184:187], v[96:99], v[156:159]
    v_add_f32 v9, v9, v95
    v_cvt_pk_bf16_f32 v111, v94, v95
    s_waitcnt vmcnt(19)
    s_barrier
    v_mfma_f32_16x16x32_bf16 v[80:83], a[64:67], a[48:51], v[124:127]
    v_exp_f32 v64, v64
    v_exp_f32 v65, v65
    v_mfma_f32_16x16x32_bf16 v[80:83], a[68:71], a[52:55], v[80:83]
    v_add_f32 v10, v10, v64
    v_add_f32 v10, v10, v65
    v_exp_f32 v66, v66
    v_mfma_f32_16x16x32_bf16 v[80:83], a[72:75], a[56:59], v[80:83]
    ds_read_b128 a[64:67], v6 offset:32768
    global_load_dwordx2 a[240:241], v49, s[60:61] offset:-4096
    v_mfma_f32_16x16x32_bf16 v[80:83], a[76:79], a[60:63], v[80:83]
    ds_read_b128 a[68:71], v6 offset:33792
    ds_read_b128 a[72:75], v6 offset:34816
    v_exp_f32 v67, v67
    v_mfma_f32_16x16x32_bf16 v[84:87], a[92:95], a[60:63], v[124:127]
    ds_read_b128 a[32:35], v18 offset:0
    global_load_dwordx2 a[242:243], v49, s[60:61] offset:-3072
    v_mfma_f32_16x16x32_bf16 v[84:87], a[88:91], a[56:59], v[84:87]
    ds_read_b128 a[36:39], v18 offset:1024
    v_cvt_pk_bf16_f32 v96, v64, v65
    v_add_f32 v10, v10, v66
    v_mfma_f32_16x16x32_bf16 v[84:87], a[84:87], a[52:55], v[84:87]
    v_add_f32 v10, v10, v67
    v_cvt_pk_bf16_f32 v97, v66, v67
    v_exp_f32 v68, v68
    v_mfma_f32_16x16x32_bf16 v[84:87], a[80:83], a[48:51], v[84:87]
    ds_read_b128 a[40:43], v18 offset:2048
    global_load_dwordx2 a[244:245], v49, s[60:61] offset:-2048
    v_mfma_f32_16x16x32_bf16 v[88:91], a[96:99], a[48:51], v[124:127]
    ds_read_b128 a[44:47], v18 offset:3072
    v_mov_b32 v120, v12
    v_exp_f32 v69, v69
    v_mfma_f32_16x16x32_bf16 v[88:91], a[100:103], a[52:55], v[88:91]
    v_mov_b32 v121, v12
    global_load_dwordx2 a[246:247], v49, s[60:61] offset:-1024
    v_mfma_f32_16x16x32_bf16 v[88:91], a[104:107], a[56:59], v[88:91]
    v_add_f32 v10, v10, v68
    v_add_f32 v10, v10, v69
    v_exp_f32 v70, v70
    v_mfma_f32_16x16x32_bf16 v[88:91], a[108:111], a[60:63], v[88:91]
    v_mov_b32 v122, v12
    v_mov_b32 v123, v12
    v_exp_f32 v71, v71
    v_mfma_f32_16x16x32_bf16 v[92:95], a[124:127], a[60:63], v[124:127]
    v_cndmask_b32_e64 v20, v7, v124, s[24:25]
    global_load_dwordx2 a[248:249], v49, s[60:61] offset:0
    v_mfma_f32_16x16x32_bf16 v[92:95], a[120:123], a[56:59], v[92:95]
    v_cndmask_b32_e64 v21, v7, v124, s[26:27]
    v_cndmask_b32_e64 v22, v7, v124, s[28:29]
    v_cvt_pk_bf16_f32 v98, v68, v69
    v_mfma_f32_16x16x32_bf16 v[92:95], a[116:119], a[52:55], v[92:95]
    v_add_f32 v10, v10, v70
    global_load_dwordx2 a[250:251], v49, s[60:61] offset:1024
    v_mfma_f32_16x16x32_bf16 v[92:95], a[112:115], a[48:51], v[92:95]
    v_add_f32 v10, v10, v71
    v_cvt_pk_bf16_f32 v99, v70, v71
    v_exp_f32 v72, v72
    v_mfma_f32_16x16x32_bf16 v[160:163], a[128:131], v[104:107], v[160:163]
    v_cndmask_b32_e64 v23, v7, v124, s[30:31]
    ds_read_b128 a[76:79], v6 offset:35840
    v_exp_f32 v73, v73
    v_mfma_f32_16x16x32_bf16 v[160:163], a[132:135], v[108:111], v[160:163]
    ds_read_b128 a[92:95], v6 offset:39936
    global_load_dwordx2 a[252:253], v49, s[60:61] offset:2048
    v_mfma_f32_16x16x32_bf16 v[164:167], a[140:143], v[108:111], v[164:167]
    v_add_f32 v10, v10, v72
    v_add_f32 v10, v10, v73
    v_exp_f32 v74, v74
    v_mfma_f32_16x16x32_bf16 v[164:167], a[136:139], v[104:107], v[164:167]
    ds_read_b128 a[88:91], v6 offset:38912
    global_load_dwordx2 a[254:255], v49, s[60:61] offset:3072
    v_mfma_f32_16x16x32_bf16 v[168:171], a[144:147], v[104:107], v[168:171]
    ds_read_b128 a[84:87], v6 offset:37888
    ds_read_b128 a[80:83], v6 offset:36864
    v_exp_f32 v75, v75
    v_mfma_f32_16x16x32_bf16 v[168:171], a[148:151], v[108:111], v[168:171]
    ds_read_b128 a[96:99], v6 offset:40960
    ds_read_b128 a[100:103], v6 offset:41984
    v_cvt_pk_bf16_f32 v100, v72, v73
    v_mfma_f32_16x16x32_bf16 v[172:175], a[156:159], v[108:111], v[172:175]
    v_add_f32 v10, v10, v74
    v_add_f32 v10, v10, v75
    v_cvt_pk_bf16_f32 v101, v74, v75
    v_mfma_f32_16x16x32_bf16 v[172:175], a[152:155], v[104:107], v[172:175]
    v_exp_f32 v76, v76
    v_mfma_f32_16x16x32_bf16 v[176:179], a[160:163], v[104:107], v[176:179]
    global_load_dwordx4 a[228:231], v48, s[56:57] offset:3584
    v_mfma_f32_16x16x32_bf16 v[176:179], a[164:167], v[108:111], v[176:179]
    ds_read_b128 a[104:107], v6 offset:43008
    ds_read_b128 a[108:111], v6 offset:44032
    v_mfma_f32_16x16x32_bf16 v[180:183], a[172:175], v[108:111], v[180:183]
    v_exp_f32 v77, v77
    v_mfma_f32_16x16x32_bf16 v[180:183], a[168:171], v[104:107], v[180:183]
    v_add_f32 v10, v10, v76
    v_add_f32 v10, v10, v77
    v_mfma_f32_16x16x32_bf16 v[184:187], a[176:179], v[104:107], v[184:187]
    v_exp_f32 v78, v78
    v_mfma_f32_16x16x32_bf16 v[184:187], a[180:183], v[108:111], v[184:187]
    v_exp_f32 v79, v79
    v_mfma_f32_16x16x32_bf16 v[188:191], a[188:191], v[108:111], v[188:191]
    v_cvt_pk_bf16_f32 v102, v76, v77
    v_add_f32 v10, v10, v78
    v_mfma_f32_16x16x32_bf16 v[188:191], a[184:187], v[104:107], v[188:191]
    v_add_f32 v10, v10, v79
    v_cvt_pk_bf16_f32 v103, v78, v79
    s_waitcnt lgkmcnt(1)
    v_mfma_f32_16x16x32_bf16 v[64:67], a[64:67], a[48:51], v[20:23]
    ds_read_b128 a[124:127], v6 offset:48128
    ds_read_b128 a[120:123], v6 offset:47104
    v_exp_f32 v80, v80
    v_mfma_f32_16x16x32_bf16 v[64:67], a[68:71], a[52:55], v[64:67]
    ds_read_b128 a[116:119], v6 offset:46080
    ds_read_b128 a[112:115], v6 offset:45056
    v_exp_f32 v81, v81
    v_mfma_f32_16x16x32_bf16 v[64:67], a[72:75], a[56:59], v[64:67]
    v_mov_b32 v41, v10
    s_mov_b32 s3, s55
    buffer_store_dwordx4 v[44:47], v63, s[16:19], s3 offen sc1
    v_mfma_f32_16x16x32_bf16 v[64:67], a[76:79], a[60:63], v[64:67]
    v_add_f32 v11, v11, v80
    v_add_f32 v11, v11, v81
    v_exp_f32 v82, v82
    v_mfma_f32_16x16x32_bf16 v[192:195], a[128:131], v[96:99], v[192:195]
    s_nop 1
    v_permlane16_swap_b32 v10, v41
    v_exp_f32 v83, v83
    v_mfma_f32_16x16x32_bf16 v[192:195], a[132:135], v[100:103], v[192:195]
    v_add_f32 v10, v10, v41
    s_xor_b32 s3, s55, 0x10000
    buffer_store_dwordx4 v[44:47], v63, s[16:19], s3 offen sc1
    v_mfma_f32_16x16x32_bf16 v[196:199], a[140:143], v[100:103], v[196:199]
    v_mov_b32 v41, v10
    v_cvt_pk_bf16_f32 v104, v80, v81
    v_add_f32 v11, v11, v82
    v_mfma_f32_16x16x32_bf16 v[196:199], a[136:139], v[96:99], v[196:199]
    v_add_f32 v11, v11, v83
    v_cvt_pk_bf16_f32 v105, v82, v83
    v_exp_f32 v84, v84
    v_mfma_f32_16x16x32_bf16 v[200:203], a[144:147], v[96:99], v[200:203]
    s_nop 1
    s_xor_b32 s3, s55, 0x20000
    buffer_store_dwordx4 v[44:47], v63, s[16:19], s3 offen sc1
    v_mfma_f32_16x16x32_bf16 v[200:203], a[148:151], v[100:103], v[200:203]
    v_permlane32_swap_b32 v10, v41
    v_add_f32 v10, v10, v41
    v_exp_f32 v85, v85
    v_mfma_f32_16x16x32_bf16 v[204:207], a[156:159], v[100:103], v[204:207]
    v_add_f32 v11, v11, v84
    v_add_f32 v11, v11, v85
    v_rcp_f32 v40, v10
    v_mfma_f32_16x16x32_bf16 v[204:207], a[152:155], v[96:99], v[204:207]
    v_cmp_nge_f32 vcc, 0x5f800000, v10
    s_xor_b32 s3, s55, 0x30000
    buffer_store_dwordx4 v[44:47], v63, s[16:19], s3 offen sc1
    v_mfma_f32_16x16x32_bf16 v[208:211], a[160:163], v[96:99], v[208:211]
    v_exp_f32 v86, v86
    v_exp_f32 v87, v87
    v_mfma_f32_16x16x32_bf16 v[208:211], a[164:167], v[100:103], v[208:211]
    s_or_b64 s[50:51], s[50:51], vcc
    v_cvt_pk_bf16_f32 v106, v84, v85
    v_add_f32 v11, v11, v86
    v_mfma_f32_16x16x32_bf16 v[212:215], a[172:175], v[100:103], v[212:215]
    v_add_f32 v11, v11, v87
    v_cvt_pk_bf16_f32 v107, v86, v87
    v_exp_f32 v88, v88
    v_mfma_f32_16x16x32_bf16 v[212:215], a[168:171], v[96:99], v[212:215]
    v_exp_f32 v89, v89
    v_add_f32 v11, v11, v88
    v_mfma_f32_16x16x32_bf16 v[216:219], a[176:179], v[96:99], v[216:219]
    global_load_dwordx4 a[232:235], v48, s[58:59] offset:0
    v_mfma_f32_16x16x32_bf16 v[216:219], a[180:183], v[100:103], v[216:219]
    v_add_f32 v11, v11, v89
    v_exp_f32 v90, v90
    v_mfma_f32_16x16x32_bf16 v[220:223], a[188:191], v[100:103], v[220:223]
    v_exp_f32 v91, v91
    v_cvt_pk_bf16_f32 v108, v88, v89
    v_mfma_f32_16x16x32_bf16 v[220:223], a[184:187], v[96:99], v[220:223]
    v_add_f32 v11, v11, v90
    v_add_f32 v11, v11, v91
    v_cvt_pk_bf16_f32 v109, v90, v91
    v_exp_f32 v92, v92
    v_exp_f32 v93, v93
    v_add_f32 v11, v11, v92
    v_add_f32 v11, v11, v93
    v_exp_f32 v94, v94
    v_exp_f32 v95, v95
    v_cvt_pk_bf16_f32 v110, v92, v93
    v_add_f32 v11, v11, v94
    v_add_f32 v11, v11, v95
    v_cvt_pk_bf16_f32 v111, v94, v95
    v_mfma_f32_16x16x32_bf16 v[80:83], a[64:67], a[0:3], v[112:115]
    v_exp_f32 v64, v64
    v_exp_f32 v65, v65
    v_mfma_f32_16x16x32_bf16 v[80:83], a[68:71], a[4:7], v[80:83]
    v_add_f32 v11, v11, v64
    v_add_f32 v11, v11, v65
    v_exp_f32 v66, v66
    v_mfma_f32_16x16x32_bf16 v[80:83], a[72:75], a[8:11], v[80:83]
    ds_read_b128 a[48:51], v18 offset:4096
    s_xor_b32 s3, s55, 0x780000
    buffer_store_dwordx4 v[44:47], v63, s[16:19], s3 offen sc1
    v_mfma_f32_16x16x32_bf16 v[80:83], a[76:79], a[12:15], v[80:83]
    ds_read_b128 a[52:55], v18 offset:5120
    ds_read_b128 a[56:59], v18 offset:6144
    v_exp_f32 v67, v67
    v_mfma_f32_16x16x32_bf16 v[84:87], a[92:95], a[12:15], v[112:115]
    ds_read_b128 a[60:63], v18 offset:7168
    v_mov_b32 v124, v13
    v_mov_b32 v125, v13
    v_mfma_f32_16x16x32_bf16 v[84:87], a[88:91], a[8:11], v[84:87]
    v_mul_f32 v192, v192, v40
    v_mul_f32 v193, v193, v40
    v_mul_f32 v194, v194, v40
    v_mfma_f32_16x16x32_bf16 v[84:87], a[84:87], a[4:7], v[84:87]
    v_mul_f32 v195, v195, v40
    s_xor_b32 s3, s55, 0x790000
    buffer_store_dwordx4 v[44:47], v63, s[16:19], s3 offen sc1
    v_mfma_f32_16x16x32_bf16 v[84:87], a[80:83], a[0:3], v[84:87]
    v_mul_f32 v196, v196, v40
    v_mul_f32 v197, v197, v40
    v_mul_f32 v198, v198, v40
    v_mfma_f32_16x16x32_bf16 v[88:91], a[96:99], a[0:3], v[112:115]
    v_mul_f32 v199, v199, v40
    v_cvt_pk_bf16_f32 v32, v192, v193
    v_cvt_pk_bf16_f32 v33, v194, v195
    v_mfma_f32_16x16x32_bf16 v[88:91], a[100:103], a[4:7], v[88:91]
    v_cvt_pk_bf16_f32 v34, v196, v197
    v_cvt_pk_bf16_f32 v35, v198, v199
    v_mfma_f32_16x16x32_bf16 v[88:91], a[104:107], a[8:11], v[88:91]
    buffer_store_dwordx4 v[32:35], v2, s[16:19], s46 offen offset:0 sc1
    v_mov_b64 v[192:193], 0
    s_waitcnt lgkmcnt(0)
    v_mfma_f32_16x16x32_bf16 v[88:91], a[108:111], a[12:15], v[88:91]
    s_xor_b32 s3, s55, 0x7a0000
    buffer_store_dwordx4 v[44:47], v63, s[16:19], s3 offen sc1
    v_mfma_f32_16x16x32_bf16 v[92:95], a[124:127], a[12:15], v[112:115]
    v_mov_b64 v[194:195], 0
    v_mov_b64 v[196:197], 0
    v_mfma_f32_16x16x32_bf16 v[92:95], a[120:123], a[8:11], v[92:95]
    v_mov_b64 v[198:199], 0
    v_mul_f32 v200, v200, v40
    v_mfma_f32_16x16x32_bf16 v[92:95], a[116:119], a[4:7], v[92:95]
    v_mul_f32 v201, v201, v40
    v_mul_f32 v202, v202, v40
    v_mfma_f32_16x16x32_bf16 v[92:95], a[112:115], a[0:3], v[92:95]
    s_xor_b32 s3, s55, 0x7b0000
    buffer_store_dwordx4 v[44:47], v63, s[16:19], s3 offen sc1
    v_mfma_f32_16x16x32_bf16 v[224:227], a[128:131], v[104:107], v[224:227]
    v_mul_f32 v203, v203, v40
    v_mul_f32 v204, v204, v40
    v_mfma_f32_16x16x32_bf16 v[224:227], a[132:135], v[108:111], v[224:227]
    v_mul_f32 v205, v205, v40
    v_mul_f32 v206, v206, v40
    v_mfma_f32_16x16x32_bf16 v[228:231], a[140:143], v[108:111], v[228:231]
    v_mul_f32 v207, v207, v40
    v_cvt_pk_bf16_f32 v36, v200, v201
    v_mfma_f32_16x16x32_bf16 v[228:231], a[136:139], v[104:107], v[228:231]
    v_cvt_pk_bf16_f32 v37, v202, v203
    ds_read_b128 a[128:131], v6 offset:49152
    v_mfma_f32_16x16x32_bf16 v[232:235], a[144:147], v[104:107], v[232:235]
    v_cvt_pk_bf16_f32 v38, v204, v205
    ds_read_b128 a[132:135], v6 offset:50176
    v_mfma_f32_16x16x32_bf16 v[232:235], a[148:151], v[108:111], v[232:235]
    v_cvt_pk_bf16_f32 v39, v206, v207
    ds_read_b128 a[140:143], v6 offset:52224
    v_mfma_f32_16x16x32_bf16 v[236:239], a[156:159], v[108:111], v[236:239]
    buffer_store_dwordx4 v[36:39], v2, s[16:19], s46 offen offset:1024 sc1
    ds_read_b128 a[136:139], v6 offset:51200
    v_mfma_f32_16x16x32_bf16 v[236:239], a[152:155], v[104:107], v[236:239]
    v_mov_b64 v[200:201], 0
    ds_read_b128 a[144:147], v6 offset:53248
    v_mfma_f32_16x16x32_bf16 v[240:243], a[160:163], v[104:107], v[240:243]
    v_mov_b64 v[202:203], 0
    ds_read_b128 a[148:151], v6 offset:54272
    v_mfma_f32_16x16x32_bf16 v[240:243], a[164:167], v[108:111], v[240:243]
    v_mov_b64 v[204:205], 0
    ds_read_b128 a[156:159], v6 offset:56320
    v_mfma_f32_16x16x32_bf16 v[244:247], a[172:175], v[108:111], v[244:247]
    v_mov_b64 v[206:207], 0
    ds_read_b128 a[152:155], v6 offset:55296
    v_mfma_f32_16x16x32_bf16 v[244:247], a[168:171], v[104:107], v[244:247]
    v_mov_b32 v126, v13
    v_mov_b32 v127, v13
    v_mfma_f32_16x16x32_bf16 v[248:251], a[176:179], v[104:107], v[248:251]
    global_load_dwordx4 a[236:239], v48, s[58:59] offset:3584
    v_mfma_f32_16x16x32_bf16 v[248:251], a[180:183], v[108:111], v[248:251]
    v_cvt_pk_bf16_f32 v96, v64, v65
    v_add_f32 v11, v11, v66
    v_mfma_f32_16x16x32_bf16 v[252:255], a[188:191], v[108:111], v[252:255]
    v_add_f32 v11, v11, v67
    v_cvt_pk_bf16_f32 v97, v66, v67
    v_mfma_f32_16x16x32_bf16 v[252:255], a[184:187], v[104:107], v[252:255]
    v_mov_b64 v[98:99], 0
    s_waitcnt vmcnt(22)
    s_barrier
    v_xor_b32 v19, s39, v6
    v_mfma_f32_16x16x32_bf16 v[64:67], a[64:67], a[16:19], v[116:119]
    v_mul_f32 v208, v208, v40
    v_mul_f32 v209, v209, v40
    buffer_store_dwordx2 v[50:51], v52, s[20:23], s78 offen sc1
    v_mfma_f32_16x16x32_bf16 v[64:67], a[68:71], a[20:23], v[64:67]
    v_mul_f32 v210, v210, v40
    v_mul_f32 v211, v211, v40
    v_exp_f32 v80, v80
    v_mfma_f32_16x16x32_bf16 v[64:67], a[72:75], a[24:27], v[64:67]
    v_cndmask_b32_e64 v20, v7, v112, s[24:25]
    v_cndmask_b32_e64 v21, v7, v112, s[26:27]
    v_exp_f32 v81, v81
    v_mfma_f32_16x16x32_bf16 v[64:67], a[76:79], a[28:31], v[64:67]
    s_mov_b32 m0, s37
    ds_read_b128 a[160:163], v6 offset:57344
    buffer_load_dwordx4 v2, s[8:11], s36 offen offset:0 sc1 lds
    v_mfma_f32_16x16x32_bf16 v[68:71], a[92:95], a[28:31], v[116:119]
    ds_read_b128 a[164:167], v6 offset:58368
    ds_read_b128 a[168:171], v6 offset:59392
    buffer_load_dwordx4 v2, s[8:11], s36 offen offset:1024 sc1 lds
    v_mfma_f32_16x16x32_bf16 v[68:71], a[88:91], a[24:27], v[68:71]
    v_add_f32 v8, v8, v80
    v_add_f32 v8, v8, v81
    v_exp_f32 v82, v82
    v_mfma_f32_16x16x32_bf16 v[68:71], a[84:87], a[20:23], v[68:71]
    ds_read_b128 a[172:175], v6 offset:60416
    ds_read_b128 a[176:179], v6 offset:61440
    buffer_load_dwordx4 v2, s[8:11], s36 offen offset:2048 sc1 lds
    v_mfma_f32_16x16x32_bf16 v[68:71], a[80:83], a[16:19], v[68:71]
    ds_read_b128 a[180:183], v6 offset:62464
    ds_read_b128 a[64:67], v19 offset:0
    v_exp_f32 v83, v83
    v_mfma_f32_16x16x32_bf16 v[72:75], a[96:99], a[16:19], v[116:119]
    v_cvt_pk_bf16_f32 v104, v80, v81
    v_add_f32 v8, v8, v82
    buffer_load_dwordx4 v2, s[8:11], s36 offen offset:3072 sc1 lds
    v_mfma_f32_16x16x32_bf16 v[72:75], a[100:103], a[20:23], v[72:75]
    v_add_f32 v8, v8, v83
    v_cvt_pk_bf16_f32 v105, v82, v83
    v_exp_f32 v84, v84
    v_mfma_f32_16x16x32_bf16 v[72:75], a[104:107], a[24:27], v[72:75]
    ds_read_b128 a[184:187], v6 offset:63488
    ds_read_b128 a[188:191], v6 offset:64512
    ds_read_b128 a[68:71], v19 offset:1024
    v_mfma_f32_16x16x32_bf16 v[72:75], a[108:111], a[28:31], v[72:75]
    v_cndmask_b32_e64 v22, v7, v112, s[28:29]
    ds_read_b128 a[72:75], v19 offset:2048
    v_exp_f32 v85, v85
    v_mfma_f32_16x16x32_bf16 v[76:79], a[124:127], a[28:31], v[116:119]
    s_add_u32 m0, s37, 4096
    ds_read_b128 a[76:79], v19 offset:3072
    buffer_load_dwordx4 v3, s[8:11], s36 offen offset:0 sc1 lds
    v_mfma_f32_16x16x32_bf16 v[76:79], a[120:123], a[24:27], v[76:79]
    ds_read_b128 a[92:95], v19 offset:7168
    ds_read_b128 a[88:91], v19 offset:6144
    buffer_load_dwordx4 v3, s[8:11], s36 offen offset:1024 sc1 lds
    v_mfma_f32_16x16x32_bf16 v[76:79], a[116:119], a[20:23], v[76:79]
    v_add_f32 v8, v8, v84
    v_add_f32 v8, v8, v85
    v_exp_f32 v86, v86
    v_mfma_f32_16x16x32_bf16 v[76:79], a[112:115], a[16:19], v[76:79]
    v_cndmask_b32_e64 v23, v7, v112, s[30:31]
    ds_read_b128 a[84:87], v19 offset:5120
    buffer_load_dwordx4 v3, s[8:11], s36 offen offset:2048 sc1 lds
    s_waitcnt lgkmcnt(5)
    v_mfma_f32_16x16x32_bf16 v[224:227], a[128:131], v[96:99], v[224:227]
    v_mov_b32 v43, v11
    ds_read_b128 a[80:83], v19 offset:4096
    v_exp_f32 v87, v87
    v_mfma_f32_16x16x32_bf16 v[228:231], a[136:139], v[96:99], v[228:231]
    s_nop 1
    ds_read_b128 a[96:99], v19 offset:8192
    buffer_load_dwordx4 v3, s[8:11], s36 offen offset:3072 sc1 lds
    v_mfma_f32_16x16x32_bf16 v[232:235], a[144:147], v[96:99], v[232:235]
    v_permlane16_swap_b32 v11, v43
    v_add_f32 v11, v11, v43
    ds_read_b128 a[100:103], v19 offset:9216
    v_mfma_f32_16x16x32_bf16 v[236:239], a[152:155], v[96:99], v[236:239]
    v_mov_b32 v43, v11
    s_nop 1
    ds_read_b128 a[104:107], v19 offset:10240
    v_mfma_f32_16x16x32_bf16 v[240:243], a[160:163], v[96:99], v[240:243]
    v_permlane32_swap_b32 v11, v43
    v_add_f32 v11, v11, v43
    ds_read_b128 a[108:111], v19 offset:11264
    v_mfma_f32_16x16x32_bf16 v[244:247], a[168:171], v[96:99], v[244:247]
    v_mul_f32 v212, v212, v40
    v_mul_f32 v213, v213, v40
    v_rcp_f32 v42, v11
    v_mfma_f32_16x16x32_bf16 v[248:251], a[176:179], v[96:99], v[248:251]
    v_cmp_nge_f32 vcc, 0x5f800000, v11
    s_or_b64 s[50:51], s[50:51], vcc
    v_mul_f32 v214, v214, v40
    v_mfma_f32_16x16x32_bf16 v[252:255], a[184:187], v[96:99], v[252:255]
    v_cvt_pk_bf16_f32 v106, v84, v85
    v_add_f32 v8, v8, v86
    v_add_f32 v8, v8, v87
    v_cvt_pk_bf16_f32 v107, v86, v87
    v_exp_f32 v88, v88
    v_exp_f32 v89, v89
    v_add_f32 v8, v8, v88
    v_add_f32 v8, v8, v89
    v_exp_f32 v90, v90
    v_exp_f32 v91, v91
    v_cvt_pk_bf16_f32 v108, v88, v89
    v_add_f32 v8, v8, v90
    v_add_f32 v8, v8, v91
    v_cvt_pk_bf16_f32 v109, v90, v91
    v_exp_f32 v92, v92
    v_exp_f32 v93, v93
    v_add_f32 v8, v8, v92
    v_add_f32 v8, v8, v93
    v_exp_f32 v94, v94
    v_exp_f32 v95, v95
    v_cvt_pk_bf16_f32 v110, v92, v93
    v_add_f32 v8, v8, v94
    v_add_f32 v8, v8, v95
    v_cvt_pk_bf16_f32 v111, v94, v95
    v_mul_f32 v215, v215, v40
    v_cvt_pk_bf16_f32 v32, v208, v209
    v_cvt_pk_bf16_f32 v33, v210, v211
    v_cvt_pk_bf16_f32 v34, v212, v213
    v_cvt_pk_bf16_f32 v35, v214, v215
    buffer_store_dwordx4 v[32:35], v2, s[16:19], s46 offen offset:2048 sc1
    v_mov_b64 v[208:209], 0
    v_mov_b64 v[210:211], 0
    v_mov_b64 v[212:213], 0
    v_mov_b64 v[214:215], 0
    v_mul_f32 v216, v216, v40
    v_mul_f32 v217, v217, v40
    v_mul_f32 v218, v218, v40
    v_mul_f32 v219, v219, v40
    v_mul_f32 v220, v220, v40
    v_mul_f32 v221, v221, v40
    v_mul_f32 v222, v222, v40
    v_mul_f32 v223, v223, v40
    v_cvt_pk_bf16_f32 v36, v216, v217
    v_cvt_pk_bf16_f32 v37, v218, v219
    v_cvt_pk_bf16_f32 v38, v220, v221
    v_cvt_pk_bf16_f32 v39, v222, v223
    buffer_store_dwordx4 v[36:39], v2, s[16:19], s46 offen offset:3072 sc1
    v_mov_b64 v[216:217], 0
    v_mov_b64 v[218:219], 0
    v_mov_b64 v[220:221], 0
    v_mov_b64 v[222:223], 0
    v_mov_b32 v6, v19
    v_mov_b64 v[10:11], 0
    s_mov_b32 s35, s52
    s_nop 3
    v_pk_mul_f32 v[224:225], v[224:225], v[42:43] op_sel_hi:[1,0]
    v_pk_mul_f32 v[226:227], v[226:227], v[42:43] op_sel_hi:[1,0]
    v_pk_mul_f32 v[228:229], v[228:229], v[42:43] op_sel_hi:[1,0]
    v_pk_mul_f32 v[230:231], v[230:231], v[42:43] op_sel_hi:[1,0]
    v_cvt_pk_bf16_f32 v32, v224, v225
    v_cvt_pk_bf16_f32 v33, v226, v227
    v_cvt_pk_bf16_f32 v34, v228, v229
    v_cvt_pk_bf16_f32 v35, v230, v231
    buffer_store_dwordx4 v[32:35], v2, s[16:19], s47 offen offset:0 sc1
    v_mov_b64 v[224:225], 0
    v_mov_b64 v[226:227], 0
    v_mov_b64 v[228:229], 0
    v_mov_b64 v[230:231], 0
    v_pk_mul_f32 v[232:233], v[232:233], v[42:43] op_sel_hi:[1,0]
    v_pk_mul_f32 v[234:235], v[234:235], v[42:43] op_sel_hi:[1,0]
    v_pk_mul_f32 v[236:237], v[236:237], v[42:43] op_sel_hi:[1,0]
    v_pk_mul_f32 v[238:239], v[238:239], v[42:43] op_sel_hi:[1,0]
    v_cvt_pk_bf16_f32 v36, v232, v233
    v_cvt_pk_bf16_f32 v37, v234, v235
    v_cvt_pk_bf16_f32 v38, v236, v237
    v_cvt_pk_bf16_f32 v39, v238, v239
    buffer_store_dwordx4 v[36:39], v2, s[16:19], s47 offen offset:1024 sc1
    v_mov_b64 v[232:233], 0
    v_mov_b64 v[234:235], 0
    v_mov_b64 v[236:237], 0
    v_mov_b64 v[238:239], 0
    v_pk_mul_f32 v[240:241], v[240:241], v[42:43] op_sel_hi:[1,0]
    v_pk_mul_f32 v[242:243], v[242:243], v[42:43] op_sel_hi:[1,0]
    v_pk_mul_f32 v[244:245], v[244:245], v[42:43] op_sel_hi:[1,0]
    v_pk_mul_f32 v[246:247], v[246:247], v[42:43] op_sel_hi:[1,0]
    v_cvt_pk_bf16_f32 v32, v240, v241
    v_cvt_pk_bf16_f32 v33, v242, v243
    v_cvt_pk_bf16_f32 v34, v244, v245
    v_cvt_pk_bf16_f32 v35, v246, v247
    buffer_store_dwordx4 v[32:35], v2, s[16:19], s47 offen offset:2048 sc1
    v_mov_b64 v[240:241], 0
    v_mov_b64 v[242:243], 0
    v_mov_b64 v[244:245], 0
    v_mov_b64 v[246:247], 0
    v_pk_mul_f32 v[248:249], v[248:249], v[42:43] op_sel_hi:[1,0]
    v_pk_mul_f32 v[250:251], v[250:251], v[42:43] op_sel_hi:[1,0]
    v_pk_mul_f32 v[252:253], v[252:253], v[42:43] op_sel_hi:[1,0]
    v_pk_mul_f32 v[254:255], v[254:255], v[42:43] op_sel_hi:[1,0]
    v_cvt_pk_bf16_f32 v36, v248, v249
    v_cvt_pk_bf16_f32 v37, v250, v251
    v_cvt_pk_bf16_f32 v38, v252, v253
    v_cvt_pk_bf16_f32 v39, v254, v255
    buffer_store_dwordx4 v[36:39], v2, s[16:19], s47 offen offset:3072 sc1
    v_mov_b64 v[248:249], 0
    v_mov_b64 v[250:251], 0
    v_mov_b64 v[252:253], 0
    v_mov_b64 v[254:255], 0
    s_waitcnt lgkmcnt(0)
    s_barrier
    s_cmp_lg_u32 s35, 0
    s_cbranch_scc1 L_p2
    s_branch L_d2_3
L_p2:
    s_waitcnt lgkmcnt(0)
    v_mfma_f32_16x16x32_bf16 v[80:83], a[64:67], a[32:35], v[120:123]
    ds_read_b128 a[124:127], v6 offset:15360
    ds_read_b128 a[120:123], v6 offset:14336
    v_exp_f32 v64, v64
    v_mfma_f32_16x16x32_bf16 v[80:83], a[68:71], a[36:39], v[80:83]
    ds_read_b128 a[116:119], v6 offset:13312
    ds_read_b128 a[112:115], v6 offset:12288
    v_exp_f32 v65, v65
    v_mfma_f32_16x16x32_bf16 v[80:83], a[72:75], a[40:43], v[80:83]
    v_add_f32 v9, v9, v64
    v_add_f32 v9, v9, v65
    v_exp_f32 v66, v66
    v_mfma_f32_16x16x32_bf16 v[80:83], a[76:79], a[44:47], v[80:83]
    s_add_u32 m0, s37, 16384
    v_exp_f32 v67, v67
    v_mfma_f32_16x16x32_bf16 v[84:87], a[92:95], a[44:47], v[120:123]
    v_cvt_pk_bf16_f32 v96, v64, v65
    v_add_f32 v9, v9, v66
    buffer_load_dwordx4 v4, s[8:11], s36 offen offset:0 sc1 lds
    v_mfma_f32_16x16x32_bf16 v[84:87], a[88:91], a[40:43], v[84:87]
    v_add_f32 v9, v9, v67
    v_cvt_pk_bf16_f32 v97, v66, v67
    v_exp_f32 v68, v68
    v_mfma_f32_16x16x32_bf16 v[84:87], a[84:87], a[36:39], v[84:87]
    buffer_load_dwordx4 v4, s[8:11], s36 offen offset:1024 sc1 lds
    v_exp_f32 v69, v69
    v_mfma_f32_16x16x32_bf16 v[84:87], a[80:83], a[32:35], v[84:87]
    v_add_f32 v9, v9, v68
    v_add_f32 v9, v9, v69
    v_mfma_f32_16x16x32_bf16 v[88:91], a[96:99], a[32:35], v[120:123]
    v_exp_f32 v70, v70
    v_mfma_f32_16x16x32_bf16 v[88:91], a[100:103], a[36:39], v[88:91]
    v_exp_f32 v71, v71
    v_mfma_f32_16x16x32_bf16 v[88:91], a[104:107], a[40:43], v[88:91]
    v_cvt_pk_bf16_f32 v98, v68, v69
    v_add_f32 v9, v9, v70
    v_mfma_f32_16x16x32_bf16 v[88:91], a[108:111], a[44:47], v[88:91]
    buffer_load_dwordx4 v4, s[8:11], s36 offen offset:2048 sc1 lds
    s_waitcnt lgkmcnt(0)
    v_mfma_f32_16x16x32_bf16 v[92:95], a[124:127], a[44:47], v[120:123]
    v_add_f32 v9, v9, v71
    v_cvt_pk_bf16_f32 v99, v70, v71
    v_mfma_f32_16x16x32_bf16 v[92:95], a[120:123], a[40:43], v[92:95]
    buffer_load_dwordx4 v4, s[8:11], s36 offen offset:3072 sc1 lds
    v_mfma_f32_16x16x32_bf16 v[92:95], a[116:119], a[36:39], v[92:95]
    v_exp_f32 v72, v72
    v_mfma_f32_16x16x32_bf16 v[92:95], a[112:115], a[32:35], v[92:95]
    v_exp_f32 v73, v73
    v_add_f32 v9, v9, v72
    v_mfma_f32_16x16x32_bf16 v[128:131], a[128:131], v[104:107], v[128:131]
    s_add_u32 m0, s37, 20480
    v_add_f32 v9, v9, v73
    v_mfma_f32_16x16x32_bf16 v[128:131], a[132:135], v[108:111], v[128:131]
    buffer_load_dwordx4 v5, s[8:11], s36 offen offset:0 sc1 lds
    v_mfma_f32_16x16x32_bf16 v[132:135], a[140:143], v[108:111], v[132:135]
    v_exp_f32 v74, v74
    v_mfma_f32_16x16x32_bf16 v[132:135], a[136:139], v[104:107], v[132:135]
    buffer_load_dwordx4 v5, s[8:11], s36 offen offset:1024 sc1 lds
    v_mfma_f32_16x16x32_bf16 v[136:139], a[144:147], v[104:107], v[136:139]
    v_exp_f32 v75, v75
    v_mfma_f32_16x16x32_bf16 v[136:139], a[148:151], v[108:111], v[136:139]
    v_cvt_pk_bf16_f32 v100, v72, v73
    v_add_f32 v9, v9, v74
    v_mfma_f32_16x16x32_bf16 v[140:143], a[156:159], v[108:111], v[140:143]
    buffer_load_dwordx4 v5, s[8:11], s36 offen offset:2048 sc1 lds
    v_mfma_f32_16x16x32_bf16 v[140:143], a[152:155], v[104:107], v[140:143]
    v_add_f32 v9, v9, v75
    v_cvt_pk_bf16_f32 v101, v74, v75
    v_mfma_f32_16x16x32_bf16 v[144:147], a[160:163], v[104:107], v[144:147]
    buffer_load_dwordx4 v5, s[8:11], s36 offen offset:3072 sc1 lds
    s_add_u32 s36, s36, 65536
    s_xor_b32 s37, s37, 0x10000
    v_mfma_f32_16x16x32_bf16 v[144:147], a[164:167], v[108:111], v[144:147]
    v_exp_f32 v76, v76
    v_mfma_f32_16x16x32_bf16 v[148:151], a[172:175], v[108:111], v[148:151]
    v_exp_f32 v77, v77
    v_mfma_f32_16x16x32_bf16 v[148:151], a[168:171], v[104:107], v[148:151]
    v_add_f32 v9, v9, v76
    v_add_f32 v9, v9, v77
    v_mfma_f32_16x16x32_bf16 v[152:155], a[176:179], v[104:107], v[152:155]
    v_exp_f32 v78, v78
    v_mfma_f32_16x16x32_bf16 v[152:155], a[180:183], v[108:111], v[152:155]
    v_exp_f32 v79, v79
    v_mfma_f32_16x16x32_bf16 v[156:159], a[188:191], v[108:111], v[156:159]
    v_cvt_pk_bf16_f32 v102, v76, v77
    v_add_f32 v9, v9, v78
    v_mfma_f32_16x16x32_bf16 v[156:159], a[184:187], v[104:107], v[156:159]
    v_add_f32 v9, v9, v79
    v_cvt_pk_bf16_f32 v103, v78, v79
    s_waitcnt vmcnt(17)
    s_barrier
    v_mfma_f32_16x16x32_bf16 v[64:67], a[64:67], a[48:51], v[124:127]
    v_exp_f32 v80, v80
    v_exp_f32 v81, v81
    v_mfma_f32_16x16x32_bf16 v[64:67], a[68:71], a[52:55], v[64:67]
    v_add_f32 v10, v10, v80
    v_add_f32 v10, v10, v81
    v_exp_f32 v82, v82
    v_mfma_f32_16x16x32_bf16 v[64:67], a[72:75], a[56:59], v[64:67]
    v_exp_f32 v83, v83
    v_cvt_pk_bf16_f32 v104, v80, v81
    v_mfma_f32_16x16x32_bf16 v[64:67], a[76:79], a[60:63], v[64:67]
    v_add_f32 v10, v10, v82
    v_add_f32 v10, v10, v83
    v_cvt_pk_bf16_f32 v105, v82, v83
    v_mfma_f32_16x16x32_bf16 v[68:71], a[92:95], a[60:63], v[124:127]
    v_exp_f32 v84, v84
    v_exp_f32 v85, v85
    v_mfma_f32_16x16x32_bf16 v[68:71], a[88:91], a[56:59], v[68:71]
    s_mov_b32 m0, s37
    s_nop 0
    buffer_load_dwordx4 v2, s[8:11], s36 offen offset:0 sc1 lds
    v_mfma_f32_16x16x32_bf16 v[68:71], a[84:87], a[52:55], v[68:71]
    v_add_f32 v10, v10, v84
    v_add_f32 v10, v10, v85
    v_mfma_f32_16x16x32_bf16 v[68:71], a[80:83], a[48:51], v[68:71]
    v_exp_f32 v86, v86
    v_mfma_f32_16x16x32_bf16 v[72:75], a[96:99], a[48:51], v[124:127]
    v_exp_f32 v87, v87
    v_mfma_f32_16x16x32_bf16 v[72:75], a[100:103], a[52:55], v[72:75]
    v_cvt_pk_bf16_f32 v106, v84, v85
    v_add_f32 v10, v10, v86
    v_mfma_f32_16x16x32_bf16 v[72:75], a[104:107], a[56:59], v[72:75]
    buffer_load_dwordx4 v2, s[8:11], s36 offen offset:1024 sc1 lds
    v_mfma_f32_16x16x32_bf16 v[72:75], a[108:111], a[60:63], v[72:75]
    v_add_f32 v10, v10, v87
    v_cvt_pk_bf16_f32 v107, v86, v87
    v_mfma_f32_16x16x32_bf16 v[76:79], a[124:127], a[60:63], v[124:127]
    v_exp_f32 v88, v88
    v_mfma_f32_16x16x32_bf16 v[76:79], a[120:123], a[56:59], v[76:79]
    v_exp_f32 v89, v89
    v_mfma_f32_16x16x32_bf16 v[76:79], a[116:119], a[52:55], v[76:79]
    v_add_f32 v10, v10, v88
    v_add_f32 v10, v10, v89
    v_mfma_f32_16x16x32_bf16 v[76:79], a[112:115], a[48:51], v[76:79]
    v_exp_f32 v90, v90
    v_mfma_f32_16x16x32_bf16 v[160:163], a[128:131], v[96:99], v[160:163]
    buffer_load_dwordx4 v2, s[8:11], s36 offen offset:2048 sc1 lds
    v_mfma_f32_16x16x32_bf16 v[160:163], a[132:135], v[100:103], v[160:163]
    ds_read_b128 a[128:131], v6 offset:16384
    ds_read_b128 a[132:135], v6 offset:17408
    v_mfma_f32_16x16x32_bf16 v[164:167], a[140:143], v[100:103], v[164:167]
    v_exp_f32 v91, v91
    v_mfma_f32_16x16x32_bf16 v[164:167], a[136:139], v[96:99], v[164:167]
    ds_read_b128 a[140:143], v6 offset:19456
    ds_read_b128 a[136:139], v6 offset:18432
    v_mfma_f32_16x16x32_bf16 v[168:171], a[144:147], v[96:99], v[168:171]
    ds_read_b128 a[144:147], v6 offset:20480
    v_cvt_pk_bf16_f32 v108, v88, v89
    v_mfma_f32_16x16x32_bf16 v[168:171], a[148:151], v[100:103], v[168:171]
    ds_read_b128 a[148:151], v6 offset:21504
    v_add_f32 v10, v10, v90
    v_mfma_f32_16x16x32_bf16 v[172:175], a[156:159], v[100:103], v[172:175]
    buffer_load_dwordx4 v2, s[8:11], s36 offen offset:3072 sc1 lds
    v_mfma_f32_16x16x32_bf16 v[172:175], a[152:155], v[96:99], v[172:175]
    ds_read_b128 a[156:159], v6 offset:23552
    ds_read_b128 a[152:155], v6 offset:22528
    v_mfma_f32_16x16x32_bf16 v[176:179], a[160:163], v[96:99], v[176:179]
    v_add_f32 v10, v10, v91
    v_cvt_pk_bf16_f32 v109, v90, v91
    v_mfma_f32_16x16x32_bf16 v[176:179], a[164:167], v[100:103], v[176:179]
    v_exp_f32 v92, v92
    v_mfma_f32_16x16x32_bf16 v[180:183], a[172:175], v[100:103], v[180:183]
    v_exp_f32 v93, v93
    v_mfma_f32_16x16x32_bf16 v[180:183], a[168:171], v[96:99], v[180:183]
    v_add_f32 v10, v10, v92
    v_add_f32 v10, v10, v93
    v_mfma_f32_16x16x32_bf16 v[184:187], a[176:179], v[96:99], v[184:187]
    v_exp_f32 v94, v94
    v_mfma_f32_16x16x32_bf16 v[184:187], a[180:183], v[100:103], v[184:187]
    v_exp_f32 v95, v95
    v_mfma_f32_16x16x32_bf16 v[188:191], a[188:191], v[100:103], v[188:191]
    v_cvt_pk_bf16_f32 v110, v92, v93
    v_add_f32 v10, v10, v94
    v_mfma_f32_16x16x32_bf16 v[188:191], a[184:187], v[96:99], v[188:191]
    v_add_f32 v10, v10, v95
    v_cvt_pk_bf16_f32 v111, v94, v95
    v_mfma_f32_16x16x32_bf16 v[80:83], a[64:67], a[0:3], v[112:115]
    ds_read_b128 a[160:163], v6 offset:24576
    ds_read_b128 a[164:167], v6 offset:25600
    v_exp_f32 v64, v64
    v_mfma_f32_16x16x32_bf16 v[80:83], a[68:71], a[4:7], v[80:83]
    ds_read_b128 a[172:175], v6 offset:27648
    ds_read_b128 a[168:171], v6 offset:26624
    v_exp_f32 v65, v65
    v_mfma_f32_16x16x32_bf16 v[80:83], a[72:75], a[8:11], v[80:83]
    v_add_f32 v11, v11, v64
    v_add_f32 v11, v11, v65
    v_exp_f32 v66, v66
    v_mfma_f32_16x16x32_bf16 v[80:83], a[76:79], a[12:15], v[80:83]
    s_add_u32 m0, s37, 4096
    ds_read_b128 a[176:179], v6 offset:28672
    buffer_load_dwordx4 v3, s[8:11], s36 offen offset:0 sc1 lds
    v_mfma_f32_16x16x32_bf16 v[84:87], a[92:95], a[12:15], v[112:115]
    ds_read_b128 a[180:183], v6 offset:29696
    ds_read_b128 a[188:191], v6 offset:31744
    v_exp_f32 v67, v67
    v_mfma_f32_16x16x32_bf16 v[84:87], a[88:91], a[8:11], v[84:87]
    ds_read_b128 a[184:187], v6 offset:30720
    v_cvt_pk_bf16_f32 v96, v64, v65
    v_add_f32 v11, v11, v66
    v_mfma_f32_16x16x32_bf16 v[84:87], a[84:87], a[4:7], v[84:87]
    v_add_f32 v11, v11, v67
    v_cvt_pk_bf16_f32 v97, v66, v67
    v_mfma_f32_16x16x32_bf16 v[84:87], a[80:83], a[0:3], v[84:87]
    v_exp_f32 v68, v68
    v_mfma_f32_16x16x32_bf16 v[88:91], a[96:99], a[0:3], v[112:115]
    buffer_load_dwordx4 v3, s[8:11], s36 offen offset:1024 sc1 lds
    v_mfma_f32_16x16x32_bf16 v[88:91], a[100:103], a[4:7], v[88:91]
    v_exp_f32 v69, v69
    v_mfma_f32_16x16x32_bf16 v[88:91], a[104:107], a[8:11], v[88:91]
    v_add_f32 v11, v11, v68
    v_add_f32 v11, v11, v69
    v_mfma_f32_16x16x32_bf16 v[88:91], a[108:111], a[12:15], v[88:91]
    v_exp_f32 v70, v70
    v_mfma_f32_16x16x32_bf16 v[92:95], a[124:127], a[12:15], v[112:115]
    v_exp_f32 v71, v71
    v_mfma_f32_16x16x32_bf16 v[92:95], a[120:123], a[8:11], v[92:95]
    v_cvt_pk_bf16_f32 v98, v68, v69
    v_add_f32 v11, v11, v70
    v_mfma_f32_16x16x32_bf16 v[92:95], a[116:119], a[4:7], v[92:95]
    buffer_load_dwordx4 v3, s[8:11], s36 offen offset:2048 sc1 lds
    v_mfma_f32_16x16x32_bf16 v[92:95], a[112:115], a[0:3], v[92:95]
    v_add_f32 v11, v11, v71
    v_cvt_pk_bf16_f32 v99, v70, v71
    s_waitcnt lgkmcnt(0)
    v_mfma_f32_16x16x32_bf16 v[192:195], a[128:131], v[104:107], v[192:195]
    v_exp_f32 v72, v72
    v_mfma_f32_16x16x32_bf16 v[192:195], a[132:135], v[108:111], v[192:195]
    v_exp_f32 v73, v73
    v_mfma_f32_16x16x32_bf16 v[196:199], a[140:143], v[108:111], v[196:199]
    v_add_f32 v11, v11, v72
    v_add_f32 v11, v11, v73
    v_mfma_f32_16x16x32_bf16 v[196:199], a[136:139], v[104:107], v[196:199]
    v_exp_f32 v74, v74
    v_mfma_f32_16x16x32_bf16 v[200:203], a[144:147], v[104:107], v[200:203]
    buffer_load_dwordx4 v3, s[8:11], s36 offen offset:3072 sc1 lds
    v_mfma_f32_16x16x32_bf16 v[200:203], a[148:151], v[108:111], v[200:203]
    v_exp_f32 v75, v75
    v_mfma_f32_16x16x32_bf16 v[204:207], a[156:159], v[108:111], v[204:207]
    v_cvt_pk_bf16_f32 v100, v72, v73
    v_add_f32 v11, v11, v74
    v_mfma_f32_16x16x32_bf16 v[204:207], a[152:155], v[104:107], v[204:207]
    v_add_f32 v11, v11, v75
    v_cvt_pk_bf16_f32 v101, v74, v75
    v_mfma_f32_16x16x32_bf16 v[208:211], a[160:163], v[104:107], v[208:211]
    s_cmp_eq_u32 s35, 1
    s_cselect_b32 s39, s49, 0x10000
    v_mfma_f32_16x16x32_bf16 v[208:211], a[164:167], v[108:111], v[208:211]
    v_exp_f32 v76, v76
    v_mfma_f32_16x16x32_bf16 v[212:215], a[172:175], v[108:111], v[212:215]
    v_exp_f32 v77, v77
    v_mfma_f32_16x16x32_bf16 v[212:215], a[168:171], v[104:107], v[212:215]
    v_add_f32 v11, v11, v76
    v_add_f32 v11, v11, v77
    v_mfma_f32_16x16x32_bf16 v[216:219], a[176:179], v[104:107], v[216:219]
    v_exp_f32 v78, v78
    v_mfma_f32_16x16x32_bf16 v[216:219], a[180:183], v[108:111], v[216:219]
    v_exp_f32 v79, v79
    v_mfma_f32_16x16x32_bf16 v[220:223], a[188:191], v[108:111], v[220:223]
    v_cvt_pk_bf16_f32 v102, v76, v77
    v_add_f32 v11, v11, v78
    v_mfma_f32_16x16x32_bf16 v[220:223], a[184:187], v[104:107], v[220:223]
    v_add_f32 v11, v11, v79
    v_cvt_pk_bf16_f32 v103, v78, v79
    s_waitcnt vmcnt(17)
    s_barrier
    v_xor_b32 v6, s39, v6
    v_mfma_f32_16x16x32_bf16 v[64:67], a[64:67], a[16:19], v[116:119]
    s_waitcnt vmcnt(16)
    buffer_load_dwordx4 v[44:47], v56, s[20:23], 0 offen sc1
    v_exp_f32 v80, v80
    v_mfma_f32_16x16x32_bf16 v[64:67], a[68:71], a[20:23], v[64:67]
    ds_read_b128 a[64:67], v6 offset:0
    ds_read_b128 a[68:71], v6 offset:1024
    v_exp_f32 v81, v81
    v_mfma_f32_16x16x32_bf16 v[64:67], a[72:75], a[24:27], v[64:67]
    v_add_f32 v8, v8, v80
    v_add_f32 v8, v8, v81
    v_exp_f32 v82, v82
    v_mfma_f32_16x16x32_bf16 v[64:67], a[76:79], a[28:31], v[64:67]
    ds_read_b128 a[72:75], v6 offset:2048
    ds_read_b128 a[76:79], v6 offset:3072
    v_exp_f32 v83, v83
    v_mfma_f32_16x16x32_bf16 v[68:71], a[92:95], a[28:31], v[116:119]
    ds_read_b128 a[92:95], v6 offset:7168
    v_cvt_pk_bf16_f32 v104, v80, v81
    v_mfma_f32_16x16x32_bf16 v[68:71], a[88:91], a[24:27], v[68:71]
    ds_read_b128 a[88:91], v6 offset:6144
    v_add_f32 v8, v8, v82
    v_mfma_f32_16x16x32_bf16 v[68:71], a[84:87], a[20:23], v[68:71]
    ds_read_b128 a[84:87], v6 offset:5120
    v_add_f32 v8, v8, v83
    v_mfma_f32_16x16x32_bf16 v[68:71], a[80:83], a[16:19], v[68:71]
    ds_read_b128 a[80:83], v6 offset:4096
    v_cvt_pk_bf16_f32 v105, v82, v83
    v_mfma_f32_16x16x32_bf16 v[72:75], a[96:99], a[16:19], v[116:119]
    v_exp_f32 v84, v84
    v_mfma_f32_16x16x32_bf16 v[72:75], a[100:103], a[20:23], v[72:75]
    ds_read_b128 a[96:99], v6 offset:8192
    ds_read_b128 a[100:103], v6 offset:9216
    v_mfma_f32_16x16x32_bf16 v[72:75], a[104:107], a[24:27], v[72:75]
    v_exp_f32 v85, v85
    v_mfma_f32_16x16x32_bf16 v[72:75], a[108:111], a[28:31], v[72:75]
    ds_read_b128 a[104:107], v6 offset:10240
    ds_read_b128 a[108:111], v6 offset:11264
    v_mfma_f32_16x16x32_bf16 v[76:79], a[124:127], a[28:31], v[116:119]
    v_add_f32 v8, v8, v84
    v_add_f32 v8, v8, v85
    v_mfma_f32_16x16x32_bf16 v[76:79], a[120:123], a[24:27], v[76:79]
    v_exp_f32 v86, v86
    v_mfma_f32_16x16x32_bf16 v[76:79], a[116:119], a[20:23], v[76:79]
    v_exp_f32 v87, v87
    v_mfma_f32_16x16x32_bf16 v[76:79], a[112:115], a[16:19], v[76:79]
    v_cvt_pk_bf16_f32 v106, v84, v85
    v_add_f32 v8, v8, v86
    v_mfma_f32_16x16x32_bf16 v[224:227], a[128:131], v[96:99], v[224:227]
    v_add_f32 v8, v8, v87
    v_cvt_pk_bf16_f32 v107, v86, v87
    v_mfma_f32_16x16x32_bf16 v[224:227], a[132:135], v[100:103], v[224:227]
    v_exp_f32 v88, v88
    v_mfma_f32_16x16x32_bf16 v[228:231], a[140:143], v[100:103], v[228:231]
    v_exp_f32 v89, v89
    v_mfma_f32_16x16x32_bf16 v[228:231], a[136:139], v[96:99], v[228:231]
    v_add_f32 v8, v8, v88
    v_add_f32 v8, v8, v89
    v_mfma_f32_16x16x32_bf16 v[232:235], a[144:147], v[96:99], v[232:235]
    s_sub_u32 s35, s35, 1
    s_cmp_lg_u32 s35, s88
    v_mfma_f32_16x16x32_bf16 v[232:235], a[148:151], v[100:103], v[232:235]
    v_exp_f32 v90, v90
    v_mfma_f32_16x16x32_bf16 v[236:239], a[156:159], v[100:103], v[236:239]
    v_exp_f32 v91, v91
    v_mfma_f32_16x16x32_bf16 v[236:239], a[152:155], v[96:99], v[236:239]
    v_cvt_pk_bf16_f32 v108, v88, v89
    v_add_f32 v8, v8, v90
    v_mfma_f32_16x16x32_bf16 v[240:243], a[160:163], v[96:99], v[240:243]
    v_add_f32 v8, v8, v91
    v_cvt_pk_bf16_f32 v109, v90, v91
    v_mfma_f32_16x16x32_bf16 v[240:243], a[164:167], v[100:103], v[240:243]
    v_exp_f32 v92, v92
    v_mfma_f32_16x16x32_bf16 v[244:247], a[172:175], v[100:103], v[244:247]
    v_exp_f32 v93, v93
    v_mfma_f32_16x16x32_bf16 v[244:247], a[168:171], v[96:99], v[244:247]
    v_add_f32 v8, v8, v92
    v_add_f32 v8, v8, v93
    v_mfma_f32_16x16x32_bf16 v[248:251], a[176:179], v[96:99], v[248:251]
    v_exp_f32 v94, v94
    v_mfma_f32_16x16x32_bf16 v[248:251], a[180:183], v[100:103], v[248:251]
    v_exp_f32 v95, v95
    v_mfma_f32_16x16x32_bf16 v[252:255], a[188:191], v[100:103], v[252:255]
    v_cvt_pk_bf16_f32 v110, v92, v93
    v_add_f32 v8, v8, v94
    v_mfma_f32_16x16x32_bf16 v[252:255], a[184:187], v[96:99], v[252:255]
    v_add_f32 v8, v8, v95
    v_cvt_pk_bf16_f32 v111, v94, v95
    s_cbranch_scc1 L_p2
    s_cmp_eq_u32 s83, 0
    s_cbranch_scc1 L_dsp2
L_mid:
    s_mov_b32 s83, 0
    s_mov_b32 s88, 0
    s_waitcnt vmcnt(17)
    s_cmp_lg_u64 s[50:51], 0
    s_cselect_b32 s3, 1, 0
    s_cmp_gt_u32 s3, s48
    s_cselect_b32 s3, 0x80000000, 0
    v_lshl_or_b32 v34, v2, 20, s3
    v_mov_b32 v32, s80
    v_mov_b32 v33, s81
    buffer_store_dwordx2 v[32:33], v34, s[20:23], s75 offen sc1
    s_waitcnt vmcnt(1)
    v_cmp_eq_u64_e64 s[4:5], s[80:81], v[44:45]
    v_cmp_eq_u64 vcc, s[80:81], v[46:47]
    s_and_b64 s[4:5], s[4:5], vcc
    s_cmp_eq_u64 s[4:5], -1
    s_cbranch_scc0 L_km_retry
L_km_back:
    s_cmp_lg_u32 s35, 0
    s_cbranch_scc1 L_p2
L_dsp2:
    s_cmp_eq_u32 s32, 1
    s_cbranch_scc1 L_d2_1
    s_cmp_eq_u32 s32, 2
    s_cbranch_scc1 L_d2_2
    s_cmp_eq_u32 s32, 3
    s_cbranch_scc1 L_d2_3
L_d2_0:
    s_waitcnt lgkmcnt(0)
    v_mfma_f32_16x16x32_bf16 v[80:83], a[64:67], a[0:3], v[20:23]
    ds_read_b128 a[124:127], v6 offset:15360
    ds_read_b128 a[120:123], v6 offset:14336
    v_exp_f32 v64, v64
    v_mfma_f32_16x16x32_bf16 v[80:83], a[68:71], a[4:7], v[80:83]
    ds_read_b128 a[116:119], v6 offset:13312
    ds_read_b128 a[112:115], v6 offset:12288
    v_exp_f32 v65, v65
    v_mfma_f32_16x16x32_bf16 v[80:83], a[72:75], a[8:11], v[80:83]
    v_add_f32 v9, v9, v64
    ds_write_b128 v14, v[192:195] offset:0
    v_mfma_f32_16x16x32_bf16 v[80:83], a[76:79], a[12:15], v[80:83]
    s_add_u32 s3, s76, 0x20000
    s_and_b32 s3, s3, 0xe0000
    s_add_u32 s3, s3, s74
    s_bitset1_b32 s3, 16
    buffer_load_dwordx4 a[192:195], v58, s[84:87], s3 offen offset:0
    v_mfma_f32_16x16x32_bf16 v[128:131], a[128:131], v[104:107], v[128:131]
    v_add_f32 v9, v9, v65
    buffer_load_dwordx4 a[196:199], v59, s[84:87], s3 offen offset:1024
    v_mfma_f32_16x16x32_bf16 v[128:131], a[132:135], v[108:111], v[128:131]
    buffer_load_dwordx4 a[200:203], v60, s[84:87], s3 offen offset:2048
    v_mfma_f32_16x16x32_bf16 v[132:135], a[140:143], v[108:111], v[132:135]
    buffer_load_dwordx4 a[204:207], v61, s[84:87], s3 offen offset:3072
    v_mfma_f32_16x16x32_bf16 v[132:135], a[136:139], v[104:107], v[132:135]
    ds_write_b128 v14, v[196:199] offset:1024
    v_mfma_f32_16x16x32_bf16 v[136:139], a[144:147], v[104:107], v[136:139]
    ds_write_b128 v14, v[200:203] offset:2048
    v_mfma_f32_16x16x32_bf16 v[136:139], a[148:151], v[108:111], v[136:139]
    ds_write_b128 v14, v[204:207] offset:3072
    v_mfma_f32_16x16x32_bf16 v[140:143], a[156:159], v[108:111], v[140:143]
    ds_write_b128 v14, v[208:211] offset:4096
    v_mfma_f32_16x16x32_bf16 v[140:143], a[152:155], v[104:107], v[140:143]
    ds_write_b128 v14, v[212:215] offset:5120
    v_mfma_f32_16x16x32_bf16 v[144:147], a[160:163], v[104:107], v[144:147]
    s_add_u32 s3, s76, 0x40000
    s_and_b32 s3, s3, 0xe0000
    s_add_u32 s3, s3, s74
    buffer_load_dwordx4 a[208:211], v58, s[84:87], s3 offen offset:0
    v_mfma_f32_16x16x32_bf16 v[144:147], a[164:167], v[108:111], v[144:147]
    buffer_load_dwordx4 a[212:215], v59, s[84:87], s3 offen offset:1024
    v_mfma_f32_16x16x32_bf16 v[148:151], a[172:175], v[108:111], v[148:151]
    buffer_load_dwordx4 a[216:219], v60, s[84:87], s3 offen offset:2048
    v_mfma_f32_16x16x32_bf16 v[148:151], a[168:171], v[104:107], v[148:151]
    buffer_load_dwordx4 a[220:223], v61, s[84:87], s3 offen offset:3072
    v_mfma_f32_16x16x32_bf16 v[152:155], a[176:179], v[104:107], v[152:155]
    ds_write_b128 v14, v[216:219] offset:6144
    v_mfma_f32_16x16x32_bf16 v[152:155], a[180:183], v[108:111], v[152:155]
    ds_write_b128 v14, v[220:223] offset:7168
    v_mfma_f32_16x16x32_bf16 v[156:159], a[188:191], v[108:111], v[156:159]
    v_exp_f32 v66, v66
    v_exp_f32 v67, v67
    v_mfma_f32_16x16x32_bf16 v[156:159], a[184:187], v[104:107], v[156:159]
    v_cvt_pk_bf16_f32 v96, v64, v65
    v_add_f32 v9, v9, v66
    v_add_f32 v9, v9, v67
    v_cvt_pk_bf16_f32 v97, v66, v67
    v_exp_f32 v68, v68
    v_exp_f32 v69, v69
    v_add_f32 v9, v9, v68
    v_add_f32 v9, v9, v69
    v_exp_f32 v70, v70
    v_exp_f32 v71, v71
    v_cvt_pk_bf16_f32 v98, v68, v69
    v_add_f32 v9, v9, v70
    v_add_f32 v9, v9, v71
    v_cvt_pk_bf16_f32 v99, v70, v71
    v_exp_f32 v72, v72
    v_exp_f32 v73, v73
    v_add_f32 v9, v9, v72
    v_add_f32 v9, v9, v73
    v_exp_f32 v74, v74
    v_exp_f32 v75, v75
    v_cvt_pk_bf16_f32 v100, v72, v73
    v_add_f32 v9, v9, v74
    v_add_f32 v9, v9, v75
    v_cvt_pk_bf16_f32 v101, v74, v75
    v_exp_f32 v76, v76
    v_exp_f32 v77, v77
    v_add_f32 v9, v9, v76
    v_add_f32 v9, v9, v77
    v_exp_f32 v78, v78
    v_exp_f32 v79, v79
    v_cvt_pk_bf16_f32 v102, v76, v77
    v_add_f32 v9, v9, v78
    v_add_f32 v9, v9, v79
    v_cvt_pk_bf16_f32 v103, v78, v79
    s_waitcnt vmcnt(8)
    s_barrier
    v_mfma_f32_16x16x32_bf16 v[64:67], a[64:67], a[16:19], v[116:119]
    s_cmp_lg_u64 s[50:51], 0
    s_cselect_b32 s3, 1, 0
    s_cmp_gt_u32 s3, s48
    s_cselect_b32 s3, 0x80000000, 0
    v_mfma_f32_16x16x32_bf16 v[64:67], a[68:71], a[20:23], v[64:67]
    s_cmp_lt_u32 s34, 7
    s_cselect_b32 s3, 0x80000000, s3
    v_lshl_or_b32 v42, v2, 20, s3
    v_mfma_f32_16x16x32_bf16 v[64:67], a[72:75], a[24:27], v[64:67]
    v_mov_b32 v40, s80
    v_mov_b32 v41, s81
    buffer_store_dwordx2 v[40:41], v42, s[20:23], s75 offen sc1
    v_mfma_f32_16x16x32_bf16 v[64:67], a[76:79], a[28:31], v[64:67]
    v_cndmask_b32_e64 v20, v7, v116, s[24:25]
    v_cndmask_b32_e64 v21, v7, v116, s[26:27]
    v_exp_f32 v80, v80
    v_mfma_f32_16x16x32_bf16 v[68:71], a[92:95], a[28:31], v[116:119]
    v_cndmask_b32_e64 v22, v7, v116, s[28:29]
    v_cndmask_b32_e64 v23, v7, v116, s[30:31]
    v_exp_f32 v81, v81
    v_mfma_f32_16x16x32_bf16 v[68:71], a[88:91], a[24:27], v[68:71]
    ds_read_b128 a[64:67], v6 offset:32768
    ds_write_b128 v14, v[224:227] offset:8192
    v_mfma_f32_16x16x32_bf16 v[68:71], a[84:87], a[20:23], v[68:71]
    ds_read_b128 a[68:71], v6 offset:33792
    ds_write_b128 v14, v[228:231] offset:9216
    v_mfma_f32_16x16x32_bf16 v[68:71], a[80:83], a[16:19], v[68:71]
    s_xor_b32 m0, s77, 0x8000
    s_add_u32 s3, s76, 0x0
    s_and_b32 s3, s3, 0xe0000
    s_add_u32 s3, s3, s74
    buffer_load_dwordx4 v58, s[84:87], s3 offen offset:0 lds
    v_mfma_f32_16x16x32_bf16 v[72:75], a[96:99], a[16:19], v[116:119]
    ds_read_b128 a[72:75], v6 offset:34816
    buffer_load_dwordx4 v59, s[84:87], s3 offen offset:1024 lds
    v_mfma_f32_16x16x32_bf16 v[72:75], a[100:103], a[20:23], v[72:75]
    ds_read_b128 a[76:79], v6 offset:35840
    ds_write_b128 v14, v[232:235] offset:10240
    v_mfma_f32_16x16x32_bf16 v[72:75], a[104:107], a[24:27], v[72:75]
    ds_read_b128 a[92:95], v6 offset:39936
    buffer_load_dwordx4 v60, s[84:87], s3 offen offset:2048 lds
    v_mfma_f32_16x16x32_bf16 v[72:75], a[108:111], a[28:31], v[72:75]
    ds_read_b128 a[88:91], v6 offset:38912
    ds_write_b128 v14, v[236:239] offset:11264
    s_waitcnt lgkmcnt(8)
    v_mfma_f32_16x16x32_bf16 v[76:79], a[124:127], a[28:31], v[116:119]
    ds_read_b128 a[84:87], v6 offset:37888
    ds_write_b128 v14, v[240:243] offset:12288
    v_mfma_f32_16x16x32_bf16 v[76:79], a[120:123], a[24:27], v[76:79]
    ds_read_b128 a[80:83], v6 offset:36864
    buffer_load_dwordx4 v61, s[84:87], s3 offen offset:3072 lds
    v_mfma_f32_16x16x32_bf16 v[76:79], a[116:119], a[20:23], v[76:79]
    ds_read_b128 a[96:99], v6 offset:40960
    ds_write_b128 v14, v[244:247] offset:13312
    v_mfma_f32_16x16x32_bf16 v[76:79], a[112:115], a[16:19], v[76:79]
    ds_read_b128 a[100:103], v6 offset:41984
    ds_write_b128 v14, v[248:251] offset:14336
    v_mfma_f32_16x16x32_bf16 v[160:163], a[128:131], v[96:99], v[160:163]
    ds_read_b128 a[128:131], v6 offset:16384
    ds_write_b128 v14, v[252:255] offset:15360
    v_mfma_f32_16x16x32_bf16 v[160:163], a[132:135], v[100:103], v[160:163]
    v_add_f32 v8, v8, v80
    v_add_f32 v8, v8, v81
    v_exp_f32 v82, v82
    v_mfma_f32_16x16x32_bf16 v[164:167], a[140:143], v[100:103], v[164:167]
    ds_read_b128 a[132:135], v6 offset:17408
    ds_read_b128 a[140:143], v6 offset:19456
    v_exp_f32 v83, v83
    v_mfma_f32_16x16x32_bf16 v[164:167], a[136:139], v[96:99], v[164:167]
    ds_read_b128 a[136:139], v6 offset:18432
    ds_read_b128 a[104:107], v6 offset:43008
    ds_read_b128 a[108:111], v6 offset:44032
    v_mfma_f32_16x16x32_bf16 v[168:171], a[144:147], v[96:99], v[168:171]
    s_add_u32 s3, s76, 0x40000
    s_and_b32 s3, s3, 0xe0000
    s_add_u32 s3, s3, s74
    s_bitset1_b32 s3, 16
    buffer_load_dwordx4 a[32:35], v58, s[84:87], s3 offen offset:0
    v_mfma_f32_16x16x32_bf16 v[168:171], a[148:151], v[100:103], v[168:171]
    ds_read_b128 a[144:147], v6 offset:20480
    buffer_load_dwordx4 a[36:39], v59, s[84:87], s3 offen offset:1024
    v_mfma_f32_16x16x32_bf16 v[172:175], a[156:159], v[100:103], v[172:175]
    ds_read_b128 a[148:151], v6 offset:21504
    ds_read_b128 a[156:159], v6 offset:23552
    v_mfma_f32_16x16x32_bf16 v[172:175], a[152:155], v[96:99], v[172:175]
    ds_read_b128 a[152:155], v6 offset:22528
    ds_read_b128 a[124:127], v6 offset:48128
    v_mfma_f32_16x16x32_bf16 v[176:179], a[160:163], v[96:99], v[176:179]
    buffer_load_dwordx4 a[40:43], v60, s[84:87], s3 offen offset:2048
    v_mfma_f32_16x16x32_bf16 v[176:179], a[164:167], v[100:103], v[176:179]
    ds_read_b128 a[120:123], v6 offset:47104
    ds_read_b128 a[116:119], v6 offset:46080
    v_mfma_f32_16x16x32_bf16 v[180:183], a[172:175], v[100:103], v[180:183]
    buffer_load_dwordx4 a[44:47], v61, s[84:87], s3 offen offset:3072
    v_mfma_f32_16x16x32_bf16 v[180:183], a[168:171], v[96:99], v[180:183]
    ds_read_b128 a[112:115], v6 offset:45056
    ds_write_b32 v16, v10 offset:0
    v_mfma_f32_16x16x32_bf16 v[184:187], a[176:179], v[96:99], v[184:187]
    ds_write_b32 v16, v11 offset:256
    v_cvt_pk_bf16_f32 v104, v80, v81
    v_mfma_f32_16x16x32_bf16 v[184:187], a[180:183], v[100:103], v[184:187]
    v_add_f32 v8, v8, v82
    v_add_f32 v8, v8, v83
    v_mfma_f32_16x16x32_bf16 v[188:191], a[188:191], v[100:103], v[188:191]
    v_cvt_pk_bf16_f32 v105, v82, v83
    v_mov_b64 v[106:107], 0
    v_mfma_f32_16x16x32_bf16 v[188:191], a[184:187], v[96:99], v[188:191]
    s_waitcnt vmcnt(17) lgkmcnt(0)
    s_barrier
    v_mfma_f32_16x16x32_bf16 v[80:83], a[64:67], a[16:19], v[116:119]
    v_xor_b32 v16, 512, v16
    ds_read_b32 v10, v16 offset:0
    v_exp_f32 v64, v64
    v_mfma_f32_16x16x32_bf16 v[80:83], a[68:71], a[20:23], v[80:83]
    ds_read_b32 v11, v16 offset:256
    ds_read_b128 a[160:163], v6 offset:24576
    v_exp_f32 v65, v65
    v_mfma_f32_16x16x32_bf16 v[80:83], a[72:75], a[24:27], v[80:83]
    v_add_f32 v9, v9, v64
    v_add_f32 v9, v9, v65
    v_exp_f32 v66, v66
    v_mfma_f32_16x16x32_bf16 v[80:83], a[76:79], a[28:31], v[80:83]
    ds_read_b128 v[192:195], v15 offset:0
    ds_read_b128 a[164:167], v6 offset:25600
    v_exp_f32 v67, v67
    v_mfma_f32_16x16x32_bf16 v[84:87], a[92:95], a[28:31], v[116:119]
    ds_read_b128 a[168:171], v6 offset:26624
    v_cvt_pk_bf16_f32 v96, v64, v65
    v_add_f32 v9, v9, v66
    v_mfma_f32_16x16x32_bf16 v[84:87], a[88:91], a[24:27], v[84:87]
    v_add_f32 v9, v9, v67
    v_cvt_pk_bf16_f32 v97, v66, v67
    v_exp_f32 v68, v68
    v_mfma_f32_16x16x32_bf16 v[84:87], a[84:87], a[20:23], v[84:87]
    ds_read_b128 a[172:175], v6 offset:27648
    ds_read_b128 a[176:179], v6 offset:28672
    v_exp_f32 v69, v69
    v_mfma_f32_16x16x32_bf16 v[84:87], a[80:83], a[16:19], v[84:87]
    s_xor_b32 m0, s77, 0x10000
    s_add_u32 s3, s76, 0x0
    s_and_b32 s3, s3, 0xe0000
    s_add_u32 s3, s3, s74
    s_bitset1_b32 s3, 16
    buffer_load_dwordx4 v58, s[84:87], s3 offen offset:0 lds
    v_mfma_f32_16x16x32_bf16 v[88:91], a[96:99], a[16:19], v[116:119]
    ds_read_b128 a[180:183], v6 offset:29696
    buffer_load_dwordx4 v59, s[84:87], s3 offen offset:1024 lds
    v_mfma_f32_16x16x32_bf16 v[88:91], a[100:103], a[20:23], v[88:91]
    ds_read_b128 a[184:187], v6 offset:30720
    buffer_load_dwordx4 v60, s[84:87], s3 offen offset:2048 lds
    v_mfma_f32_16x16x32_bf16 v[88:91], a[104:107], a[24:27], v[88:91]
    ds_read_b128 a[188:191], v6 offset:31744
    buffer_load_dwordx4 v61, s[84:87], s3 offen offset:3072 lds
    v_mfma_f32_16x16x32_bf16 v[88:91], a[108:111], a[28:31], v[88:91]
    v_add_f32 v9, v9, v68
    v_add_f32 v9, v9, v69
    v_exp_f32 v70, v70
    v_mfma_f32_16x16x32_bf16 v[92:95], a[124:127], a[28:31], v[20:23]
    ds_read_b128 v[196:199], v15 offset:1024
    ds_read_b128 v[200:203], v15 offset:2048
    v_exp_f32 v71, v71
    v_mfma_f32_16x16x32_bf16 v[92:95], a[120:123], a[24:27], v[92:95]
    ds_read_b128 v[204:207], v15 offset:3072
    v_cvt_pk_bf16_f32 v98, v68, v69
    v_add_f32 v9, v9, v70
    v_mfma_f32_16x16x32_bf16 v[92:95], a[116:119], a[20:23], v[92:95]
    v_add_f32 v9, v9, v71
    v_cvt_pk_bf16_f32 v99, v70, v71
    v_exp_f32 v72, v72
    v_mfma_f32_16x16x32_bf16 v[92:95], a[112:115], a[16:19], v[92:95]
    ds_read_b128 v[208:211], v15 offset:4096
    ds_read_b128 v[212:215], v15 offset:5120
    v_exp_f32 v73, v73
    v_mfma_f32_16x16x32_bf16 v[128:131], a[128:131], v[104:107], v[128:131]
    s_xor_b32 m0, s77, 0x18000
    s_add_u32 s3, s76, 0x20000
    s_and_b32 s3, s3, 0xe0000
    s_add_u32 s3, s3, s74
    buffer_load_dwordx4 v58, s[84:87], s3 offen offset:0 lds
    v_mfma_f32_16x16x32_bf16 v[132:135], a[136:139], v[104:107], v[132:135]
    ds_read_b128 v[216:219], v15 offset:6144
    buffer_load_dwordx4 v59, s[84:87], s3 offen offset:1024 lds
    v_mfma_f32_16x16x32_bf16 v[136:139], a[144:147], v[104:107], v[136:139]
    ds_read_b128 v[220:223], v15 offset:7168
    buffer_load_dwordx4 v60, s[84:87], s3 offen offset:2048 lds
    v_mfma_f32_16x16x32_bf16 v[140:143], a[152:155], v[104:107], v[140:143]
    v_add_f32 v9, v9, v72
    buffer_load_dwordx4 v61, s[84:87], s3 offen offset:3072 lds
    s_waitcnt lgkmcnt(4)
    v_mfma_f32_16x16x32_bf16 v[144:147], a[160:163], v[104:107], v[144:147]
    v_add_f32 v9, v9, v73
    v_exp_f32 v74, v74
    v_mfma_f32_16x16x32_bf16 v[148:151], a[168:171], v[104:107], v[148:151]
    v_exp_f32 v75, v75
    v_cvt_pk_bf16_f32 v100, v72, v73
    v_mfma_f32_16x16x32_bf16 v[152:155], a[176:179], v[104:107], v[152:155]
    v_add_f32 v9, v9, v74
    v_add_f32 v9, v9, v75
    v_cvt_pk_bf16_f32 v101, v74, v75
    v_mfma_f32_16x16x32_bf16 v[156:159], a[184:187], v[104:107], v[156:159]
    v_exp_f32 v76, v76
    v_exp_f32 v77, v77
    v_add_f32 v9, v9, v76
    v_add_f32 v9, v9, v77
    v_exp_f32 v78, v78
    v_exp_f32 v79, v79
    v_cvt_pk_bf16_f32 v102, v76, v77
    v_add_f32 v9, v9, v78
    v_add_f32 v9, v9, v79
    v_cvt_pk_bf16_f32 v103, v78, v79
    v_mfma_f32_16x16x32_bf16 v[160:163], a[128:131], v[96:99], v[160:163]
    v_add_f32 v8, v8, v10
    v_mov_b32 v41, v8
    s_nop 1
    v_mfma_f32_16x16x32_bf16 v[160:163], a[132:135], v[100:103], v[160:163]
    v_permlane16_swap_b32 v8, v41
    v_add_f32 v8, v8, v41
    v_mov_b32 v41, v8
    v_mfma_f32_16x16x32_bf16 v[164:167], a[140:143], v[100:103], v[164:167]
    s_nop 1
    v_permlane32_swap_b32 v8, v41
    v_exp_f32 v80, v80
    v_mfma_f32_16x16x32_bf16 v[164:167], a[136:139], v[96:99], v[164:167]
    s_add_u32 s3, s76, 0x60000
    s_and_b32 s3, s3, 0xe0000
    s_add_u32 s3, s3, s74
    buffer_load_dwordx4 a[48:51], v58, s[84:87], s3 offen offset:0
    v_mfma_f32_16x16x32_bf16 v[168:171], a[144:147], v[96:99], v[168:171]
    v_add_f32 v8, v8, v41
    buffer_load_dwordx4 a[52:55], v59, s[84:87], s3 offen offset:1024
    v_mfma_f32_16x16x32_bf16 v[168:171], a[148:151], v[100:103], v[168:171]
    ds_read_b128 v[224:227], v15 offset:8192
    buffer_load_dwordx4 a[56:59], v60, s[84:87], s3 offen offset:2048
    v_mfma_f32_16x16x32_bf16 v[172:175], a[156:159], v[100:103], v[172:175]
    ds_read_b128 a[64:67], v6 offset:49152
    ds_read_b128 a[68:71], v6 offset:50176
    ds_read_b128 a[76:79], v6 offset:52224
    ds_read_b128 a[72:75], v6 offset:51200
    ds_read_b128 a[80:83], v6 offset:53248
    ds_read_b128 a[84:87], v6 offset:54272
    ds_read_b128 a[92:95], v6 offset:56320
    ds_read_b128 a[88:91], v6 offset:55296
    ds_read_b128 a[96:99], v6 offset:57344
    ds_read_b128 a[100:103], v6 offset:58368
    ds_read_b128 a[108:111], v6 offset:60416
    ds_read_b128 a[104:107], v6 offset:59392
    ds_read_b128 a[112:115], v6 offset:61440
    ds_read_b128 a[116:119], v6 offset:62464
    ds_read_b128 a[124:127], v6 offset:64512
    ds_read_b128 a[120:123], v6 offset:63488
    v_mfma_f32_16x16x32_bf16 v[172:175], a[152:155], v[96:99], v[172:175]
    ds_read_b128 v[228:231], v15 offset:9216
    ds_read_b128 v[232:235], v15 offset:10240
    v_rcp_f32 v40, v8
    v_mfma_f32_16x16x32_bf16 v[176:179], a[160:163], v[96:99], v[176:179]
    v_cmp_nge_f32 vcc, 0x5f800000, v8
    buffer_load_dwordx4 a[60:63], v61, s[84:87], s3 offen offset:3072
    v_mfma_f32_16x16x32_bf16 v[176:179], a[164:167], v[100:103], v[176:179]
    ds_read_b128 v[236:239], v15 offset:11264
    ds_read_b128 v[240:243], v15 offset:12288
    v_exp_f32 v81, v81
    v_mfma_f32_16x16x32_bf16 v[180:183], a[172:175], v[100:103], v[180:183]
    v_add_f32 v9, v9, v80
    v_add_f32 v9, v9, v81
    v_exp_f32 v82, v82
    v_mfma_f32_16x16x32_bf16 v[180:183], a[168:171], v[96:99], v[180:183]
    ds_read_b128 v[244:247], v15 offset:13312
    buffer_load_dwordx4 v[44:47], v57, s[20:23], 0 offen sc1
    v_mfma_f32_16x16x32_bf16 v[184:187], a[176:179], v[96:99], v[184:187]
    ds_read_b128 v[248:251], v15 offset:14336
    ds_read_b128 v[252:255], v15 offset:15360
    v_exp_f32 v83, v83
    v_mfma_f32_16x16x32_bf16 v[184:187], a[180:183], v[100:103], v[184:187]
    s_or_b64 s[50:51], s[50:51], vcc
    v_cvt_pk_bf16_f32 v104, v80, v81
    v_add_f32 v9, v9, v82
    v_mfma_f32_16x16x32_bf16 v[188:191], a[188:191], v[100:103], v[188:191]
    v_add_f32 v9, v9, v83
    v_cvt_pk_bf16_f32 v105, v82, v83
    v_exp_f32 v84, v84
    v_mfma_f32_16x16x32_bf16 v[188:191], a[184:187], v[96:99], v[188:191]
    v_exp_f32 v85, v85
    v_add_f32 v9, v9, v84
    v_add_f32 v9, v9, v85
    v_exp_f32 v86, v86
    v_exp_f32 v87, v87
    v_cvt_pk_bf16_f32 v106, v84, v85
    v_add_f32 v9, v9, v86
    v_add_f32 v9, v9, v87
    v_cvt_pk_bf16_f32 v107, v86, v87
    v_exp_f32 v88, v88
    v_exp_f32 v89, v89
    v_add_f32 v9, v9, v88
    v_add_f32 v9, v9, v89
    v_exp_f32 v90, v90
    v_exp_f32 v91, v91
    v_cvt_pk_bf16_f32 v108, v88, v89
    v_add_f32 v9, v9, v90
    v_add_f32 v9, v9, v91
    v_cvt_pk_bf16_f32 v109, v90, v91
    v_exp_f32 v92, v92
    v_exp_f32 v93, v93
    v_add_f32 v9, v9, v92
    v_add_f32 v9, v9, v93
    v_exp_f32 v94, v94
    v_exp_f32 v95, v95
    v_cvt_pk_bf16_f32 v110, v92, v93
    v_add_f32 v9, v9, v94
    v_add_f32 v9, v9, v95
    v_cvt_pk_bf16_f32 v111, v94, v95
    v_add_f32 v128, v128, v192
    v_add_f32 v129, v129, v193
    v_add_f32 v130, v130, v194
    v_add_f32 v131, v131, v195
    v_add_f32 v132, v132, v196
    v_add_f32 v133, v133, v197
    v_add_f32 v134, v134, v198
    v_add_f32 v135, v135, v199
    v_mul_f32 v128, v128, v40
    v_mul_f32 v129, v129, v40
    v_mul_f32 v130, v130, v40
    v_mul_f32 v131, v131, v40
    v_mul_f32 v132, v132, v40
    v_mul_f32 v133, v133, v40
    v_mul_f32 v134, v134, v40
    v_mul_f32 v135, v135, v40
    v_cvt_pk_bf16_f32 v32, v128, v129
    v_cvt_pk_bf16_f32 v33, v130, v131
    v_cvt_pk_bf16_f32 v34, v132, v133
    v_cvt_pk_bf16_f32 v35, v134, v135
    s_nop 0
    s_waitcnt lgkmcnt(0)
    v_mfma_f32_16x16x32_bf16 v[160:163], a[64:67], v[104:107], v[160:163]
    buffer_store_dwordx4 v[32:35], v2, s[16:19], s44 offen offset:0 sc1
    v_add_f32 v136, v136, v200
    v_add_f32 v137, v137, v201
    v_mfma_f32_16x16x32_bf16 v[160:163], a[68:71], v[108:111], v[160:163]
    v_add_f32 v138, v138, v202
    v_add_f32 v139, v139, v203
    v_add_f32 v140, v140, v204
    v_mfma_f32_16x16x32_bf16 v[164:167], a[76:79], v[108:111], v[164:167]
    v_add_f32 v141, v141, v205
    v_add_f32 v142, v142, v206
    v_add_f32 v143, v143, v207
    v_mfma_f32_16x16x32_bf16 v[164:167], a[72:75], v[104:107], v[164:167]
    v_mul_f32 v136, v136, v40
    v_mul_f32 v137, v137, v40
    v_mul_f32 v138, v138, v40
    v_mfma_f32_16x16x32_bf16 v[168:171], a[80:83], v[104:107], v[168:171]
    v_mul_f32 v139, v139, v40
    v_mul_f32 v140, v140, v40
    v_mul_f32 v141, v141, v40
    v_mfma_f32_16x16x32_bf16 v[168:171], a[84:87], v[108:111], v[168:171]
    v_mul_f32 v142, v142, v40
    v_mul_f32 v143, v143, v40
    v_cvt_pk_bf16_f32 v36, v136, v137
    v_mfma_f32_16x16x32_bf16 v[172:175], a[92:95], v[108:111], v[172:175]
    v_cvt_pk_bf16_f32 v37, v138, v139
    v_cvt_pk_bf16_f32 v38, v140, v141
    v_cvt_pk_bf16_f32 v39, v142, v143
    v_mfma_f32_16x16x32_bf16 v[172:175], a[88:91], v[104:107], v[172:175]
    buffer_store_dwordx4 v[36:39], v2, s[16:19], s44 offen offset:1024 sc1
    v_add_f32 v144, v144, v208
    v_add_f32 v145, v145, v209
    v_mfma_f32_16x16x32_bf16 v[176:179], a[96:99], v[104:107], v[176:179]
    v_add_f32 v146, v146, v210
    v_add_f32 v147, v147, v211
    v_add_f32 v148, v148, v212
    v_mfma_f32_16x16x32_bf16 v[176:179], a[100:103], v[108:111], v[176:179]
    v_add_f32 v149, v149, v213
    v_add_f32 v150, v150, v214
    v_add_f32 v151, v151, v215
    v_mfma_f32_16x16x32_bf16 v[180:183], a[108:111], v[108:111], v[180:183]
    v_mul_f32 v144, v144, v40
    v_mul_f32 v145, v145, v40
    v_mul_f32 v146, v146, v40
    v_mfma_f32_16x16x32_bf16 v[180:183], a[104:107], v[104:107], v[180:183]
    v_mul_f32 v147, v147, v40
    v_mul_f32 v148, v148, v40
    v_mul_f32 v149, v149, v40
    v_mfma_f32_16x16x32_bf16 v[184:187], a[112:115], v[104:107], v[184:187]
    v_mul_f32 v150, v150, v40
    v_mul_f32 v151, v151, v40
    v_cvt_pk_bf16_f32 v32, v144, v145
    v_mfma_f32_16x16x32_bf16 v[184:187], a[116:119], v[108:111], v[184:187]
    v_cvt_pk_bf16_f32 v33, v146, v147
    v_cvt_pk_bf16_f32 v34, v148, v149
    v_cvt_pk_bf16_f32 v35, v150, v151
    v_mfma_f32_16x16x32_bf16 v[188:191], a[124:127], v[108:111], v[188:191]
    buffer_store_dwordx4 v[32:35], v2, s[16:19], s44 offen offset:2048 sc1
    v_add_f32 v152, v152, v216
    v_add_f32 v153, v153, v217
    v_mfma_f32_16x16x32_bf16 v[188:191], a[120:123], v[104:107], v[188:191]
    v_add_f32 v154, v154, v218
    v_add_f32 v155, v155, v219
    v_add_f32 v156, v156, v220
    v_add_f32 v157, v157, v221
    v_add_f32 v158, v158, v222
    v_add_f32 v159, v159, v223
    v_mul_f32 v152, v152, v40
    v_mul_f32 v153, v153, v40
    v_mul_f32 v154, v154, v40
    v_mul_f32 v155, v155, v40
    v_mul_f32 v156, v156, v40
    v_mul_f32 v157, v157, v40
    v_mul_f32 v158, v158, v40
    v_mul_f32 v159, v159, v40
    v_cvt_pk_bf16_f32 v36, v152, v153
    v_cvt_pk_bf16_f32 v37, v154, v155
    v_cvt_pk_bf16_f32 v38, v156, v157
    v_cvt_pk_bf16_f32 v39, v158, v159
    buffer_store_dwordx4 v[36:39], v2, s[16:19], s44 offen offset:3072 sc1
    v_add_f32 v9, v9, v11
    v_mov_b32 v43, v9
    s_nop 1
    v_permlane16_swap_b32 v9, v43
    v_add_f32 v9, v9, v43
    v_mov_b32 v43, v9
    s_nop 1
    v_permlane32_swap_b32 v9, v43
    v_add_f32 v9, v9, v43
    v_rcp_f32 v42, v9
    v_cmp_nge_f32 vcc, 0x5f800000, v9
    s_or_b64 s[50:51], s[50:51], vcc
    s_nop 3
    v_pk_add_f32 v[160:161], v[160:161], v[224:225]
    v_pk_add_f32 v[162:163], v[162:163], v[226:227]
    v_pk_add_f32 v[164:165], v[164:165], v[228:229]
    v_pk_add_f32 v[166:167], v[166:167], v[230:231]
    v_pk_mul_f32 v[160:161], v[160:161], v[42:43] op_sel_hi:[1,0]
    v_pk_mul_f32 v[162:163], v[162:163], v[42:43] op_sel_hi:[1,0]
    v_pk_mul_f32 v[164:165], v[164:165], v[42:43] op_sel_hi:[1,0]
    v_pk_mul_f32 v[166:167], v[166:167], v[42:43] op_sel_hi:[1,0]
    v_cvt_pk_bf16_f32 v32, v160, v161
    v_cvt_pk_bf16_f32 v33, v162, v163
    v_cvt_pk_bf16_f32 v34, v164, v165
    v_cvt_pk_bf16_f32 v35, v166, v167
    buffer_store_dwordx4 v[32:35], v2, s[16:19], s45 offen offset:0 sc1
    v_pk_add_f32 v[168:169], v[168:169], v[232:233]
    v_pk_add_f32 v[170:171], v[170:171], v[234:235]
    v_pk_add_f32 v[172:173], v[172:173], v[236:237]
    v_pk_add_f32 v[174:175], v[174:175], v[238:239]
    v_pk_mul_f32 v[168:169], v[168:169], v[42:43] op_sel_hi:[1,0]
    v_pk_mul_f32 v[170:171], v[170:171], v[42:43] op_sel_hi:[1,0]
    v_pk_mul_f32 v[172:173], v[172:173], v[42:43] op_sel_hi:[1,0]
    v_pk_mul_f32 v[174:175], v[174:175], v[42:43] op_sel_hi:[1,0]
    v_cvt_pk_bf16_f32 v36, v168, v169
    v_cvt_pk_bf16_f32 v37, v170, v171
    v_cvt_pk_bf16_f32 v38, v172, v173
    v_cvt_pk_bf16_f32 v39, v174, v175
    buffer_store_dwordx4 v[36:39], v2, s[16:19], s45 offen offset:1024 sc1
    v_pk_add_f32 v[176:177], v[176:177], v[240:241]
    v_pk_add_f32 v[178:179], v[178:179], v[242:243]
    v_pk_add_f32 v[180:181], v[180:181], v[244:245]
    v_pk_add_f32 v[182:183], v[182:183], v[246:247]
    v_pk_mul_f32 v[176:177], v[176:177], v[42:43] op_sel_hi:[1,0]
    v_pk_mul_f32 v[178:179], v[178:179], v[42:43] op_sel_hi:[1,0]
    v_pk_mul_f32 v[180:181], v[180:181], v[42:43] op_sel_hi:[1,0]
    v_pk_mul_f32 v[182:183], v[182:183], v[42:43] op_sel_hi:[1,0]
    v_cvt_pk_bf16_f32 v32, v176, v177
    v_cvt_pk_bf16_f32 v33, v178, v179
    v_cvt_pk_bf16_f32 v34, v180, v181
    v_cvt_pk_bf16_f32 v35, v182, v183
    buffer_store_dwordx4 v[32:35], v2, s[16:19], s45 offen offset:2048 sc1
    v_pk_add_f32 v[184:185], v[184:185], v[248:249]
    v_pk_add_f32 v[186:187], v[186:187], v[250:251]
    v_pk_add_f32 v[188:189], v[188:189], v[252:253]
    v_pk_add_f32 v[190:191], v[190:191], v[254:255]
    v_pk_mul_f32 v[184:185], v[184:185], v[42:43] op_sel_hi:[1,0]
    v_pk_mul_f32 v[186:187], v[186:187], v[42:43] op_sel_hi:[1,0]
    v_pk_mul_f32 v[188:189], v[188:189], v[42:43] op_sel_hi:[1,0]
    v_pk_mul_f32 v[190:191], v[190:191], v[42:43] op_sel_hi:[1,0]
    v_cvt_pk_bf16_f32 v36, v184, v185
    v_cvt_pk_bf16_f32 v37, v186, v187
    v_cvt_pk_bf16_f32 v38, v188, v189
    v_cvt_pk_bf16_f32 v39, v190, v191
    buffer_store_dwordx4 v[36:39], v2, s[16:19], s45 offen offset:3072 sc1
    s_branch L_fin
L_d2_1:
    s_waitcnt lgkmcnt(0)
    v_mfma_f32_16x16x32_bf16 v[80:83], a[64:67], a[0:3], v[112:115]
    ds_read_b128 a[124:127], v6 offset:15360
    ds_read_b128 a[120:123], v6 offset:14336
    v_exp_f32 v64, v64
    v_mfma_f32_16x16x32_bf16 v[80:83], a[68:71], a[4:7], v[80:83]
    ds_read_b128 a[116:119], v6 offset:13312
    ds_read_b128 a[112:115], v6 offset:12288
    v_exp_f32 v65, v65
    v_mfma_f32_16x16x32_bf16 v[80:83], a[72:75], a[8:11], v[80:83]
    v_add_f32 v9, v9, v64
    ds_write_b128 v14, v[192:195] offset:0
    v_mfma_f32_16x16x32_bf16 v[80:83], a[76:79], a[12:15], v[80:83]
    s_add_u32 s3, s76, 0x20000
    s_and_b32 s3, s3, 0xe0000
    s_add_u32 s3, s3, s74
    s_bitset1_b32 s3, 16
    buffer_load_dwordx4 a[192:195], v58, s[84:87], s3 offen offset:0
    v_mfma_f32_16x16x32_bf16 v[84:87], a[92:95], a[12:15], v[20:23]
    v_add_f32 v9, v9, v65
    buffer_load_dwordx4 a[196:199], v59, s[84:87], s3 offen offset:1024
    v_mfma_f32_16x16x32_bf16 v[84:87], a[88:91], a[8:11], v[84:87]
    buffer_load_dwordx4 a[200:203], v60, s[84:87], s3 offen offset:2048
    v_mfma_f32_16x16x32_bf16 v[84:87], a[84:87], a[4:7], v[84:87]
    v_exp_f32 v66, v66
    v_exp_f32 v67, v67
    v_mfma_f32_16x16x32_bf16 v[84:87], a[80:83], a[0:3], v[84:87]
    v_cvt_pk_bf16_f32 v96, v64, v65
    ds_write_b128 v14, v[196:199] offset:1024
    v_mfma_f32_16x16x32_bf16 v[128:131], a[128:131], v[104:107], v[128:131]
    v_add_f32 v9, v9, v66
    buffer_load_dwordx4 a[204:207], v61, s[84:87], s3 offen offset:3072
    v_mfma_f32_16x16x32_bf16 v[128:131], a[132:135], v[108:111], v[128:131]
    v_add_f32 v9, v9, v67
    ds_write_b128 v14, v[200:203] offset:2048
    v_mfma_f32_16x16x32_bf16 v[132:135], a[140:143], v[108:111], v[132:135]
    v_cvt_pk_bf16_f32 v97, v66, v67
    ds_write_b128 v14, v[204:207] offset:3072
    v_mfma_f32_16x16x32_bf16 v[132:135], a[136:139], v[104:107], v[132:135]
    v_exp_f32 v68, v68
    v_exp_f32 v69, v69
    v_mfma_f32_16x16x32_bf16 v[136:139], a[144:147], v[104:107], v[136:139]
    v_add_f32 v9, v9, v68
    ds_write_b128 v14, v[208:211] offset:4096
    v_mfma_f32_16x16x32_bf16 v[136:139], a[148:151], v[108:111], v[136:139]
    v_add_f32 v9, v9, v69
    ds_write_b128 v14, v[212:215] offset:5120
    v_mfma_f32_16x16x32_bf16 v[140:143], a[156:159], v[108:111], v[140:143]
    s_add_u32 s3, s76, 0x40000
    s_and_b32 s3, s3, 0xe0000
    s_add_u32 s3, s3, s74
    buffer_load_dwordx4 a[208:211], v58, s[84:87], s3 offen offset:0
    v_mfma_f32_16x16x32_bf16 v[140:143], a[152:155], v[104:107], v[140:143]
    buffer_load_dwordx4 a[212:215], v59, s[84:87], s3 offen offset:1024
    v_mfma_f32_16x16x32_bf16 v[144:147], a[160:163], v[104:107], v[144:147]
    buffer_load_dwordx4 a[216:219], v60, s[84:87], s3 offen offset:2048
    v_mfma_f32_16x16x32_bf16 v[144:147], a[164:167], v[108:111], v[144:147]
    v_exp_f32 v70, v70
    v_exp_f32 v71, v71
    v_mfma_f32_16x16x32_bf16 v[148:151], a[172:175], v[108:111], v[148:151]
    v_cvt_pk_bf16_f32 v98, v68, v69
    ds_write_b128 v14, v[216:219] offset:6144
    v_mfma_f32_16x16x32_bf16 v[148:151], a[168:171], v[104:107], v[148:151]
    v_add_f32 v9, v9, v70
    buffer_load_dwordx4 a[220:223], v61, s[84:87], s3 offen offset:3072
    v_mfma_f32_16x16x32_bf16 v[152:155], a[176:179], v[104:107], v[152:155]
    v_add_f32 v9, v9, v71
    ds_write_b128 v14, v[220:223] offset:7168
    v_mfma_f32_16x16x32_bf16 v[152:155], a[180:183], v[108:111], v[152:155]
    v_cvt_pk_bf16_f32 v99, v70, v71
    v_exp_f32 v72, v72
    v_mfma_f32_16x16x32_bf16 v[156:159], a[188:191], v[108:111], v[156:159]
    v_exp_f32 v73, v73
    v_add_f32 v9, v9, v72
    v_mfma_f32_16x16x32_bf16 v[156:159], a[184:187], v[104:107], v[156:159]
    v_add_f32 v9, v9, v73
    v_exp_f32 v74, v74
    v_exp_f32 v75, v75
    v_cvt_pk_bf16_f32 v100, v72, v73
    v_add_f32 v9, v9, v74
    v_add_f32 v9, v9, v75
    v_cvt_pk_bf16_f32 v101, v74, v75
    v_exp_f32 v76, v76
    v_exp_f32 v77, v77
    v_add_f32 v9, v9, v76
    v_add_f32 v9, v9, v77
    v_exp_f32 v78, v78
    v_exp_f32 v79, v79
    v_cvt_pk_bf16_f32 v102, v76, v77
    v_add_f32 v9, v9, v78
    v_add_f32 v9, v9, v79
    v_cvt_pk_bf16_f32 v103, v78, v79
    s_waitcnt vmcnt(8)
    s_barrier
    v_mfma_f32_16x16x32_bf16 v[64:67], a[64:67], a[16:19], v[116:119]
    s_cmp_lg_u64 s[50:51], 0
    s_cselect_b32 s3, 1, 0
    s_cmp_gt_u32 s3, s48
    s_cselect_b32 s3, 0x80000000, 0
    v_mfma_f32_16x16x32_bf16 v[64:67], a[68:71], a[20:23], v[64:67]
    s_cmp_lt_u32 s34, 7
    s_cselect_b32 s3, 0x80000000, s3
    v_lshl_or_b32 v42, v2, 20, s3
    v_mfma_f32_16x16x32_bf16 v[64:67], a[72:75], a[24:27], v[64:67]
    v_mov_b32 v40, s80
    v_mov_b32 v41, s81
    buffer_store_dwordx2 v[40:41], v42, s[20:23], s75 offen sc1
    v_mfma_f32_16x16x32_bf16 v[64:67], a[76:79], a[28:31], v[64:67]
    v_cndmask_b32_e64 v20, v7, v116, s[24:25]
    v_cndmask_b32_e64 v21, v7, v116, s[26:27]
    v_exp_f32 v80, v80
    v_mfma_f32_16x16x32_bf16 v[68:71], a[92:95], a[28:31], v[116:119]
    v_cndmask_b32_e64 v22, v7, v116, s[28:29]
    v_cndmask_b32_e64 v23, v7, v116, s[30:31]
    v_exp_f32 v81, v81
    v_mfma_f32_16x16x32_bf16 v[68:71], a[88:91], a[24:27], v[68:71]
    ds_read_b128 a[64:67], v6 offset:32768
    ds_write_b128 v14, v[224:227] offset:8192
    v_mfma_f32_16x16x32_bf16 v[68:71], a[84:87], a[20:23], v[68:71]
    ds_read_b128 a[68:71], v6 offset:33792
    ds_write_b128 v14, v[228:231] offset:9216
    v_mfma_f32_16x16x32_bf16 v[68:71], a[80:83], a[16:19], v[68:71]
    s_xor_b32 m0, s77, 0x8000
    s_add_u32 s3, s76, 0x0
    s_and_b32 s3, s3, 0xe0000
    s_add_u32 s3, s3, s74
    buffer_load_dwordx4 v58, s[84:87], s3 offen offset:0 lds
    v_mfma_f32_16x16x32_bf16 v[72:75], a[96:99], a[16:19], v[116:119]
    ds_read_b128 a[72:75], v6 offset:34816
    buffer_load_dwordx4 v59, s[84:87], s3 offen offset:1024 lds
    v_mfma_f32_16x16x32_bf16 v[72:75], a[100:103], a[20:23], v[72:75]
    ds_read_b128 a[76:79], v6 offset:35840
    ds_write_b128 v14, v[232:235] offset:10240
    v_mfma_f32_16x16x32_bf16 v[72:75], a[104:107], a[24:27], v[72:75]
    ds_read_b128 a[92:95], v6 offset:39936
    buffer_load_dwordx4 v60, s[84:87], s3 offen offset:2048 lds
    v_mfma_f32_16x16x32_bf16 v[72:75], a[108:111], a[28:31], v[72:75]
    ds_read_b128 a[88:91], v6 offset:38912
    ds_write_b128 v14, v[236:239] offset:11264
    s_waitcnt lgkmcnt(8)
    v_mfma_f32_16x16x32_bf16 v[76:79], a[124:127], a[28:31], v[116:119]
    v_add_f32 v8, v8, v80
    v_add_f32 v8, v8, v81
    v_exp_f32 v82, v82
    v_mfma_f32_16x16x32_bf16 v[76:79], a[120:123], a[24:27], v[76:79]
    ds_read_b128 a[84:87], v6 offset:37888
    buffer_load_dwordx4 v61, s[84:87], s3 offen offset:3072 lds
    v_mfma_f32_16x16x32_bf16 v[76:79], a[116:119], a[20:23], v[76:79]
    ds_read_b128 a[80:83], v6 offset:36864
    ds_read_b128 a[96:99], v6 offset:40960
    v_exp_f32 v83, v83
    v_mfma_f32_16x16x32_bf16 v[76:79], a[112:115], a[16:19], v[76:79]
    v_cvt_pk_bf16_f32 v104, v80, v81
    ds_write_b128 v14, v[240:243] offset:12288
    v_mfma_f32_16x16x32_bf16 v[160:163], a[128:131], v[96:99], v[160:163]
    ds_read_b128 a[128:131], v6 offset:16384
    ds_write_b128 v14, v[244:247] offset:13312
    v_mfma_f32_16x16x32_bf16 v[160:163], a[132:135], v[100:103], v[160:163]
    ds_read_b128 a[132:135], v6 offset:17408
    ds_write_b128 v14, v[248:251] offset:14336
    v_mfma_f32_16x16x32_bf16 v[164:167], a[140:143], v[100:103], v[164:167]
    v_add_f32 v8, v8, v82
    ds_write_b128 v14, v[252:255] offset:15360
    v_mfma_f32_16x16x32_bf16 v[164:167], a[136:139], v[96:99], v[164:167]
    v_add_f32 v8, v8, v83
    v_cvt_pk_bf16_f32 v105, v82, v83
    v_exp_f32 v84, v84
    v_mfma_f32_16x16x32_bf16 v[168:171], a[144:147], v[96:99], v[168:171]
    s_add_u32 s3, s76, 0x40000
    s_and_b32 s3, s3, 0xe0000
    s_add_u32 s3, s3, s74
    s_bitset1_b32 s3, 16
    buffer_load_dwordx4 a[32:35], v58, s[84:87], s3 offen offset:0
    v_mfma_f32_16x16x32_bf16 v[168:171], a[148:151], v[100:103], v[168:171]
    ds_read_b128 a[140:143], v6 offset:19456
    buffer_load_dwordx4 a[36:39], v59, s[84:87], s3 offen offset:1024
    v_mfma_f32_16x16x32_bf16 v[172:175], a[156:159], v[100:103], v[172:175]
    ds_read_b128 a[136:139], v6 offset:18432
    ds_read_b128 a[144:147], v6 offset:20480
    v_exp_f32 v85, v85
    v_mfma_f32_16x16x32_bf16 v[172:175], a[152:155], v[96:99], v[172:175]
    ds_read_b128 a[148:151], v6 offset:21504
    buffer_load_dwordx4 a[40:43], v60, s[84:87], s3 offen offset:2048
    v_mfma_f32_16x16x32_bf16 v[176:179], a[160:163], v[96:99], v[176:179]
    v_add_f32 v8, v8, v84
    v_add_f32 v8, v8, v85
    v_exp_f32 v86, v86
    v_mfma_f32_16x16x32_bf16 v[176:179], a[164:167], v[100:103], v[176:179]
    ds_read_b128 a[156:159], v6 offset:23552
    ds_read_b128 a[152:155], v6 offset:22528
    ds_read_b128 a[100:103], v6 offset:41984
    v_mfma_f32_16x16x32_bf16 v[180:183], a[172:175], v[100:103], v[180:183]
    buffer_load_dwordx4 a[44:47], v61, s[84:87], s3 offen offset:3072
    v_mfma_f32_16x16x32_bf16 v[180:183], a[168:171], v[96:99], v[180:183]
    ds_read_b128 a[104:107], v6 offset:43008
    ds_read_b128 a[108:111], v6 offset:44032
    v_mfma_f32_16x16x32_bf16 v[184:187], a[176:179], v[96:99], v[184:187]
    ds_write_b32 v16, v10 offset:0
    ds_write_b32 v16, v11 offset:256
    v_mfma_f32_16x16x32_bf16 v[184:187], a[180:183], v[100:103], v[184:187]
    v_exp_f32 v87, v87
    v_mfma_f32_16x16x32_bf16 v[188:191], a[188:191], v[100:103], v[188:191]
    v_cvt_pk_bf16_f32 v106, v84, v85
    v_add_f32 v8, v8, v86
    v_mfma_f32_16x16x32_bf16 v[188:191], a[184:187], v[96:99], v[188:191]
    v_add_f32 v8, v8, v87
    v_cvt_pk_bf16_f32 v107, v86, v87
    s_waitcnt vmcnt(17) lgkmcnt(0)
    s_barrier
    v_mfma_f32_16x16x32_bf16 v[80:83], a[64:67], a[16:19], v[116:119]
    v_xor_b32 v16, 512, v16
    ds_read_b128 a[160:163], v6 offset:24576
    v_exp_f32 v64, v64
    v_mfma_f32_16x16x32_bf16 v[80:83], a[68:71], a[20:23], v[80:83]
    ds_read_b128 a[164:167], v6 offset:25600
    ds_read_b128 a[168:171], v6 offset:26624
    v_exp_f32 v65, v65
    v_mfma_f32_16x16x32_bf16 v[80:83], a[72:75], a[24:27], v[80:83]
    v_add_f32 v9, v9, v64
    v_add_f32 v9, v9, v65
    v_exp_f32 v66, v66
    v_mfma_f32_16x16x32_bf16 v[80:83], a[76:79], a[28:31], v[80:83]
    ds_read_b128 a[172:175], v6 offset:27648
    ds_read_b128 a[176:179], v6 offset:28672
    v_exp_f32 v67, v67
    v_mfma_f32_16x16x32_bf16 v[84:87], a[92:95], a[28:31], v[116:119]
    ds_read_b128 a[180:183], v6 offset:29696
    v_cvt_pk_bf16_f32 v96, v64, v65
    v_add_f32 v9, v9, v66
    v_mfma_f32_16x16x32_bf16 v[84:87], a[88:91], a[24:27], v[84:87]
    v_add_f32 v9, v9, v67
    v_cvt_pk_bf16_f32 v97, v66, v67
    v_exp_f32 v68, v68
    v_mfma_f32_16x16x32_bf16 v[84:87], a[84:87], a[20:23], v[84:87]
    ds_read_b128 a[184:187], v6 offset:30720
    ds_read_b128 a[188:191], v6 offset:31744
    v_exp_f32 v69, v69
    v_mfma_f32_16x16x32_bf16 v[84:87], a[80:83], a[16:19], v[84:87]
    s_xor_b32 m0, s77, 0x10000
    s_add_u32 s3, s76, 0x0
    s_and_b32 s3, s3, 0xe0000
    s_add_u32 s3, s3, s74
    s_bitset1_b32 s3, 16
    buffer_load_dwordx4 v58, s[84:87], s3 offen offset:0 lds
    v_mfma_f32_16x16x32_bf16 v[88:91], a[96:99], a[16:19], v[20:23]
    buffer_load_dwordx4 v59, s[84:87], s3 offen offset:1024 lds
    v_mfma_f32_16x16x32_bf16 v[88:91], a[100:103], a[20:23], v[88:91]
    ds_read_b32 v10, v16 offset:0
    buffer_load_dwordx4 v60, s[84:87], s3 offen offset:2048 lds
    v_mfma_f32_16x16x32_bf16 v[88:91], a[104:107], a[24:27], v[88:91]
    ds_read_b32 v11, v16 offset:256
    buffer_load_dwordx4 v61, s[84:87], s3 offen offset:3072 lds
    v_mfma_f32_16x16x32_bf16 v[88:91], a[108:111], a[28:31], v[88:91]
    ds_read_b128 v[192:195], v15 offset:0
    ds_read_b128 v[196:199], v15 offset:1024
    ds_read_b128 v[200:203], v15 offset:2048
    v_mfma_f32_16x16x32_bf16 v[128:131], a[128:131], v[104:107], v[128:131]
    ds_read_b128 v[204:207], v15 offset:3072
    ds_read_b128 v[208:211], v15 offset:4096
    ds_read_b128 v[212:215], v15 offset:5120
    v_mfma_f32_16x16x32_bf16 v[132:135], a[136:139], v[104:107], v[132:135]
    ds_read_b128 v[216:219], v15 offset:6144
    ds_read_b128 v[220:223], v15 offset:7168
    v_add_f32 v9, v9, v68
    v_mfma_f32_16x16x32_bf16 v[136:139], a[144:147], v[104:107], v[136:139]
    s_xor_b32 m0, s77, 0x18000
    s_add_u32 s3, s76, 0x20000
    s_and_b32 s3, s3, 0xe0000
    s_add_u32 s3, s3, s74
    buffer_load_dwordx4 v58, s[84:87], s3 offen offset:0 lds
    v_mfma_f32_16x16x32_bf16 v[140:143], a[152:155], v[104:107], v[140:143]
    buffer_load_dwordx4 v59, s[84:87], s3 offen offset:1024 lds
    s_waitcnt lgkmcnt(9)
    v_mfma_f32_16x16x32_bf16 v[144:147], a[160:163], v[104:107], v[144:147]
    v_add_f32 v9, v9, v69
    buffer_load_dwordx4 v60, s[84:87], s3 offen offset:2048 lds
    v_mfma_f32_16x16x32_bf16 v[148:151], a[168:171], v[104:107], v[148:151]
    buffer_load_dwordx4 v61, s[84:87], s3 offen offset:3072 lds
    v_mfma_f32_16x16x32_bf16 v[152:155], a[176:179], v[104:107], v[152:155]
    v_exp_f32 v70, v70
    v_exp_f32 v71, v71
    v_mfma_f32_16x16x32_bf16 v[156:159], a[184:187], v[104:107], v[156:159]
    v_cvt_pk_bf16_f32 v98, v68, v69
    v_add_f32 v9, v9, v70
    v_add_f32 v9, v9, v71
    v_cvt_pk_bf16_f32 v99, v70, v71
    v_exp_f32 v72, v72
    v_exp_f32 v73, v73
    v_add_f32 v9, v9, v72
    v_add_f32 v9, v9, v73
    v_exp_f32 v74, v74
    v_exp_f32 v75, v75
    v_cvt_pk_bf16_f32 v100, v72, v73
    v_add_f32 v9, v9, v74
    v_add_f32 v9, v9, v75
    v_cvt_pk_bf16_f32 v101, v74, v75
    v_exp_f32 v76, v76
    v_exp_f32 v77, v77
    v_add_f32 v9, v9, v76
    v_add_f32 v9, v9, v77
    v_exp_f32 v78, v78
    v_exp_f32 v79, v79
    v_cvt_pk_bf16_f32 v102, v76, v77
    v_add_f32 v9, v9, v78
    v_add_f32 v9, v9, v79
    v_cvt_pk_bf16_f32 v103, v78, v79
    v_mfma_f32_16x16x32_bf16 v[160:163], a[128:131], v[96:99], v[160:163]
    v_add_f32 v8, v8, v10
    v_mov_b32 v41, v8
    s_nop 1
    v_mfma_f32_16x16x32_bf16 v[160:163], a[132:135], v[100:103], v[160:163]
    v_permlane16_swap_b32 v8, v41
    v_add_f32 v8, v8, v41
    v_mov_b32 v41, v8
    v_mfma_f32_16x16x32_bf16 v[164:167], a[140:143], v[100:103], v[164:167]
    s_nop 1
    v_permlane32_swap_b32 v8, v41
    v_exp_f32 v80, v80
    v_mfma_f32_16x16x32_bf16 v[164:167], a[136:139], v[96:99], v[164:167]
    s_add_u32 s3, s76, 0x60000
    s_and_b32 s3, s3, 0xe0000
    s_add_u32 s3, s3, s74
    buffer_load_dwordx4 a[48:51], v58, s[84:87], s3 offen offset:0
    v_mfma_f32_16x16x32_bf16 v[168:171], a[144:147], v[96:99], v[168:171]
    v_add_f32 v8, v8, v41
    buffer_load_dwordx4 a[52:55], v59, s[84:87], s3 offen offset:1024
    v_mfma_f32_16x16x32_bf16 v[168:171], a[148:151], v[100:103], v[168:171]
    ds_read_b128 v[224:227], v15 offset:8192
    buffer_load_dwordx4 a[56:59], v60, s[84:87], s3 offen offset:2048
    v_mfma_f32_16x16x32_bf16 v[172:175], a[156:159], v[100:103], v[172:175]
    ds_read_b128 a[64:67], v6 offset:49152
    ds_read_b128 a[68:71], v6 offset:50176
    ds_read_b128 a[76:79], v6 offset:52224
    ds_read_b128 a[72:75], v6 offset:51200
    ds_read_b128 a[80:83], v6 offset:53248
    ds_read_b128 a[84:87], v6 offset:54272
    ds_read_b128 a[92:95], v6 offset:56320
    ds_read_b128 a[88:91], v6 offset:55296
    ds_read_b128 a[96:99], v6 offset:57344
    ds_read_b128 a[100:103], v6 offset:58368
    ds_read_b128 a[108:111], v6 offset:60416
    ds_read_b128 a[104:107], v6 offset:59392
    ds_read_b128 a[112:115], v6 offset:61440
    ds_read_b128 a[116:119], v6 offset:62464
    ds_read_b128 a[124:127], v6 offset:64512
    ds_read_b128 a[120:123], v6 offset:63488
    v_mfma_f32_16x16x32_bf16 v[172:175], a[152:155], v[96:99], v[172:175]
    ds_read_b128 v[228:231], v15 offset:9216
    ds_read_b128 v[232:235], v15 offset:10240
    v_rcp_f32 v40, v8
    v_mfma_f32_16x16x32_bf16 v[176:179], a[160:163], v[96:99], v[176:179]
    v_cmp_nge_f32 vcc, 0x5f800000, v8
    buffer_load_dwordx4 a[60:63], v61, s[84:87], s3 offen offset:3072
    v_mfma_f32_16x16x32_bf16 v[176:179], a[164:167], v[100:103], v[176:179]
    ds_read_b128 v[236:239], v15 offset:11264
    ds_read_b128 v[240:243], v15 offset:12288
    v_exp_f32 v81, v81
    v_mfma_f32_16x16x32_bf16 v[180:183], a[172:175], v[100:103], v[180:183]
    v_add_f32 v9, v9, v80
    v_add_f32 v9, v9, v81
    v_exp_f32 v82, v82
    v_mfma_f32_16x16x32_bf16 v[180:183], a[168:171], v[96:99], v[180:183]
    ds_read_b128 v[244:247], v15 offset:13312
    buffer_load_dwordx4 v[44:47], v57, s[20:23], 0 offen sc1
    v_mfma_f32_16x16x32_bf16 v[184:187], a[176:179], v[96:99], v[184:187]
    ds_read_b128 v[248:251], v15 offset:14336
    ds_read_b128 v[252:255], v15 offset:15360
    v_exp_f32 v83, v83
    v_mfma_f32_16x16x32_bf16 v[184:187], a[180:183], v[100:103], v[184:187]
    s_or_b64 s[50:51], s[50:51], vcc
    v_cvt_pk_bf16_f32 v104, v80, v81
    v_add_f32 v9, v9, v82
    v_mfma_f32_16x16x32_bf16 v[188:191], a[188:191], v[100:103], v[188:191]
    v_add_f32 v9, v9, v83
    v_cvt_pk_bf16_f32 v105, v82, v83
    v_exp_f32 v84, v84
    v_mfma_f32_16x16x32_bf16 v[188:191], a[184:187], v[96:99], v[188:191]
    v_exp_f32 v85, v85
    v_add_f32 v9, v9, v84
    v_add_f32 v9, v9, v85
    v_exp_f32 v86, v86
    v_exp_f32 v87, v87
    v_cvt_pk_bf16_f32 v106, v84, v85
    v_add_f32 v9, v9, v86
    v_add_f32 v9, v9, v87
    v_cvt_pk_bf16_f32 v107, v86, v87
    v_exp_f32 v88, v88
    v_exp_f32 v89, v89
    v_add_f32 v9, v9, v88
    v_add_f32 v9, v9, v89
    v_exp_f32 v90, v90
    v_exp_f32 v91, v91
    v_cvt_pk_bf16_f32 v108, v88, v89
    v_add_f32 v9, v9, v90
    v_add_f32 v9, v9, v91
    v_cvt_pk_bf16_f32 v109, v90, v91
    v_mov_b64 v[110:111], 0
    s_waitcnt lgkmcnt(0)
    v_add_f32 v128, v128, v192
    v_add_f32 v129, v129, v193
    v_add_f32 v130, v130, v194
    v_add_f32 v131, v131, v195
    v_add_f32 v132, v132, v196
    v_add_f32 v133, v133, v197
    v_add_f32 v134, v134, v198
    v_add_f32 v135, v135, v199
    v_mul_f32 v128, v128, v40
    v_mul_f32 v129, v129, v40
    v_mul_f32 v130, v130, v40
    v_mul_f32 v131, v131, v40
    v_mul_f32 v132, v132, v40
    v_mul_f32 v133, v133, v40
    v_mul_f32 v134, v134, v40
    v_mul_f32 v135, v135, v40
    v_cvt_pk_bf16_f32 v32, v128, v129
    v_cvt_pk_bf16_f32 v33, v130, v131
    v_cvt_pk_bf16_f32 v34, v132, v133
    v_cvt_pk_bf16_f32 v35, v134, v135
    s_nop 0
    v_mfma_f32_16x16x32_bf16 v[160:163], a[64:67], v[104:107], v[160:163]
    buffer_store_dwordx4 v[32:35], v2, s[16:19], s44 offen offset:0 sc1
    v_add_f32 v136, v136, v200
    v_add_f32 v137, v137, v201
    v_mfma_f32_16x16x32_bf16 v[160:163], a[68:71], v[108:111], v[160:163]
    v_add_f32 v138, v138, v202
    v_add_f32 v139, v139, v203
    v_add_f32 v140, v140, v204
    v_mfma_f32_16x16x32_bf16 v[164:167], a[76:79], v[108:111], v[164:167]
    v_add_f32 v141, v141, v205
    v_add_f32 v142, v142, v206
    v_add_f32 v143, v143, v207
    v_mfma_f32_16x16x32_bf16 v[164:167], a[72:75], v[104:107], v[164:167]
    v_mul_f32 v136, v136, v40
    v_mul_f32 v137, v137, v40
    v_mul_f32 v138, v138, v40
    v_mfma_f32_16x16x32_bf16 v[168:171], a[80:83], v[104:107], v[168:171]
    v_mul_f32 v139, v139, v40
    v_mul_f32 v140, v140, v40
    v_mul_f32 v141, v141, v40
    v_mfma_f32_16x16x32_bf16 v[168:171], a[84:87], v[108:111], v[168:171]
    v_mul_f32 v142, v142, v40
    v_mul_f32 v143, v143, v40
    v_cvt_pk_bf16_f32 v36, v136, v137
    v_mfma_f32_16x16x32_bf16 v[172:175], a[92:95], v[108:111], v[172:175]
    v_cvt_pk_bf16_f32 v37, v138, v139
    v_cvt_pk_bf16_f32 v38, v140, v141
    v_cvt_pk_bf16_f32 v39, v142, v143
    v_mfma_f32_16x16x32_bf16 v[172:175], a[88:91], v[104:107], v[172:175]
    buffer_store_dwordx4 v[36:39], v2, s[16:19], s44 offen offset:1024 sc1
    v_add_f32 v144, v144, v208
    v_add_f32 v145, v145, v209
    v_mfma_f32_16x16x32_bf16 v[176:179], a[96:99], v[104:107], v[176:179]
    v_add_f32 v146, v146, v210
    v_add_f32 v147, v147, v211
    v_add_f32 v148, v148, v212
    v_mfma_f32_16x16x32_bf16 v[176:179], a[100:103], v[108:111], v[176:179]
    v_add_f32 v149, v149, v213
    v_add_f32 v150, v150, v214
    v_add_f32 v151, v151, v215
    v_mfma_f32_16x16x32_bf16 v[180:183], a[108:111], v[108:111], v[180:183]
    v_mul_f32 v144, v144, v40
    v_mul_f32 v145, v145, v40
    v_mul_f32 v146, v146, v40
    v_mfma_f32_16x16x32_bf16 v[180:183], a[104:107], v[104:107], v[180:183]
    v_mul_f32 v147, v147, v40
    v_mul_f32 v148, v148, v40
    v_mul_f32 v149, v149, v40
    v_mfma_f32_16x16x32_bf16 v[184:187], a[112:115], v[104:107], v[184:187]
    v_mul_f32 v150, v150, v40
    v_mul_f32 v151, v151, v40
    v_cvt_pk_bf16_f32 v32, v144, v145
    v_mfma_f32_16x16x32_bf16 v[184:187], a[116:119], v[108:111], v[184:187]
    v_cvt_pk_bf16_f32 v33, v146, v147
    v_cvt_pk_bf16_f32 v34, v148, v149
    v_cvt_pk_bf16_f32 v35, v150, v151
    v_mfma_f32_16x16x32_bf16 v[188:191], a[124:127], v[108:111], v[188:191]
    buffer_store_dwordx4 v[32:35], v2, s[16:19], s44 offen offset:2048 sc1
    v_add_f32 v152, v152, v216
    v_add_f32 v153, v153, v217
    v_mfma_f32_16x16x32_bf16 v[188:191], a[120:123], v[104:107], v[188:191]
    v_add_f32 v154, v154, v218
    v_add_f32 v155, v155, v219
    v_add_f32 v156, v156, v220
    v_add_f32 v157, v157, v221
    v_add_f32 v158, v158, v222
    v_add_f32 v159, v159, v223
    v_mul_f32 v152, v152, v40
    v_mul_f32 v153, v153, v40
    v_mul_f32 v154, v154, v40
    v_mul_f32 v155, v155, v40
    v_mul_f32 v156, v156, v40
    v_mul_f32 v157, v157, v40
    v_mul_f32 v158, v158, v40
    v_mul_f32 v159, v159, v40
    v_cvt_pk_bf16_f32 v36, v152, v153
    v_cvt_pk_bf16_f32 v37, v154, v155
    v_cvt_pk_bf16_f32 v38, v156, v157
    v_cvt_pk_bf16_f32 v39, v158, v159
    buffer_store_dwordx4 v[36:39], v2, s[16:19], s44 offen offset:3072 sc1
    v_add_f32 v9, v9, v11
    v_mov_b32 v43, v9
    s_nop 1
    v_permlane16_swap_b32 v9, v43
    v_add_f32 v9, v9, v43
    v_mov_b32 v43, v9
    s_nop 1
    v_permlane32_swap_b32 v9, v43
    v_add_f32 v9, v9, v43
    v_rcp_f32 v42, v9
    v_cmp_nge_f32 vcc, 0x5f800000, v9
    s_or_b64 s[50:51], s[50:51], vcc
    s_nop 3
    v_pk_add_f32 v[160:161], v[160:161], v[224:225]
    v_pk_add_f32 v[162:163], v[162:163], v[226:227]
    v_pk_add_f32 v[164:165], v[164:165], v[228:229]
    v_pk_add_f32 v[166:167], v[166:167], v[230:231]
    v_pk_mul_f32 v[160:161], v[160:161], v[42:43] op_sel_hi:[1,0]
    v_pk_mul_f32 v[162:163], v[162:163], v[42:43] op_sel_hi:[1,0]
    v_pk_mul_f32 v[164:165], v[164:165], v[42:43] op_sel_hi:[1,0]
    v_pk_mul_f32 v[166:167], v[166:167], v[42:43] op_sel_hi:[1,0]
    v_cvt_pk_bf16_f32 v32, v160, v161
    v_cvt_pk_bf16_f32 v33, v162, v163
    v_cvt_pk_bf16_f32 v34, v164, v165
    v_cvt_pk_bf16_f32 v35, v166, v167
    buffer_store_dwordx4 v[32:35], v2, s[16:19], s45 offen offset:0 sc1
    v_pk_add_f32 v[168:169], v[168:169], v[232:233]
    v_pk_add_f32 v[170:171], v[170:171], v[234:235]
    v_pk_add_f32 v[172:173], v[172:173], v[236:237]
    v_pk_add_f32 v[174:175], v[174:175], v[238:239]
    v_pk_mul_f32 v[168:169], v[168:169], v[42:43] op_sel_hi:[1,0]
    v_pk_mul_f32 v[170:171], v[170:171], v[42:43] op_sel_hi:[1,0]
    v_pk_mul_f32 v[172:173], v[172:173], v[42:43] op_sel_hi:[1,0]
    v_pk_mul_f32 v[174:175], v[174:175], v[42:43] op_sel_hi:[1,0]
    v_cvt_pk_bf16_f32 v36, v168, v169
    v_cvt_pk_bf16_f32 v37, v170, v171
    v_cvt_pk_bf16_f32 v38, v172, v173
    v_cvt_pk_bf16_f32 v39, v174, v175
    buffer_store_dwordx4 v[36:39], v2, s[16:19], s45 offen offset:1024 sc1
    v_pk_add_f32 v[176:177], v[176:177], v[240:241]
    v_pk_add_f32 v[178:179], v[178:179], v[242:243]
    v_pk_add_f32 v[180:181], v[180:181], v[244:245]
    v_pk_add_f32 v[182:183], v[182:183], v[246:247]
    v_pk_mul_f32 v[176:177], v[176:177], v[42:43] op_sel_hi:[1,0]
    v_pk_mul_f32 v[178:179], v[178:179], v[42:43] op_sel_hi:[1,0]
    v_pk_mul_f32 v[180:181], v[180:181], v[42:43] op_sel_hi:[1,0]
    v_pk_mul_f32 v[182:183], v[182:183], v[42:43] op_sel_hi:[1,0]
    v_cvt_pk_bf16_f32 v32, v176, v177
    v_cvt_pk_bf16_f32 v33, v178, v179
    v_cvt_pk_bf16_f32 v34, v180, v181
    v_cvt_pk_bf16_f32 v35, v182, v183
    buffer_store_dwordx4 v[32:35], v2, s[16:19], s45 offen offset:2048 sc1
    v_pk_add_f32 v[184:185], v[184:185], v[248:249]
    v_pk_add_f32 v[186:187], v[186:187], v[250:251]
    v_pk_add_f32 v[188:189], v[188:189], v[252:253]
    v_pk_add_f32 v[190:191], v[190:191], v[254:255]
    v_pk_mul_f32 v[184:185], v[184:185], v[42:43] op_sel_hi:[1,0]
    v_pk_mul_f32 v[186:187], v[186:187], v[42:43] op_sel_hi:[1,0]
    v_pk_mul_f32 v[188:189], v[188:189], v[42:43] op_sel_hi:[1,0]
    v_pk_mul_f32 v[190:191], v[190:191], v[42:43] op_sel_hi:[1,0]
    v_cvt_pk_bf16_f32 v36, v184, v185
    v_cvt_pk_bf16_f32 v37, v186, v187
    v_cvt_pk_bf16_f32 v38, v188, v189
    v_cvt_pk_bf16_f32 v39, v190, v191
    buffer_store_dwordx4 v[36:39], v2, s[16:19], s45 offen offset:3072 sc1
    s_branch L_fin
L_d2_2:
    s_waitcnt lgkmcnt(0)
    v_mfma_f32_16x16x32_bf16 v[80:83], a[64:67], a[0:3], v[112:115]
    ds_read_b128 a[124:127], v6 offset:15360
    ds_read_b128 a[120:123], v6 offset:14336
    v_exp_f32 v64, v64
    v_mfma_f32_16x16x32_bf16 v[80:83], a[68:71], a[4:7], v[80:83]
    ds_read_b128 a[116:119], v6 offset:13312
    ds_read_b128 a[112:115], v6 offset:12288
    v_exp_f32 v65, v65
    v_mfma_f32_16x16x32_bf16 v[80:83], a[72:75], a[8:11], v[80:83]
    v_add_f32 v9, v9, v64
    ds_write_b128 v14, v[192:195] offset:0
    v_mfma_f32_16x16x32_bf16 v[80:83], a[76:79], a[12:15], v[80:83]
    s_add_u32 s3, s76, 0x20000
    s_and_b32 s3, s3, 0xe0000
    s_add_u32 s3, s3, s74
    s_bitset1_b32 s3, 16
    buffer_load_dwordx4 a[192:195], v58, s[84:87], s3 offen offset:0
    v_mfma_f32_16x16x32_bf16 v[84:87], a[92:95], a[12:15], v[112:115]
    v_add_f32 v9, v9, v65
    buffer_load_dwordx4 a[196:199], v59, s[84:87], s3 offen offset:1024
    v_mfma_f32_16x16x32_bf16 v[84:87], a[88:91], a[8:11], v[84:87]
    v_exp_f32 v66, v66
    v_exp_f32 v67, v67
    v_mfma_f32_16x16x32_bf16 v[84:87], a[84:87], a[4:7], v[84:87]
    v_cvt_pk_bf16_f32 v96, v64, v65
    buffer_load_dwordx4 a[200:203], v60, s[84:87], s3 offen offset:2048
    v_mfma_f32_16x16x32_bf16 v[84:87], a[80:83], a[0:3], v[84:87]
    v_add_f32 v9, v9, v66
    ds_write_b128 v14, v[196:199] offset:1024
    v_mfma_f32_16x16x32_bf16 v[88:91], a[96:99], a[0:3], v[20:23]
    v_add_f32 v9, v9, v67
    ds_write_b128 v14, v[200:203] offset:2048
    v_mfma_f32_16x16x32_bf16 v[88:91], a[100:103], a[4:7], v[88:91]
    v_cvt_pk_bf16_f32 v97, v66, v67
    buffer_load_dwordx4 a[204:207], v61, s[84:87], s3 offen offset:3072
    v_mfma_f32_16x16x32_bf16 v[88:91], a[104:107], a[8:11], v[88:91]
    v_exp_f32 v68, v68
    v_exp_f32 v69, v69
    v_mfma_f32_16x16x32_bf16 v[88:91], a[108:111], a[12:15], v[88:91]
    v_add_f32 v9, v9, v68
    ds_write_b128 v14, v[204:207] offset:3072
    v_mfma_f32_16x16x32_bf16 v[128:131], a[128:131], v[104:107], v[128:131]
    v_add_f32 v9, v9, v69
    ds_write_b128 v14, v[208:211] offset:4096
    v_mfma_f32_16x16x32_bf16 v[128:131], a[132:135], v[108:111], v[128:131]
    v_exp_f32 v70, v70
    v_exp_f32 v71, v71
    v_mfma_f32_16x16x32_bf16 v[132:135], a[140:143], v[108:111], v[132:135]
    v_cvt_pk_bf16_f32 v98, v68, v69
    ds_write_b128 v14, v[212:215] offset:5120
    v_mfma_f32_16x16x32_bf16 v[132:135], a[136:139], v[104:107], v[132:135]
    v_add_f32 v9, v9, v70
    v_add_f32 v9, v9, v71
    v_cvt_pk_bf16_f32 v99, v70, v71
    v_mfma_f32_16x16x32_bf16 v[136:139], a[144:147], v[104:107], v[136:139]
    s_add_u32 s3, s76, 0x40000
    s_and_b32 s3, s3, 0xe0000
    s_add_u32 s3, s3, s74
    buffer_load_dwordx4 a[208:211], v58, s[84:87], s3 offen offset:0
    v_mfma_f32_16x16x32_bf16 v[136:139], a[148:151], v[108:111], v[136:139]
    buffer_load_dwordx4 a[212:215], v59, s[84:87], s3 offen offset:1024
    v_mfma_f32_16x16x32_bf16 v[140:143], a[156:159], v[108:111], v[140:143]
    v_exp_f32 v72, v72
    v_exp_f32 v73, v73
    v_mfma_f32_16x16x32_bf16 v[140:143], a[152:155], v[104:107], v[140:143]
    v_add_f32 v9, v9, v72
    buffer_load_dwordx4 a[216:219], v60, s[84:87], s3 offen offset:2048
    v_mfma_f32_16x16x32_bf16 v[144:147], a[160:163], v[104:107], v[144:147]
    v_add_f32 v9, v9, v73
    ds_write_b128 v14, v[216:219] offset:6144
    v_mfma_f32_16x16x32_bf16 v[144:147], a[164:167], v[108:111], v[144:147]
    v_exp_f32 v74, v74
    v_exp_f32 v75, v75
    v_mfma_f32_16x16x32_bf16 v[148:151], a[172:175], v[108:111], v[148:151]
    v_cvt_pk_bf16_f32 v100, v72, v73
    buffer_load_dwordx4 a[220:223], v61, s[84:87], s3 offen offset:3072
    v_mfma_f32_16x16x32_bf16 v[148:151], a[168:171], v[104:107], v[148:151]
    v_add_f32 v9, v9, v74
    ds_write_b128 v14, v[220:223] offset:7168
    v_mfma_f32_16x16x32_bf16 v[152:155], a[176:179], v[104:107], v[152:155]
    v_add_f32 v9, v9, v75
    v_cvt_pk_bf16_f32 v101, v74, v75
    v_exp_f32 v76, v76
    v_mfma_f32_16x16x32_bf16 v[152:155], a[180:183], v[108:111], v[152:155]
    v_exp_f32 v77, v77
    v_add_f32 v9, v9, v76
    v_mfma_f32_16x16x32_bf16 v[156:159], a[188:191], v[108:111], v[156:159]
    v_add_f32 v9, v9, v77
    v_exp_f32 v78, v78
    v_mfma_f32_16x16x32_bf16 v[156:159], a[184:187], v[104:107], v[156:159]
    v_exp_f32 v79, v79
    v_cvt_pk_bf16_f32 v102, v76, v77
    v_add_f32 v9, v9, v78
    v_add_f32 v9, v9, v79
    v_cvt_pk_bf16_f32 v103, v78, v79
    s_waitcnt vmcnt(8)
    s_barrier
    v_mfma_f32_16x16x32_bf16 v[64:67], a[64:67], a[16:19], v[116:119]
    s_cmp_lg_u64 s[50:51], 0
    s_cselect_b32 s3, 1, 0
    s_cmp_gt_u32 s3, s48
    s_cselect_b32 s3, 0x80000000, 0
    v_mfma_f32_16x16x32_bf16 v[64:67], a[68:71], a[20:23], v[64:67]
    s_cmp_lt_u32 s34, 7
    s_cselect_b32 s3, 0x80000000, s3
    v_lshl_or_b32 v42, v2, 20, s3
    v_mfma_f32_16x16x32_bf16 v[64:67], a[72:75], a[24:27], v[64:67]
    v_mov_b32 v40, s80
    v_mov_b32 v41, s81
    buffer_store_dwordx2 v[40:41], v42, s[20:23], s75 offen sc1
    v_mfma_f32_16x16x32_bf16 v[64:67], a[76:79], a[28:31], v[64:67]
    v_cndmask_b32_e64 v20, v7, v116, s[24:25]
    v_cndmask_b32_e64 v21, v7, v116, s[26:27]
    v_exp_f32 v80, v80
    v_mfma_f32_16x16x32_bf16 v[68:71], a[92:95], a[28:31], v[116:119]
    v_cndmask_b32_e64 v22, v7, v116, s[28:29]
    v_cndmask_b32_e64 v23, v7, v116, s[30:31]
    v_exp_f32 v81, v81
    v_mfma_f32_16x16x32_bf16 v[68:71], a[88:91], a[24:27], v[68:71]
    ds_read_b128 a[64:67], v6 offset:32768
    ds_write_b128 v14, v[224:227] offset:8192
    v_mfma_f32_16x16x32_bf16 v[68:71], a[84:87], a[20:23], v[68:71]
    ds_read_b128 a[68:71], v6 offset:33792
    ds_write_b128 v14, v[228:231] offset:9216
    v_mfma_f32_16x16x32_bf16 v[68:71], a[80:83], a[16:19], v[68:71]
    s_xor_b32 m0, s77, 0x8000
    s_add_u32 s3, s76, 0x0
    s_and_b32 s3, s3, 0xe0000
    s_add_u32 s3, s3, s74
    buffer_load_dwordx4 v58, s[84:87], s3 offen offset:0 lds
    v_mfma_f32_16x16x32_bf16 v[72:75], a[96:99], a[16:19], v[116:119]
    ds_read_b128 a[72:75], v6 offset:34816
    buffer_load_dwordx4 v59, s[84:87], s3 offen offset:1024 lds
    v_mfma_f32_16x16x32_bf16 v[72:75], a[100:103], a[20:23], v[72:75]
    ds_read_b128 a[76:79], v6 offset:35840
    ds_write_b128 v14, v[232:235] offset:10240
    v_mfma_f32_16x16x32_bf16 v[72:75], a[104:107], a[24:27], v[72:75]
    ds_read_b128 a[92:95], v6 offset:39936
    buffer_load_dwordx4 v60, s[84:87], s3 offen offset:2048 lds
    v_mfma_f32_16x16x32_bf16 v[72:75], a[108:111], a[28:31], v[72:75]
    v_add_f32 v8, v8, v80
    v_add_f32 v8, v8, v81
    v_exp_f32 v82, v82
    s_waitcnt lgkmcnt(6)
    v_mfma_f32_16x16x32_bf16 v[76:79], a[124:127], a[28:31], v[116:119]
    ds_read_b128 a[88:91], v6 offset:38912
    ds_read_b128 a[84:87], v6 offset:37888
    v_exp_f32 v83, v83
    v_mfma_f32_16x16x32_bf16 v[76:79], a[120:123], a[24:27], v[76:79]
    ds_read_b128 a[80:83], v6 offset:36864
    buffer_load_dwordx4 v61, s[84:87], s3 offen offset:3072 lds
    v_mfma_f32_16x16x32_bf16 v[76:79], a[116:119], a[20:23], v[76:79]
    v_cvt_pk_bf16_f32 v104, v80, v81
    ds_write_b128 v14, v[236:239] offset:11264
    v_mfma_f32_16x16x32_bf16 v[76:79], a[112:115], a[16:19], v[76:79]
    v_add_f32 v8, v8, v82
    ds_write_b128 v14, v[240:243] offset:12288
    v_mfma_f32_16x16x32_bf16 v[160:163], a[128:131], v[96:99], v[160:163]
    ds_read_b128 a[128:131], v6 offset:16384
    ds_write_b128 v14, v[244:247] offset:13312
    v_mfma_f32_16x16x32_bf16 v[160:163], a[132:135], v[100:103], v[160:163]
    ds_read_b128 a[132:135], v6 offset:17408
    ds_write_b128 v14, v[248:251] offset:14336
    v_mfma_f32_16x16x32_bf16 v[164:167], a[140:143], v[100:103], v[164:167]
    ds_read_b128 a[140:143], v6 offset:19456
    ds_write_b128 v14, v[252:255] offset:15360
    v_mfma_f32_16x16x32_bf16 v[164:167], a[136:139], v[96:99], v[164:167]
    v_add_f32 v8, v8, v83
    v_cvt_pk_bf16_f32 v105, v82, v83
    v_exp_f32 v84, v84
    v_mfma_f32_16x16x32_bf16 v[168:171], a[144:147], v[96:99], v[168:171]
    s_add_u32 s3, s76, 0x40000
    s_and_b32 s3, s3, 0xe0000
    s_add_u32 s3, s3, s74
    s_bitset1_b32 s3, 16
    buffer_load_dwordx4 a[32:35], v58, s[84:87], s3 offen offset:0
    v_mfma_f32_16x16x32_bf16 v[168:171], a[148:151], v[100:103], v[168:171]
    ds_read_b128 a[136:139], v6 offset:18432
    buffer_load_dwordx4 a[36:39], v59, s[84:87], s3 offen offset:1024
    v_mfma_f32_16x16x32_bf16 v[172:175], a[156:159], v[100:103], v[172:175]
    ds_read_b128 a[144:147], v6 offset:20480
    ds_read_b128 a[148:151], v6 offset:21504
    v_exp_f32 v85, v85
    v_mfma_f32_16x16x32_bf16 v[172:175], a[152:155], v[96:99], v[172:175]
    ds_read_b128 a[156:159], v6 offset:23552
    buffer_load_dwordx4 a[40:43], v60, s[84:87], s3 offen offset:2048
    v_mfma_f32_16x16x32_bf16 v[176:179], a[160:163], v[96:99], v[176:179]
    v_add_f32 v8, v8, v84
    v_add_f32 v8, v8, v85
    v_exp_f32 v86, v86
    v_mfma_f32_16x16x32_bf16 v[176:179], a[164:167], v[100:103], v[176:179]
    ds_read_b128 a[152:155], v6 offset:22528
    ds_write_b32 v16, v10 offset:0
    v_exp_f32 v87, v87
    v_mfma_f32_16x16x32_bf16 v[180:183], a[172:175], v[100:103], v[180:183]
    ds_write_b32 v16, v11 offset:256
    buffer_load_dwordx4 a[44:47], v61, s[84:87], s3 offen offset:3072
    v_mfma_f32_16x16x32_bf16 v[180:183], a[168:171], v[96:99], v[180:183]
    v_cvt_pk_bf16_f32 v106, v84, v85
    v_add_f32 v8, v8, v86
    v_add_f32 v8, v8, v87
    v_mfma_f32_16x16x32_bf16 v[184:187], a[176:179], v[96:99], v[184:187]
    v_cvt_pk_bf16_f32 v107, v86, v87
    v_exp_f32 v88, v88
    v_mfma_f32_16x16x32_bf16 v[184:187], a[180:183], v[100:103], v[184:187]
    v_exp_f32 v89, v89
    v_add_f32 v8, v8, v88
    v_mfma_f32_16x16x32_bf16 v[188:191], a[188:191], v[100:103], v[188:191]
    v_add_f32 v8, v8, v89
    v_exp_f32 v90, v90
    v_mfma_f32_16x16x32_bf16 v[188:191], a[184:187], v[96:99], v[188:191]
    v_exp_f32 v91, v91
    v_cvt_pk_bf16_f32 v108, v88, v89
    v_add_f32 v8, v8, v90
    v_add_f32 v8, v8, v91
    v_cvt_pk_bf16_f32 v109, v90, v91
    v_mov_b64 v[110:111], 0
    s_waitcnt vmcnt(17) lgkmcnt(0)
    s_barrier
    v_mfma_f32_16x16x32_bf16 v[80:83], a[64:67], a[16:19], v[116:119]
    v_xor_b32 v16, 512, v16
    ds_read_b32 v10, v16 offset:0
    v_exp_f32 v64, v64
    v_mfma_f32_16x16x32_bf16 v[80:83], a[68:71], a[20:23], v[80:83]
    ds_read_b32 v11, v16 offset:256
    ds_read_b128 a[160:163], v6 offset:24576
    v_exp_f32 v65, v65
    v_mfma_f32_16x16x32_bf16 v[80:83], a[72:75], a[24:27], v[80:83]
    v_add_f32 v9, v9, v64
    v_add_f32 v9, v9, v65
    v_exp_f32 v66, v66
    v_mfma_f32_16x16x32_bf16 v[80:83], a[76:79], a[28:31], v[80:83]
    ds_read_b128 a[164:167], v6 offset:25600
    ds_read_b128 a[172:175], v6 offset:27648
    v_exp_f32 v67, v67
    v_mfma_f32_16x16x32_bf16 v[84:87], a[92:95], a[28:31], v[20:23]
    ds_read_b128 a[168:171], v6 offset:26624
    v_cvt_pk_bf16_f32 v96, v64, v65
    v_add_f32 v9, v9, v66
    v_mfma_f32_16x16x32_bf16 v[84:87], a[88:91], a[24:27], v[84:87]
    v_add_f32 v9, v9, v67
    v_cvt_pk_bf16_f32 v97, v66, v67
    v_exp_f32 v68, v68
    v_mfma_f32_16x16x32_bf16 v[84:87], a[84:87], a[20:23], v[84:87]
    ds_read_b128 a[176:179], v6 offset:28672
    ds_read_b128 a[180:183], v6 offset:29696
    v_exp_f32 v69, v69
    v_mfma_f32_16x16x32_bf16 v[84:87], a[80:83], a[16:19], v[84:87]
    s_xor_b32 m0, s77, 0x10000
    s_add_u32 s3, s76, 0x0
    s_and_b32 s3, s3, 0xe0000
    s_add_u32 s3, s3, s74
    s_bitset1_b32 s3, 16
    buffer_load_dwordx4 v58, s[84:87], s3 offen offset:0 lds
    v_mfma_f32_16x16x32_bf16 v[128:131], a[128:131], v[104:107], v[128:131]
    ds_read_b128 a[188:191], v6 offset:31744
    buffer_load_dwordx4 v59, s[84:87], s3 offen offset:1024 lds
    v_mfma_f32_16x16x32_bf16 v[128:131], a[132:135], v[108:111], v[128:131]
    ds_read_b128 a[184:187], v6 offset:30720
    buffer_load_dwordx4 v60, s[84:87], s3 offen offset:2048 lds
    v_mfma_f32_16x16x32_bf16 v[132:135], a[140:143], v[108:111], v[132:135]
    ds_read_b128 v[192:195], v15 offset:0
    buffer_load_dwordx4 v61, s[84:87], s3 offen offset:3072 lds
    v_mfma_f32_16x16x32_bf16 v[132:135], a[136:139], v[104:107], v[132:135]
    v_add_f32 v9, v9, v68
    v_add_f32 v9, v9, v69
    v_exp_f32 v70, v70
    v_mfma_f32_16x16x32_bf16 v[136:139], a[144:147], v[104:107], v[136:139]
    ds_read_b128 v[196:199], v15 offset:1024
    ds_read_b128 v[200:203], v15 offset:2048
    v_exp_f32 v71, v71
    v_mfma_f32_16x16x32_bf16 v[136:139], a[148:151], v[108:111], v[136:139]
    ds_read_b128 v[204:207], v15 offset:3072
    v_cvt_pk_bf16_f32 v98, v68, v69
    v_add_f32 v9, v9, v70
    v_mfma_f32_16x16x32_bf16 v[140:143], a[156:159], v[108:111], v[140:143]
    v_add_f32 v9, v9, v71
    v_cvt_pk_bf16_f32 v99, v70, v71
    v_exp_f32 v72, v72
    v_mfma_f32_16x16x32_bf16 v[140:143], a[152:155], v[104:107], v[140:143]
    ds_read_b128 v[208:211], v15 offset:4096
    ds_read_b128 v[212:215], v15 offset:5120
    v_exp_f32 v73, v73
    s_waitcnt lgkmcnt(5)
    v_mfma_f32_16x16x32_bf16 v[144:147], a[160:163], v[104:107], v[144:147]
    s_xor_b32 m0, s77, 0x18000
    s_add_u32 s3, s76, 0x20000
    s_and_b32 s3, s3, 0xe0000
    s_add_u32 s3, s3, s74
    buffer_load_dwordx4 v58, s[84:87], s3 offen offset:0 lds
    v_mfma_f32_16x16x32_bf16 v[144:147], a[164:167], v[108:111], v[144:147]
    ds_read_b128 v[216:219], v15 offset:6144
    buffer_load_dwordx4 v59, s[84:87], s3 offen offset:1024 lds
    v_mfma_f32_16x16x32_bf16 v[148:151], a[172:175], v[108:111], v[148:151]
    ds_read_b128 v[220:223], v15 offset:7168
    buffer_load_dwordx4 v60, s[84:87], s3 offen offset:2048 lds
    v_mfma_f32_16x16x32_bf16 v[148:151], a[168:171], v[104:107], v[148:151]
    v_add_f32 v9, v9, v72
    buffer_load_dwordx4 v61, s[84:87], s3 offen offset:3072 lds
    v_mfma_f32_16x16x32_bf16 v[152:155], a[176:179], v[104:107], v[152:155]
    v_add_f32 v9, v9, v73
    v_exp_f32 v74, v74
    v_mfma_f32_16x16x32_bf16 v[152:155], a[180:183], v[108:111], v[152:155]
    v_exp_f32 v75, v75
    v_cvt_pk_bf16_f32 v100, v72, v73
    v_mfma_f32_16x16x32_bf16 v[156:159], a[188:191], v[108:111], v[156:159]
    v_add_f32 v9, v9, v74
    v_add_f32 v9, v9, v75
    v_cvt_pk_bf16_f32 v101, v74, v75
    v_mfma_f32_16x16x32_bf16 v[156:159], a[184:187], v[104:107], v[156:159]
    v_exp_f32 v76, v76
    v_exp_f32 v77, v77
    v_add_f32 v9, v9, v76
    v_add_f32 v9, v9, v77
    v_exp_f32 v78, v78
    v_exp_f32 v79, v79
    v_cvt_pk_bf16_f32 v102, v76, v77
    v_add_f32 v9, v9, v78
    v_add_f32 v9, v9, v79
    v_cvt_pk_bf16_f32 v103, v78, v79
    v_mfma_f32_16x16x32_bf16 v[160:163], a[128:131], v[96:99], v[160:163]
    ds_read_b128 a[64:67], v6 offset:49152
    ds_read_b128 a[72:75], v6 offset:51200
    ds_read_b128 a[80:83], v6 offset:53248
    v_mfma_f32_16x16x32_bf16 v[160:163], a[132:135], v[100:103], v[160:163]
    ds_read_b128 a[88:91], v6 offset:55296
    ds_read_b128 a[96:99], v6 offset:57344
    ds_read_b128 a[104:107], v6 offset:59392
    v_mfma_f32_16x16x32_bf16 v[164:167], a[140:143], v[100:103], v[164:167]
    ds_read_b128 a[112:115], v6 offset:61440
    ds_read_b128 a[120:123], v6 offset:63488
    v_exp_f32 v80, v80
    v_mfma_f32_16x16x32_bf16 v[164:167], a[136:139], v[96:99], v[164:167]
    s_add_u32 s3, s76, 0x60000
    s_and_b32 s3, s3, 0xe0000
    s_add_u32 s3, s3, s74
    buffer_load_dwordx4 a[48:51], v58, s[84:87], s3 offen offset:0
    v_mfma_f32_16x16x32_bf16 v[168:171], a[144:147], v[96:99], v[168:171]
    v_add_f32 v8, v8, v10
    buffer_load_dwordx4 a[52:55], v59, s[84:87], s3 offen offset:1024
    v_mfma_f32_16x16x32_bf16 v[168:171], a[148:151], v[100:103], v[168:171]
    ds_read_b128 v[224:227], v15 offset:8192
    buffer_load_dwordx4 a[56:59], v60, s[84:87], s3 offen offset:2048
    v_mfma_f32_16x16x32_bf16 v[172:175], a[156:159], v[100:103], v[172:175]
    ds_read_b128 v[228:231], v15 offset:9216
    ds_read_b128 v[232:235], v15 offset:10240
    v_exp_f32 v81, v81
    v_mfma_f32_16x16x32_bf16 v[172:175], a[152:155], v[96:99], v[172:175]
    v_add_f32 v9, v9, v80
    v_add_f32 v9, v9, v81
    v_exp_f32 v82, v82
    v_mfma_f32_16x16x32_bf16 v[176:179], a[160:163], v[96:99], v[176:179]
    ds_read_b128 v[236:239], v15 offset:11264
    buffer_load_dwordx4 a[60:63], v61, s[84:87], s3 offen offset:3072
    v_mfma_f32_16x16x32_bf16 v[176:179], a[164:167], v[100:103], v[176:179]
    ds_read_b128 v[240:243], v15 offset:12288
    ds_read_b128 v[244:247], v15 offset:13312
    v_exp_f32 v83, v83
    v_mfma_f32_16x16x32_bf16 v[180:183], a[172:175], v[100:103], v[180:183]
    ds_read_b128 v[248:251], v15 offset:14336
    ds_read_b128 v[252:255], v15 offset:15360
    v_cvt_pk_bf16_f32 v104, v80, v81
    v_mfma_f32_16x16x32_bf16 v[180:183], a[168:171], v[96:99], v[180:183]
    v_add_f32 v9, v9, v82
    buffer_load_dwordx4 v[44:47], v57, s[20:23], 0 offen sc1
    v_mfma_f32_16x16x32_bf16 v[184:187], a[176:179], v[96:99], v[184:187]
    v_add_f32 v9, v9, v83
    v_cvt_pk_bf16_f32 v105, v82, v83
    v_exp_f32 v84, v84
    v_mfma_f32_16x16x32_bf16 v[184:187], a[180:183], v[100:103], v[184:187]
    v_mov_b32 v41, v8
    s_nop 1
    v_exp_f32 v85, v85
    v_mfma_f32_16x16x32_bf16 v[188:191], a[188:191], v[100:103], v[188:191]
    v_add_f32 v9, v9, v84
    v_add_f32 v9, v9, v85
    v_exp_f32 v86, v86
    v_mfma_f32_16x16x32_bf16 v[188:191], a[184:187], v[96:99], v[188:191]
    v_exp_f32 v87, v87
    v_cvt_pk_bf16_f32 v106, v84, v85
    v_add_f32 v9, v9, v86
    v_add_f32 v9, v9, v87
    v_cvt_pk_bf16_f32 v107, v86, v87
    v_permlane16_swap_b32 v8, v41
    v_add_f32 v8, v8, v41
    v_mov_b32 v41, v8
    s_nop 1
    v_permlane32_swap_b32 v8, v41
    v_add_f32 v8, v8, v41
    v_rcp_f32 v40, v8
    v_cmp_nge_f32 vcc, 0x5f800000, v8
    s_or_b64 s[50:51], s[50:51], vcc
    v_add_f32 v128, v128, v192
    v_add_f32 v129, v129, v193
    v_add_f32 v130, v130, v194
    v_add_f32 v131, v131, v195
    s_waitcnt lgkmcnt(0)
    v_add_f32 v132, v132, v196
    v_add_f32 v133, v133, v197
    v_add_f32 v134, v134, v198
    v_add_f32 v135, v135, v199
    v_mul_f32 v128, v128, v40
    v_mul_f32 v129, v129, v40
    v_mul_f32 v130, v130, v40
    v_mul_f32 v131, v131, v40
    v_mul_f32 v132, v132, v40
    v_mul_f32 v133, v133, v40
    v_mul_f32 v134, v134, v40
    v_mul_f32 v135, v135, v40
    v_cvt_pk_bf16_f32 v32, v128, v129
    v_cvt_pk_bf16_f32 v33, v130, v131
    v_cvt_pk_bf16_f32 v34, v132, v133
    v_cvt_pk_bf16_f32 v35, v134, v135
    s_nop 0
    v_mfma_f32_16x16x32_bf16 v[160:163], a[64:67], v[104:107], v[160:163]
    buffer_store_dwordx4 v[32:35], v2, s[16:19], s44 offen offset:0 sc1
    v_add_f32 v136, v136, v200
    v_add_f32 v137, v137, v201
    v_mfma_f32_16x16x32_bf16 v[164:167], a[72:75], v[104:107], v[164:167]
    v_add_f32 v138, v138, v202
    v_add_f32 v139, v139, v203
    v_add_f32 v140, v140, v204
    v_mfma_f32_16x16x32_bf16 v[168:171], a[80:83], v[104:107], v[168:171]
    v_add_f32 v141, v141, v205
    v_add_f32 v142, v142, v206
    v_add_f32 v143, v143, v207
    v_mfma_f32_16x16x32_bf16 v[172:175], a[88:91], v[104:107], v[172:175]
    v_mul_f32 v136, v136, v40
    v_mul_f32 v137, v137, v40
    v_mul_f32 v138, v138, v40
    v_mfma_f32_16x16x32_bf16 v[176:179], a[96:99], v[104:107], v[176:179]
    v_mul_f32 v139, v139, v40
    v_mul_f32 v140, v140, v40
    v_mul_f32 v141, v141, v40
    v_mfma_f32_16x16x32_bf16 v[180:183], a[104:107], v[104:107], v[180:183]
    v_mul_f32 v142, v142, v40
    v_mul_f32 v143, v143, v40
    v_cvt_pk_bf16_f32 v36, v136, v137
    v_mfma_f32_16x16x32_bf16 v[184:187], a[112:115], v[104:107], v[184:187]
    v_cvt_pk_bf16_f32 v37, v138, v139
    v_cvt_pk_bf16_f32 v38, v140, v141
    v_cvt_pk_bf16_f32 v39, v142, v143
    v_mfma_f32_16x16x32_bf16 v[188:191], a[120:123], v[104:107], v[188:191]
    buffer_store_dwordx4 v[36:39], v2, s[16:19], s44 offen offset:1024 sc1
    v_add_f32 v144, v144, v208
    v_add_f32 v145, v145, v209
    v_add_f32 v146, v146, v210
    v_add_f32 v147, v147, v211
    v_add_f32 v148, v148, v212
    v_add_f32 v149, v149, v213
    v_add_f32 v150, v150, v214
    v_add_f32 v151, v151, v215
    v_mul_f32 v144, v144, v40
    v_mul_f32 v145, v145, v40
    v_mul_f32 v146, v146, v40
    v_mul_f32 v147, v147, v40
    v_mul_f32 v148, v148, v40
    v_mul_f32 v149, v149, v40
    v_mul_f32 v150, v150, v40
    v_mul_f32 v151, v151, v40
    v_cvt_pk_bf16_f32 v32, v144, v145
    v_cvt_pk_bf16_f32 v33, v146, v147
    v_cvt_pk_bf16_f32 v34, v148, v149
    v_cvt_pk_bf16_f32 v35, v150, v151
    buffer_store_dwordx4 v[32:35], v2, s[16:19], s44 offen offset:2048 sc1
    v_add_f32 v152, v152, v216
    v_add_f32 v153, v153, v217
    v_add_f32 v154, v154, v218
    v_add_f32 v155, v155, v219
    v_add_f32 v156, v156, v220
    v_add_f32 v157, v157, v221
    v_add_f32 v158, v158, v222
    v_add_f32 v159, v159, v223
    v_mul_f32 v152, v152, v40
    v_mul_f32 v153, v153, v40
    v_mul_f32 v154, v154, v40
    v_mul_f32 v155, v155, v40
    v_mul_f32 v156, v156, v40
    v_mul_f32 v157, v157, v40
    v_mul_f32 v158, v158, v40
    v_mul_f32 v159, v159, v40
    v_cvt_pk_bf16_f32 v36, v152, v153
    v_cvt_pk_bf16_f32 v37, v154, v155
    v_cvt_pk_bf16_f32 v38, v156, v157
    v_cvt_pk_bf16_f32 v39, v158, v159
    buffer_store_dwordx4 v[36:39], v2, s[16:19], s44 offen offset:3072 sc1
    v_add_f32 v9, v9, v11
    v_mov_b32 v43, v9
    s_nop 1
    v_permlane16_swap_b32 v9, v43
    v_add_f32 v9, v9, v43
    v_mov_b32 v43, v9
    s_nop 1
    v_permlane32_swap_b32 v9, v43
    v_add_f32 v9, v9, v43
    v_rcp_f32 v42, v9
    v_cmp_nge_f32 vcc, 0x5f800000, v9
    s_or_b64 s[50:51], s[50:51], vcc
    s_nop 3
    v_pk_add_f32 v[160:161], v[160:161], v[224:225]
    v_pk_add_f32 v[162:163], v[162:163], v[226:227]
    v_pk_add_f32 v[164:165], v[164:165], v[228:229]
    v_pk_add_f32 v[166:167], v[166:167], v[230:231]
    v_pk_mul_f32 v[160:161], v[160:161], v[42:43] op_sel_hi:[1,0]
    v_pk_mul_f32 v[162:163], v[162:163], v[42:43] op_sel_hi:[1,0]
    v_pk_mul_f32 v[164:165], v[164:165], v[42:43] op_sel_hi:[1,0]
    v_pk_mul_f32 v[166:167], v[166:167], v[42:43] op_sel_hi:[1,0]
    v_cvt_pk_bf16_f32 v32, v160, v161
    v_cvt_pk_bf16_f32 v33, v162, v163
    v_cvt_pk_bf16_f32 v34, v164, v165
    v_cvt_pk_bf16_f32 v35, v166, v167
    buffer_store_dwordx4 v[32:35], v2, s[16:19], s45 offen offset:0 sc1
    v_pk_add_f32 v[168:169], v[168:169], v[232:233]
    v_pk_add_f32 v[170:171], v[170:171], v[234:235]
    v_pk_add_f32 v[172:173], v[172:173], v[236:237]
    v_pk_add_f32 v[174:175], v[174:175], v[238:239]
    v_pk_mul_f32 v[168:169], v[168:169], v[42:43] op_sel_hi:[1,0]
    v_pk_mul_f32 v[170:171], v[170:171], v[42:43] op_sel_hi:[1,0]
    v_pk_mul_f32 v[172:173], v[172:173], v[42:43] op_sel_hi:[1,0]
    v_pk_mul_f32 v[174:175], v[174:175], v[42:43] op_sel_hi:[1,0]
    v_cvt_pk_bf16_f32 v36, v168, v169
    v_cvt_pk_bf16_f32 v37, v170, v171
    v_cvt_pk_bf16_f32 v38, v172, v173
    v_cvt_pk_bf16_f32 v39, v174, v175
    buffer_store_dwordx4 v[36:39], v2, s[16:19], s45 offen offset:1024 sc1
    v_pk_add_f32 v[176:177], v[176:177], v[240:241]
    v_pk_add_f32 v[178:179], v[178:179], v[242:243]
    v_pk_add_f32 v[180:181], v[180:181], v[244:245]
    v_pk_add_f32 v[182:183], v[182:183], v[246:247]
    v_pk_mul_f32 v[176:177], v[176:177], v[42:43] op_sel_hi:[1,0]
    v_pk_mul_f32 v[178:179], v[178:179], v[42:43] op_sel_hi:[1,0]
    v_pk_mul_f32 v[180:181], v[180:181], v[42:43] op_sel_hi:[1,0]
    v_pk_mul_f32 v[182:183], v[182:183], v[42:43] op_sel_hi:[1,0]
    v_cvt_pk_bf16_f32 v32, v176, v177
    v_cvt_pk_bf16_f32 v33, v178, v179
    v_cvt_pk_bf16_f32 v34, v180, v181
    v_cvt_pk_bf16_f32 v35, v182, v183
    buffer_store_dwordx4 v[32:35], v2, s[16:19], s45 offen offset:2048 sc1
    v_pk_add_f32 v[184:185], v[184:185], v[248:249]
    v_pk_add_f32 v[186:187], v[186:187], v[250:251]
    v_pk_add_f32 v[188:189], v[188:189], v[252:253]
    v_pk_add_f32 v[190:191], v[190:191], v[254:255]
    v_pk_mul_f32 v[184:185], v[184:185], v[42:43] op_sel_hi:[1,0]
    v_pk_mul_f32 v[186:187], v[186:187], v[42:43] op_sel_hi:[1,0]
    v_pk_mul_f32 v[188:189], v[188:189], v[42:43] op_sel_hi:[1,0]
    v_pk_mul_f32 v[190:191], v[190:191], v[42:43] op_sel_hi:[1,0]
    v_cvt_pk_bf16_f32 v36, v184, v185
    v_cvt_pk_bf16_f32 v37, v186, v187
    v_cvt_pk_bf16_f32 v38, v188, v189
    v_cvt_pk_bf16_f32 v39, v190, v191
    buffer_store_dwordx4 v[36:39], v2, s[16:19], s45 offen offset:3072 sc1
    s_branch L_fin
L_d2_3:
    s_waitcnt lgkmcnt(0)
    v_mfma_f32_16x16x32_bf16 v[80:83], a[64:67], a[0:3], v[112:115]
    ds_read_b128 a[124:127], v6 offset:15360
    ds_read_b128 a[120:123], v6 offset:14336
    v_exp_f32 v64, v64
    v_mfma_f32_16x16x32_bf16 v[80:83], a[68:71], a[4:7], v[80:83]
    ds_read_b128 a[116:119], v6 offset:13312
    ds_read_b128 a[112:115], v6 offset:12288
    v_exp_f32 v65, v65
    v_mfma_f32_16x16x32_bf16 v[80:83], a[72:75], a[8:11], v[80:83]
    v_add_f32 v9, v9, v64
    ds_write_b128 v14, v[192:195] offset:0
    v_mfma_f32_16x16x32_bf16 v[80:83], a[76:79], a[12:15], v[80:83]
    s_add_u32 s3, s76, 0x20000
    s_and_b32 s3, s3, 0xe0000
    s_add_u32 s3, s3, s74
    s_bitset1_b32 s3, 16
    buffer_load_dwordx4 a[192:195], v58, s[84:87], s3 offen offset:0
    v_mfma_f32_16x16x32_bf16 v[84:87], a[92:95], a[12:15], v[112:115]
    v_add_f32 v9, v9, v65
    buffer_load_dwordx4 a[196:199], v59, s[84:87], s3 offen offset:1024
    v_mfma_f32_16x16x32_bf16 v[84:87], a[88:91], a[8:11], v[84:87]
    v_exp_f32 v66, v66
    v_exp_f32 v67, v67
    v_mfma_f32_16x16x32_bf16 v[84:87], a[84:87], a[4:7], v[84:87]
    v_cvt_pk_bf16_f32 v96, v64, v65
    ds_write_b128 v14, v[196:199] offset:1024
    v_mfma_f32_16x16x32_bf16 v[84:87], a[80:83], a[0:3], v[84:87]
    v_add_f32 v9, v9, v66
    buffer_load_dwordx4 a[200:203], v60, s[84:87], s3 offen offset:2048
    v_mfma_f32_16x16x32_bf16 v[88:91], a[96:99], a[0:3], v[112:115]
    v_add_f32 v9, v9, v67
    ds_write_b128 v14, v[200:203] offset:2048
    v_mfma_f32_16x16x32_bf16 v[88:91], a[100:103], a[4:7], v[88:91]
    v_cvt_pk_bf16_f32 v97, v66, v67
    ds_write_b128 v14, v[204:207] offset:3072
    v_mfma_f32_16x16x32_bf16 v[88:91], a[104:107], a[8:11], v[88:91]
    v_exp_f32 v68, v68
    v_exp_f32 v69, v69
    v_mfma_f32_16x16x32_bf16 v[88:91], a[108:111], a[12:15], v[88:91]
    v_add_f32 v9, v9, v68
    buffer_load_dwordx4 a[204:207], v61, s[84:87], s3 offen offset:3072
    s_waitcnt lgkmcnt(3)
    v_mfma_f32_16x16x32_bf16 v[92:95], a[124:127], a[12:15], v[20:23]
    v_add_f32 v9, v9, v69
    ds_write_b128 v14, v[208:211] offset:4096
    v_mfma_f32_16x16x32_bf16 v[92:95], a[120:123], a[8:11], v[92:95]
    v_exp_f32 v70, v70
    v_exp_f32 v71, v71
    v_mfma_f32_16x16x32_bf16 v[92:95], a[116:119], a[4:7], v[92:95]
    v_cvt_pk_bf16_f32 v98, v68, v69
    ds_write_b128 v14, v[212:215] offset:5120
    v_mfma_f32_16x16x32_bf16 v[92:95], a[112:115], a[0:3], v[92:95]
    v_add_f32 v9, v9, v70
    ds_write_b128 v14, v[216:219] offset:6144
    v_mfma_f32_16x16x32_bf16 v[128:131], a[128:131], v[104:107], v[128:131]
    v_add_f32 v9, v9, v71
    v_cvt_pk_bf16_f32 v99, v70, v71
    v_exp_f32 v72, v72
    v_mfma_f32_16x16x32_bf16 v[128:131], a[132:135], v[108:111], v[128:131]
    v_exp_f32 v73, v73
    v_add_f32 v9, v9, v72
    v_mfma_f32_16x16x32_bf16 v[132:135], a[140:143], v[108:111], v[132:135]
    s_add_u32 s3, s76, 0x40000
    s_and_b32 s3, s3, 0xe0000
    s_add_u32 s3, s3, s74
    buffer_load_dwordx4 a[208:211], v58, s[84:87], s3 offen offset:0
    v_mfma_f32_16x16x32_bf16 v[132:135], a[136:139], v[104:107], v[132:135]
    v_add_f32 v9, v9, v73
    buffer_load_dwordx4 a[212:215], v59, s[84:87], s3 offen offset:1024
    v_mfma_f32_16x16x32_bf16 v[136:139], a[144:147], v[104:107], v[136:139]
    v_exp_f32 v74, v74
    v_exp_f32 v75, v75
    v_mfma_f32_16x16x32_bf16 v[136:139], a[148:151], v[108:111], v[136:139]
    v_cvt_pk_bf16_f32 v100, v72, v73
    ds_write_b128 v14, v[220:223] offset:7168
    v_mfma_f32_16x16x32_bf16 v[140:143], a[156:159], v[108:111], v[140:143]
    v_add_f32 v9, v9, v74
    buffer_load_dwordx4 a[216:219], v60, s[84:87], s3 offen offset:2048
    v_mfma_f32_16x16x32_bf16 v[140:143], a[152:155], v[104:107], v[140:143]
    v_add_f32 v9, v9, v75
    v_cvt_pk_bf16_f32 v101, v74, v75
    v_mfma_f32_16x16x32_bf16 v[144:147], a[160:163], v[104:107], v[144:147]
    v_exp_f32 v76, v76
    v_mfma_f32_16x16x32_bf16 v[144:147], a[164:167], v[108:111], v[144:147]
    v_exp_f32 v77, v77
    v_mfma_f32_16x16x32_bf16 v[148:151], a[172:175], v[108:111], v[148:151]
    buffer_load_dwordx4 a[220:223], v61, s[84:87], s3 offen offset:3072
    v_mfma_f32_16x16x32_bf16 v[148:151], a[168:171], v[104:107], v[148:151]
    v_add_f32 v9, v9, v76
    v_add_f32 v9, v9, v77
    v_mfma_f32_16x16x32_bf16 v[152:155], a[176:179], v[104:107], v[152:155]
    v_exp_f32 v78, v78
    v_mfma_f32_16x16x32_bf16 v[152:155], a[180:183], v[108:111], v[152:155]
    v_exp_f32 v79, v79
    v_mfma_f32_16x16x32_bf16 v[156:159], a[188:191], v[108:111], v[156:159]
    v_cvt_pk_bf16_f32 v102, v76, v77
    v_add_f32 v9, v9, v78
    v_mfma_f32_16x16x32_bf16 v[156:159], a[184:187], v[104:107], v[156:159]
    v_add_f32 v9, v9, v79
    v_cvt_pk_bf16_f32 v103, v78, v79
    s_waitcnt vmcnt(8)
    s_barrier
    v_mfma_f32_16x16x32_bf16 v[64:67], a[64:67], a[16:19], v[116:119]
    s_cmp_lg_u64 s[50:51], 0
    s_cselect_b32 s3, 1, 0
    s_cmp_gt_u32 s3, s48
    s_cselect_b32 s3, 0x80000000, 0
    v_mfma_f32_16x16x32_bf16 v[64:67], a[68:71], a[20:23], v[64:67]
    s_cmp_lt_u32 s34, 7
    s_cselect_b32 s3, 0x80000000, s3
    v_lshl_or_b32 v42, v2, 20, s3
    v_mfma_f32_16x16x32_bf16 v[64:67], a[72:75], a[24:27], v[64:67]
    v_mov_b32 v40, s80
    v_mov_b32 v41, s81
    buffer_store_dwordx2 v[40:41], v42, s[20:23], s75 offen sc1
    v_mfma_f32_16x16x32_bf16 v[64:67], a[76:79], a[28:31], v[64:67]
    v_cndmask_b32_e64 v20, v7, v116, s[24:25]
    v_cndmask_b32_e64 v21, v7, v116, s[26:27]
    v_exp_f32 v80, v80
    v_mfma_f32_16x16x32_bf16 v[68:71], a[92:95], a[28:31], v[116:119]
    v_cndmask_b32_e64 v22, v7, v116, s[28:29]
    v_cndmask_b32_e64 v23, v7, v116, s[30:31]
    v_exp_f32 v81, v81
    v_mfma_f32_16x16x32_bf16 v[68:71], a[88:91], a[24:27], v[68:71]
    ds_read_b128 a[64:67], v6 offset:32768
    ds_write_b128 v14, v[224:227] offset:8192
    v_mfma_f32_16x16x32_bf16 v[68:71], a[84:87], a[20:23], v[68:71]
    ds_read_b128 a[68:71], v6 offset:33792
    ds_write_b128 v14, v[228:231] offset:9216
    v_mfma_f32_16x16x32_bf16 v[68:71], a[80:83], a[16:19], v[68:71]
    s_xor_b32 m0, s77, 0x8000
    s_add_u32 s3, s76, 0x0
    s_and_b32 s3, s3, 0xe0000
    s_add_u32 s3, s3, s74
    buffer_load_dwordx4 v58, s[84:87], s3 offen offset:0 lds
    v_mfma_f32_16x16x32_bf16 v[72:75], a[96:99], a[16:19], v[116:119]
    ds_read_b128 a[72:75], v6 offset:34816
    buffer_load_dwordx4 v59, s[84:87], s3 offen offset:1024 lds
    v_mfma_f32_16x16x32_bf16 v[72:75], a[100:103], a[20:23], v[72:75]
    ds_read_b128 a[76:79], v6 offset:35840
    ds_write_b128 v14, v[232:235] offset:10240
    v_mfma_f32_16x16x32_bf16 v[72:75], a[104:107], a[24:27], v[72:75]
    v_add_f32 v8, v8, v80
    buffer_load_dwordx4 v60, s[84:87], s3 offen offset:2048 lds
    v_mfma_f32_16x16x32_bf16 v[72:75], a[108:111], a[28:31], v[72:75]
    v_add_f32 v8, v8, v81
    ds_write_b128 v14, v[236:239] offset:11264
    v_mfma_f32_16x16x32_bf16 v[76:79], a[124:127], a[28:31], v[116:119]
    v_exp_f32 v82, v82
    v_exp_f32 v83, v83
    v_mfma_f32_16x16x32_bf16 v[76:79], a[120:123], a[24:27], v[76:79]
    v_cvt_pk_bf16_f32 v104, v80, v81
    buffer_load_dwordx4 v61, s[84:87], s3 offen offset:3072 lds
    v_mfma_f32_16x16x32_bf16 v[76:79], a[116:119], a[20:23], v[76:79]
    v_add_f32 v8, v8, v82
    ds_write_b128 v14, v[240:243] offset:12288
    v_mfma_f32_16x16x32_bf16 v[76:79], a[112:115], a[16:19], v[76:79]
    v_add_f32 v8, v8, v83
    ds_write_b128 v14, v[244:247] offset:13312
    v_mfma_f32_16x16x32_bf16 v[160:163], a[128:131], v[96:99], v[160:163]
    ds_read_b128 a[128:131], v6 offset:16384
    ds_write_b128 v14, v[248:251] offset:14336
    v_mfma_f32_16x16x32_bf16 v[160:163], a[132:135], v[100:103], v[160:163]
    ds_read_b128 a[132:135], v6 offset:17408
    ds_write_b128 v14, v[252:255] offset:15360
    v_mfma_f32_16x16x32_bf16 v[164:167], a[140:143], v[100:103], v[164:167]
    ds_read_b128 a[140:143], v6 offset:19456
    v_cvt_pk_bf16_f32 v105, v82, v83
    v_exp_f32 v84, v84
    v_mfma_f32_16x16x32_bf16 v[164:167], a[136:139], v[96:99], v[164:167]
    ds_read_b128 a[136:139], v6 offset:18432
    ds_write_b32 v16, v10 offset:0
    v_exp_f32 v85, v85
    v_mfma_f32_16x16x32_bf16 v[168:171], a[144:147], v[96:99], v[168:171]
    s_add_u32 s3, s76, 0x40000
    s_and_b32 s3, s3, 0xe0000
    s_add_u32 s3, s3, s74
    s_bitset1_b32 s3, 16
    buffer_load_dwordx4 a[32:35], v58, s[84:87], s3 offen offset:0
    v_mfma_f32_16x16x32_bf16 v[168:171], a[148:151], v[100:103], v[168:171]
    ds_read_b128 a[144:147], v6 offset:20480
    buffer_load_dwordx4 a[36:39], v59, s[84:87], s3 offen offset:1024
    v_mfma_f32_16x16x32_bf16 v[172:175], a[156:159], v[100:103], v[172:175]
    v_add_f32 v8, v8, v84
    v_add_f32 v8, v8, v85
    v_exp_f32 v86, v86
    v_mfma_f32_16x16x32_bf16 v[172:175], a[152:155], v[96:99], v[172:175]
    ds_read_b128 a[148:151], v6 offset:21504
    buffer_load_dwordx4 a[40:43], v60, s[84:87], s3 offen offset:2048
    v_mfma_f32_16x16x32_bf16 v[176:179], a[160:163], v[96:99], v[176:179]
    ds_read_b128 a[156:159], v6 offset:23552
    ds_read_b128 a[152:155], v6 offset:22528
    v_exp_f32 v87, v87
    v_mfma_f32_16x16x32_bf16 v[176:179], a[164:167], v[100:103], v[176:179]
    v_cvt_pk_bf16_f32 v106, v84, v85
    v_add_f32 v8, v8, v86
    v_add_f32 v8, v8, v87
    v_mfma_f32_16x16x32_bf16 v[180:183], a[172:175], v[100:103], v[180:183]
    v_cvt_pk_bf16_f32 v107, v86, v87
    buffer_load_dwordx4 a[44:47], v61, s[84:87], s3 offen offset:3072
    v_mfma_f32_16x16x32_bf16 v[180:183], a[168:171], v[96:99], v[180:183]
    v_exp_f32 v88, v88
    v_exp_f32 v89, v89
    v_mfma_f32_16x16x32_bf16 v[184:187], a[176:179], v[96:99], v[184:187]
    ds_write_b32 v16, v11 offset:256
    v_add_f32 v8, v8, v88
    v_add_f32 v8, v8, v89
    v_mfma_f32_16x16x32_bf16 v[184:187], a[180:183], v[100:103], v[184:187]
    v_exp_f32 v90, v90
    v_exp_f32 v91, v91
    v_mfma_f32_16x16x32_bf16 v[188:191], a[188:191], v[100:103], v[188:191]
    v_cvt_pk_bf16_f32 v108, v88, v89
    v_add_f32 v8, v8, v90
    v_add_f32 v8, v8, v91
    v_mfma_f32_16x16x32_bf16 v[188:191], a[184:187], v[96:99], v[188:191]
    v_cvt_pk_bf16_f32 v109, v90, v91
    v_exp_f32 v92, v92
    v_exp_f32 v93, v93
    v_add_f32 v8, v8, v92
    v_add_f32 v8, v8, v93
    v_exp_f32 v94, v94
    v_exp_f32 v95, v95
    v_cvt_pk_bf16_f32 v110, v92, v93
    v_add_f32 v8, v8, v94
    v_add_f32 v8, v8, v95
    v_cvt_pk_bf16_f32 v111, v94, v95
    s_waitcnt vmcnt(17) lgkmcnt(0)
    s_barrier
    v_mfma_f32_16x16x32_bf16 v[80:83], a[64:67], a[16:19], v[20:23]
    ds_read_b128 a[160:163], v6 offset:24576
    ds_read_b128 a[164:167], v6 offset:25600
    v_exp_f32 v64, v64
    v_mfma_f32_16x16x32_bf16 v[80:83], a[68:71], a[20:23], v[80:83]
    ds_read_b128 a[172:175], v6 offset:27648
    ds_read_b128 a[168:171], v6 offset:26624
    v_exp_f32 v65, v65
    v_mfma_f32_16x16x32_bf16 v[80:83], a[72:75], a[24:27], v[80:83]
    v_add_f32 v9, v9, v64
    v_add_f32 v9, v9, v65
    v_exp_f32 v66, v66
    v_mfma_f32_16x16x32_bf16 v[80:83], a[76:79], a[28:31], v[80:83]
    ds_read_b128 a[176:179], v6 offset:28672
    ds_read_b128 a[180:183], v6 offset:29696
    v_exp_f32 v67, v67
    v_mfma_f32_16x16x32_bf16 v[128:131], a[128:131], v[104:107], v[128:131]
    v_xor_b32 v16, 512, v16
    ds_read_b32 v10, v16 offset:0
    ds_read_b128 a[188:191], v6 offset:31744
    v_mfma_f32_16x16x32_bf16 v[128:131], a[132:135], v[108:111], v[128:131]
    ds_read_b128 a[184:187], v6 offset:30720
    v_cvt_pk_bf16_f32 v96, v64, v65
    v_add_f32 v9, v9, v66
    v_mfma_f32_16x16x32_bf16 v[132:135], a[140:143], v[108:111], v[132:135]
    v_add_f32 v9, v9, v67
    v_cvt_pk_bf16_f32 v97, v66, v67
    v_exp_f32 v68, v68
    v_mfma_f32_16x16x32_bf16 v[132:135], a[136:139], v[104:107], v[132:135]
    s_xor_b32 m0, s77, 0x10000
    s_add_u32 s3, s76, 0x0
    s_and_b32 s3, s3, 0xe0000
    s_add_u32 s3, s3, s74
    s_bitset1_b32 s3, 16
    buffer_load_dwordx4 v58, s[84:87], s3 offen offset:0 lds
    v_mfma_f32_16x16x32_bf16 v[136:139], a[144:147], v[104:107], v[136:139]
    buffer_load_dwordx4 v59, s[84:87], s3 offen offset:1024 lds
    v_mfma_f32_16x16x32_bf16 v[136:139], a[148:151], v[108:111], v[136:139]
    ds_read_b32 v11, v16 offset:256
    buffer_load_dwordx4 v60, s[84:87], s3 offen offset:2048 lds
    v_mfma_f32_16x16x32_bf16 v[140:143], a[156:159], v[108:111], v[140:143]
    ds_read_b128 v[192:195], v15 offset:0
    buffer_load_dwordx4 v61, s[84:87], s3 offen offset:3072 lds
    v_mfma_f32_16x16x32_bf16 v[140:143], a[152:155], v[104:107], v[140:143]
    ds_read_b128 v[196:199], v15 offset:1024
    ds_read_b128 v[200:203], v15 offset:2048
    v_exp_f32 v69, v69
    s_waitcnt lgkmcnt(4)
    v_mfma_f32_16x16x32_bf16 v[144:147], a[160:163], v[104:107], v[144:147]
    ds_read_b128 v[204:207], v15 offset:3072
    ds_read_b128 v[208:211], v15 offset:4096
    ds_read_b128 v[212:215], v15 offset:5120
    v_mfma_f32_16x16x32_bf16 v[144:147], a[164:167], v[108:111], v[144:147]
    ds_read_b128 v[216:219], v15 offset:6144
    ds_read_b128 v[220:223], v15 offset:7168
    v_add_f32 v9, v9, v68
    v_mfma_f32_16x16x32_bf16 v[148:151], a[172:175], v[108:111], v[148:151]
    s_xor_b32 m0, s77, 0x18000
    s_add_u32 s3, s76, 0x20000
    s_and_b32 s3, s3, 0xe0000
    s_add_u32 s3, s3, s74
    buffer_load_dwordx4 v58, s[84:87], s3 offen offset:0 lds
    v_mfma_f32_16x16x32_bf16 v[148:151], a[168:171], v[104:107], v[148:151]
    buffer_load_dwordx4 v59, s[84:87], s3 offen offset:1024 lds
    v_mfma_f32_16x16x32_bf16 v[152:155], a[176:179], v[104:107], v[152:155]
    v_add_f32 v9, v9, v69
    buffer_load_dwordx4 v60, s[84:87], s3 offen offset:2048 lds
    v_mfma_f32_16x16x32_bf16 v[152:155], a[180:183], v[108:111], v[152:155]
    buffer_load_dwordx4 v61, s[84:87], s3 offen offset:3072 lds
    v_mfma_f32_16x16x32_bf16 v[156:159], a[188:191], v[108:111], v[156:159]
    v_exp_f32 v70, v70
    v_exp_f32 v71, v71
    v_mfma_f32_16x16x32_bf16 v[156:159], a[184:187], v[104:107], v[156:159]
    v_cvt_pk_bf16_f32 v98, v68, v69
    v_add_f32 v9, v9, v70
    v_add_f32 v9, v9, v71
    v_cvt_pk_bf16_f32 v99, v70, v71
    v_exp_f32 v72, v72
    v_exp_f32 v73, v73
    v_add_f32 v9, v9, v72
    v_add_f32 v9, v9, v73
    v_exp_f32 v74, v74
    v_exp_f32 v75, v75
    v_cvt_pk_bf16_f32 v100, v72, v73
    v_add_f32 v9, v9, v74
    v_add_f32 v9, v9, v75
    v_cvt_pk_bf16_f32 v101, v74, v75
    v_exp_f32 v76, v76
    v_exp_f32 v77, v77
    v_add_f32 v9, v9, v76
    v_add_f32 v9, v9, v77
    v_exp_f32 v78, v78
    v_exp_f32 v79, v79
    v_cvt_pk_bf16_f32 v102, v76, v77
    v_add_f32 v9, v9, v78
    v_add_f32 v9, v9, v79
    v_cvt_pk_bf16_f32 v103, v78, v79
    v_mfma_f32_16x16x32_bf16 v[160:163], a[128:131], v[96:99], v[160:163]
    ds_read_b128 a[64:67], v6 offset:49152
    ds_read_b128 a[72:75], v6 offset:51200
    ds_read_b128 a[80:83], v6 offset:53248
    v_mfma_f32_16x16x32_bf16 v[160:163], a[132:135], v[100:103], v[160:163]
    ds_read_b128 a[88:91], v6 offset:55296
    ds_read_b128 a[96:99], v6 offset:57344
    ds_read_b128 a[104:107], v6 offset:59392
    v_mfma_f32_16x16x32_bf16 v[164:167], a[140:143], v[100:103], v[164:167]
    ds_read_b128 a[112:115], v6 offset:61440
    ds_read_b128 a[120:123], v6 offset:63488
    v_exp_f32 v80, v80
    v_mfma_f32_16x16x32_bf16 v[164:167], a[136:139], v[96:99], v[164:167]
    s_add_u32 s3, s76, 0x60000
    s_and_b32 s3, s3, 0xe0000
    s_add_u32 s3, s3, s74
    buffer_load_dwordx4 a[48:51], v58, s[84:87], s3 offen offset:0
    v_mfma_f32_16x16x32_bf16 v[168:171], a[144:147], v[96:99], v[168:171]
    v_add_f32 v8, v8, v10
    buffer_load_dwordx4 a[52:55], v59, s[84:87], s3 offen offset:1024
    v_mfma_f32_16x16x32_bf16 v[168:171], a[148:151], v[100:103], v[168:171]
    ds_read_b128 v[224:227], v15 offset:8192
    buffer_load_dwordx4 a[56:59], v60, s[84:87], s3 offen offset:2048
    v_mfma_f32_16x16x32_bf16 v[172:175], a[156:159], v[100:103], v[172:175]
    ds_read_b128 v[228:231], v15 offset:9216
    ds_read_b128 v[232:235], v15 offset:10240
    v_exp_f32 v81, v81
    v_mfma_f32_16x16x32_bf16 v[172:175], a[152:155], v[96:99], v[172:175]
    v_add_f32 v9, v9, v80
    v_add_f32 v9, v9, v81
    v_exp_f32 v82, v82
    v_mfma_f32_16x16x32_bf16 v[176:179], a[160:163], v[96:99], v[176:179]
    ds_read_b128 v[236:239], v15 offset:11264
    buffer_load_dwordx4 a[60:63], v61, s[84:87], s3 offen offset:3072
    v_mfma_f32_16x16x32_bf16 v[176:179], a[164:167], v[100:103], v[176:179]
    ds_read_b128 v[240:243], v15 offset:12288
    ds_read_b128 v[244:247], v15 offset:13312
    v_exp_f32 v83, v83
    v_mfma_f32_16x16x32_bf16 v[180:183], a[172:175], v[100:103], v[180:183]
    ds_read_b128 v[248:251], v15 offset:14336
    ds_read_b128 v[252:255], v15 offset:15360
    v_cvt_pk_bf16_f32 v104, v80, v81
    v_mfma_f32_16x16x32_bf16 v[180:183], a[168:171], v[96:99], v[180:183]
    v_add_f32 v9, v9, v82
    buffer_load_dwordx4 v[44:47], v57, s[20:23], 0 offen sc1
    v_mfma_f32_16x16x32_bf16 v[184:187], a[176:179], v[96:99], v[184:187]
    v_add_f32 v9, v9, v83
    v_cvt_pk_bf16_f32 v105, v82, v83
    v_mov_b64 v[106:107], 0
    v_mfma_f32_16x16x32_bf16 v[184:187], a[180:183], v[100:103], v[184:187]
    v_mov_b32 v41, v8
    s_nop 1
    v_permlane16_swap_b32 v8, v41
    v_mfma_f32_16x16x32_bf16 v[188:191], a[188:191], v[100:103], v[188:191]
    v_add_f32 v8, v8, v41
    v_mov_b32 v41, v8
    s_nop 1
    v_mfma_f32_16x16x32_bf16 v[188:191], a[184:187], v[96:99], v[188:191]
    v_permlane32_swap_b32 v8, v41
    v_add_f32 v8, v8, v41
    v_rcp_f32 v40, v8
    v_cmp_nge_f32 vcc, 0x5f800000, v8
    s_or_b64 s[50:51], s[50:51], vcc
    s_waitcnt lgkmcnt(0)
    v_add_f32 v128, v128, v192
    v_add_f32 v129, v129, v193
    v_add_f32 v130, v130, v194
    v_add_f32 v131, v131, v195
    v_add_f32 v132, v132, v196
    v_add_f32 v133, v133, v197
    v_add_f32 v134, v134, v198
    v_add_f32 v135, v135, v199
    v_mul_f32 v128, v128, v40
    v_mul_f32 v129, v129, v40
    v_mul_f32 v130, v130, v40
    v_mul_f32 v131, v131, v40
    v_mul_f32 v132, v132, v40
    v_mul_f32 v133, v133, v40
    v_mul_f32 v134, v134, v40
    v_mul_f32 v135, v135, v40
    v_cvt_pk_bf16_f32 v32, v128, v129
    v_cvt_pk_bf16_f32 v33, v130, v131
    v_cvt_pk_bf16_f32 v34, v132, v133
    v_cvt_pk_bf16_f32 v35, v134, v135
    s_nop 0
    v_mfma_f32_16x16x32_bf16 v[160:163], a[64:67], v[104:107], v[160:163]
    buffer_store_dwordx4 v[32:35], v2, s[16:19], s44 offen offset:0 sc1
    v_add_f32 v136, v136, v200
    v_add_f32 v137, v137, v201
    v_mfma_f32_16x16x32_bf16 v[164:167], a[72:75], v[104:107], v[164:167]
    v_add_f32 v138, v138, v202
    v_add_f32 v139, v139, v203
    v_add_f32 v140, v140, v204
    v_mfma_f32_16x16x32_bf16 v[168:171], a[80:83], v[104:107], v[168:171]
    v_add_f32 v141, v141, v205
    v_add_f32 v142, v142, v206
    v_add_f32 v143, v143, v207
    v_mfma_f32_16x16x32_bf16 v[172:175], a[88:91], v[104:107], v[172:175]
    v_mul_f32 v136, v136, v40
    v_mul_f32 v137, v137, v40
    v_mul_f32 v138, v138, v40
    v_mfma_f32_16x16x32_bf16 v[176:179], a[96:99], v[104:107], v[176:179]
    v_mul_f32 v139, v139, v40
    v_mul_f32 v140, v140, v40
    v_mul_f32 v141, v141, v40
    v_mfma_f32_16x16x32_bf16 v[180:183], a[104:107], v[104:107], v[180:183]
    v_mul_f32 v142, v142, v40
    v_mul_f32 v143, v143, v40
    v_cvt_pk_bf16_f32 v36, v136, v137
    v_mfma_f32_16x16x32_bf16 v[184:187], a[112:115], v[104:107], v[184:187]
    v_cvt_pk_bf16_f32 v37, v138, v139
    v_cvt_pk_bf16_f32 v38, v140, v141
    v_cvt_pk_bf16_f32 v39, v142, v143
    v_mfma_f32_16x16x32_bf16 v[188:191], a[120:123], v[104:107], v[188:191]
    buffer_store_dwordx4 v[36:39], v2, s[16:19], s44 offen offset:1024 sc1
    v_add_f32 v144, v144, v208
    v_add_f32 v145, v145, v209
    v_add_f32 v146, v146, v210
    v_add_f32 v147, v147, v211
    v_add_f32 v148, v148, v212
    v_add_f32 v149, v149, v213
    v_add_f32 v150, v150, v214
    v_add_f32 v151, v151, v215
    v_mul_f32 v144, v144, v40
    v_mul_f32 v145, v145, v40
    v_mul_f32 v146, v146, v40
    v_mul_f32 v147, v147, v40
    v_mul_f32 v148, v148, v40
    v_mul_f32 v149, v149, v40
    v_mul_f32 v150, v150, v40
    v_mul_f32 v151, v151, v40
    v_cvt_pk_bf16_f32 v32, v144, v145
    v_cvt_pk_bf16_f32 v33, v146, v147
    v_cvt_pk_bf16_f32 v34, v148, v149
    v_cvt_pk_bf16_f32 v35, v150, v151
    buffer_store_dwordx4 v[32:35], v2, s[16:19], s44 offen offset:2048 sc1
    v_add_f32 v152, v152, v216
    v_add_f32 v153, v153, v217
    v_add_f32 v154, v154, v218
    v_add_f32 v155, v155, v219
    v_add_f32 v156, v156, v220
    v_add_f32 v157, v157, v221
    v_add_f32 v158, v158, v222
    v_add_f32 v159, v159, v223
    v_mul_f32 v152, v152, v40
    v_mul_f32 v153, v153, v40
    v_mul_f32 v154, v154, v40
    v_mul_f32 v155, v155, v40
    v_mul_f32 v156, v156, v40
    v_mul_f32 v157, v157, v40
    v_mul_f32 v158, v158, v40
    v_mul_f32 v159, v159, v40
    v_cvt_pk_bf16_f32 v36, v152, v153
    v_cvt_pk_bf16_f32 v37, v154, v155
    v_cvt_pk_bf16_f32 v38, v156, v157
    v_cvt_pk_bf16_f32 v39, v158, v159
    buffer_store_dwordx4 v[36:39], v2, s[16:19], s44 offen offset:3072 sc1
    v_add_f32 v9, v9, v11
    v_mov_b32 v43, v9
    s_nop 1
    v_permlane16_swap_b32 v9, v43
    v_add_f32 v9, v9, v43
    v_mov_b32 v43, v9
    s_nop 1
    v_permlane32_swap_b32 v9, v43
    v_add_f32 v9, v9, v43
    v_rcp_f32 v42, v9
    v_cmp_nge_f32 vcc, 0x5f800000, v9
    s_or_b64 s[50:51], s[50:51], vcc
    s_nop 3
    v_pk_add_f32 v[160:161], v[160:161], v[224:225]
    v_pk_add_f32 v[162:163], v[162:163], v[226:227]
    v_pk_add_f32 v[164:165], v[164:165], v[228:229]
    v_pk_add_f32 v[166:167], v[166:167], v[230:231]
    v_pk_mul_f32 v[160:161], v[160:161], v[42:43] op_sel_hi:[1,0]
    v_pk_mul_f32 v[162:163], v[162:163], v[42:43] op_sel_hi:[1,0]
    v_pk_mul_f32 v[164:165], v[164:165], v[42:43] op_sel_hi:[1,0]
    v_pk_mul_f32 v[166:167], v[166:167], v[42:43] op_sel_hi:[1,0]
    v_cvt_pk_bf16_f32 v32, v160, v161
    v_cvt_pk_bf16_f32 v33, v162, v163
    v_cvt_pk_bf16_f32 v34, v164, v165
    v_cvt_pk_bf16_f32 v35, v166, v167
    buffer_store_dwordx4 v[32:35], v2, s[16:19], s45 offen offset:0 sc1
    v_pk_add_f32 v[168:169], v[168:169], v[232:233]
    v_pk_add_f32 v[170:171], v[170:171], v[234:235]
    v_pk_add_f32 v[172:173], v[172:173], v[236:237]
    v_pk_add_f32 v[174:175], v[174:175], v[238:239]
    v_pk_mul_f32 v[168:169], v[168:169], v[42:43] op_sel_hi:[1,0]
    v_pk_mul_f32 v[170:171], v[170:171], v[42:43] op_sel_hi:[1,0]
    v_pk_mul_f32 v[172:173], v[172:173], v[42:43] op_sel_hi:[1,0]
    v_pk_mul_f32 v[174:175], v[174:175], v[42:43] op_sel_hi:[1,0]
    v_cvt_pk_bf16_f32 v36, v168, v169
    v_cvt_pk_bf16_f32 v37, v170, v171
    v_cvt_pk_bf16_f32 v38, v172, v173
    v_cvt_pk_bf16_f32 v39, v174, v175
    buffer_store_dwordx4 v[36:39], v2, s[16:19], s45 offen offset:1024 sc1
    v_pk_add_f32 v[176:177], v[176:177], v[240:241]
    v_pk_add_f32 v[178:179], v[178:179], v[242:243]
    v_pk_add_f32 v[180:181], v[180:181], v[244:245]
    v_pk_add_f32 v[182:183], v[182:183], v[246:247]
    v_pk_mul_f32 v[176:177], v[176:177], v[42:43] op_sel_hi:[1,0]
    v_pk_mul_f32 v[178:179], v[178:179], v[42:43] op_sel_hi:[1,0]
    v_pk_mul_f32 v[180:181], v[180:181], v[42:43] op_sel_hi:[1,0]
    v_pk_mul_f32 v[182:183], v[182:183], v[42:43] op_sel_hi:[1,0]
    v_cvt_pk_bf16_f32 v32, v176, v177
    v_cvt_pk_bf16_f32 v33, v178, v179
    v_cvt_pk_bf16_f32 v34, v180, v181
    v_cvt_pk_bf16_f32 v35, v182, v183
    buffer_store_dwordx4 v[32:35], v2, s[16:19], s45 offen offset:2048 sc1
    v_pk_add_f32 v[184:185], v[184:185], v[248:249]
    v_pk_add_f32 v[186:187], v[186:187], v[250:251]
    v_pk_add_f32 v[188:189], v[188:189], v[252:253]
    v_pk_add_f32 v[190:191], v[190:191], v[254:255]
    v_pk_mul_f32 v[184:185], v[184:185], v[42:43] op_sel_hi:[1,0]
    v_pk_mul_f32 v[186:187], v[186:187], v[42:43] op_sel_hi:[1,0]
    v_pk_mul_f32 v[188:189], v[188:189], v[42:43] op_sel_hi:[1,0]
    v_pk_mul_f32 v[190:191], v[190:191], v[42:43] op_sel_hi:[1,0]
    v_cvt_pk_bf16_f32 v36, v184, v185
    v_cvt_pk_bf16_f32 v37, v186, v187
    v_cvt_pk_bf16_f32 v38, v188, v189
    v_cvt_pk_bf16_f32 v39, v190, v191
    buffer_store_dwordx4 v[36:39], v2, s[16:19], s45 offen offset:3072 sc1
    s_branch L_fin
L_fin:
    s_load_dwordx2 s[24:25], s[0:1], 0
    s_load_dwordx2 s[28:29], s[0:1], 56
    s_load_dwordx2 s[8:9], s[0:1], 104
    s_cmp_lg_u64 s[50:51], 0
    s_cselect_b32 s4, 1, 0
    v_mov_b32 v192, s4
    s_lshl2_add_u32 s4, s32, s54
    v_and_b32 v193, 0x30, v2
    v_lshl_add_u32 v193, v193, 8, s4
    v_mov_b32 v194, s77
    ds_write_b32 v193, v192 offset:2048
    v_add_u32 v6, s54, v2
    v_xor_b32 v7, 0x10000, v6
    v_add_u32 v8, 0x20000, v2
    v_bfe_u32 v195, v2, 6, 3
    s_lshl_b32 s4, s32, 1
    v_xor_b32 v195, s4, v195
    v_bfe_u32 v196, v2, 6, 2
    v_lshlrev_b32 v196, 10, v196
    v_lshl_or_b32 v195, v195, 5, v196
    v_and_b32 v196, 0x300, v2
    v_bfe_u32 v197, v2, 4, 2
    v_lshl_or_b32 v196, v197, 3, v196
    v_or_b32 v195, v195, v196
    v_add_u32 v9, s54, v195
    v_xor_b32 v10, 32, v9
    v_xor_b32 v11, 0x10000, v9
    v_xor_b32 v12, 32, v11
    v_add_u32 v13, 0x20000, v195
    v_xor_b32 v14, 32, v13
    v_add_u32 v200, s77, v2
    v_xor_b32 v201, 0x10000, v200
    s_xor_b32 s62, s34, 7
    s_lshr_b32 s63, s33, 3
    s_bfe_u32 s4, s33, 0x10002
    s_lshl1_add_u32 s89, s62, s4
    s_lshl_b32 s5, s32, 12
    s_add_u32 s35, s5, 0x20000
    s_lshr_b32 s37, s76, 3
    s_lshr_b32 s6, s32, 1
    s_lshl_b32 s6, s6, 14
    s_add_u32 s39, s37, s6
    s_lshl_b32 s6, s63, 17
    s_add_u32 s6, s6, 0x2400000
    s_lshl_b32 s36, s89, 19
    s_add_u32 s36, s36, s6
    s_add_u32 s36, s36, s5
    s_xor_b32 s7, s89, 30
    s_lshl_b32 s7, s7, 19
    s_and_b32 s5, s5, 0x1000
    s_add_u32 s5, s5, s6
    s_add_u32 s38, s5, s7
    s_waitcnt vmcnt(8) lgkmcnt(0)
    s_barrier
    ds_read_b128 v[196:199], v194 offset:2048
    v_cmp_eq_u64_e64 s[4:5], s[80:81], v[44:45]
    v_cmp_eq_u64 vcc, s[80:81], v[46:47]
    s_and_b64 s[4:5], s[4:5], vcc
    s_waitcnt lgkmcnt(0)
    v_or3_b32 v196, v196, v197, v198
    v_or_b32 v196, v196, v199
    s_nop 0
    v_readfirstlane_b32 s3, v196
    s_cmp_gt_u32 s3, s48
    s_cbranch_scc1 L_again
    s_cmp_eq_u64 s[4:5], -1
    s_cbranch_scc0 L_cs_retry
L_cs_back:
    s_mov_b32 m0, s77
    s_add_u32 s3, s37, 0x0
    s_and_b32 s3, s3, 0x1c000
    s_add_u32 s3, s3, s36
    buffer_load_dwordx4 v2, s[16:19], s3 offen offset:0 sc1 lds
    ds_read_b64_tr_b16 a[64:65], v9 offset:32768
    ds_read_b64_tr_b16 a[66:67], v9 offset:36864
    buffer_load_dwordx4 v2, s[16:19], s3 offen offset:1024 sc1 lds
    ds_read_b64_tr_b16 a[68:69], v10 offset:32768
    ds_read_b64_tr_b16 a[70:71], v10 offset:36864
    ds_read_b64_tr_b16 a[72:73], v9 offset:40960
    buffer_load_dwordx4 v2, s[16:19], s3 offen offset:2048 sc1 lds
    ds_read_b64_tr_b16 a[74:75], v9 offset:45056
    ds_read_b64_tr_b16 a[76:77], v10 offset:40960
    ds_read_b64_tr_b16 a[78:79], v10 offset:45056
    buffer_load_dwordx4 v2, s[16:19], s3 offen offset:3072 sc1 lds
    ds_read_b64_tr_b16 a[80:81], v11 offset:0
    ds_read_b64_tr_b16 a[82:83], v11 offset:4096
    s_mov_b32 m0, s35
    s_add_u32 s3, s37, 0x4000
    s_and_b32 s3, s3, 0x1c000
    s_add_u32 s3, s3, s36
    buffer_load_dwordx4 v2, s[16:19], s3 offen offset:0 sc1 lds
    ds_read_b64_tr_b16 a[84:85], v12 offset:0
    ds_read_b64_tr_b16 a[86:87], v12 offset:4096
    ds_read_b64_tr_b16 a[88:89], v11 offset:8192
    buffer_load_dwordx4 v2, s[16:19], s3 offen offset:1024 sc1 lds
    ds_read_b64_tr_b16 a[90:91], v11 offset:12288
    ds_read_b64_tr_b16 a[92:93], v12 offset:8192
    ds_read_b64_tr_b16 a[94:95], v12 offset:12288
    buffer_load_dwordx4 v2, s[16:19], s3 offen offset:2048 sc1 lds
    ds_read_b64_tr_b16 a[96:97], v11 offset:32768
    ds_read_b64_tr_b16 a[98:99], v11 offset:36864
    buffer_load_dwordx4 v2, s[16:19], s3 offen offset:3072 sc1 lds
    ds_read_b64_tr_b16 a[100:101], v12 offset:32768
    ds_read_b64_tr_b16 a[102:103], v12 offset:36864
    ds_read_b64_tr_b16 a[104:105], v11 offset:40960
    s_add_u32 m0, s35, 0x4000
    s_add_u32 s3, s76, 0x60000
    s_and_b32 s3, s3, 0xe0000
    s_add_u32 s3, s3, s74
    s_bitset1_b32 s3, 16
    buffer_load_dwordx4 v58, s[84:87], s3 offen offset:0 lds
    ds_read_b64_tr_b16 a[106:107], v11 offset:45056
    ds_read_b64_tr_b16 a[108:109], v12 offset:40960
    ds_read_b64_tr_b16 a[110:111], v12 offset:45056
    buffer_load_dwordx4 v59, s[84:87], s3 offen offset:1024 lds
    ds_write_b128 v200, a[192:195] offset:16384
    ds_write_b128 v200, a[196:199] offset:17408
    buffer_load_dwordx4 v60, s[84:87], s3 offen offset:2048 lds
    ds_write_b128 v200, a[200:203] offset:18432
    ds_write_b128 v200, a[204:207] offset:19456
    ds_write_b128 v200, a[208:211] offset:49152
    buffer_load_dwordx4 v61, s[84:87], s3 offen offset:3072 lds
    ds_write_b128 v200, a[212:215] offset:50176
    ds_write_b128 v200, a[216:219] offset:51200
    ds_write_b128 v200, a[220:223] offset:52224
    s_waitcnt vmcnt(8) lgkmcnt(0)
    s_barrier
    ds_read_b128 v[24:27], v6 offset:0
    ds_read_b128 v[28:31], v6 offset:4096
    ds_read_b128 v[32:35], v6 offset:8192
    ds_read_b128 v[36:39], v6 offset:12288
    v_mov_b32 v192, s80
    v_mov_b32 v193, s81
    buffer_store_dwordx2 v[192:193], v0, s[20:23], s79 offen sc1
    s_waitcnt lgkmcnt(3)
    v_mfma_f32_16x16x32_bf16 v[96:99], a[64:67], v[24:27], 0
    ds_read_b128 v[40:43], v6 offset:1024
    ds_read_b64_tr_b16 a[112:113], v9 offset:16384
    ds_read_b128 v[44:47], v6 offset:5120
    v_mfma_f32_16x16x32_bf16 v[100:103], a[68:71], v[24:27], 0
    ds_read_b64_tr_b16 a[114:115], v9 offset:20480
    ds_read_b64_tr_b16 a[116:117], v10 offset:16384
    ds_read_b128 v[48:51], v6 offset:9216
    s_waitcnt lgkmcnt(8)
    v_mfma_f32_16x16x32_bf16 v[104:107], a[64:67], v[28:31], 0
    ds_read_b64_tr_b16 a[118:119], v10 offset:20480
    ds_read_b64_tr_b16 a[120:121], v9 offset:24576
    ds_read_b64_tr_b16 a[122:123], v9 offset:28672
    v_mfma_f32_16x16x32_bf16 v[108:111], a[68:71], v[28:31], 0
    ds_read_b64_tr_b16 a[124:125], v10 offset:24576
    ds_read_b64_tr_b16 a[126:127], v10 offset:28672
    ds_read_b128 v[52:55], v6 offset:13312
    s_waitcnt lgkmcnt(13)
    v_mfma_f32_16x16x32_bf16 v[112:115], a[64:67], v[32:35], 0
    s_xor_b32 m0, s77, 0x8000
    s_add_u32 s3, s37, 0x8000
    s_and_b32 s3, s3, 0x1c000
    s_add_u32 s3, s3, s36
    buffer_load_dwordx4 v2, s[16:19], s3 offen offset:0 sc1 lds
    v_mfma_f32_16x16x32_bf16 v[116:119], a[68:71], v[32:35], 0
    buffer_load_dwordx4 v2, s[16:19], s3 offen offset:1024 sc1 lds
    ds_read_b128 v[24:27], v6 offset:2048
    s_waitcnt lgkmcnt(11)
    v_mfma_f32_16x16x32_bf16 v[120:123], a[64:67], v[36:39], 0
    ds_read_b64_tr_b16 a[128:129], v9 offset:49152
    buffer_load_dwordx4 v2, s[16:19], s3 offen offset:2048 sc1 lds
    v_mfma_f32_16x16x32_bf16 v[124:127], a[68:71], v[36:39], 0
    ds_read_b64_tr_b16 a[130:131], v9 offset:53248
    ds_read_b64_tr_b16 a[132:133], v10 offset:49152
    ds_read_b128 v[28:31], v6 offset:6144
    v_mfma_f32_16x16x32_bf16 v[96:99], a[72:75], v[40:43], v[96:99]
    ds_read_b64_tr_b16 a[134:135], v10 offset:53248
    buffer_load_dwordx4 v2, s[16:19], s3 offen offset:3072 sc1 lds
    v_mfma_f32_16x16x32_bf16 v[100:103], a[76:79], v[40:43], v[100:103]
    ds_read_b64_tr_b16 a[136:137], v9 offset:57344
    ds_read_b64_tr_b16 a[138:139], v9 offset:61440
    ds_read_b128 v[32:35], v6 offset:10240
    s_waitcnt lgkmcnt(9)
    v_mfma_f32_16x16x32_bf16 v[104:107], a[72:75], v[44:47], v[104:107]
    ds_read_b64_tr_b16 a[140:141], v10 offset:57344
    ds_read_b64_tr_b16 a[142:143], v10 offset:61440
    ds_write_b128 v201, a[32:35] offset:16384
    v_mfma_f32_16x16x32_bf16 v[108:111], a[76:79], v[44:47], v[108:111]
    ds_write_b128 v201, a[36:39] offset:17408
    ds_write_b128 v201, a[40:43] offset:18432
    ds_read_b128 v[36:39], v6 offset:14336
    v_mfma_f32_16x16x32_bf16 v[112:115], a[72:75], v[48:51], v[112:115]
    ds_write_b128 v201, a[44:47] offset:19456
    ds_write_b128 v201, a[48:51] offset:49152
    ds_write_b128 v201, a[52:55] offset:50176
    v_mfma_f32_16x16x32_bf16 v[116:119], a[76:79], v[48:51], v[116:119]
    ds_read_b128 v[40:43], v6 offset:3072
    ds_read_b128 v[44:47], v6 offset:7168
    ds_read_b128 v[48:51], v6 offset:11264
    v_mfma_f32_16x16x32_bf16 v[120:123], a[72:75], v[52:55], v[120:123]
    s_xor_b32 m0, s77, 0x10000
    s_add_u32 s3, s76, 0x80000
    s_and_b32 s3, s3, 0xe0000
    s_add_u32 s3, s3, s74
    buffer_load_dwordx4 v58, s[84:87], s3 offen offset:0 lds
    v_mfma_f32_16x16x32_bf16 v[124:127], a[76:79], v[52:55], v[124:127]
    buffer_load_dwordx4 v59, s[84:87], s3 offen offset:1024 lds
    ds_read_b128 v[52:55], v6 offset:15360
    s_waitcnt lgkmcnt(11)
    v_mfma_f32_16x16x32_bf16 v[96:99], a[80:83], v[24:27], v[96:99]
    ds_write_b128 v201, a[56:59] offset:51200
    buffer_load_dwordx4 v60, s[84:87], s3 offen offset:2048 lds
    v_mfma_f32_16x16x32_bf16 v[100:103], a[84:87], v[24:27], v[100:103]
    ds_write_b128 v201, a[60:63] offset:52224
    s_mov_b32 s26, 0x200000
    s_mov_b32 s27, 0x20000
    v_mfma_f32_16x16x32_bf16 v[104:107], a[80:83], v[28:31], v[104:107]
    s_mov_b32 s30, 0x400
    s_mov_b32 s31, 0x20000
    s_mov_b32 s10, 0x200000
    v_mfma_f32_16x16x32_bf16 v[108:111], a[84:87], v[28:31], v[108:111]
    buffer_load_dwordx4 v61, s[84:87], s3 offen offset:3072 lds
    s_mov_b32 s11, 0x20000
    v_mfma_f32_16x16x32_bf16 v[112:115], a[80:83], v[32:35], v[112:115]
    s_and_b32 s4, s33, 3
    s_xor_b32 s7, s89, 30
    s_lshl2_add_u32 s4, s63, s4
    v_mfma_f32_16x16x32_bf16 v[116:119], a[84:87], v[32:35], v[116:119]
    s_lshl4_add_u32 s49, s89, s4
    s_cmp_lt_u32 s32, 2
    s_cselect_b32 s5, s89, s7
    s_waitcnt lgkmcnt(2)
    v_mfma_f32_16x16x32_bf16 v[120:123], a[80:83], v[36:39], v[120:123]
    s_and_b32 s6, s32, 1
    s_lshl1_add_u32 s5, s5, s6
    s_lshl4_add_u32 s5, s5, s4
    v_mfma_f32_16x16x32_bf16 v[124:127], a[84:87], v[36:39], v[124:127]
    s_lshl_b32 s12, s5, 13
    s_add_u32 s12, s12, 0x4000000
    s_add_u32 s13, s12, 4096
    s_lshl_b32 s15, s5, 11
    s_lshl_b32 s5, s5, 1
    s_sub_u32 s5, 0x7ff, s5
    s_cmp_ge_u32 s32, 2
    s_cselect_b32 s6, 0x80000000, 0
    v_bfe_u32 v195, v2, 6, 1
    v_sub_u32 v20, s5, v195
    v_lshrrev_b32 v196, 1, v2
    v_and_b32 v196, 0x1c0, v196
    s_waitcnt vmcnt(13) lgkmcnt(0)
    s_barrier
    v_mfma_f32_16x16x32_bf16 v[96:99], a[88:91], v[40:43], v[96:99]
    ds_read_b128 v[24:27], v8 offset:0
    ds_read_b64_tr_b16 a[144:145], v11 offset:16384
    ds_read_b128 v[28:31], v8 offset:4096
    v_mfma_f32_16x16x32_bf16 v[100:103], a[92:95], v[40:43], v[100:103]
    ds_read_b64_tr_b16 a[146:147], v11 offset:20480
    ds_read_b64_tr_b16 a[148:149], v12 offset:16384
    ds_read_b128 v[32:35], v8 offset:8192
    v_mfma_f32_16x16x32_bf16 v[104:107], a[88:91], v[44:47], v[104:107]
    ds_read_b64_tr_b16 a[150:151], v12 offset:20480
    ds_read_b64_tr_b16 a[152:153], v11 offset:24576
    ds_read_b64_tr_b16 a[154:155], v11 offset:28672
    v_mfma_f32_16x16x32_bf16 v[108:111], a[92:95], v[44:47], v[108:111]
    ds_read_b64_tr_b16 a[156:157], v12 offset:24576
    ds_read_b128 v[36:39], v8 offset:12288
    ds_read_b128 v[40:43], v8 offset:1024
    v_mfma_f32_16x16x32_bf16 v[112:115], a[88:91], v[48:51], v[112:115]
    s_xor_b32 m0, s77, 0x18000
    s_add_u32 s3, s76, 0x80000
    s_and_b32 s3, s3, 0xe0000
    s_add_u32 s3, s3, s74
    s_bitset1_b32 s3, 16
    buffer_load_dwordx4 v58, s[84:87], s3 offen offset:0 lds
    v_mfma_f32_16x16x32_bf16 v[116:119], a[92:95], v[48:51], v[116:119]
    ds_read_b64_tr_b16 a[158:159], v12 offset:28672
    buffer_load_dwordx4 v59, s[84:87], s3 offen offset:1024 lds
    v_mfma_f32_16x16x32_bf16 v[120:123], a[88:91], v[52:55], v[120:123]
    buffer_load_dwordx4 v60, s[84:87], s3 offen offset:2048 lds
    ds_read_b128 v[44:47], v8 offset:5120
    v_mfma_f32_16x16x32_bf16 v[124:127], a[92:95], v[52:55], v[124:127]
    ds_read_b64_tr_b16 a[160:161], v11 offset:49152
    ds_read_b128 v[48:51], v8 offset:9216
    ds_read_b128 v[52:55], v8 offset:13312
    s_waitcnt lgkmcnt(9)
    v_mfma_f32_16x16x32_bf16 v[96:99], a[96:99], v[24:27], v[96:99]
    ds_read_b64_tr_b16 a[162:163], v11 offset:53248
    buffer_load_dwordx4 v61, s[84:87], s3 offen offset:3072 lds
    v_mfma_f32_16x16x32_bf16 v[100:103], a[100:103], v[24:27], v[100:103]
    ds_read_b128 v[24:27], v8 offset:2048
    v_and_or_b32 v22, v2, 48, v196
    v_lshl_or_b32 v16, v195, 10, v22
    v_mfma_f32_16x16x32_bf16 v[104:107], a[96:99], v[28:31], v[104:107]
    ds_read_b64_tr_b16 a[164:165], v12 offset:49152
    v_or_b32 v15, s6, v2
    v_mov_b32 v17, s80
    v_mfma_f32_16x16x32_bf16 v[108:111], a[100:103], v[28:31], v[108:111]
    ds_read_b64_tr_b16 a[166:167], v12 offset:53248
    ds_read_b128 v[28:31], v8 offset:6144
    s_mov_b32 s41, 0x7060500
    v_mfma_f32_16x16x32_bf16 v[112:115], a[96:99], v[32:35], v[112:115]
    s_mov_b32 s42, 0x7060501
    s_mov_b32 s43, 0x7060502
    s_mov_b32 s44, 0x7060503
    v_mfma_f32_16x16x32_bf16 v[116:119], a[100:103], v[32:35], v[116:119]
    s_xor_b32 m0, s77, 0x4000
    s_add_u32 s3, s37, 0xc000
    s_and_b32 s3, s3, 0x1c000
    s_add_u32 s3, s3, s36
    buffer_load_dwordx4 v2, s[16:19], s3 offen offset:0 sc1 lds
    s_waitcnt lgkmcnt(4)
    v_mfma_f32_16x16x32_bf16 v[120:123], a[96:99], v[36:39], v[120:123]
    ds_read_b64_tr_b16 a[168:169], v11 offset:57344
    buffer_load_dwordx4 v2, s[16:19], s3 offen offset:1024 sc1 lds
    v_mfma_f32_16x16x32_bf16 v[124:127], a[100:103], v[36:39], v[124:127]
    buffer_load_dwordx4 v2, s[16:19], s3 offen offset:2048 sc1 lds
    ds_read_b128 v[32:35], v8 offset:10240
    v_mfma_f32_16x16x32_bf16 v[96:99], a[104:107], v[40:43], v[96:99]
    ds_read_b128 v[36:39], v8 offset:14336
    s_mov_b32 s45, 0x0c0c0400
    s_mov_b32 s46, 0x04000c0c
    v_mfma_f32_16x16x32_bf16 v[100:103], a[108:111], v[40:43], v[100:103]
    buffer_load_dwordx4 v2, s[16:19], s3 offen offset:3072 sc1 lds
    s_and_b32 s4, s2, 7
    v_mfma_f32_16x16x32_bf16 v[104:107], a[104:107], v[44:47], v[104:107]
    s_mul_i32 s4, s4, 28
    s_lshr_b32 s5, s2, 3
    s_add_u32 s4, s4, s5
    v_mfma_f32_16x16x32_bf16 v[108:111], a[108:111], v[44:47], v[108:111]
    s_sub_u32 s4, s4, 4
    s_cmp_ge_u32 s5, 4
    s_cselect_b32 s40, s4, 0
    s_cselect_b32 s5, 7168, 0
    v_mfma_f32_16x16x32_bf16 v[112:115], a[104:107], v[48:51], v[112:115]
    ds_read_b64_tr_b16 a[170:171], v11 offset:61440
    ds_read_b64_tr_b16 a[172:173], v12 offset:57344
    v_mfma_f32_16x16x32_bf16 v[116:119], a[108:111], v[48:51], v[116:119]
    ds_read_b64_tr_b16 a[174:175], v12 offset:61440
    ds_read_b128 v[40:43], v8 offset:3072
    v_mfma_f32_16x16x32_bf16 v[120:123], a[104:107], v[52:55], v[120:123]
    ds_read_b128 v[44:47], v8 offset:7168
    ds_read_b128 v[48:51], v8 offset:11264
    v_mfma_f32_16x16x32_bf16 v[124:127], a[108:111], v[52:55], v[124:127]
    s_xor_b32 m0, s77, 0xc000
    s_add_u32 s3, s76, 0xa0000
    s_and_b32 s3, s3, 0xe0000
    s_add_u32 s3, s3, s74
    buffer_load_dwordx4 v58, s[84:87], s3 offen offset:0 lds
    s_waitcnt lgkmcnt(6)
    v_mfma_f32_16x16x32_bf16 v[96:99], a[112:115], v[24:27], v[96:99]
    buffer_load_dwordx4 v59, s[84:87], s3 offen offset:1024 lds
    ds_read_b128 v[52:55], v8 offset:15360
    v_mfma_f32_16x16x32_bf16 v[100:103], a[116:119], v[24:27], v[100:103]
    buffer_load_dwordx4 v60, s[84:87], s3 offen offset:2048 lds
    v_mfma_f32_16x16x32_bf16 v[104:107], a[112:115], v[28:31], v[104:107]
    v_lshrrev_b32 v21, 24, v0
    v_mul_u32_u24 v18, s5, v21
    v_mfma_f32_16x16x32_bf16 v[108:111], a[116:119], v[28:31], v[108:111]
    buffer_load_dwordx4 v61, s[84:87], s3 offen offset:3072 lds
    v_mfma_f32_16x16x32_bf16 v[112:115], a[112:115], v[32:35], v[112:115]
    v_lshl_add_u32 v18, s40, 4, v18
    v_and_b32 v19, 127, v21
    v_mfma_f32_16x16x32_bf16 v[116:119], a[116:119], v[32:35], v[116:119]
    s_lshl_b32 s4, s40, 13
    s_add_u32 s4, s4, 4096
    v_mfma_f32_16x16x32_bf16 v[120:123], a[112:115], v[36:39], v[120:123]
    v_lshl_add_u32 v19, v19, 3, s4
    v_mul_u32_u24 v23, 0x3100, v21
    v_mfma_f32_16x16x32_bf16 v[124:127], a[116:119], v[36:39], v[124:127]
    v_cmp_gt_u32 vcc, 8, v21
    s_nop 1
    v_cndmask_b32 v23, v0, v23, vcc
    s_lshl2_add_u32 s4, s62, s63
    s_waitcnt vmcnt(16) lgkmcnt(0)
    s_barrier
    v_mfma_f32_16x16x32_bf16 v[96:99], a[120:123], v[40:43], v[96:99]
    ds_read_b128 v[24:27], v6 offset:32768
    ds_read_b128 v[28:31], v6 offset:36864
    v_mfma_f32_16x16x32_bf16 v[100:103], a[124:127], v[40:43], v[100:103]
    ds_read_b64_tr_b16 a[176:177], v13 offset:16384
    ds_read_b128 v[32:35], v6 offset:40960
    v_mfma_f32_16x16x32_bf16 v[104:107], a[120:123], v[44:47], v[104:107]
    ds_read_b64_tr_b16 a[178:179], v13 offset:20480
    ds_read_b64_tr_b16 a[180:181], v14 offset:16384
    v_mfma_f32_16x16x32_bf16 v[108:111], a[124:127], v[44:47], v[108:111]
    ds_read_b128 v[36:39], v6 offset:45056
    ds_read_b128 v[40:43], v6 offset:33792
    v_mfma_f32_16x16x32_bf16 v[112:115], a[120:123], v[48:51], v[112:115]
    s_xor_b32 m0, s77, 0x1c000
    s_add_u32 s3, s37, 0x10000
    s_and_b32 s3, s3, 0x1c000
    s_add_u32 s3, s3, s36
    buffer_load_dwordx4 v2, s[16:19], s3 offen offset:0 sc1 lds
    v_mfma_f32_16x16x32_bf16 v[116:119], a[124:127], v[48:51], v[116:119]
    buffer_load_dwordx4 v2, s[16:19], s3 offen offset:1024 sc1 lds
    v_mfma_f32_16x16x32_bf16 v[120:123], a[120:123], v[52:55], v[120:123]
    ds_read_b64_tr_b16 a[182:183], v14 offset:20480
    s_lshl_b32 s4, s4, 6
    v_mfma_f32_16x16x32_bf16 v[124:127], a[124:127], v[52:55], v[124:127]
    ds_read_b128 v[44:47], v6 offset:37888
    ds_read_b128 v[48:51], v6 offset:41984
    s_waitcnt lgkmcnt(7)
    v_mfma_f32_16x16x32_bf16 v[96:99], a[128:131], v[24:27], v[96:99]
    buffer_load_dwordx4 v2, s[16:19], s3 offen offset:2048 sc1 lds
    v_mfma_f32_16x16x32_bf16 v[100:103], a[132:135], v[24:27], v[100:103]
    ds_read_b64_tr_b16 a[184:185], v13 offset:24576
    ds_read_b128 v[52:55], v6 offset:46080
    v_mfma_f32_16x16x32_bf16 v[104:107], a[128:131], v[28:31], v[104:107]
    ds_read_b64_tr_b16 a[186:187], v13 offset:28672
    ds_read_b128 v[24:27], v6 offset:34816
    v_mfma_f32_16x16x32_bf16 v[108:111], a[132:135], v[28:31], v[108:111]
    buffer_load_dwordx4 v2, s[16:19], s3 offen offset:3072 sc1 lds
    v_mfma_f32_16x16x32_bf16 v[112:115], a[128:131], v[32:35], v[112:115]
    ds_read_b128 v[28:31], v6 offset:38912
    s_add_u32 s4, s4, 0xa000
    v_mfma_f32_16x16x32_bf16 v[116:119], a[132:135], v[32:35], v[116:119]
    ds_read_b64_tr_b16 a[188:189], v14 offset:24576
    v_and_b32 v208, 0x30, v2
    s_waitcnt lgkmcnt(8)
    v_mfma_f32_16x16x32_bf16 v[120:123], a[128:131], v[36:39], v[120:123]
    ds_read_b128 v[32:35], v6 offset:43008
    v_add_u32 v208, s4, v208
    v_mfma_f32_16x16x32_bf16 v[124:127], a[132:135], v[36:39], v[124:127]
    ds_read_b128 v[36:39], v6 offset:47104
    v_and_b32 v195, 16, v2
    v_mfma_f32_16x16x32_bf16 v[96:99], a[136:139], v[40:43], v[96:99]
    ds_read_b64_tr_b16 a[190:191], v14 offset:28672
    v_lshrrev_b32 v209, 5, v2
    v_mfma_f32_16x16x32_bf16 v[100:103], a[140:143], v[40:43], v[100:103]
    ds_read_b128 v[40:43], v6 offset:35840
    v_lshlrev_b32 v195, 1, v195
    s_waitcnt lgkmcnt(6)
    v_mfma_f32_16x16x32_bf16 v[104:107], a[136:139], v[44:47], v[104:107]
    s_xor_b32 m0, s77, 0x14000
    s_add_u32 s3, s76, 0xa0000
    s_and_b32 s3, s3, 0xe0000
    s_add_u32 s3, s3, s74
    s_bitset1_b32 s3, 16
    buffer_load_dwordx4 v58, s[84:87], s3 offen offset:0 lds
    v_mfma_f32_16x16x32_bf16 v[108:111], a[140:143], v[44:47], v[108:111]
    buffer_load_dwordx4 v59, s[84:87], s3 offen offset:1024 lds
    v_mfma_f32_16x16x32_bf16 v[112:115], a[136:139], v[48:51], v[112:115]
    ds_read_b128 v[44:47], v6 offset:39936
    v_lshl_or_b32 v209, v209, 7, v195
    v_mfma_f32_16x16x32_bf16 v[116:119], a[140:143], v[48:51], v[116:119]
    v_add_u32 v209, 0x9000, v209
    s_lshl_b32 s4, s34, 3
    v_mfma_f32_16x16x32_bf16 v[120:123], a[136:139], v[52:55], v[120:123]
    buffer_load_dwordx4 v60, s[84:87], s3 offen offset:2048 lds
    v_mfma_f32_16x16x32_bf16 v[124:127], a[140:143], v[52:55], v[124:127]
    ds_read_b128 v[48:51], v6 offset:44032
    ds_read_b128 v[52:55], v6 offset:48128
    v_mfma_f32_16x16x32_bf16 v[96:99], a[144:147], v[24:27], v[96:99]
    s_and_b32 s5, s89, 1
    s_add_u32 s4, s4, s5
    v_mfma_f32_16x16x32_bf16 v[100:103], a[148:151], v[24:27], v[100:103]
    s_lshl_b32 s4, s4, 7
    s_add_u32 s4, s4, 0xb000
    s_waitcnt lgkmcnt(3)
    v_mfma_f32_16x16x32_bf16 v[104:107], a[144:147], v[28:31], v[104:107]
    buffer_load_dwordx4 v61, s[84:87], s3 offen offset:3072 lds
    v_mfma_f32_16x16x32_bf16 v[108:111], a[148:151], v[28:31], v[108:111]
    v_bfe_u32 v195, v2, 7, 2
    v_and_b32 v196, 0x70, v2
    v_mfma_f32_16x16x32_bf16 v[112:115], a[144:147], v[32:35], v[112:115]
    v_lshl_or_b32 v195, v195, 8, v196
    v_add_u32 v210, s4, v195
    v_mfma_f32_16x16x32_bf16 v[116:119], a[148:151], v[32:35], v[116:119]
    v_mfma_f32_16x16x32_bf16 v[120:123], a[144:147], v[36:39], v[120:123]
    v_mfma_f32_16x16x32_bf16 v[124:127], a[148:151], v[36:39], v[124:127]
    s_waitcnt vmcnt(12) lgkmcnt(0)
    s_barrier
    v_mfma_f32_16x16x32_bf16 v[96:99], a[152:155], v[40:43], v[96:99]
    ds_read_b128 v[24:27], v6 offset:16384
    ds_read_b128 v[28:31], v6 offset:20480
    v_mfma_f32_16x16x32_bf16 v[100:103], a[156:159], v[40:43], v[100:103]
    buffer_load_dwordx4 v[204:207], v208, s[20:23], 0 offen sc1
    v_mfma_f32_16x16x32_bf16 v[104:107], a[152:155], v[44:47], v[104:107]
    ds_read_b64_tr_b16 a[192:193], v11 offset:0
    ds_read_b128 v[32:35], v6 offset:24576
    v_mfma_f32_16x16x32_bf16 v[108:111], a[156:159], v[44:47], v[108:111]
    ds_read_b64_tr_b16 a[194:195], v11 offset:4096
    ds_read_b128 v[36:39], v6 offset:28672
    v_mfma_f32_16x16x32_bf16 v[112:115], a[152:155], v[48:51], v[112:115]
    ds_read_b64_tr_b16 a[196:197], v12 offset:0
    ds_read_b128 v[40:43], v6 offset:17408
    v_mfma_f32_16x16x32_bf16 v[116:119], a[156:159], v[48:51], v[116:119]
    ds_read_b128 v[44:47], v6 offset:21504
    ds_read_b128 v[48:51], v6 offset:25600
    v_mfma_f32_16x16x32_bf16 v[120:123], a[152:155], v[52:55], v[120:123]
    s_mov_b32 m0, s35
    s_add_u32 s3, s37, 0x14000
    s_and_b32 s3, s3, 0x1c000
    s_add_u32 s3, s3, s36
    buffer_load_dwordx4 v2, s[16:19], s3 offen offset:0 sc1 lds
    v_mfma_f32_16x16x32_bf16 v[124:127], a[156:159], v[52:55], v[124:127]
    buffer_load_dwordx4 v2, s[16:19], s3 offen offset:1024 sc1 lds
    s_waitcnt lgkmcnt(8)
    v_mfma_f32_16x16x32_bf16 v[96:99], a[160:163], v[24:27], v[96:99]
    buffer_load_dwordx4 v2, s[16:19], s3 offen offset:2048 sc1 lds
    v_mfma_f32_16x16x32_bf16 v[100:103], a[164:167], v[24:27], v[100:103]
    buffer_load_dwordx4 v2, s[16:19], s3 offen offset:3072 sc1 lds
    v_mfma_f32_16x16x32_bf16 v[104:107], a[160:163], v[28:31], v[104:107]
    ds_read_b64_tr_b16 a[198:199], v12 offset:4096
    ds_read_b64_tr_b16 a[200:201], v11 offset:8192
    v_mfma_f32_16x16x32_bf16 v[108:111], a[164:167], v[28:31], v[108:111]
    ds_read_b64_tr_b16 a[202:203], v11 offset:12288
    ds_read_b128 v[52:55], v6 offset:29696
    s_waitcnt lgkmcnt(5)
    v_mfma_f32_16x16x32_bf16 v[112:115], a[160:163], v[32:35], v[112:115]
    ds_read_b64_tr_b16 a[204:205], v12 offset:8192
    ds_read_b64_tr_b16 a[206:207], v12 offset:12288
    v_mfma_f32_16x16x32_bf16 v[116:119], a[164:167], v[32:35], v[116:119]
    ds_read_b64_tr_b16 a[208:209], v11 offset:32768
    ds_read_b128 v[24:27], v6 offset:18432
    v_mfma_f32_16x16x32_bf16 v[120:123], a[160:163], v[36:39], v[120:123]
    ds_read_b128 v[28:31], v6 offset:22528
    ds_read_b128 v[32:35], v6 offset:26624
    v_mfma_f32_16x16x32_bf16 v[124:127], a[164:167], v[36:39], v[124:127]
    s_mov_b32 m0, s77
    s_add_u32 s3, s76, 0xc0000
    s_and_b32 s3, s3, 0xe0000
    s_add_u32 s3, s3, s74
    buffer_load_dwordx4 v58, s[84:87], s3 offen offset:0 lds
    v_mfma_f32_16x16x32_bf16 v[96:99], a[168:171], v[40:43], v[96:99]
    buffer_load_dwordx4 v59, s[84:87], s3 offen offset:1024 lds
    v_mfma_f32_16x16x32_bf16 v[100:103], a[172:175], v[40:43], v[100:103]
    buffer_load_dwordx4 v60, s[84:87], s3 offen offset:2048 lds
    v_mfma_f32_16x16x32_bf16 v[104:107], a[168:171], v[44:47], v[104:107]
    buffer_load_dwordx4 v61, s[84:87], s3 offen offset:3072 lds
    v_mfma_f32_16x16x32_bf16 v[108:111], a[172:175], v[44:47], v[108:111]
    ds_read_b64_tr_b16 a[210:211], v11 offset:36864
    ds_read_b128 v[36:39], v6 offset:30720
    s_waitcnt lgkmcnt(5)
    v_mfma_f32_16x16x32_bf16 v[112:115], a[168:171], v[48:51], v[112:115]
    ds_read_b64_tr_b16 a[212:213], v12 offset:32768
    ds_read_b64_tr_b16 a[214:215], v12 offset:36864
    v_mfma_f32_16x16x32_bf16 v[116:119], a[172:175], v[48:51], v[116:119]
    ds_read_b64_tr_b16 a[216:217], v11 offset:40960
    ds_read_b128 v[40:43], v6 offset:19456
    v_mfma_f32_16x16x32_bf16 v[120:123], a[168:171], v[52:55], v[120:123]
    ds_read_b64_tr_b16 a[218:219], v11 offset:45056
    ds_read_b64_tr_b16 a[220:221], v12 offset:40960
    v_mfma_f32_16x16x32_bf16 v[124:127], a[172:175], v[52:55], v[124:127]
    ds_read_b64_tr_b16 a[222:223], v12 offset:45056
    ds_read_b128 v[44:47], v6 offset:23552
    s_waitcnt lgkmcnt(10)
    v_mfma_f32_16x16x32_bf16 v[96:99], a[176:179], v[24:27], v[96:99]
    s_add_u32 m0, s35, 0x4000
    s_add_u32 s3, s76, 0xc0000
    s_and_b32 s3, s3, 0xe0000
    s_add_u32 s3, s3, s74
    s_bitset1_b32 s3, 16
    buffer_load_dwordx4 v58, s[84:87], s3 offen offset:0 lds
    v_mfma_f32_16x16x32_bf16 v[100:103], a[180:183], v[24:27], v[100:103]
    ds_read_b128 v[48:51], v6 offset:27648
    ds_read_b128 v[52:55], v6 offset:31744
    v_mfma_f32_16x16x32_bf16 v[104:107], a[176:179], v[28:31], v[104:107]
    buffer_load_dwordx4 v59, s[84:87], s3 offen offset:1024 lds
    v_mfma_f32_16x16x32_bf16 v[108:111], a[180:183], v[28:31], v[108:111]
    buffer_load_dwordx4 v60, s[84:87], s3 offen offset:2048 lds
    v_mfma_f32_16x16x32_bf16 v[112:115], a[176:179], v[32:35], v[112:115]
    buffer_load_dwordx4 v61, s[84:87], s3 offen offset:3072 lds
    v_mfma_f32_16x16x32_bf16 v[116:119], a[180:183], v[32:35], v[116:119]
    s_waitcnt lgkmcnt(4)
    v_mfma_f32_16x16x32_bf16 v[120:123], a[176:179], v[36:39], v[120:123]
    v_mfma_f32_16x16x32_bf16 v[124:127], a[180:183], v[36:39], v[124:127]
    s_waitcnt vmcnt(13) lgkmcnt(0)
    s_barrier
    v_mfma_f32_16x16x32_bf16 v[96:99], a[184:187], v[40:43], v[96:99]
    ds_read_b128 v[24:27], v7 offset:49152
    ds_read_b128 v[28:31], v7 offset:53248
    v_mfma_f32_16x16x32_bf16 v[100:103], a[188:191], v[40:43], v[100:103]
    ds_read_b64_tr_b16 a[32:33], v9 offset:49152
    ds_read_b128 v[32:35], v7 offset:57344
    v_mfma_f32_16x16x32_bf16 v[104:107], a[184:187], v[44:47], v[104:107]
    ds_read_b64_tr_b16 a[34:35], v9 offset:53248
    ds_read_b64_tr_b16 a[36:37], v10 offset:49152
    v_mfma_f32_16x16x32_bf16 v[108:111], a[188:191], v[44:47], v[108:111]
    ds_read_b128 v[36:39], v7 offset:61440
    ds_read_b128 v[40:43], v7 offset:50176
    v_mfma_f32_16x16x32_bf16 v[112:115], a[184:187], v[48:51], v[112:115]
    s_xor_b32 m0, s77, 0x8000
    s_add_u32 s3, s37, 0x18000
    s_and_b32 s3, s3, 0x1c000
    s_add_u32 s3, s3, s36
    buffer_load_dwordx4 v2, s[16:19], s3 offen offset:0 sc1 lds
    v_mfma_f32_16x16x32_bf16 v[116:119], a[188:191], v[48:51], v[116:119]
    buffer_load_dwordx4 v2, s[16:19], s3 offen offset:1024 sc1 lds
    v_mfma_f32_16x16x32_bf16 v[120:123], a[184:187], v[52:55], v[120:123]
    ds_read_b64_tr_b16 a[38:39], v10 offset:53248
    ds_read_b64_tr_b16 a[40:41], v9 offset:57344
    v_mfma_f32_16x16x32_bf16 v[124:127], a[188:191], v[52:55], v[124:127]
    ds_read_b64_tr_b16 a[42:43], v9 offset:61440
    ds_read_b128 v[44:47], v7 offset:54272
    s_waitcnt lgkmcnt(8)
    v_mfma_f32_16x16x32_bf16 v[96:99], a[192:195], v[24:27], v[96:99]
    buffer_load_dwordx4 v2, s[16:19], s3 offen offset:2048 sc1 lds
    v_mfma_f32_16x16x32_bf16 v[100:103], a[196:199], v[24:27], v[100:103]
    ds_read_b64_tr_b16 a[44:45], v10 offset:57344
    ds_read_b128 v[48:51], v7 offset:58368
    v_mfma_f32_16x16x32_bf16 v[104:107], a[192:195], v[28:31], v[104:107]
    ds_read_b64_tr_b16 a[46:47], v10 offset:61440
    ds_read_b128 v[52:55], v7 offset:62464
    v_mfma_f32_16x16x32_bf16 v[108:111], a[196:199], v[28:31], v[108:111]
    buffer_load_dwordx4 v2, s[16:19], s3 offen offset:3072 sc1 lds
    v_mfma_f32_16x16x32_bf16 v[112:115], a[192:195], v[32:35], v[112:115]
    ds_read_b64_tr_b16 a[48:49], v11 offset:16384
    ds_read_b64_tr_b16 a[50:51], v11 offset:20480
    v_mfma_f32_16x16x32_bf16 v[116:119], a[196:199], v[32:35], v[116:119]
    ds_read_b64_tr_b16 a[52:53], v12 offset:16384
    ds_read_b128 v[24:27], v7 offset:51200
    s_waitcnt lgkmcnt(10)
    v_mfma_f32_16x16x32_bf16 v[120:123], a[192:195], v[36:39], v[120:123]
    ds_read_b64_tr_b16 a[54:55], v12 offset:20480
    ds_read_b64_tr_b16 a[56:57], v11 offset:24576
    v_mfma_f32_16x16x32_bf16 v[124:127], a[196:199], v[36:39], v[124:127]
    ds_read_b64_tr_b16 a[58:59], v11 offset:28672
    ds_read_b128 v[28:31], v7 offset:55296
    v_mfma_f32_16x16x32_bf16 v[96:99], a[200:203], v[40:43], v[96:99]
    ds_read_b64_tr_b16 a[60:61], v12 offset:24576
    ds_read_b128 v[32:35], v7 offset:59392
    v_mfma_f32_16x16x32_bf16 v[100:103], a[204:207], v[40:43], v[100:103]
    ds_read_b128 v[36:39], v7 offset:63488
    ds_read_b128 v[40:43], v7 offset:52224
    s_waitcnt lgkmcnt(12)
    v_mfma_f32_16x16x32_bf16 v[104:107], a[200:203], v[44:47], v[104:107]
    s_xor_b32 m0, s77, 0x10000
    s_add_u32 s3, s76, 0xe0000
    s_and_b32 s3, s3, 0xe0000
    s_add_u32 s3, s3, s74
    buffer_load_dwordx4 v58, s[84:87], s3 offen offset:0 lds
    v_mfma_f32_16x16x32_bf16 v[108:111], a[204:207], v[44:47], v[108:111]
    buffer_load_dwordx4 v59, s[84:87], s3 offen offset:1024 lds
    v_mfma_f32_16x16x32_bf16 v[112:115], a[200:203], v[48:51], v[112:115]
    s_waitcnt vmcnt(18)
    v_cmp_eq_u64_e64 s[4:5], s[80:81], v[204:205]
    v_cmp_eq_u64 vcc, s[80:81], v[206:207]
    v_mfma_f32_16x16x32_bf16 v[116:119], a[204:207], v[48:51], v[116:119]
    ds_read_b64_tr_b16 a[62:63], v12 offset:28672
    ds_read_b128 v[44:47], v7 offset:56320
    v_mfma_f32_16x16x32_bf16 v[120:123], a[200:203], v[52:55], v[120:123]
    buffer_load_dwordx4 v60, s[84:87], s3 offen offset:2048 lds
    v_mfma_f32_16x16x32_bf16 v[124:127], a[204:207], v[52:55], v[124:127]
    ds_read_b128 v[48:51], v7 offset:60416
    ds_read_b128 v[52:55], v7 offset:64512
    s_waitcnt lgkmcnt(4)
    v_mfma_f32_16x16x32_bf16 v[96:99], a[208:211], v[24:27], v[96:99]
    s_and_b64 s[4:5], s[4:5], vcc
    v_mfma_f32_16x16x32_bf16 v[100:103], a[212:215], v[24:27], v[100:103]
    v_mfma_f32_16x16x32_bf16 v[104:107], a[208:211], v[28:31], v[104:107]
    buffer_load_dwordx4 v61, s[84:87], s3 offen offset:3072 lds
    v_mfma_f32_16x16x32_bf16 v[108:111], a[212:215], v[28:31], v[108:111]
    v_mfma_f32_16x16x32_bf16 v[112:115], a[208:211], v[32:35], v[112:115]
    v_mfma_f32_16x16x32_bf16 v[116:119], a[212:215], v[32:35], v[116:119]
    v_mfma_f32_16x16x32_bf16 v[120:123], a[208:211], v[36:39], v[120:123]
    v_mfma_f32_16x16x32_bf16 v[124:127], a[212:215], v[36:39], v[124:127]
    s_waitcnt vmcnt(8) lgkmcnt(0)
    s_barrier
    s_cmp_eq_u64 s[4:5], -1
    s_cbranch_scc0 L_cl_retry
L_cl_back:
    v_mfma_f32_16x16x32_bf16 v[96:99], a[216:219], v[40:43], v[96:99]
    ds_read_b128 v[24:27], v8 offset:0
    ds_read_b128 v[28:31], v8 offset:4096
    v_mfma_f32_16x16x32_bf16 v[100:103], a[220:223], v[40:43], v[100:103]
    ds_read_b64_tr_b16 a[0:1], v9 offset:0
    ds_read_b128 v[32:35], v8 offset:8192
    v_mfma_f32_16x16x32_bf16 v[104:107], a[216:219], v[44:47], v[104:107]
    ds_read_b64_tr_b16 a[2:3], v9 offset:4096
    ds_read_b64_tr_b16 a[4:5], v10 offset:0
    v_mfma_f32_16x16x32_bf16 v[108:111], a[220:223], v[44:47], v[108:111]
    ds_read_b128 v[36:39], v8 offset:12288
    ds_read_b128 v[40:43], v8 offset:1024
    v_mfma_f32_16x16x32_bf16 v[112:115], a[216:219], v[48:51], v[112:115]
    s_xor_b32 m0, s77, 0x18000
    s_add_u32 s3, s37, 0x1c000
    s_and_b32 s3, s3, 0x1c000
    s_add_u32 s3, s3, s36
    buffer_load_dwordx4 v2, s[16:19], s3 offen offset:0 sc1 lds
    v_mfma_f32_16x16x32_bf16 v[116:119], a[220:223], v[48:51], v[116:119]
    buffer_load_dwordx4 v2, s[16:19], s3 offen offset:1024 sc1 lds
    v_mfma_f32_16x16x32_bf16 v[120:123], a[216:219], v[52:55], v[120:123]
    ds_read_b64_tr_b16 a[6:7], v10 offset:4096
    ds_read_b64_tr_b16 a[8:9], v9 offset:8192
    v_mfma_f32_16x16x32_bf16 v[124:127], a[220:223], v[52:55], v[124:127]
    ds_read_b64_tr_b16 a[10:11], v9 offset:12288
    ds_read_b128 v[44:47], v8 offset:5120
    s_waitcnt lgkmcnt(8)
    v_mfma_f32_16x16x32_bf16 v[96:99], a[32:35], v[24:27], v[96:99]
    buffer_load_dwordx4 v2, s[16:19], s3 offen offset:2048 sc1 lds
    v_mfma_f32_16x16x32_bf16 v[100:103], a[36:39], v[24:27], v[100:103]
    ds_read_b64_tr_b16 a[12:13], v10 offset:8192
    ds_read_b128 v[48:51], v8 offset:9216
    v_mfma_f32_16x16x32_bf16 v[104:107], a[32:35], v[28:31], v[104:107]
    ds_read_b64_tr_b16 a[14:15], v10 offset:12288
    ds_read_b128 v[52:55], v8 offset:13312
    v_mfma_f32_16x16x32_bf16 v[108:111], a[36:39], v[28:31], v[108:111]
    buffer_load_dwordx4 v2, s[16:19], s3 offen offset:3072 sc1 lds
    v_mfma_f32_16x16x32_bf16 v[112:115], a[32:35], v[32:35], v[112:115]
    ds_read_b64_tr_b16 a[16:17], v13 offset:16384
    ds_read_b64_tr_b16 a[18:19], v13 offset:20480
    v_mfma_f32_16x16x32_bf16 v[116:119], a[36:39], v[32:35], v[116:119]
    ds_read_b64_tr_b16 a[20:21], v14 offset:16384
    ds_read_b128 v[24:27], v8 offset:2048
    s_waitcnt lgkmcnt(10)
    v_mfma_f32_16x16x32_bf16 v[120:123], a[32:35], v[36:39], v[120:123]
    ds_read_b64_tr_b16 a[22:23], v14 offset:20480
    ds_read_b64_tr_b16 a[24:25], v13 offset:24576
    v_mfma_f32_16x16x32_bf16 v[124:127], a[36:39], v[36:39], v[124:127]
    ds_read_b64_tr_b16 a[26:27], v13 offset:28672
    ds_read_b128 v[28:31], v8 offset:6144
    v_mfma_f32_16x16x32_bf16 v[96:99], a[40:43], v[40:43], v[96:99]
    ds_read_b64_tr_b16 a[28:29], v14 offset:24576
    ds_read_b128 v[32:35], v8 offset:10240
    v_mfma_f32_16x16x32_bf16 v[100:103], a[44:47], v[40:43], v[100:103]
    ds_read_b128 v[36:39], v8 offset:14336
    ds_read_b128 v[40:43], v8 offset:3072
    s_waitcnt lgkmcnt(12)
    v_mfma_f32_16x16x32_bf16 v[104:107], a[40:43], v[44:47], v[104:107]
    s_xor_b32 m0, s77, 0x4000
    s_add_u32 s3, s76, 0xe0000
    s_and_b32 s3, s3, 0xe0000
    s_add_u32 s3, s3, s74
    s_bitset1_b32 s3, 16
    buffer_load_dwordx4 v58, s[84:87], s3 offen offset:0 lds
    v_mfma_f32_16x16x32_bf16 v[108:111], a[44:47], v[44:47], v[108:111]
    buffer_load_dwordx4 v59, s[84:87], s3 offen offset:1024 lds
    v_mfma_f32_16x16x32_bf16 v[112:115], a[40:43], v[48:51], v[112:115]
    ds_read_b64_tr_b16 a[30:31], v14 offset:28672
    ds_read_b128 v[44:47], v8 offset:7168
    v_mfma_f32_16x16x32_bf16 v[116:119], a[44:47], v[48:51], v[116:119]
    ds_read_b128 v[48:51], v8 offset:11264
    v_mfma_f32_16x16x32_bf16 v[120:123], a[40:43], v[52:55], v[120:123]
    buffer_load_dwordx4 v60, s[84:87], s3 offen offset:2048 lds
    v_mfma_f32_16x16x32_bf16 v[124:127], a[44:47], v[52:55], v[124:127]
    ds_read_b128 v[52:55], v8 offset:15360
    s_waitcnt lgkmcnt(5)
    v_mfma_f32_16x16x32_bf16 v[96:99], a[48:51], v[24:27], v[96:99]
    v_mfma_f32_16x16x32_bf16 v[100:103], a[52:55], v[24:27], v[100:103]
    v_mfma_f32_16x16x32_bf16 v[104:107], a[48:51], v[28:31], v[104:107]
    buffer_load_dwordx4 v61, s[84:87], s3 offen offset:3072 lds
    v_mfma_f32_16x16x32_bf16 v[108:111], a[52:55], v[28:31], v[108:111]
    v_mfma_f32_16x16x32_bf16 v[112:115], a[48:51], v[32:35], v[112:115]
    v_mfma_f32_16x16x32_bf16 v[116:119], a[52:55], v[32:35], v[116:119]
    v_mfma_f32_16x16x32_bf16 v[120:123], a[48:51], v[36:39], v[120:123]
    v_mfma_f32_16x16x32_bf16 v[124:127], a[52:55], v[36:39], v[124:127]
    s_waitcnt vmcnt(8) lgkmcnt(0)
    s_barrier
    v_mfma_f32_16x16x32_bf16 v[96:99], a[56:59], v[40:43], v[96:99]
    ds_read_b128 v[24:27], v6 offset:32768
    ds_read_b128 v[28:31], v6 offset:36864
    v_mfma_f32_16x16x32_bf16 v[100:103], a[60:63], v[40:43], v[100:103]
    ds_read_b128 v[32:35], v6 offset:40960
    ds_read_b128 v[36:39], v6 offset:45056
    v_mfma_f32_16x16x32_bf16 v[104:107], a[56:59], v[44:47], v[104:107]
    buffer_load_dwordx4 v[192:195], v209, s[20:23], 0 offen offset:0 sc1
    v_mfma_f32_16x16x32_bf16 v[108:111], a[60:63], v[44:47], v[108:111]
    buffer_load_dwordx4 v[196:199], v209, s[20:23], 0 offen offset:16 sc1
    v_mfma_f32_16x16x32_bf16 v[112:115], a[56:59], v[48:51], v[112:115]
    ds_read_b64_tr_b16 v[64:65], v11 offset:0
    ds_read_b64_tr_b16 v[66:67], v11 offset:4096
    v_mfma_f32_16x16x32_bf16 v[116:119], a[60:63], v[48:51], v[116:119]
    ds_read_b64_tr_b16 v[68:69], v12 offset:0
    ds_read_b128 v[40:43], v6 offset:33792
    v_mfma_f32_16x16x32_bf16 v[120:123], a[56:59], v[52:55], v[120:123]
    buffer_load_dwordx4 v[200:203], v210, s[20:23], 0 offen offset:0 sc1
    v_mfma_f32_16x16x32_bf16 v[124:127], a[60:63], v[52:55], v[124:127]
    ds_read_b64_tr_b16 v[70:71], v12 offset:4096
    ds_read_b128 v[44:47], v6 offset:37888
    s_waitcnt lgkmcnt(8)
    v_mfma_f32_16x16x32_bf16 v[96:99], a[0:3], v[24:27], v[96:99]
    ds_read_b64_tr_b16 v[72:73], v11 offset:8192
    ds_read_b128 v[48:51], v6 offset:41984
    v_mfma_f32_16x16x32_bf16 v[100:103], a[4:7], v[24:27], v[100:103]
    ds_read_b128 v[52:55], v6 offset:46080
    ds_read_b128 v[24:27], v6 offset:34816
    v_mfma_f32_16x16x32_bf16 v[104:107], a[0:3], v[28:31], v[104:107]
    ds_read_b64_tr_b16 v[74:75], v11 offset:12288
    v_mfma_f32_16x16x32_bf16 v[108:111], a[4:7], v[28:31], v[108:111]
    s_xor_b32 m0, s77, 0x1c000
    s_add_u32 s3, s39, 0x0
    s_and_b32 s3, s3, 0x1c000
    s_add_u32 s3, s3, s38
    buffer_load_dwordx4 v2, s[16:19], s3 offen offset:0 sc1 lds
    s_waitcnt lgkmcnt(7)
    v_mfma_f32_16x16x32_bf16 v[112:115], a[0:3], v[32:35], v[112:115]
    buffer_load_dwordx4 v2, s[16:19], s3 offen offset:1024 sc1 lds
    v_mfma_f32_16x16x32_bf16 v[116:119], a[4:7], v[32:35], v[116:119]
    ds_read_b64_tr_b16 v[76:77], v12 offset:8192
    ds_read_b128 v[28:31], v6 offset:38912
    v_mfma_f32_16x16x32_bf16 v[120:123], a[0:3], v[36:39], v[120:123]
    buffer_load_dwordx4 v2, s[16:19], s3 offen offset:2048 sc1 lds
    v_mfma_f32_16x16x32_bf16 v[124:127], a[4:7], v[36:39], v[124:127]
    ds_read_b128 v[32:35], v6 offset:43008
    ds_read_b128 v[36:39], v6 offset:47104
    v_mfma_f32_16x16x32_bf16 v[96:99], a[8:11], v[40:43], v[96:99]
    buffer_load_dwordx4 v2, s[16:19], s3 offen offset:3072 sc1 lds
    v_mfma_f32_16x16x32_bf16 v[100:103], a[12:15], v[40:43], v[100:103]
    ds_read_b64_tr_b16 v[78:79], v12 offset:12288
    ds_read_b128 v[40:43], v6 offset:35840
    s_waitcnt lgkmcnt(6)
    v_mfma_f32_16x16x32_bf16 v[104:107], a[8:11], v[44:47], v[104:107]
    v_mfma_f32_16x16x32_bf16 v[108:111], a[12:15], v[44:47], v[108:111]
    ds_read_b128 v[44:47], v6 offset:39936
    v_mfma_f32_16x16x32_bf16 v[112:115], a[8:11], v[48:51], v[112:115]
    v_mfma_f32_16x16x32_bf16 v[116:119], a[12:15], v[48:51], v[116:119]
    ds_read_b128 v[48:51], v6 offset:44032
    v_mfma_f32_16x16x32_bf16 v[120:123], a[8:11], v[52:55], v[120:123]
    s_xor_b32 m0, s77, 0xc000
    s_add_u32 s3, s39, 0x8000
    s_and_b32 s3, s3, 0x1c000
    s_add_u32 s3, s3, s38
    buffer_load_dwordx4 v2, s[16:19], s3 offen offset:0 sc1 lds
    v_mfma_f32_16x16x32_bf16 v[124:127], a[12:15], v[52:55], v[124:127]
    ds_read_b128 v[52:55], v6 offset:48128
    v_mfma_f32_16x16x32_bf16 v[96:99], a[16:19], v[24:27], v[96:99]
    buffer_load_dwordx4 v2, s[16:19], s3 offen offset:1024 sc1 lds
    v_mfma_f32_16x16x32_bf16 v[100:103], a[20:23], v[24:27], v[100:103]
    buffer_load_dwordx4 v2, s[16:19], s3 offen offset:2048 sc1 lds
    s_waitcnt lgkmcnt(3)
    v_mfma_f32_16x16x32_bf16 v[104:107], a[16:19], v[28:31], v[104:107]
    v_mfma_f32_16x16x32_bf16 v[108:111], a[20:23], v[28:31], v[108:111]
    buffer_load_dwordx4 v2, s[16:19], s3 offen offset:3072 sc1 lds
    v_mfma_f32_16x16x32_bf16 v[112:115], a[16:19], v[32:35], v[112:115]
    v_mfma_f32_16x16x32_bf16 v[116:119], a[20:23], v[32:35], v[116:119]
    v_mfma_f32_16x16x32_bf16 v[120:123], a[16:19], v[36:39], v[120:123]
    v_mfma_f32_16x16x32_bf16 v[124:127], a[20:23], v[36:39], v[124:127]
    s_waitcnt vmcnt(11) lgkmcnt(0)
    s_barrier
    v_mfma_f32_16x16x32_bf16 v[96:99], a[24:27], v[40:43], v[96:99]
    ds_read_b128 v[24:27], v7 offset:32768
    ds_read_b128 v[28:31], v7 offset:36864
    v_mfma_f32_16x16x32_bf16 v[100:103], a[28:31], v[40:43], v[100:103]
    ds_read_b64_tr_b16 v[80:81], v9 offset:16384
    ds_read_b128 v[32:35], v7 offset:40960
    v_mfma_f32_16x16x32_bf16 v[104:107], a[24:27], v[44:47], v[104:107]
    ds_read_b64_tr_b16 v[82:83], v9 offset:20480
    ds_read_b64_tr_b16 v[84:85], v10 offset:16384
    v_mfma_f32_16x16x32_bf16 v[108:111], a[28:31], v[44:47], v[108:111]
    ds_read_b128 v[36:39], v7 offset:45056
    ds_read_b128 v[40:43], v7 offset:33792
    v_mfma_f32_16x16x32_bf16 v[112:115], a[24:27], v[48:51], v[112:115]
    s_xor_b32 m0, s77, 0x14000
    s_add_u32 s3, s39, 0x10000
    s_and_b32 s3, s3, 0x1c000
    s_add_u32 s3, s3, s38
    buffer_load_dwordx4 v2, s[16:19], s3 offen offset:0 sc1 lds
    v_mfma_f32_16x16x32_bf16 v[116:119], a[28:31], v[48:51], v[116:119]
    buffer_load_dwordx4 v2, s[16:19], s3 offen offset:1024 sc1 lds
    v_mfma_f32_16x16x32_bf16 v[120:123], a[24:27], v[52:55], v[120:123]
    ds_read_b64_tr_b16 v[86:87], v10 offset:20480
    ds_read_b64_tr_b16 v[88:89], v9 offset:24576
    v_mfma_f32_16x16x32_bf16 v[124:127], a[28:31], v[52:55], v[124:127]
    ds_read_b64_tr_b16 v[90:91], v9 offset:28672
    ds_read_b128 v[44:47], v7 offset:37888
    s_waitcnt lgkmcnt(8)
    v_mfma_f32_16x16x32_bf16 v[96:99], v[64:67], v[24:27], v[96:99]
    buffer_load_dwordx4 v2, s[16:19], s3 offen offset:2048 sc1 lds
    v_mfma_f32_16x16x32_bf16 v[100:103], v[68:71], v[24:27], v[100:103]
    ds_read_b64_tr_b16 v[92:93], v10 offset:24576
    ds_read_b128 v[48:51], v7 offset:41984
    v_mfma_f32_16x16x32_bf16 v[104:107], v[64:67], v[28:31], v[104:107]
    ds_read_b64_tr_b16 v[94:95], v10 offset:28672
    ds_read_b128 v[52:55], v7 offset:46080
    v_mfma_f32_16x16x32_bf16 v[108:111], v[68:71], v[28:31], v[108:111]
    buffer_load_dwordx4 v2, s[16:19], s3 offen offset:3072 sc1 lds
    v_mfma_f32_16x16x32_bf16 v[112:115], v[64:67], v[32:35], v[112:115]
    ds_read_b128 v[24:27], v7 offset:34816
    ds_read_b128 v[28:31], v7 offset:38912
    v_mfma_f32_16x16x32_bf16 v[116:119], v[68:71], v[32:35], v[116:119]
    ds_read_b128 v[32:35], v7 offset:43008
    s_waitcnt lgkmcnt(9)
    v_mfma_f32_16x16x32_bf16 v[120:123], v[64:67], v[36:39], v[120:123]
    v_mfma_f32_16x16x32_bf16 v[124:127], v[68:71], v[36:39], v[124:127]
    ds_read_b128 v[36:39], v7 offset:47104
    v_mfma_f32_16x16x32_bf16 v[96:99], v[72:75], v[40:43], v[96:99]
    v_mfma_f32_16x16x32_bf16 v[100:103], v[76:79], v[40:43], v[100:103]
    ds_read_b128 v[40:43], v7 offset:35840
    s_waitcnt lgkmcnt(7)
    v_mfma_f32_16x16x32_bf16 v[104:107], v[72:75], v[44:47], v[104:107]
    s_mov_b32 m0, s35
    s_add_u32 s3, s39, 0x18000
    s_and_b32 s3, s3, 0x1c000
    s_add_u32 s3, s3, s38
    buffer_load_dwordx4 v2, s[16:19], s3 offen offset:0 sc1 lds
    v_mfma_f32_16x16x32_bf16 v[108:111], v[76:79], v[44:47], v[108:111]
    buffer_load_dwordx4 v2, s[16:19], s3 offen offset:1024 sc1 lds
    v_mfma_f32_16x16x32_bf16 v[112:115], v[72:75], v[48:51], v[112:115]
    ds_read_b128 v[44:47], v7 offset:39936
    v_mfma_f32_16x16x32_bf16 v[116:119], v[76:79], v[48:51], v[116:119]
    ds_read_b128 v[48:51], v7 offset:44032
    s_waitcnt lgkmcnt(4)
    v_mfma_f32_16x16x32_bf16 v[120:123], v[72:75], v[52:55], v[120:123]
    buffer_load_dwordx4 v2, s[16:19], s3 offen offset:2048 sc1 lds
    v_mfma_f32_16x16x32_bf16 v[124:127], v[76:79], v[52:55], v[124:127]
    ds_read_b128 v[52:55], v7 offset:48128
    v_mfma_f32_16x16x32_bf16 v[96:99], v[80:83], v[24:27], v[96:99]
    v_mfma_f32_16x16x32_bf16 v[100:103], v[84:87], v[24:27], v[100:103]
    v_mfma_f32_16x16x32_bf16 v[104:107], v[80:83], v[28:31], v[104:107]
    buffer_load_dwordx4 v2, s[16:19], s3 offen offset:3072 sc1 lds
    v_mfma_f32_16x16x32_bf16 v[108:111], v[84:87], v[28:31], v[108:111]
    v_mfma_f32_16x16x32_bf16 v[112:115], v[80:83], v[32:35], v[112:115]
    v_mfma_f32_16x16x32_bf16 v[116:119], v[84:87], v[32:35], v[116:119]
    s_waitcnt lgkmcnt(2)
    v_mfma_f32_16x16x32_bf16 v[120:123], v[80:83], v[36:39], v[120:123]
    v_mfma_f32_16x16x32_bf16 v[124:127], v[84:87], v[36:39], v[124:127]
    s_waitcnt vmcnt(12)
    s_barrier
    v_mfma_f32_16x16x32_bf16 v[96:99], v[88:91], v[40:43], v[96:99]
    ds_read_b128 v[24:27], v7 offset:49152
    ds_read_b128 v[28:31], v7 offset:53248
    v_mfma_f32_16x16x32_bf16 v[100:103], v[92:95], v[40:43], v[100:103]
    ds_read_b128 v[32:35], v7 offset:50176
    ds_read_b128 v[36:39], v7 offset:54272
    v_mfma_f32_16x16x32_bf16 v[104:107], v[88:91], v[44:47], v[104:107]
    ds_read_b128 v[40:43], v7 offset:51200
    v_mfma_f32_16x16x32_bf16 v[108:111], v[92:95], v[44:47], v[108:111]
    ds_read_b128 v[44:47], v7 offset:55296
    s_waitcnt lgkmcnt(6)
    v_mfma_f32_16x16x32_bf16 v[112:115], v[88:91], v[48:51], v[112:115]
    s_mov_b32 m0, s77
    s_add_u32 s3, s39, 0x0
    s_and_b32 s3, s3, 0x1c000
    s_add_u32 s3, s3, s38
    s_bitset1_b32 s3, 13
    buffer_load_dwordx4 v2, s[16:19], s3 offen offset:0 sc1 lds
    v_mfma_f32_16x16x32_bf16 v[116:119], v[92:95], v[48:51], v[116:119]
    buffer_load_dwordx4 v2, s[16:19], s3 offen offset:1024 sc1 lds
    v_mfma_f32_16x16x32_bf16 v[120:123], v[88:91], v[52:55], v[120:123]
    buffer_load_dwordx4 v2, s[16:19], s3 offen offset:2048 sc1 lds
    v_mfma_f32_16x16x32_bf16 v[124:127], v[92:95], v[52:55], v[124:127]
    buffer_load_dwordx4 v2, s[16:19], s3 offen offset:3072 sc1 lds
    s_waitcnt lgkmcnt(4)
    v_mfma_f32_16x16x32_bf16 v[128:131], a[64:67], v[24:27], 0
    ds_read_b128 v[48:51], v7 offset:52224
    ds_read_b128 v[52:55], v7 offset:56320
    v_mfma_f32_16x16x32_bf16 v[132:135], a[68:71], v[24:27], 0
    ds_read_b128 v[24:27], v7 offset:57344
    v_mfma_f32_16x16x32_bf16 v[136:139], a[64:67], v[28:31], 0
    v_mfma_f32_16x16x32_bf16 v[140:143], a[68:71], v[28:31], 0
    ds_read_b128 v[28:31], v7 offset:61440
    s_waitcnt lgkmcnt(4)
    v_mfma_f32_16x16x32_bf16 v[128:131], a[72:75], v[32:35], v[128:131]
    v_cvt_pk_bf16_f32 v96, v96, v97
    v_mfma_f32_16x16x32_bf16 v[132:135], a[76:79], v[32:35], v[132:135]
    v_cvt_pk_bf16_f32 v97, v98, v99
    ds_read_b128 v[32:35], v7 offset:58368
    v_mfma_f32_16x16x32_bf16 v[136:139], a[72:75], v[36:39], v[136:139]
    v_cvt_pk_bf16_f32 v98, v100, v101
    v_mfma_f32_16x16x32_bf16 v[140:143], a[76:79], v[36:39], v[140:143]
    ds_read_b128 v[36:39], v7 offset:62464
    v_mfma_f32_16x16x32_bf16 v[128:131], a[80:83], v[40:43], v[128:131]
    v_cvt_pk_bf16_f32 v99, v102, v103
    v_mfma_f32_16x16x32_bf16 v[132:135], a[84:87], v[40:43], v[132:135]
    v_permlane16_swap_b32 v96, v98
    ds_read_b128 v[40:43], v7 offset:59392
    v_mfma_f32_16x16x32_bf16 v[136:139], a[80:83], v[44:47], v[136:139]
    v_cmp_eq_u64_e64 s[4:5], s[80:81], v[192:193]
    v_cmp_eq_u64 vcc, s[80:81], v[194:195]
    v_mfma_f32_16x16x32_bf16 v[140:143], a[84:87], v[44:47], v[140:143]
    v_permlane16_swap_b32 v97, v99
    s_and_b64 s[4:5], s[4:5], vcc
    s_waitcnt lgkmcnt(3)
    v_mfma_f32_16x16x32_bf16 v[128:131], a[88:91], v[48:51], v[128:131]
    s_mov_b32 s52, s55
    buffer_store_dwordx4 v[96:99], v63, s[16:19], s52 offen sc1
    v_mfma_f32_16x16x32_bf16 v[132:135], a[92:95], v[48:51], v[132:135]
    v_cmp_eq_u64 vcc, s[80:81], v[196:197]
    s_and_b64 s[4:5], s[4:5], vcc
    v_mfma_f32_16x16x32_bf16 v[136:139], a[88:91], v[52:55], v[136:139]
    v_cmp_eq_u64 vcc, s[80:81], v[198:199]
    s_and_b64 s[4:5], s[4:5], vcc
    v_mfma_f32_16x16x32_bf16 v[140:143], a[92:95], v[52:55], v[140:143]
    v_cvt_pk_bf16_f32 v104, v104, v105
    ds_read_b128 v[44:47], v7 offset:63488
    v_mfma_f32_16x16x32_bf16 v[128:131], a[96:99], v[24:27], v[128:131]
    v_cvt_pk_bf16_f32 v105, v106, v107
    v_cmp_eq_u64 vcc, s[80:81], v[200:201]
    v_mfma_f32_16x16x32_bf16 v[132:135], a[100:103], v[24:27], v[132:135]
    v_cvt_pk_bf16_f32 v106, v108, v109
    ds_read_b128 v[48:51], v7 offset:60416
    v_mfma_f32_16x16x32_bf16 v[136:139], a[96:99], v[28:31], v[136:139]
    v_cvt_pk_bf16_f32 v107, v110, v111
    s_and_b64 s[4:5], s[4:5], vcc
    v_mfma_f32_16x16x32_bf16 v[140:143], a[100:103], v[28:31], v[140:143]
    v_permlane16_swap_b32 v104, v106
    ds_read_b128 v[52:55], v7 offset:64512
    s_waitcnt lgkmcnt(3)
    v_mfma_f32_16x16x32_bf16 v[128:131], a[104:107], v[32:35], v[128:131]
    v_cmp_eq_u64 vcc, s[80:81], v[202:203]
    s_and_b64 s[4:5], s[4:5], vcc
    v_mfma_f32_16x16x32_bf16 v[132:135], a[108:111], v[32:35], v[132:135]
    v_permlane16_swap_b32 v105, v107
    v_mfma_f32_16x16x32_bf16 v[136:139], a[104:107], v[36:39], v[136:139]
    s_xor_b32 s52, s55, 0x10000
    buffer_store_dwordx4 v[104:107], v63, s[16:19], s52 offen sc1
    v_mfma_f32_16x16x32_bf16 v[140:143], a[108:111], v[36:39], v[140:143]
    s_waitcnt vmcnt(10)
    s_barrier
    s_cmp_eq_u64 s[4:5], -1
    s_cbranch_scc0 L_af_retry
L_af_back:
    v_mfma_f32_16x16x32_bf16 v[128:131], a[112:115], v[40:43], v[128:131]
    ds_read_b128 v[24:27], v6 offset:49152
    ds_read_b128 v[28:31], v6 offset:53248
    v_mfma_f32_16x16x32_bf16 v[132:135], a[116:119], v[40:43], v[132:135]
    v_cvt_pk_bf16_f32 v112, v112, v113
    ds_read_b128 v[32:35], v6 offset:50176
    s_waitcnt lgkmcnt(3)
    v_mfma_f32_16x16x32_bf16 v[136:139], a[112:115], v[44:47], v[136:139]
    v_cvt_pk_bf16_f32 v113, v114, v115
    ds_read_b128 v[36:39], v6 offset:54272
    v_mfma_f32_16x16x32_bf16 v[140:143], a[116:119], v[44:47], v[140:143]
    v_cvt_pk_bf16_f32 v114, v116, v117
    ds_read_b128 v[40:43], v6 offset:51200
    v_mfma_f32_16x16x32_bf16 v[128:131], a[120:123], v[48:51], v[128:131]
    ds_read_b128 v[44:47], v6 offset:55296
    v_mfma_f32_16x16x32_bf16 v[132:135], a[124:127], v[48:51], v[132:135]
    v_cvt_pk_bf16_f32 v115, v118, v119
    ds_read_b128 v[48:51], v6 offset:52224
    v_mfma_f32_16x16x32_bf16 v[136:139], a[120:123], v[52:55], v[136:139]
    v_permlane16_swap_b32 v112, v114
    v_mfma_f32_16x16x32_bf16 v[140:143], a[124:127], v[52:55], v[140:143]
    ds_read_b128 v[52:55], v6 offset:56320
    s_waitcnt lgkmcnt(6)
    v_mfma_f32_16x16x32_bf16 v[128:131], a[128:131], v[24:27], v[128:131]
    v_permlane16_swap_b32 v113, v115
    v_mfma_f32_16x16x32_bf16 v[132:135], a[132:135], v[24:27], v[132:135]
    s_xor_b32 s52, s55, 0x20000
    buffer_store_dwordx4 v[112:115], v63, s[16:19], s52 offen sc1
    v_mfma_f32_16x16x32_bf16 v[136:139], a[128:131], v[28:31], v[136:139]
    ds_read_b128 v[24:27], v6 offset:57344
    v_mfma_f32_16x16x32_bf16 v[140:143], a[132:135], v[28:31], v[140:143]
    ds_read_b128 v[28:31], v6 offset:61440
    s_waitcnt lgkmcnt(4)
    v_mfma_f32_16x16x32_bf16 v[128:131], a[136:139], v[32:35], v[128:131]
    v_cvt_pk_bf16_f32 v120, v120, v121
    v_mfma_f32_16x16x32_bf16 v[132:135], a[140:143], v[32:35], v[132:135]
    v_cvt_pk_bf16_f32 v121, v122, v123
    ds_read_b128 v[32:35], v6 offset:58368
    v_mfma_f32_16x16x32_bf16 v[136:139], a[136:139], v[36:39], v[136:139]
    v_cvt_pk_bf16_f32 v122, v124, v125
    v_mfma_f32_16x16x32_bf16 v[140:143], a[140:143], v[36:39], v[140:143]
    ds_read_b128 v[36:39], v6 offset:62464
    v_mfma_f32_16x16x32_bf16 v[128:131], a[144:147], v[40:43], v[128:131]
    v_cvt_pk_bf16_f32 v123, v126, v127
    v_mfma_f32_16x16x32_bf16 v[132:135], a[148:151], v[40:43], v[132:135]
    v_permlane16_swap_b32 v120, v122
    ds_read_b128 v[40:43], v6 offset:59392
    v_mfma_f32_16x16x32_bf16 v[136:139], a[144:147], v[44:47], v[136:139]
    v_mfma_f32_16x16x32_bf16 v[140:143], a[148:151], v[44:47], v[140:143]
    v_permlane16_swap_b32 v121, v123
    ds_read_b128 v[44:47], v6 offset:63488
    s_waitcnt lgkmcnt(4)
    v_mfma_f32_16x16x32_bf16 v[128:131], a[152:155], v[48:51], v[128:131]
    s_xor_b32 s52, s55, 0x30000
    buffer_store_dwordx4 v[120:123], v63, s[16:19], s52 offen sc1
    v_mfma_f32_16x16x32_bf16 v[132:135], a[156:159], v[48:51], v[132:135]
    ds_read_b128 v[48:51], v6 offset:60416
    v_mfma_f32_16x16x32_bf16 v[136:139], a[152:155], v[52:55], v[136:139]
    v_mfma_f32_16x16x32_bf16 v[140:143], a[156:159], v[52:55], v[140:143]
    ds_read_b128 v[52:55], v6 offset:64512
    v_mfma_f32_16x16x32_bf16 v[128:131], a[160:163], v[24:27], v[128:131]
    v_mfma_f32_16x16x32_bf16 v[132:135], a[164:167], v[24:27], v[132:135]
    ds_read_b128 v[24:27], v7 offset:16384
    v_mfma_f32_16x16x32_bf16 v[136:139], a[160:163], v[28:31], v[136:139]
    buffer_load_dwordx4 v[144:147], v16, s[24:27], s15 offen offset:0
    v_mfma_f32_16x16x32_bf16 v[140:143], a[164:167], v[28:31], v[140:143]
    ds_read_b128 v[28:31], v7 offset:20480
    s_waitcnt lgkmcnt(4)
    v_mfma_f32_16x16x32_bf16 v[128:131], a[168:171], v[32:35], v[128:131]
    v_mfma_f32_16x16x32_bf16 v[132:135], a[172:175], v[32:35], v[132:135]
    buffer_load_dwordx4 v[148:151], v16, s[24:27], s15 offen offset:512
    v_mfma_f32_16x16x32_bf16 v[136:139], a[168:171], v[36:39], v[136:139]
    ds_read_b128 v[32:35], v7 offset:17408
    v_mfma_f32_16x16x32_bf16 v[140:143], a[172:175], v[36:39], v[140:143]
    ds_read_b128 v[36:39], v7 offset:21504
    v_mfma_f32_16x16x32_bf16 v[128:131], a[176:179], v[40:43], v[128:131]
    buffer_load_dwordx4 v[184:187], v22, s[28:31], 0 offen offset:0
    v_mfma_f32_16x16x32_bf16 v[132:135], a[180:183], v[40:43], v[132:135]
    ds_read_b128 v[40:43], v7 offset:18432
    v_mfma_f32_16x16x32_bf16 v[136:139], a[176:179], v[44:47], v[136:139]
    v_mfma_f32_16x16x32_bf16 v[140:143], a[180:183], v[44:47], v[140:143]
    buffer_load_dwordx4 v[188:191], v22, s[28:31], 0 offen offset:512
    s_waitcnt lgkmcnt(3)
    v_mfma_f32_16x16x32_bf16 v[128:131], a[184:187], v[48:51], v[128:131]
    s_add_u32 m0, s35, 0x4000
    s_add_u32 s3, s39, 0x8000
    s_and_b32 s3, s3, 0x1c000
    s_add_u32 s3, s3, s38
    s_bitset1_b32 s3, 13
    buffer_load_dwordx4 v2, s[16:19], s3 offen offset:0 sc1 lds
    v_mfma_f32_16x16x32_bf16 v[132:135], a[188:191], v[48:51], v[132:135]
    buffer_load_dwordx4 v2, s[16:19], s3 offen offset:1024 sc1 lds
    v_mfma_f32_16x16x32_bf16 v[136:139], a[184:187], v[52:55], v[136:139]
    s_movk_i32 s53, 0x5800
    buffer_load_dwordx4 v[152:155], v22, s[20:23], s53 offen offset:0 sc1
    v_mfma_f32_16x16x32_bf16 v[140:143], a[188:191], v[52:55], v[140:143]
    ds_read_b128 v[44:47], v7 offset:22528
    ds_read_b128 v[48:51], v7 offset:19456
    v_mfma_f32_16x16x32_bf16 v[128:131], a[192:195], v[24:27], v[128:131]
    buffer_load_dwordx4 v2, s[16:19], s3 offen offset:2048 sc1 lds
    v_mfma_f32_16x16x32_bf16 v[132:135], a[196:199], v[24:27], v[132:135]
    buffer_load_dwordx4 v2, s[16:19], s3 offen offset:3072 sc1 lds
    v_mfma_f32_16x16x32_bf16 v[136:139], a[192:195], v[28:31], v[136:139]
    buffer_load_dwordx4 v[156:159], v22, s[20:23], s53 offen offset:512 sc1
    v_mfma_f32_16x16x32_bf16 v[140:143], a[196:199], v[28:31], v[140:143]
    ds_read_b128 v[52:55], v7 offset:23552
    ds_read_b128 v[24:27], v7 offset:24576
    s_waitcnt lgkmcnt(4)
    v_mfma_f32_16x16x32_bf16 v[128:131], a[200:203], v[32:35], v[128:131]
    buffer_load_dwordx4 v[168:171], v22, s[20:23], s53 offen offset:1024 sc1
    v_mfma_f32_16x16x32_bf16 v[132:135], a[204:207], v[32:35], v[132:135]
    ds_read_b128 v[28:31], v7 offset:28672
    ds_read_b128 v[32:35], v7 offset:25600
    v_mfma_f32_16x16x32_bf16 v[136:139], a[200:203], v[36:39], v[136:139]
    v_mfma_f32_16x16x32_bf16 v[140:143], a[204:207], v[36:39], v[140:143]
    buffer_load_dwordx4 v[172:175], v22, s[20:23], s53 offen offset:1536 sc1
    v_mfma_f32_16x16x32_bf16 v[128:131], a[208:211], v[40:43], v[128:131]
    ds_read_b128 v[36:39], v7 offset:29696
    v_mfma_f32_16x16x32_bf16 v[132:135], a[212:215], v[40:43], v[132:135]
    ds_read_b128 v[40:43], v7 offset:26624
    s_waitcnt lgkmcnt(6)
    v_mfma_f32_16x16x32_bf16 v[136:139], a[208:211], v[44:47], v[136:139]
    buffer_load_dwordx4 v[160:163], v22, s[20:23], s53 offen offset:2048 sc1
    v_mfma_f32_16x16x32_bf16 v[140:143], a[212:215], v[44:47], v[140:143]
    ds_read_b128 v[44:47], v7 offset:30720
    v_mfma_f32_16x16x32_bf16 v[128:131], a[216:219], v[48:51], v[128:131]
    v_mfma_f32_16x16x32_bf16 v[132:135], a[220:223], v[48:51], v[132:135]
    buffer_load_dwordx4 v[164:167], v22, s[20:23], s53 offen offset:2560 sc1
    s_waitcnt lgkmcnt(3)
    v_mfma_f32_16x16x32_bf16 v[136:139], a[216:219], v[52:55], v[136:139]
    ds_read_b128 v[48:51], v7 offset:27648
    v_mfma_f32_16x16x32_bf16 v[140:143], a[220:223], v[52:55], v[140:143]
    ds_read_b128 v[52:55], v7 offset:31744
    v_mfma_f32_16x16x32_bf16 v[128:131], a[32:35], v[24:27], v[128:131]
    buffer_load_dwordx4 v[176:179], v22, s[20:23], s53 offen offset:3072 sc1
    v_mfma_f32_16x16x32_bf16 v[132:135], a[36:39], v[24:27], v[132:135]
    v_mfma_f32_16x16x32_bf16 v[136:139], a[32:35], v[28:31], v[136:139]
    v_mfma_f32_16x16x32_bf16 v[140:143], a[36:39], v[28:31], v[140:143]
    buffer_load_dwordx4 v[180:183], v22, s[20:23], s53 offen offset:3584 sc1
    v_mfma_f32_16x16x32_bf16 v[128:131], a[40:43], v[32:35], v[128:131]
    v_mfma_f32_16x16x32_bf16 v[132:135], a[44:47], v[32:35], v[132:135]
    s_waitcnt lgkmcnt(2)
    v_mfma_f32_16x16x32_bf16 v[136:139], a[40:43], v[36:39], v[136:139]
    v_mfma_f32_16x16x32_bf16 v[140:143], a[44:47], v[36:39], v[140:143]
    s_waitcnt vmcnt(20)
    s_barrier
    v_mfma_f32_16x16x32_bf16 v[128:131], a[48:51], v[40:43], v[128:131]
    ds_read_b128 v[24:27], v8 offset:0
    ds_read_b128 v[28:31], v8 offset:4096
    v_mfma_f32_16x16x32_bf16 v[132:135], a[52:55], v[40:43], v[132:135]
    ds_read_b128 v[32:35], v8 offset:1024
    ds_read_b128 v[36:39], v8 offset:5120
    v_mfma_f32_16x16x32_bf16 v[136:139], a[48:51], v[44:47], v[136:139]
    ds_read_b128 v[40:43], v8 offset:2048
    v_mfma_f32_16x16x32_bf16 v[140:143], a[52:55], v[44:47], v[140:143]
    ds_read_b128 v[44:47], v8 offset:6144
    s_waitcnt lgkmcnt(6)
    v_mfma_f32_16x16x32_bf16 v[128:131], a[56:59], v[48:51], v[128:131]
    s_xor_b32 m0, s77, 0x8000
    s_add_u32 s3, s39, 0x10000
    s_and_b32 s3, s3, 0x1c000
    s_add_u32 s3, s3, s38
    s_bitset1_b32 s3, 13
    buffer_load_dwordx4 v2, s[16:19], s3 offen offset:0 sc1 lds
    v_mfma_f32_16x16x32_bf16 v[132:135], a[60:63], v[48:51], v[132:135]
    buffer_load_dwordx4 v2, s[16:19], s3 offen offset:1024 sc1 lds
    v_mfma_f32_16x16x32_bf16 v[136:139], a[56:59], v[52:55], v[136:139]
    ds_read_b128 v[48:51], v8 offset:3072
    v_mfma_f32_16x16x32_bf16 v[140:143], a[60:63], v[52:55], v[140:143]
    ds_read_b128 v[52:55], v8 offset:7168
    s_waitcnt lgkmcnt(6)
    v_mfma_f32_16x16x32_bf16 v[128:131], a[0:3], v[24:27], v[128:131]
    buffer_load_dwordx4 v2, s[16:19], s3 offen offset:2048 sc1 lds
    v_mfma_f32_16x16x32_bf16 v[132:135], a[4:7], v[24:27], v[132:135]
    ds_read_b128 v[24:27], v8 offset:8192
    v_mfma_f32_16x16x32_bf16 v[136:139], a[0:3], v[28:31], v[136:139]
    v_mfma_f32_16x16x32_bf16 v[140:143], a[4:7], v[28:31], v[140:143]
    buffer_load_dwordx4 v2, s[16:19], s3 offen offset:3072 sc1 lds
    s_waitcnt lgkmcnt(3)
    v_mfma_f32_16x16x32_bf16 v[128:131], a[8:11], v[32:35], v[128:131]
    ds_read_b128 v[28:31], v8 offset:12288
    v_mfma_f32_16x16x32_bf16 v[132:135], a[12:15], v[32:35], v[132:135]
    ds_read_b128 v[32:35], v8 offset:9216
    v_mfma_f32_16x16x32_bf16 v[136:139], a[8:11], v[36:39], v[136:139]
    v_mfma_f32_16x16x32_bf16 v[140:143], a[12:15], v[36:39], v[140:143]
    ds_read_b128 v[36:39], v8 offset:13312
    v_mfma_f32_16x16x32_bf16 v[128:131], a[16:19], v[40:43], v[128:131]
    v_mfma_f32_16x16x32_bf16 v[132:135], a[20:23], v[40:43], v[132:135]
    ds_read_b128 v[40:43], v8 offset:10240
    v_mfma_f32_16x16x32_bf16 v[136:139], a[16:19], v[44:47], v[136:139]
    s_xor_b32 m0, s77, 0x10000
    s_add_u32 s3, s39, 0x18000
    s_and_b32 s3, s3, 0x1c000
    s_add_u32 s3, s3, s38
    s_bitset1_b32 s3, 13
    buffer_load_dwordx4 v2, s[16:19], s3 offen offset:0 sc1 lds
    v_mfma_f32_16x16x32_bf16 v[140:143], a[20:23], v[44:47], v[140:143]
    buffer_load_dwordx4 v2, s[16:19], s3 offen offset:1024 sc1 lds
    s_waitcnt lgkmcnt(3)
    v_mfma_f32_16x16x32_bf16 v[128:131], a[24:27], v[48:51], v[128:131]
    ds_read_b128 v[44:47], v8 offset:14336
    v_mfma_f32_16x16x32_bf16 v[132:135], a[28:31], v[48:51], v[132:135]
    ds_read_b128 v[48:51], v8 offset:11264
    v_mfma_f32_16x16x32_bf16 v[136:139], a[24:27], v[52:55], v[136:139]
    buffer_load_dwordx4 v2, s[16:19], s3 offen offset:2048 sc1 lds
    v_mfma_f32_16x16x32_bf16 v[140:143], a[28:31], v[52:55], v[140:143]
    ds_read_b128 v[52:55], v8 offset:15360
    v_mfma_f32_16x16x32_bf16 v[128:131], v[64:67], v[24:27], v[128:131]
    v_mfma_f32_16x16x32_bf16 v[132:135], v[68:71], v[24:27], v[132:135]
    ds_read_b128 v[24:27], v6 offset:0
    v_mfma_f32_16x16x32_bf16 v[136:139], v[64:67], v[28:31], v[136:139]
    buffer_load_dwordx4 v2, s[16:19], s3 offen offset:3072 sc1 lds
    v_mfma_f32_16x16x32_bf16 v[140:143], v[68:71], v[28:31], v[140:143]
    ds_read_b128 v[28:31], v6 offset:4096
    s_waitcnt lgkmcnt(5)
    v_mfma_f32_16x16x32_bf16 v[128:131], v[72:75], v[32:35], v[128:131]
    v_mfma_f32_16x16x32_bf16 v[132:135], v[76:79], v[32:35], v[132:135]
    ds_read_b128 v[32:35], v6 offset:1024
    v_mfma_f32_16x16x32_bf16 v[136:139], v[72:75], v[36:39], v[136:139]
    v_mfma_f32_16x16x32_bf16 v[140:143], v[76:79], v[36:39], v[140:143]
    ds_read_b128 v[36:39], v6 offset:5120
    v_mfma_f32_16x16x32_bf16 v[128:131], v[80:83], v[40:43], v[128:131]
    v_mfma_f32_16x16x32_bf16 v[132:135], v[84:87], v[40:43], v[132:135]
    ds_read_b128 v[40:43], v6 offset:2048
    s_waitcnt lgkmcnt(4)
    v_mfma_f32_16x16x32_bf16 v[136:139], v[80:83], v[44:47], v[136:139]
    v_mfma_f32_16x16x32_bf16 v[140:143], v[84:87], v[44:47], v[140:143]
    ds_read_b128 v[44:47], v6 offset:6144
    v_mfma_f32_16x16x32_bf16 v[128:131], v[88:91], v[48:51], v[128:131]
    v_mfma_f32_16x16x32_bf16 v[132:135], v[92:95], v[48:51], v[132:135]
    ds_read_b128 v[48:51], v6 offset:3072
    v_mfma_f32_16x16x32_bf16 v[136:139], v[88:91], v[52:55], v[136:139]
    v_mfma_f32_16x16x32_bf16 v[140:143], v[92:95], v[52:55], v[140:143]
    ds_read_b128 v[52:55], v6 offset:7168
    v_mfma_f32_16x16x32_bf16 v[96:99], a[64:67], v[24:27], 0
    v_mfma_f32_16x16x32_bf16 v[100:103], a[68:71], v[24:27], 0
    ds_read_b128 v[24:27], v6 offset:8192
    s_waitcnt lgkmcnt(5)
    v_mfma_f32_16x16x32_bf16 v[104:107], a[64:67], v[28:31], 0
    v_cvt_pk_bf16_f32 v128, v128, v129
    v_mfma_f32_16x16x32_bf16 v[108:111], a[68:71], v[28:31], 0
    ds_read_b128 v[28:31], v6 offset:12288
    v_mfma_f32_16x16x32_bf16 v[96:99], a[72:75], v[32:35], v[96:99]
    v_cvt_pk_bf16_f32 v129, v130, v131
    v_mfma_f32_16x16x32_bf16 v[100:103], a[76:79], v[32:35], v[100:103]
    ds_read_b128 v[32:35], v6 offset:9216
    v_mfma_f32_16x16x32_bf16 v[104:107], a[72:75], v[36:39], v[104:107]
    v_mfma_f32_16x16x32_bf16 v[108:111], a[76:79], v[36:39], v[108:111]
    v_cvt_pk_bf16_f32 v130, v132, v133
    ds_read_b128 v[36:39], v6 offset:13312
    s_waitcnt lgkmcnt(4)
    v_mfma_f32_16x16x32_bf16 v[96:99], a[80:83], v[40:43], v[96:99]
    v_mfma_f32_16x16x32_bf16 v[100:103], a[84:87], v[40:43], v[100:103]
    ds_read_b128 v[40:43], v6 offset:10240
    v_mfma_f32_16x16x32_bf16 v[104:107], a[80:83], v[44:47], v[104:107]
    v_cvt_pk_bf16_f32 v131, v134, v135
    v_mfma_f32_16x16x32_bf16 v[108:111], a[84:87], v[44:47], v[108:111]
    ds_read_b128 v[44:47], v6 offset:14336
    v_mfma_f32_16x16x32_bf16 v[96:99], a[88:91], v[48:51], v[96:99]
    v_mfma_f32_16x16x32_bf16 v[100:103], a[92:95], v[48:51], v[100:103]
    v_permlane16_swap_b32 v128, v130
    ds_read_b128 v[48:51], v6 offset:11264
    v_mfma_f32_16x16x32_bf16 v[104:107], a[88:91], v[52:55], v[104:107]
    v_mfma_f32_16x16x32_bf16 v[108:111], a[92:95], v[52:55], v[108:111]
    ds_read_b128 v[52:55], v6 offset:15360
    s_waitcnt lgkmcnt(4)
    v_mfma_f32_16x16x32_bf16 v[96:99], a[96:99], v[24:27], v[96:99]
    v_permlane16_swap_b32 v129, v131
    v_mfma_f32_16x16x32_bf16 v[100:103], a[100:103], v[24:27], v[100:103]
    v_mfma_f32_16x16x32_bf16 v[104:107], a[96:99], v[28:31], v[104:107]
    v_mfma_f32_16x16x32_bf16 v[108:111], a[100:103], v[28:31], v[108:111]
    s_xor_b32 s52, s55, 0x780000
    buffer_store_dwordx4 v[128:131], v63, s[16:19], s52 offen sc1
    v_mfma_f32_16x16x32_bf16 v[96:99], a[104:107], v[32:35], v[96:99]
    v_mfma_f32_16x16x32_bf16 v[100:103], a[108:111], v[32:35], v[100:103]
    v_mfma_f32_16x16x32_bf16 v[104:107], a[104:107], v[36:39], v[104:107]
    v_mfma_f32_16x16x32_bf16 v[108:111], a[108:111], v[36:39], v[108:111]
    s_waitcnt vmcnt(16)
    s_barrier
    s_waitcnt lgkmcnt(0)
    v_mfma_f32_16x16x32_bf16 v[96:99], a[112:115], v[40:43], v[96:99]
    ds_read_b128 v[24:27], v8 offset:16384
    ds_read_b128 v[28:31], v8 offset:20480
    v_mfma_f32_16x16x32_bf16 v[100:103], a[116:119], v[40:43], v[100:103]
    v_cvt_pk_bf16_f32 v136, v136, v137
    ds_read_b128 v[32:35], v8 offset:17408
    v_mfma_f32_16x16x32_bf16 v[104:107], a[112:115], v[44:47], v[104:107]
    ds_read_b128 v[36:39], v8 offset:21504
    ds_read_b128 v[40:43], v8 offset:18432
    v_mfma_f32_16x16x32_bf16 v[108:111], a[116:119], v[44:47], v[108:111]
    ds_read_b128 v[44:47], v8 offset:22528
    v_mfma_f32_16x16x32_bf16 v[96:99], a[120:123], v[48:51], v[96:99]
    v_cvt_pk_bf16_f32 v137, v138, v139
    v_mfma_f32_16x16x32_bf16 v[100:103], a[124:127], v[48:51], v[100:103]
    ds_read_b128 v[48:51], v8 offset:19456
    v_mfma_f32_16x16x32_bf16 v[104:107], a[120:123], v[52:55], v[104:107]
    v_mfma_f32_16x16x32_bf16 v[108:111], a[124:127], v[52:55], v[108:111]
    v_cvt_pk_bf16_f32 v138, v140, v141
    ds_read_b128 v[52:55], v8 offset:23552
    s_waitcnt lgkmcnt(6)
    v_mfma_f32_16x16x32_bf16 v[96:99], a[128:131], v[24:27], v[96:99]
    v_mfma_f32_16x16x32_bf16 v[100:103], a[132:135], v[24:27], v[100:103]
    ds_read_b128 v[24:27], v8 offset:24576
    v_mfma_f32_16x16x32_bf16 v[104:107], a[128:131], v[28:31], v[104:107]
    v_cvt_pk_bf16_f32 v139, v142, v143
    v_mfma_f32_16x16x32_bf16 v[108:111], a[132:135], v[28:31], v[108:111]
    ds_read_b128 v[28:31], v8 offset:28672
    s_waitcnt lgkmcnt(4)
    v_mfma_f32_16x16x32_bf16 v[96:99], a[136:139], v[32:35], v[96:99]
    v_mfma_f32_16x16x32_bf16 v[100:103], a[140:143], v[32:35], v[100:103]
    v_permlane16_swap_b32 v136, v138
    ds_read_b128 v[32:35], v8 offset:25600
    v_mfma_f32_16x16x32_bf16 v[104:107], a[136:139], v[36:39], v[104:107]
    v_mfma_f32_16x16x32_bf16 v[108:111], a[140:143], v[36:39], v[108:111]
    ds_read_b128 v[36:39], v8 offset:29696
    v_mfma_f32_16x16x32_bf16 v[96:99], a[144:147], v[40:43], v[96:99]
    v_permlane16_swap_b32 v137, v139
    v_mfma_f32_16x16x32_bf16 v[100:103], a[148:151], v[40:43], v[100:103]
    ds_read_b128 v[40:43], v8 offset:26624
    v_mfma_f32_16x16x32_bf16 v[104:107], a[144:147], v[44:47], v[104:107]
    v_mfma_f32_16x16x32_bf16 v[108:111], a[148:151], v[44:47], v[108:111]
    s_xor_b32 s52, s55, 0x790000
    buffer_store_dwordx4 v[136:139], v63, s[16:19], s52 offen sc1
    s_waitcnt lgkmcnt(3)
    v_mfma_f32_16x16x32_bf16 v[96:99], a[152:155], v[48:51], v[96:99]
    ds_read_b128 v[44:47], v8 offset:30720
    v_mfma_f32_16x16x32_bf16 v[100:103], a[156:159], v[48:51], v[100:103]
    ds_read_b128 v[48:51], v8 offset:27648
    v_mfma_f32_16x16x32_bf16 v[104:107], a[152:155], v[52:55], v[104:107]
    v_mfma_f32_16x16x32_bf16 v[108:111], a[156:159], v[52:55], v[108:111]
    ds_read_b128 v[52:55], v8 offset:31744
    v_mfma_f32_16x16x32_bf16 v[96:99], a[160:163], v[24:27], v[96:99]
    v_mfma_f32_16x16x32_bf16 v[100:103], a[164:167], v[24:27], v[100:103]
    v_mfma_f32_16x16x32_bf16 v[104:107], a[160:163], v[28:31], v[104:107]
    v_mfma_f32_16x16x32_bf16 v[108:111], a[164:167], v[28:31], v[108:111]
    s_waitcnt lgkmcnt(3)
    v_mfma_f32_16x16x32_bf16 v[96:99], a[168:171], v[32:35], v[96:99]
    v_mfma_f32_16x16x32_bf16 v[100:103], a[172:175], v[32:35], v[100:103]
    v_mfma_f32_16x16x32_bf16 v[104:107], a[168:171], v[36:39], v[104:107]
    v_mfma_f32_16x16x32_bf16 v[108:111], a[172:175], v[36:39], v[108:111]
    s_waitcnt vmcnt(2)
    s_barrier
    v_mfma_f32_16x16x32_bf16 v[96:99], a[176:179], v[40:43], v[96:99]
    ds_read_b128 v[24:27], v6 offset:32768
    ds_read_b128 v[28:31], v6 offset:36864
    v_mfma_f32_16x16x32_bf16 v[100:103], a[180:183], v[40:43], v[100:103]
    ds_read_b128 v[32:35], v6 offset:33792
    ds_read_b128 v[36:39], v6 offset:37888
    s_waitcnt lgkmcnt(4)
    v_mfma_f32_16x16x32_bf16 v[104:107], a[176:179], v[44:47], v[104:107]
    buffer_load_dwordx4 v[224:227], v15, s[16:19], s12 offen offset:0 sc1
    v_mfma_f32_16x16x32_bf16 v[108:111], a[180:183], v[44:47], v[108:111]
    ds_read_b128 v[40:43], v6 offset:34816
    ds_read_b128 v[44:47], v6 offset:38912
    v_mfma_f32_16x16x32_bf16 v[96:99], a[184:187], v[48:51], v[96:99]
    v_mfma_f32_16x16x32_bf16 v[100:103], a[188:191], v[48:51], v[100:103]
    buffer_load_dwordx4 v[228:231], v15, s[16:19], s12 offen offset:1024 sc1
    v_mfma_f32_16x16x32_bf16 v[104:107], a[184:187], v[52:55], v[104:107]
    ds_read_b128 v[48:51], v6 offset:35840
    v_mfma_f32_16x16x32_bf16 v[108:111], a[188:191], v[52:55], v[108:111]
    ds_read_b128 v[52:55], v6 offset:39936
    s_waitcnt lgkmcnt(7)
    v_mfma_f32_16x16x32_bf16 v[96:99], a[192:195], v[24:27], v[96:99]
    v_mfma_f32_16x16x32_bf16 v[100:103], a[196:199], v[24:27], v[100:103]
    ds_read_b128 v[24:27], v6 offset:40960
    s_waitcnt lgkmcnt(5)
    v_mfma_f32_16x16x32_bf16 v[104:107], a[192:195], v[28:31], v[104:107]
    buffer_load_dwordx4 v[232:235], v15, s[16:19], s12 offen offset:2048 sc1
    v_mfma_f32_16x16x32_bf16 v[108:111], a[196:199], v[28:31], v[108:111]
    ds_read_b128 v[28:31], v6 offset:45056
    v_mfma_f32_16x16x32_bf16 v[96:99], a[200:203], v[32:35], v[96:99]
    v_mfma_f32_16x16x32_bf16 v[100:103], a[204:207], v[32:35], v[100:103]
    ds_read_b128 v[32:35], v6 offset:41984
    v_mfma_f32_16x16x32_bf16 v[104:107], a[200:203], v[36:39], v[104:107]
    v_mfma_f32_16x16x32_bf16 v[108:111], a[204:207], v[36:39], v[108:111]
    buffer_load_dwordx4 v[236:239], v15, s[16:19], s12 offen offset:3072 sc1
    s_waitcnt lgkmcnt(3)
    v_mfma_f32_16x16x32_bf16 v[96:99], a[208:211], v[40:43], v[96:99]
    ds_read_b128 v[36:39], v6 offset:46080
    v_mfma_f32_16x16x32_bf16 v[100:103], a[212:215], v[40:43], v[100:103]
    ds_read_b128 v[40:43], v6 offset:43008
    v_mfma_f32_16x16x32_bf16 v[104:107], a[208:211], v[44:47], v[104:107]
    v_mfma_f32_16x16x32_bf16 v[108:111], a[212:215], v[44:47], v[108:111]
    ds_read_b128 v[44:47], v6 offset:47104
    v_mfma_f32_16x16x32_bf16 v[96:99], a[216:219], v[48:51], v[96:99]
    buffer_load_dwordx4 v[240:243], v15, s[16:19], s13 offen offset:0 sc1
    v_mfma_f32_16x16x32_bf16 v[100:103], a[220:223], v[48:51], v[100:103]
    ds_read_b128 v[48:51], v6 offset:44032
    v_mfma_f32_16x16x32_bf16 v[104:107], a[216:219], v[52:55], v[104:107]
    v_mfma_f32_16x16x32_bf16 v[108:111], a[220:223], v[52:55], v[108:111]
    ds_read_b128 v[52:55], v6 offset:48128
    s_waitcnt lgkmcnt(5)
    v_mfma_f32_16x16x32_bf16 v[96:99], a[32:35], v[24:27], v[96:99]
    v_mfma_f32_16x16x32_bf16 v[100:103], a[36:39], v[24:27], v[100:103]
    buffer_load_dwordx4 v[244:247], v15, s[16:19], s13 offen offset:1024 sc1
    v_mfma_f32_16x16x32_bf16 v[104:107], a[32:35], v[28:31], v[104:107]
    ds_read_b128 v[24:27], v7 offset:0
    v_mfma_f32_16x16x32_bf16 v[108:111], a[36:39], v[28:31], v[108:111]
    ds_read_b128 v[28:31], v7 offset:4096
    v_mfma_f32_16x16x32_bf16 v[96:99], a[40:43], v[32:35], v[96:99]
    v_mfma_f32_16x16x32_bf16 v[100:103], a[44:47], v[32:35], v[100:103]
    ds_read_b128 v[32:35], v7 offset:1024
    s_waitcnt lgkmcnt(4)
    v_mfma_f32_16x16x32_bf16 v[104:107], a[40:43], v[36:39], v[104:107]
    buffer_load_dwordx4 v[248:251], v15, s[16:19], s13 offen offset:2048 sc1
    v_mfma_f32_16x16x32_bf16 v[108:111], a[44:47], v[36:39], v[108:111]
    ds_read_b128 v[36:39], v7 offset:5120
    v_mfma_f32_16x16x32_bf16 v[96:99], a[48:51], v[40:43], v[96:99]
    v_mfma_f32_16x16x32_bf16 v[100:103], a[52:55], v[40:43], v[100:103]
    ds_read_b128 v[40:43], v7 offset:2048
    v_mfma_f32_16x16x32_bf16 v[104:107], a[48:51], v[44:47], v[104:107]
    v_mfma_f32_16x16x32_bf16 v[108:111], a[52:55], v[44:47], v[108:111]
    buffer_load_dwordx4 v[252:255], v15, s[16:19], s13 offen offset:3072 sc1
    v_mfma_f32_16x16x32_bf16 v[96:99], a[56:59], v[48:51], v[96:99]
    ds_read_b128 v[44:47], v7 offset:6144
    v_mfma_f32_16x16x32_bf16 v[100:103], a[60:63], v[48:51], v[100:103]
    ds_read_b128 v[48:51], v7 offset:3072
    s_waitcnt lgkmcnt(4)
    v_mfma_f32_16x16x32_bf16 v[104:107], a[56:59], v[52:55], v[104:107]
    v_mfma_f32_16x16x32_bf16 v[108:111], a[60:63], v[52:55], v[108:111]
    ds_read_b128 v[52:55], v7 offset:7168
    v_mfma_f32_16x16x32_bf16 v[96:99], a[0:3], v[24:27], v[96:99]
    v_mfma_f32_16x16x32_bf16 v[100:103], a[4:7], v[24:27], v[100:103]
    ds_read_b128 v[24:27], v7 offset:8192
    v_mfma_f32_16x16x32_bf16 v[104:107], a[0:3], v[28:31], v[104:107]
    v_mfma_f32_16x16x32_bf16 v[108:111], a[4:7], v[28:31], v[108:111]
    ds_read_b128 v[28:31], v7 offset:12288
    v_mfma_f32_16x16x32_bf16 v[96:99], a[8:11], v[32:35], v[96:99]
    v_mfma_f32_16x16x32_bf16 v[100:103], a[12:15], v[32:35], v[100:103]
    ds_read_b128 v[32:35], v7 offset:9216
    s_waitcnt lgkmcnt(5)
    v_mfma_f32_16x16x32_bf16 v[104:107], a[8:11], v[36:39], v[104:107]
    v_mfma_f32_16x16x32_bf16 v[108:111], a[12:15], v[36:39], v[108:111]
    ds_read_b128 v[36:39], v7 offset:13312
    v_mfma_f32_16x16x32_bf16 v[96:99], a[16:19], v[40:43], v[96:99]
    v_mfma_f32_16x16x32_bf16 v[100:103], a[20:23], v[40:43], v[100:103]
    ds_read_b128 v[40:43], v7 offset:10240
    v_mfma_f32_16x16x32_bf16 v[104:107], a[16:19], v[44:47], v[104:107]
    v_mfma_f32_16x16x32_bf16 v[108:111], a[20:23], v[44:47], v[108:111]
    ds_read_b128 v[44:47], v7 offset:14336
    s_waitcnt lgkmcnt(5)
    v_mfma_f32_16x16x32_bf16 v[96:99], a[24:27], v[48:51], v[96:99]
    v_mfma_f32_16x16x32_bf16 v[100:103], a[28:31], v[48:51], v[100:103]
    ds_read_b128 v[48:51], v7 offset:11264
    v_mfma_f32_16x16x32_bf16 v[104:107], a[24:27], v[52:55], v[104:107]
    v_mfma_f32_16x16x32_bf16 v[108:111], a[28:31], v[52:55], v[108:111]
    ds_read_b128 v[52:55], v7 offset:15360
    v_mfma_f32_16x16x32_bf16 v[96:99], v[64:67], v[24:27], v[96:99]
    v_mfma_f32_16x16x32_bf16 v[100:103], v[68:71], v[24:27], v[100:103]
    s_waitcnt lgkmcnt(4)
    v_mfma_f32_16x16x32_bf16 v[104:107], v[64:67], v[28:31], v[104:107]
    v_mfma_f32_16x16x32_bf16 v[108:111], v[68:71], v[28:31], v[108:111]
    v_mfma_f32_16x16x32_bf16 v[96:99], v[72:75], v[32:35], v[96:99]
    v_mfma_f32_16x16x32_bf16 v[100:103], v[76:79], v[32:35], v[100:103]
    v_mfma_f32_16x16x32_bf16 v[104:107], v[72:75], v[36:39], v[104:107]
    v_mfma_f32_16x16x32_bf16 v[108:111], v[76:79], v[36:39], v[108:111]
    s_waitcnt lgkmcnt(1)
    v_mfma_f32_16x16x32_bf16 v[96:99], v[80:83], v[40:43], v[96:99]
    v_mfma_f32_16x16x32_bf16 v[100:103], v[84:87], v[40:43], v[100:103]
    v_mfma_f32_16x16x32_bf16 v[104:107], v[80:83], v[44:47], v[104:107]
    v_mfma_f32_16x16x32_bf16 v[108:111], v[84:87], v[44:47], v[108:111]
    v_mfma_f32_16x16x32_bf16 v[96:99], v[88:91], v[48:51], v[96:99]
    v_mfma_f32_16x16x32_bf16 v[100:103], v[92:95], v[48:51], v[100:103]
    s_waitcnt lgkmcnt(0)
    v_mfma_f32_16x16x32_bf16 v[104:107], v[88:91], v[52:55], v[104:107]
    v_mfma_f32_16x16x32_bf16 v[108:111], v[92:95], v[52:55], v[108:111]
    s_nop 3
    v_cvt_pk_bf16_f32 v96, v96, v97
    s_nop 2
    v_cvt_pk_bf16_f32 v97, v98, v99
    s_nop 2
    v_cvt_pk_bf16_f32 v98, v100, v101
    s_nop 1
    v_cvt_pk_bf16_f32 v99, v102, v103
    s_nop 0
    v_permlane16_swap_b32 v96, v98
    s_nop 0
    v_permlane16_swap_b32 v97, v99
    s_xor_b32 s52, s55, 0x7a0000
    buffer_store_dwordx4 v[96:99], v63, s[16:19], s52 offen sc1
    v_cvt_pk_bf16_f32 v104, v104, v105
    v_cvt_pk_bf16_f32 v105, v106, v107
    v_cvt_pk_bf16_f32 v106, v108, v109
    v_cvt_pk_bf16_f32 v107, v110, v111
    s_nop 0
    v_permlane16_swap_b32 v104, v106
    s_nop 0
    v_permlane16_swap_b32 v105, v107
    s_xor_b32 s52, s55, 0x7b0000
    buffer_store_dwordx4 v[104:107], v63, s[16:19], s52 offen sc1
    v_lshlrev_b32 v112, 16, v184
    v_and_b32 v113, 0xffff0000, v184
    v_lshlrev_b32 v114, 16, v185
    v_and_b32 v115, 0xffff0000, v185
    v_lshlrev_b32 v116, 16, v186
    v_and_b32 v117, 0xffff0000, v186
    v_lshlrev_b32 v118, 16, v187
    v_and_b32 v119, 0xffff0000, v187
    v_lshlrev_b32 v120, 16, v188
    v_and_b32 v121, 0xffff0000, v188
    v_lshlrev_b32 v122, 16, v189
    v_and_b32 v123, 0xffff0000, v189
    v_lshlrev_b32 v124, 16, v190
    v_and_b32 v125, 0xffff0000, v190
    v_lshlrev_b32 v126, 16, v191
    v_and_b32 v127, 0xffff0000, v191
    v_lshlrev_b32 v80, 16, v168
    v_and_b32 v81, 0xffff0000, v168
    v_lshlrev_b32 v82, 16, v169
    v_and_b32 v83, 0xffff0000, v169
    v_lshlrev_b32 v84, 16, v170
    v_and_b32 v85, 0xffff0000, v170
    v_lshlrev_b32 v86, 16, v171
    v_and_b32 v87, 0xffff0000, v171
    v_lshlrev_b32 v88, 16, v172
    v_and_b32 v89, 0xffff0000, v172
    v_lshlrev_b32 v90, 16, v173
    v_and_b32 v91, 0xffff0000, v173
    v_lshlrev_b32 v92, 16, v174
    v_and_b32 v93, 0xffff0000, v174
    v_lshlrev_b32 v94, 16, v175
    v_and_b32 v95, 0xffff0000, v175
    v_lshlrev_b32 v64, 16, v160
    v_and_b32 v65, 0xffff0000, v160
    v_lshlrev_b32 v66, 16, v161
    v_and_b32 v67, 0xffff0000, v161
    v_lshlrev_b32 v68, 16, v162
    v_and_b32 v69, 0xffff0000, v162
    v_lshlrev_b32 v70, 16, v163
    v_and_b32 v71, 0xffff0000, v163
    v_lshlrev_b32 v72, 16, v164
    v_and_b32 v73, 0xffff0000, v164
    v_lshlrev_b32 v74, 16, v165
    v_and_b32 v75, 0xffff0000, v165
    v_lshlrev_b32 v76, 16, v166
    v_and_b32 v77, 0xffff0000, v166
    v_lshlrev_b32 v78, 16, v167
    v_and_b32 v79, 0xffff0000, v167
    v_pk_add_f32 v[64:65], v[64:65], 1.0 op_sel_hi:[1,0]
    v_pk_add_f32 v[66:67], v[66:67], 1.0 op_sel_hi:[1,0]
    v_pk_add_f32 v[68:69], v[68:69], 1.0 op_sel_hi:[1,0]
    v_pk_add_f32 v[70:71], v[70:71], 1.0 op_sel_hi:[1,0]
    v_pk_add_f32 v[72:73], v[72:73], 1.0 op_sel_hi:[1,0]
    v_pk_add_f32 v[74:75], v[74:75], 1.0 op_sel_hi:[1,0]
    v_pk_add_f32 v[76:77], v[76:77], 1.0 op_sel_hi:[1,0]
    v_pk_add_f32 v[78:79], v[78:79], 1.0 op_sel_hi:[1,0]
    v_cvt_pk_bf16_f32 v160, v64, v65
    v_cvt_pk_bf16_f32 v161, v66, v67
    v_cvt_pk_bf16_f32 v162, v68, v69
    v_cvt_pk_bf16_f32 v163, v70, v71
    v_cvt_pk_bf16_f32 v164, v72, v73
    v_cvt_pk_bf16_f32 v165, v74, v75
    v_cvt_pk_bf16_f32 v166, v76, v77
    v_cvt_pk_bf16_f32 v167, v78, v79
    v_lshlrev_b32 v64, 16, v160
    v_and_b32 v65, 0xffff0000, v160
    v_lshlrev_b32 v66, 16, v161
    v_and_b32 v67, 0xffff0000, v161
    v_lshlrev_b32 v68, 16, v162
    v_and_b32 v69, 0xffff0000, v162
    v_lshlrev_b32 v70, 16, v163
    v_and_b32 v71, 0xffff0000, v163
    v_lshlrev_b32 v72, 16, v164
    v_and_b32 v73, 0xffff0000, v164
    v_lshlrev_b32 v74, 16, v165
    v_and_b32 v75, 0xffff0000, v165
    v_lshlrev_b32 v76, 16, v166
    v_and_b32 v77, 0xffff0000, v166
    v_lshlrev_b32 v78, 16, v167
    v_and_b32 v79, 0xffff0000, v167
    v_pk_mul_f32 v[58:59], v[80:81], v[112:113]
    v_pk_fma_f32 v[58:59], v[82:83], v[114:115], v[58:59]
    v_pk_fma_f32 v[58:59], v[84:85], v[116:117], v[58:59]
    v_pk_fma_f32 v[58:59], v[86:87], v[118:119], v[58:59]
    v_pk_fma_f32 v[58:59], v[88:89], v[120:121], v[58:59]
    v_pk_fma_f32 v[58:59], v[90:91], v[122:123], v[58:59]
    v_pk_fma_f32 v[58:59], v[92:93], v[124:125], v[58:59]
    v_pk_fma_f32 v[58:59], v[94:95], v[126:127], v[58:59]
    v_pk_mul_f32 v[112:113], v[112:113], v[64:65]
    v_pk_mul_f32 v[114:115], v[114:115], v[66:67]
    v_pk_mul_f32 v[116:117], v[116:117], v[68:69]
    v_pk_mul_f32 v[118:119], v[118:119], v[70:71]
    v_pk_mul_f32 v[120:121], v[120:121], v[72:73]
    v_pk_mul_f32 v[122:123], v[122:123], v[74:75]
    v_pk_mul_f32 v[124:125], v[124:125], v[76:77]
    v_pk_mul_f32 v[126:127], v[126:127], v[78:79]
    v_pk_add_f32 v[60:61], v[112:113], v[114:115]
    v_pk_add_f32 v[60:61], v[60:61], v[116:117]
    v_pk_add_f32 v[60:61], v[60:61], v[118:119]
    v_pk_add_f32 v[60:61], v[60:61], v[120:121]
    v_pk_add_f32 v[60:61], v[60:61], v[122:123]
    v_pk_add_f32 v[60:61], v[60:61], v[124:125]
    v_pk_add_f32 v[60:61], v[60:61], v[126:127]
    v_add_f32 v57, v58, v59
    v_add_f32 v56, v60, v61
    s_nop 1
    v_add_f32_dpp v56, v56, v56 quad_perm:[1,0,3,2] row_mask:0xf bank_mask:0xf
    v_add_f32_dpp v57, v57, v57 quad_perm:[1,0,3,2] row_mask:0xf bank_mask:0xf
    s_nop 0
    v_add_f32_dpp v56, v56, v56 quad_perm:[2,3,0,1] row_mask:0xf bank_mask:0xf
    s_nop 0
    v_add_f32_dpp v57, v57, v57 quad_perm:[2,3,0,1] row_mask:0xf bank_mask:0xf
    s_nop 0
    v_add_f32_dpp v56, v56, v56 row_ror:8 row_mask:0xf bank_mask:0xf
    s_nop 0
    v_add_f32_dpp v57, v57, v57 row_ror:8 row_mask:0xf bank_mask:0xf
    v_mov_b32 v58, v56
    v_mov_b32 v59, v57
    s_nop 0
    v_permlane16_swap_b32 v56, v58
    s_nop 0
    v_permlane16_swap_b32 v57, v59
    v_add_f32 v56, v56, v58
    v_add_f32 v57, v57, v59
    v_mov_b32 v58, v56
    v_mov_b32 v59, v57
    s_nop 0
    v_permlane32_swap_b32 v56, v58
    s_nop 0
    v_permlane32_swap_b32 v57, v59
    v_add_f32 v56, v56, v58
    v_add_f32 v57, v57, v59
    v_lshlrev_b32 v24, 16, v144
    v_and_b32 v25, 0xffff0000, v144
    v_lshlrev_b32 v26, 16, v145
    v_and_b32 v27, 0xffff0000, v145
    v_lshlrev_b32 v28, 16, v146
    v_and_b32 v29, 0xffff0000, v146
    v_lshlrev_b32 v30, 16, v147
    v_and_b32 v31, 0xffff0000, v147
    v_lshlrev_b32 v32, 16, v148
    v_and_b32 v33, 0xffff0000, v148
    v_lshlrev_b32 v34, 16, v149
    v_and_b32 v35, 0xffff0000, v149
    v_lshlrev_b32 v36, 16, v150
    v_and_b32 v37, 0xffff0000, v150
    v_lshlrev_b32 v38, 16, v151
    v_and_b32 v39, 0xffff0000, v151
    v_lshlrev_b32 v40, 16, v152
    v_and_b32 v41, 0xffff0000, v152
    v_lshlrev_b32 v42, 16, v153
    v_and_b32 v43, 0xffff0000, v153
    v_lshlrev_b32 v44, 16, v154
    v_and_b32 v45, 0xffff0000, v154
    v_lshlrev_b32 v46, 16, v155
    v_and_b32 v47, 0xffff0000, v155
    v_lshlrev_b32 v48, 16, v156
    v_and_b32 v49, 0xffff0000, v156
    v_lshlrev_b32 v50, 16, v157
    v_and_b32 v51, 0xffff0000, v157
    v_lshlrev_b32 v52, 16, v158
    v_and_b32 v53, 0xffff0000, v158
    v_lshlrev_b32 v54, 16, v159
    v_and_b32 v55, 0xffff0000, v159
    s_cmp_ge_u32 s32, 2
    s_cbranch_scc1 L_h1
    s_waitcnt vmcnt(8)
    v_max3_u32 v58, v224, v226, v228
    s_waitcnt vmcnt(7)
    v_max3_u32 v59, v230, v232, v234
    s_waitcnt vmcnt(6)
    v_max3_u32 v58, v58, v236, v238
    s_waitcnt vmcnt(5)
    v_max3_u32 v59, v59, v240, v242
    s_waitcnt vmcnt(4)
    v_max3_u32 v58, v58, v244, v246
    s_waitcnt vmcnt(3)
    v_max3_u32 v59, v59, v248, v250
    s_waitcnt vmcnt(2)
    v_max3_u32 v58, v58, v252, v254
    v_max_u32 v58, v58, v59
    v_cmp_ne_u32 vcc, -1, v58
    s_cmp_eq_u64 vcc, -1
    s_cbranch_scc1 L_h1_ok
L_h1:
    s_waitcnt vmcnt(9)
    buffer_load_dwordx4 v[224:227], v2, s[16:19], s12 offen offset:0 sc1
    s_waitcnt vmcnt(9)
    buffer_load_dwordx4 v[228:231], v2, s[16:19], s12 offen offset:1024 sc1
    s_waitcnt vmcnt(9)
    buffer_load_dwordx4 v[232:235], v2, s[16:19], s12 offen offset:2048 sc1
    s_waitcnt vmcnt(9)
    buffer_load_dwordx4 v[236:239], v2, s[16:19], s12 offen offset:3072 sc1
    s_waitcnt vmcnt(9)
    buffer_load_dwordx4 v[240:243], v2, s[16:19], s13 offen offset:0 sc1
    s_waitcnt vmcnt(9)
    buffer_load_dwordx4 v[244:247], v2, s[16:19], s13 offen offset:1024 sc1
    s_waitcnt vmcnt(9)
    buffer_load_dwordx4 v[248:251], v2, s[16:19], s13 offen offset:2048 sc1
    s_waitcnt vmcnt(9)
    buffer_load_dwordx4 v[252:255], v2, s[16:19], s13 offen offset:3072 sc1
    s_waitcnt vmcnt(0)
    v_max3_u32 v58, v224, v226, v228
    v_max3_u32 v59, v230, v232, v234
    v_max3_u32 v58, v58, v236, v238
    v_max3_u32 v59, v59, v240, v242
    v_max3_u32 v58, v58, v244, v246
    v_max3_u32 v59, v59, v248, v250
    v_max3_u32 v58, v58, v252, v254
    v_max_u32 v58, v58, v59
    v_cmp_ne_u32 vcc, -1, v58
    s_cmp_eq_u64 vcc, -1
    s_cbranch_scc1 L_h1_ok
    s_sub_u32 s82, s82, 1
    s_cbranch_scc0 L_h1
    s_mov_b32 s82, 0
L_h1_ok:
    v_lshlrev_b32 v192, 16, v224
    v_and_b32 v193, 0xffff0000, v224
    v_lshlrev_b32 v194, 16, v225
    v_and_b32 v195, 0xffff0000, v225
    v_lshlrev_b32 v196, 16, v226
    v_and_b32 v197, 0xffff0000, v226
    v_lshlrev_b32 v198, 16, v227
    v_and_b32 v199, 0xffff0000, v227
    v_lshlrev_b32 v200, 16, v228
    v_and_b32 v201, 0xffff0000, v228
    v_lshlrev_b32 v202, 16, v229
    v_and_b32 v203, 0xffff0000, v229
    v_lshlrev_b32 v204, 16, v230
    v_and_b32 v205, 0xffff0000, v230
    v_lshlrev_b32 v206, 16, v231
    v_and_b32 v207, 0xffff0000, v231
    v_lshlrev_b32 v208, 16, v232
    v_and_b32 v209, 0xffff0000, v232
    v_lshlrev_b32 v210, 16, v233
    v_and_b32 v211, 0xffff0000, v233
    v_lshlrev_b32 v212, 16, v234
    v_and_b32 v213, 0xffff0000, v234
    v_lshlrev_b32 v214, 16, v235
    v_and_b32 v215, 0xffff0000, v235
    v_lshlrev_b32 v216, 16, v236
    v_and_b32 v217, 0xffff0000, v236
    v_lshlrev_b32 v218, 16, v237
    v_and_b32 v219, 0xffff0000, v237
    v_lshlrev_b32 v220, 16, v238
    v_and_b32 v221, 0xffff0000, v238
    v_lshlrev_b32 v222, 16, v239
    v_and_b32 v223, 0xffff0000, v239
    v_pk_add_f32 v[192:193], v[192:193], v[208:209]
    v_pk_add_f32 v[194:195], v[194:195], v[210:211]
    v_pk_add_f32 v[196:197], v[196:197], v[212:213]
    v_pk_add_f32 v[198:199], v[198:199], v[214:215]
    v_pk_add_f32 v[200:201], v[200:201], v[216:217]
    v_pk_add_f32 v[202:203], v[202:203], v[218:219]
    v_pk_add_f32 v[204:205], v[204:205], v[220:221]
    v_pk_add_f32 v[206:207], v[206:207], v[222:223]
    v_lshlrev_b32 v208, 16, v240
    v_and_b32 v209, 0xffff0000, v240
    v_lshlrev_b32 v210, 16, v241
    v_and_b32 v211, 0xffff0000, v241
    v_lshlrev_b32 v212, 16, v242
    v_and_b32 v213, 0xffff0000, v242
    v_lshlrev_b32 v214, 16, v243
    v_and_b32 v215, 0xffff0000, v243
    v_lshlrev_b32 v216, 16, v244
    v_and_b32 v217, 0xffff0000, v244
    v_lshlrev_b32 v218, 16, v245
    v_and_b32 v219, 0xffff0000, v245
    v_lshlrev_b32 v220, 16, v246
    v_and_b32 v221, 0xffff0000, v246
    v_lshlrev_b32 v222, 16, v247
    v_and_b32 v223, 0xffff0000, v247
    v_pk_add_f32 v[192:193], v[192:193], v[208:209]
    v_pk_add_f32 v[194:195], v[194:195], v[210:211]
    v_pk_add_f32 v[196:197], v[196:197], v[212:213]
    v_pk_add_f32 v[198:199], v[198:199], v[214:215]
    v_pk_add_f32 v[200:201], v[200:201], v[216:217]
    v_pk_add_f32 v[202:203], v[202:203], v[218:219]
    v_pk_add_f32 v[204:205], v[204:205], v[220:221]
    v_pk_add_f32 v[206:207], v[206:207], v[222:223]
    v_lshlrev_b32 v208, 16, v248
    v_and_b32 v209, 0xffff0000, v248
    v_lshlrev_b32 v210, 16, v249
    v_and_b32 v211, 0xffff0000, v249
    v_lshlrev_b32 v212, 16, v250
    v_and_b32 v213, 0xffff0000, v250
    v_lshlrev_b32 v214, 16, v251
    v_and_b32 v215, 0xffff0000, v251
    v_lshlrev_b32 v216, 16, v252
    v_and_b32 v217, 0xffff0000, v252
    v_lshlrev_b32 v218, 16, v253
    v_and_b32 v219, 0xffff0000, v253
    v_lshlrev_b32 v220, 16, v254
    v_and_b32 v221, 0xffff0000, v254
    v_lshlrev_b32 v222, 16, v255
    v_and_b32 v223, 0xffff0000, v255
    v_pk_add_f32 v[192:193], v[192:193], v[208:209]
    v_pk_add_f32 v[194:195], v[194:195], v[210:211]
    v_pk_add_f32 v[196:197], v[196:197], v[212:213]
    v_pk_add_f32 v[198:199], v[198:199], v[214:215]
    v_pk_add_f32 v[200:201], v[200:201], v[216:217]
    v_pk_add_f32 v[202:203], v[202:203], v[218:219]
    v_pk_add_f32 v[204:205], v[204:205], v[220:221]
    v_pk_add_f32 v[206:207], v[206:207], v[222:223]
    v_pk_fma_f32 v[24:25], v[192:193], v[40:41], v[24:25]
    v_pk_fma_f32 v[26:27], v[194:195], v[42:43], v[26:27]
    v_pk_fma_f32 v[28:29], v[196:197], v[44:45], v[28:29]
    v_pk_fma_f32 v[30:31], v[198:199], v[46:47], v[30:31]
    v_pk_fma_f32 v[32:33], v[200:201], v[48:49], v[32:33]
    v_pk_fma_f32 v[34:35], v[202:203], v[50:51], v[34:35]
    v_pk_fma_f32 v[36:37], v[204:205], v[52:53], v[36:37]
    v_pk_fma_f32 v[38:39], v[206:207], v[54:55], v[38:39]
    v_cvt_pk_bf16_f32 v240, v24, v25
    v_cvt_pk_bf16_f32 v241, v26, v27
    v_cvt_pk_bf16_f32 v242, v28, v29
    v_cvt_pk_bf16_f32 v243, v30, v31
    v_cvt_pk_bf16_f32 v244, v32, v33
    v_cvt_pk_bf16_f32 v245, v34, v35
    v_cvt_pk_bf16_f32 v246, v36, v37
    v_cvt_pk_bf16_f32 v247, v38, v39
    v_lshlrev_b32 v24, 16, v240
    v_and_b32 v25, 0xffff0000, v240
    v_lshlrev_b32 v26, 16, v241
    v_and_b32 v27, 0xffff0000, v241
    v_lshlrev_b32 v28, 16, v242
    v_and_b32 v29, 0xffff0000, v242
    v_lshlrev_b32 v30, 16, v243
    v_and_b32 v31, 0xffff0000, v243
    v_lshlrev_b32 v32, 16, v244
    v_and_b32 v33, 0xffff0000, v244
    v_lshlrev_b32 v34, 16, v245
    v_and_b32 v35, 0xffff0000, v245
    v_lshlrev_b32 v36, 16, v246
    v_and_b32 v37, 0xffff0000, v246
    v_lshlrev_b32 v38, 16, v247
    v_and_b32 v39, 0xffff0000, v247
    v_pk_add_f32 v[212:213], v[24:25], v[26:27]
    v_pk_mul_f32 v[214:215], v[24:25], v[24:25]
    v_pk_mul_f32 v[216:217], v[24:25], v[112:113]
    v_pk_fma_f32 v[214:215], v[26:27], v[26:27], v[214:215]
    v_pk_fma_f32 v[216:217], v[26:27], v[114:115], v[216:217]
    v_pk_add_f32 v[212:213], v[212:213], v[28:29]
    v_pk_fma_f32 v[214:215], v[28:29], v[28:29], v[214:215]
    v_pk_fma_f32 v[216:217], v[28:29], v[116:117], v[216:217]
    v_pk_add_f32 v[212:213], v[212:213], v[30:31]
    v_pk_fma_f32 v[214:215], v[30:31], v[30:31], v[214:215]
    v_pk_fma_f32 v[216:217], v[30:31], v[118:119], v[216:217]
    v_pk_add_f32 v[212:213], v[212:213], v[32:33]
    v_pk_fma_f32 v[214:215], v[32:33], v[32:33], v[214:215]
    v_pk_fma_f32 v[216:217], v[32:33], v[120:121], v[216:217]
    v_pk_add_f32 v[212:213], v[212:213], v[34:35]
    v_pk_fma_f32 v[214:215], v[34:35], v[34:35], v[214:215]
    v_pk_fma_f32 v[216:217], v[34:35], v[122:123], v[216:217]
    v_pk_add_f32 v[212:213], v[212:213], v[36:37]
    v_pk_fma_f32 v[214:215], v[36:37], v[36:37], v[214:215]
    v_pk_fma_f32 v[216:217], v[36:37], v[124:125], v[216:217]
    v_pk_add_f32 v[212:213], v[212:213], v[38:39]
    v_pk_fma_f32 v[214:215], v[38:39], v[38:39], v[214:215]
    v_pk_fma_f32 v[216:217], v[38:39], v[126:127], v[216:217]
    v_add_f32 v208, v212, v213
    v_add_f32 v209, v214, v215
    v_add_f32 v210, v216, v217
    v_add_f32_dpp v208, v208, v208 quad_perm:[1,0,3,2] row_mask:0xf bank_mask:0xf
    v_add_f32_dpp v209, v209, v209 quad_perm:[1,0,3,2] row_mask:0xf bank_mask:0xf
    v_add_f32_dpp v210, v210, v210 quad_perm:[1,0,3,2] row_mask:0xf bank_mask:0xf
    v_add_f32_dpp v208, v208, v208 quad_perm:[2,3,0,1] row_mask:0xf bank_mask:0xf
    v_add_f32_dpp v209, v209, v209 quad_perm:[2,3,0,1] row_mask:0xf bank_mask:0xf
    v_add_f32_dpp v210, v210, v210 quad_perm:[2,3,0,1] row_mask:0xf bank_mask:0xf
    v_add_f32_dpp v208, v208, v208 row_ror:8 row_mask:0xf bank_mask:0xf
    v_add_f32_dpp v209, v209, v209 row_ror:8 row_mask:0xf bank_mask:0xf
    v_add_f32_dpp v210, v210, v210 row_ror:8 row_mask:0xf bank_mask:0xf
    v_mov_b32 v212, v208
    v_mov_b32 v213, v209
    v_mov_b32 v214, v210
    v_permlane16_swap_b32 v208, v212
    v_permlane16_swap_b32 v209, v213
    v_permlane16_swap_b32 v210, v214
    v_add_f32 v208, v208, v212
    v_add_f32 v209, v209, v213
    v_add_f32 v210, v210, v214
    v_mov_b32 v212, v208
    v_mov_b32 v213, v209
    v_mov_b32 v214, v210
    v_permlane32_swap_b32 v208, v212
    v_permlane32_swap_b32 v209, v213
    v_permlane32_swap_b32 v210, v214
    v_add_f32 v208, v208, v212
    v_add_f32 v209, v209, v213
    v_add_f32 v210, v210, v214
    v_mul_f32 v208, 0x3b000000, v208
    v_mul_f32 v209, 0x3b000000, v209
    v_fma_f32 v209, -v208, v208, v209
    v_max_f32 v209, 0, v209
    v_add_f32 v209, 0x3727c5ac, v209
    v_rsq_f32 v209, v209
    v_fma_f32 v210, -v208, v56, v210
    v_fma_f32 v210, v210, v209, v57
    v_ashrrev_i32 v211, 31, v210
    v_or_b32 v211, 0x80000000, v211
    s_movk_i32 s6, 0x7ff
    v_xor_b32 v211, v211, v210
    v_bfi_b32 v211, s6, v20, v211
    s_lshl_b32 s3, s32, 2
    v_mov_b32 v213, s3
    v_readlane_b32 s4, v211, 0
    v_readlane_b32 s5, v211, 4
    s_max_u32 s47, s4, s5
    v_mov_b32 v212, s47
    ds_write_b32 v213, v212 offset:16384
    v_mov_b32 v213, 0
    v_mul_f32 v208, -v208, v209
    v_fma_f32 v224, v24, v209, v208
    v_fma_f32 v225, v25, v209, v208
    v_fma_f32 v226, v26, v209, v208
    v_fma_f32 v227, v27, v209, v208
    v_fma_f32 v228, v28, v209, v208
    v_fma_f32 v229, v29, v209, v208
    v_fma_f32 v230, v30, v209, v208
    v_fma_f32 v231, v31, v209, v208
    s_waitcnt lgkmcnt(0)
    s_barrier
    ds_read_b128 v[216:219], v213 offset:16384
    v_fma_f32 v232, v32, v209, v208
    v_fma_f32 v233, v33, v209, v208
    v_fma_f32 v234, v34, v209, v208
    v_fma_f32 v235, v35, v209, v208
    v_fma_f32 v236, v36, v209, v208
    v_fma_f32 v237, v37, v209, v208
    v_fma_f32 v238, v38, v209, v208
    v_fma_f32 v239, v39, v209, v208
    v_pk_fma_f32 v[224:225], v[224:225], v[64:65], v[80:81]
    v_pk_fma_f32 v[226:227], v[226:227], v[66:67], v[82:83]
    v_pk_fma_f32 v[228:229], v[228:229], v[68:69], v[84:85]
    v_pk_fma_f32 v[230:231], v[230:231], v[70:71], v[86:87]
    v_pk_fma_f32 v[232:233], v[232:233], v[72:73], v[88:89]
    v_pk_fma_f32 v[234:235], v[234:235], v[74:75], v[90:91]
    v_pk_fma_f32 v[236:237], v[236:237], v[76:77], v[92:93]
    v_pk_fma_f32 v[238:239], v[238:239], v[78:79], v[94:95]
    s_lshl_b32 s3, s2, 5
    s_add_u32 s3, s3, 0x10000
    s_waitcnt lgkmcnt(0)
    v_max3_u32 v216, v216, v217, v218
    v_max_u32 v216, v216, v219
    v_mov_b32 v217, s80
    buffer_store_dwordx2 v[216:217], v23, s[20:23], s3 offen sc1
    v_readfirstlane_b32 s48, v216
    s_cmp_lg_u32 s48, s47
    s_cbranch_scc1 L_nopub
    s_and_b32 s4, s80, 0xffff
    v_lshrrev_b32 v213, 16, v17
    s_mov_b32 s6, 0xffff0000
    s_lshl_b32 s3, s49, 12
    s_add_u32 s3, s3, 0x100000
    v_lshlrev_b32 v214, 1, v22
    v_cmp_eq_u32 s[96:97], s48, v211
    v_cvt_pk_bf16_f32 v212, v224, v225
    v_lshl_or_b32 v112, v212, 16, s4
    v_and_or_b32 v113, v212, s6, v213
    v_cvt_pk_bf16_f32 v212, v226, v227
    v_lshl_or_b32 v114, v212, 16, s4
    v_and_or_b32 v115, v212, s6, v213
    v_cvt_pk_bf16_f32 v212, v228, v229
    v_lshl_or_b32 v116, v212, 16, s4
    v_and_or_b32 v117, v212, s6, v213
    v_cvt_pk_bf16_f32 v212, v230, v231
    v_lshl_or_b32 v118, v212, 16, s4
    v_and_or_b32 v119, v212, s6, v213
    v_cvt_pk_bf16_f32 v212, v232, v233
    v_lshl_or_b32 v120, v212, 16, s4
    v_and_or_b32 v121, v212, s6, v213
    v_cvt_pk_bf16_f32 v212, v234, v235
    v_lshl_or_b32 v122, v212, 16, s4
    v_and_or_b32 v123, v212, s6, v213
    v_cvt_pk_bf16_f32 v212, v236, v237
    v_lshl_or_b32 v124, v212, 16, s4
    v_and_or_b32 v125, v212, s6, v213
    v_cvt_pk_bf16_f32 v212, v238, v239
    v_lshl_or_b32 v126, v212, 16, s4
    v_and_or_b32 v127, v212, s6, v213
    s_mov_b64 exec, s[96:97]
    buffer_store_dwordx4 v[112:115], v214, s[20:23], s3 offen offset:0 sc1
    buffer_store_dwordx4 v[116:119], v214, s[20:23], s3 offen offset:16 sc1
    buffer_store_dwordx4 v[120:123], v214, s[20:23], s3 offen offset:1024 sc1
    buffer_store_dwordx4 v[124:127], v214, s[20:23], s3 offen offset:1040 sc1
    s_mov_b64 exec, -1
    v_lshl_or_b32 v40, v240, 16, s4
    v_and_or_b32 v41, v240, s6, v213
    v_lshl_or_b32 v42, v241, 16, s4
    v_and_or_b32 v43, v241, s6, v213
    v_lshl_or_b32 v44, v242, 16, s4
    v_and_or_b32 v45, v242, s6, v213
    v_lshl_or_b32 v46, v243, 16, s4
    v_and_or_b32 v47, v243, s6, v213
    v_lshl_or_b32 v48, v244, 16, s4
    v_and_or_b32 v49, v244, s6, v213
    v_lshl_or_b32 v50, v245, 16, s4
    v_and_or_b32 v51, v245, s6, v213
    v_lshl_or_b32 v52, v246, 16, s4
    v_and_or_b32 v53, v246, s6, v213
    v_lshl_or_b32 v54, v247, 16, s4
    v_and_or_b32 v55, v247, s6, v213
    s_mov_b64 exec, s[96:97]
    buffer_store_dwordx4 v[40:43], v214, s[20:23], s3 offen offset:2048 sc1
    buffer_store_dwordx4 v[44:47], v214, s[20:23], s3 offen offset:2064 sc1
    buffer_store_dwordx4 v[48:51], v214, s[20:23], s3 offen offset:3072 sc1
    buffer_store_dwordx4 v[52:55], v214, s[20:23], s3 offen offset:3088 sc1
    s_mov_b64 exec, -1
L_nopub:
    s_and_b32 s3, s2, 7
    s_mul_i32 s3, s3, 0x3100
    s_add_u32 s52, s3, 0x10000
    v_lshlrev_b32 v23, 3, v21
    v_lshlrev_b32 v210, 5, v21
    v_lshlrev_b32 v128, 16, v176
    v_and_b32 v129, 0xffff0000, v176
    v_lshlrev_b32 v130, 16, v177
    v_and_b32 v131, 0xffff0000, v177
    v_lshlrev_b32 v132, 16, v178
    v_and_b32 v133, 0xffff0000, v178
    v_lshlrev_b32 v134, 16, v179
    v_and_b32 v135, 0xffff0000, v179
    v_lshlrev_b32 v136, 16, v180
    v_and_b32 v137, 0xffff0000, v180
    v_lshlrev_b32 v138, 16, v181
    v_and_b32 v139, 0xffff0000, v181
    v_lshlrev_b32 v140, 16, v182
    v_and_b32 v141, 0xffff0000, v182
    v_lshlrev_b32 v142, 16, v183
    v_and_b32 v143, 0xffff0000, v183
    v_pk_fma_f32 v[224:225], v[224:225], v[128:129], v[24:25]
    v_pk_fma_f32 v[226:227], v[226:227], v[130:131], v[26:27]
    v_pk_fma_f32 v[228:229], v[228:229], v[132:133], v[28:29]
    v_pk_fma_f32 v[230:231], v[230:231], v[134:135], v[30:31]
    v_pk_fma_f32 v[232:233], v[232:233], v[136:137], v[32:33]
    v_pk_fma_f32 v[234:235], v[234:235], v[138:139], v[34:35]
    v_pk_fma_f32 v[236:237], v[236:237], v[140:141], v[36:37]
    v_pk_fma_f32 v[238:239], v[238:239], v[142:143], v[38:39]
    v_cvt_pk_bf16_f32 v248, v224, v225
    v_cvt_pk_bf16_f32 v249, v226, v227
    v_cvt_pk_bf16_f32 v250, v228, v229
    v_cvt_pk_bf16_f32 v251, v230, v231
    v_cvt_pk_bf16_f32 v252, v232, v233
    v_cvt_pk_bf16_f32 v253, v234, v235
    v_cvt_pk_bf16_f32 v254, v236, v237
    v_cvt_pk_bf16_f32 v255, v238, v239
    s_and_b32 s47, s48, 0x7ff
    v_cmp_ne_u32 s[96:97], s47, v20
    s_mov_b64 exec, s[96:97]
    buffer_store_dwordx4 v[248:251], v16, s[8:11], s15 offen offset:0 nt
    buffer_store_dwordx4 v[252:255], v16, s[8:11], s15 offen offset:512 nt
    s_mov_b64 exec, -1
    v_accvgpr_read_b32 v145, a224
    v_accvgpr_read_b32 v147, a225
    v_accvgpr_read_b32 v149, a226
    v_accvgpr_read_b32 v151, a227
    v_accvgpr_read_b32 v153, a228
    v_accvgpr_read_b32 v155, a229
    v_accvgpr_read_b32 v157, a230
    v_accvgpr_read_b32 v159, a231
    v_accvgpr_read_b32 v161, a232
    v_accvgpr_read_b32 v163, a233
    v_accvgpr_read_b32 v165, a234
    v_accvgpr_read_b32 v167, a235
    v_accvgpr_read_b32 v169, a236
    v_accvgpr_read_b32 v171, a237
    v_accvgpr_read_b32 v173, a238
    v_accvgpr_read_b32 v175, a239
    v_lshlrev_b32 v144, 16, v145
    v_and_b32 v145, 0xffff0000, v145
    v_lshlrev_b32 v146, 16, v147
    v_and_b32 v147, 0xffff0000, v147
    v_lshlrev_b32 v148, 16, v149
    v_and_b32 v149, 0xffff0000, v149
    v_lshlrev_b32 v150, 16, v151
    v_and_b32 v151, 0xffff0000, v151
    v_lshlrev_b32 v152, 16, v153
    v_and_b32 v153, 0xffff0000, v153
    v_lshlrev_b32 v154, 16, v155
    v_and_b32 v155, 0xffff0000, v155
    v_lshlrev_b32 v156, 16, v157
    v_and_b32 v157, 0xffff0000, v157
    v_lshlrev_b32 v158, 16, v159
    v_and_b32 v159, 0xffff0000, v159
    v_lshlrev_b32 v160, 16, v161
    v_and_b32 v161, 0xffff0000, v161
    v_lshlrev_b32 v162, 16, v163
    v_and_b32 v163, 0xffff0000, v163
    v_lshlrev_b32 v164, 16, v165
    v_and_b32 v165, 0xffff0000, v165
    v_lshlrev_b32 v166, 16, v167
    v_and_b32 v167, 0xffff0000, v167
    v_lshlrev_b32 v168, 16, v169
    v_and_b32 v169, 0xffff0000, v169
    v_lshlrev_b32 v170, 16, v171
    v_and_b32 v171, 0xffff0000, v171
    v_lshlrev_b32 v172, 16, v173
    v_and_b32 v173, 0xffff0000, v173
    v_lshlrev_b32 v174, 16, v175
    v_and_b32 v175, 0xffff0000, v175
    v_accvgpr_read_b32 v177, a240
    v_accvgpr_read_b32 v179, a241
    v_accvgpr_read_b32 v181, a242
    v_accvgpr_read_b32 v183, a243
    v_accvgpr_read_b32 v185, a244
    v_accvgpr_read_b32 v187, a245
    v_accvgpr_read_b32 v189, a246
    v_accvgpr_read_b32 v191, a247
    v_accvgpr_read_b32 v97, a248
    v_accvgpr_read_b32 v99, a249
    v_accvgpr_read_b32 v101, a250
    v_accvgpr_read_b32 v103, a251
    v_accvgpr_read_b32 v105, a252
    v_accvgpr_read_b32 v107, a253
    v_accvgpr_read_b32 v109, a254
    v_accvgpr_read_b32 v111, a255
    v_lshlrev_b32 v176, 16, v177
    v_and_b32 v177, 0xffff0000, v177
    v_lshlrev_b32 v178, 16, v179
    v_and_b32 v179, 0xffff0000, v179
    v_lshlrev_b32 v180, 16, v181
    v_and_b32 v181, 0xffff0000, v181
    v_lshlrev_b32 v182, 16, v183
    v_and_b32 v183, 0xffff0000, v183
    v_lshlrev_b32 v184, 16, v185
    v_and_b32 v185, 0xffff0000, v185
    v_lshlrev_b32 v186, 16, v187
    v_and_b32 v187, 0xffff0000, v187
    v_lshlrev_b32 v188, 16, v189
    v_and_b32 v189, 0xffff0000, v189
    v_lshlrev_b32 v190, 16, v191
    v_and_b32 v191, 0xffff0000, v191
    v_lshlrev_b32 v96, 16, v97
    v_and_b32 v97, 0xffff0000, v97
    v_lshlrev_b32 v98, 16, v99
    v_and_b32 v99, 0xffff0000, v99
    v_lshlrev_b32 v100, 16, v101
    v_and_b32 v101, 0xffff0000, v101
    v_lshlrev_b32 v102, 16, v103
    v_and_b32 v103, 0xffff0000, v103
    v_lshlrev_b32 v104, 16, v105
    v_and_b32 v105, 0xffff0000, v105
    v_lshlrev_b32 v106, 16, v107
    v_and_b32 v107, 0xffff0000, v107
    v_lshlrev_b32 v108, 16, v109
    v_and_b32 v109, 0xffff0000, v109
    v_lshlrev_b32 v110, 16, v111
    v_and_b32 v111, 0xffff0000, v111
L_h2:
    buffer_load_dwordx2 v[208:209], v210, s[20:23], s52 offen sc1
    s_waitcnt vmcnt(0)
    v_cmp_eq_u32 vcc, s80, v209
    s_cmp_eq_u64 vcc, -1
    s_cbranch_scc1 L_h2_ok
    s_sub_u32 s82, s82, 1
    s_cbranch_scc0 L_h2
    s_mov_b32 s82, 0
L_h2_ok:
    v_max_u32_dpp v208, v208, v208 quad_perm:[1,0,3,2] row_mask:0xf bank_mask:0xf
    s_nop 1
    v_max_u32_dpp v208, v208, v208 quad_perm:[2,3,0,1] row_mask:0xf bank_mask:0xf
    s_nop 1
    v_max_u32_dpp v208, v208, v208 row_half_mirror row_mask:0xf bank_mask:0xf
    s_nop 1
    v_max_u32_dpp v208, v208, v208 row_mirror row_mask:0xf bank_mask:0xf
    v_mov_b32 v209, v208
    s_nop 1
    v_permlane16_swap_b32 v208, v209
    v_max_u32 v208, v208, v209
    v_mov_b32 v209, v208
    s_nop 1
    v_permlane32_swap_b32 v208, v209
    v_max_u32 v208, v208, v209
    s_lshl_b32 s3, s32, 2
    v_mov_b32 v209, s3
    ds_write_b32 v209, v208 offset:16400
    v_mov_b32 v209, 0
    s_waitcnt lgkmcnt(0)
    s_barrier
    ds_read_b128 v[212:215], v209 offset:16400
    s_waitcnt lgkmcnt(0)
    v_max3_u32 v208, v212, v213, v214
    v_max_u32 v208, v208, v215
    s_nop 0
    v_readfirstlane_b32 s48, v208
    s_andn2_b32 s50, 0x7ff, s48
    s_lshr_b32 s3, s50, 6
    s_xor_b32 s4, s3, 30
    s_min_u32 s3, s3, s4
    s_bfe_u32 s4, s50, 0x40001
    s_lshl4_add_u32 s3, s3, s4
    s_lshl_b32 s53, s3, 12
    s_add_u32 s53, s53, 0x100000
    s_and_b32 s4, s48, 0x7ff
    v_cmp_ne_u32 s[96:97], s4, v20
    s_mov_b32 s6, 0x05040100
    v_cmp_eq_u32 vcc, s47, v20
    s_and_b64 s[96:97], s[96:97], vcc
    s_cmp_lt_u32 s2, 32
    s_cbranch_scc1 L_last

L_h3:
    buffer_load_dwordx2 v[216:217], v23, s[20:23], s53 offen sc1
    s_waitcnt vmcnt(0)
    v_perm_b32 v218, v217, v216, s6
    v_cmp_eq_u32 vcc, s80, v218
    s_cmp_eq_u64 vcc, -1
    s_cbranch_scc1 L_h3_ok
    s_sub_u32 s82, s82, 1
    s_cbranch_scc0 L_h3
    s_mov_b32 s82, 0
L_h3_ok:
    v_and_b32 v212, 0xffff0000, v216
    v_and_b32 v214, 0xffff0000, v217
    v_pk_mul_f32 v[112:113], v[144:145], v[212:213] op_sel_hi:[1,0]
    v_pk_mul_f32 v[114:115], v[146:147], v[212:213] op_sel_hi:[1,0]
    v_pk_mul_f32 v[116:117], v[148:149], v[212:213] op_sel_hi:[1,0]
    v_pk_mul_f32 v[118:119], v[150:151], v[212:213] op_sel_hi:[1,0]
    v_pk_mul_f32 v[120:121], v[160:161], v[212:213] op_sel_hi:[1,0]
    v_pk_mul_f32 v[122:123], v[162:163], v[212:213] op_sel_hi:[1,0]
    v_pk_mul_f32 v[124:125], v[164:165], v[212:213] op_sel_hi:[1,0]
    v_pk_mul_f32 v[126:127], v[166:167], v[212:213] op_sel_hi:[1,0]
    v_pk_fma_f32 v[112:113], v[152:153], v[214:215], v[112:113] op_sel_hi:[1,0,1]
    v_pk_fma_f32 v[114:115], v[154:155], v[214:215], v[114:115] op_sel_hi:[1,0,1]
    v_pk_fma_f32 v[116:117], v[156:157], v[214:215], v[116:117] op_sel_hi:[1,0,1]
    v_pk_fma_f32 v[118:119], v[158:159], v[214:215], v[118:119] op_sel_hi:[1,0,1]
    v_pk_fma_f32 v[120:121], v[168:169], v[214:215], v[120:121] op_sel_hi:[1,0,1]
    v_pk_fma_f32 v[122:123], v[170:171], v[214:215], v[122:123] op_sel_hi:[1,0,1]
    v_pk_fma_f32 v[124:125], v[172:173], v[214:215], v[124:125] op_sel_hi:[1,0,1]
    v_pk_fma_f32 v[126:127], v[174:175], v[214:215], v[126:127] op_sel_hi:[1,0,1]
    v_permlane32_swap_b32 v112, v120
    v_permlane32_swap_b32 v113, v121
    v_permlane32_swap_b32 v114, v122
    v_permlane32_swap_b32 v115, v123
    v_permlane32_swap_b32 v116, v124
    v_permlane32_swap_b32 v117, v125
    v_permlane32_swap_b32 v118, v126
    v_permlane32_swap_b32 v119, v127
    v_add_f32 v112, v112, v120
    v_add_f32 v113, v113, v121
    v_add_f32 v114, v114, v122
    v_add_f32 v115, v115, v123
    v_add_f32 v116, v116, v124
    v_add_f32 v117, v117, v125
    v_add_f32 v118, v118, v126
    v_add_f32 v119, v119, v127
    v_permlane16_swap_b32 v112, v116
    v_permlane16_swap_b32 v113, v117
    v_permlane16_swap_b32 v114, v118
    v_permlane16_swap_b32 v115, v119
    v_add_f32 v112, v112, v116
    v_add_f32 v113, v113, v117
    v_add_f32 v114, v114, v118
    v_add_f32 v115, v115, v119
    v_add_f32_dpp v112, v112, v112 quad_perm:[1,0,3,2] row_mask:0xf bank_mask:0xf
    v_add_f32_dpp v113, v113, v113 quad_perm:[1,0,3,2] row_mask:0xf bank_mask:0xf
    v_add_f32_dpp v114, v114, v114 quad_perm:[1,0,3,2] row_mask:0xf bank_mask:0xf
    v_add_f32_dpp v115, v115, v115 quad_perm:[1,0,3,2] row_mask:0xf bank_mask:0xf
    v_add_f32_dpp v112, v112, v112 quad_perm:[2,3,0,1] row_mask:0xf bank_mask:0xf
    v_add_f32_dpp v113, v113, v113 quad_perm:[2,3,0,1] row_mask:0xf bank_mask:0xf
    v_add_f32_dpp v114, v114, v114 quad_perm:[2,3,0,1] row_mask:0xf bank_mask:0xf
    v_add_f32_dpp v115, v115, v115 quad_perm:[2,3,0,1] row_mask:0xf bank_mask:0xf
    v_add_f32_dpp v112, v112, v112 row_half_mirror row_mask:0xf bank_mask:0xf
    v_add_f32_dpp v113, v113, v113 row_half_mirror row_mask:0xf bank_mask:0xf
    v_add_f32_dpp v114, v114, v114 row_half_mirror row_mask:0xf bank_mask:0xf
    v_add_f32_dpp v115, v115, v115 row_half_mirror row_mask:0xf bank_mask:0xf
    v_add_f32_dpp v112, v112, v112 row_mirror row_mask:0xf bank_mask:0xf
    v_add_f32_dpp v113, v113, v113 row_mirror row_mask:0xf bank_mask:0xf
    v_add_f32_dpp v114, v114, v114 row_mirror row_mask:0xf bank_mask:0xf
    v_add_f32_dpp v115, v115, v115 row_mirror row_mask:0xf bank_mask:0xf
    v_lshrrev_b32 v216, 4, v21
    v_lshlrev_b32 v216, 4, v216
    ds_write_b128 v216, v[112:115] offset:17408
    v_lshrrev_b32 v216, 2, v2
    s_waitcnt lgkmcnt(0)
    s_barrier
    ds_read_b32 v112, v216 offset:17408
    s_mov_b64 exec, s[96:97]
    buffer_store_dwordx4 v[248:251], v16, s[8:11], s15 offen offset:0 nt
    buffer_store_dwordx4 v[252:255], v16, s[8:11], s15 offen offset:512 nt
    s_mov_b64 exec, -1
    s_waitcnt lgkmcnt(0)
    v_mov_b32 v212, v112
    s_nop 1
    v_permlane16_swap_b32 v112, v212
    v_add_f32 v112, v112, v212
    v_mov_b32 v212, v112
    s_nop 1
    v_permlane32_swap_b32 v112, v212
    v_add_f32 v112, v112, v212
    v_cvt_pk_bf16_f32 v113, v112, v112
    v_lshlrev_b32 v112, 16, v113
    v_mul_f32 v113, 0xbfb8aa3b, v112
    v_exp_f32 v113, v113
    v_mov_b32_dpp v114, v112 row_ror:8 row_mask:0xf bank_mask:0xf
    v_add_f32 v113, 1.0, v113
    v_rcp_f32 v113, v113
    s_nop 0
    v_mul_f32 v112, v112, v113
    v_cvt_pk_bf16_f32 v113, v112, v112
    v_lshlrev_b32 v112, 16, v113
    v_mul_f32 v112, v112, v114
    v_cvt_pk_bf16_f32 v113, v112, v112
    v_lshlrev_b32 v112, 16, v113
    s_nop 0
    v_readlane_b32 s64, v112, 0
    v_readlane_b32 s65, v112, 1
    v_readlane_b32 s66, v112, 2
    v_readlane_b32 s67, v112, 3
    v_readlane_b32 s68, v112, 4
    v_readlane_b32 s69, v112, 5
    v_readlane_b32 s70, v112, 6
    v_readlane_b32 s71, v112, 7
    s_cmp_ge_u32 s32, 2
    s_cbranch_scc1 L_rest
    v_mul_f32 v112, s64, v176
    v_mul_f32 v113, s64, v177
    v_mul_f32 v114, s64, v178
    v_mul_f32 v115, s64, v179
    v_fmac_f32 v112, s65, v180
    v_fmac_f32 v113, s65, v181
    v_fmac_f32 v114, s65, v182
    v_fmac_f32 v115, s65, v183
    v_fmac_f32 v112, s66, v184
    v_fmac_f32 v113, s66, v185
    v_fmac_f32 v114, s66, v186
    v_fmac_f32 v115, s66, v187
    v_fmac_f32 v112, s67, v188
    v_fmac_f32 v113, s67, v189
    v_fmac_f32 v114, s67, v190
    v_fmac_f32 v115, s67, v191
    v_fmac_f32 v112, s68, v96
    v_fmac_f32 v113, s68, v97
    v_fmac_f32 v114, s68, v98
    v_fmac_f32 v115, s68, v99
    v_fmac_f32 v112, s69, v100
    v_fmac_f32 v113, s69, v101
    v_fmac_f32 v114, s69, v102
    v_fmac_f32 v115, s69, v103
    v_fmac_f32 v112, s70, v104
    v_fmac_f32 v113, s70, v105
    v_fmac_f32 v114, s70, v106
    v_fmac_f32 v115, s70, v107
    v_fmac_f32 v112, s71, v108
    v_fmac_f32 v113, s71, v109
    v_fmac_f32 v114, s71, v110
    v_fmac_f32 v115, s71, v111
    v_lshlrev_b32 v216, 4, v21
    s_lshl_b32 s3, s40, 11
    s_add_u32 s3, s3, 0x80000
    v_perm_b32 v112, v112, v17, s41
    v_perm_b32 v113, v113, v17, s42
    v_perm_b32 v114, v114, v17, s43
    v_perm_b32 v115, v115, v17, s44
    buffer_store_dwordx4 v[112:115], v216, s[20:23], s3 offen sc1
L_rest:
L_done:
    s_mov_b64 exec, -1
    s_endpgm
L_last:
    s_and_b32 s3, s2, 7
    s_lshr_b32 s4, s2, 3
    s_lshl2_add_u32 s40, s3, s4
    v_and_b32 v23, 0x30, v2
    v_lshrrev_b32 v216, 6, v2
    v_cmp_gt_u32 s[98:99], 14, v216
    v_min_u32 v216, 13, v216
    v_lshl_or_b32 v216, v216, 11, v23
    v_lshrrev_b32 v217, 1, v23
    s_lshl_b32 s3, s40, 6
    s_add_u32 s52, s53, s3
    s_mul_i32 s53, s32, 114688
    s_add_u32 s53, s53, s3
    s_add_u32 s53, s53, 0x80000
    s_lshr_b32 s3, s3, 1
    s_add_u32 s4, s3, 0x6400
    buffer_load_dwordx2 v[168:169], v217, s[20:23], s4 offen sc1
    s_lshl_b32 s50, s50, 10
    s_add_u32 s50, s50, s3
    s_mov_b64 exec, s[96:97]
    buffer_store_dwordx4 v[248:251], v16, s[8:11], s15 offen offset:0 nt
    buffer_store_dwordx4 v[252:255], v16, s[8:11], s15 offen offset:512 nt
    s_mov_b64 exec, -1
    s_andn2_b32 s3, s48, 0x7ff
    s_ashr_i32 s4, s3, 31
    s_orn2_b32 s4, 0x80000000, s4
    s_xor_b32 s3, s3, s4
    v_mov_b32 v211, s3
    v_cvt_pk_bf16_f32 v218, v211, v211
    v_lshlrev_b32 v211, 16, v218
    v_mul_f32 v211, 0xbfb8aa3b, v211
    v_exp_f32 v211, v211
    s_nop 0
    v_add_f32 v211, 1.0, v211
    v_rcp_f32 v211, v211
    s_nop 0
    v_cvt_pk_bf16_f32 v218, v211, v211
    v_lshlrev_b32 v211, 16, v218
L_h4:
    buffer_load_dwordx4 v[160:163], v23, s[20:23], s52 offen offset:0 sc1
    buffer_load_dwordx4 v[164:167], v23, s[20:23], s52 offen offset:2048 sc1
    s_add_u32 s4, s53, 0
    buffer_load_dwordx4 v[144:147], v216, s[20:23], s4 offen sc1
    s_add_u32 s4, s53, 28672
    buffer_load_dwordx4 v[148:151], v216, s[20:23], s4 offen sc1
    s_add_u32 s4, s53, 57344
    buffer_load_dwordx4 v[152:155], v216, s[20:23], s4 offen sc1
    s_add_u32 s4, s53, 86016
    buffer_load_dwordx4 v[156:159], v216, s[20:23], s4 offen sc1
    s_waitcnt vmcnt(0)
    v_perm_b32 v59, v145, v144, s45
    v_perm_b32 v60, v147, v146, s46
    v_bitop3_b32 v59, v59, v60, s80 bitop3:0x56
    v_perm_b32 v61, v149, v148, s45
    v_perm_b32 v62, v151, v150, s46
    v_bitop3_b32 v61, v61, v62, s80 bitop3:0x56
    v_or_b32 v58, v59, v61
    v_perm_b32 v59, v153, v152, s45
    v_perm_b32 v60, v155, v154, s46
    v_bitop3_b32 v59, v59, v60, s80 bitop3:0x56
    v_perm_b32 v61, v157, v156, s45
    v_perm_b32 v62, v159, v158, s46
    v_bitop3_b32 v61, v61, v62, s80 bitop3:0x56
    v_or3_b32 v58, v58, v59, v61
    v_perm_b32 v59, v161, v160, s6
    v_bitop3_b32 v58, v58, v59, s80 bitop3:0xf6
    v_perm_b32 v59, v163, v162, s6
    v_bitop3_b32 v58, v58, v59, s80 bitop3:0xf6
    v_perm_b32 v59, v165, v164, s6
    v_bitop3_b32 v58, v58, v59, s80 bitop3:0xf6
    v_perm_b32 v59, v167, v166, s6
    v_bitop3_b32 v58, v58, v59, s80 bitop3:0xf6
    v_cmp_eq_u32 vcc, 0, v58
    s_cmp_eq_u64 vcc, -1
    s_cbranch_scc1 L_h4_ok
    s_sub_u32 s82, s82, 1
    s_cbranch_scc0 L_h4
    s_mov_b32 s82, 0
L_h4_ok:
    v_and_b32 v144, 0xffffff00, v144
    v_and_b32 v145, 0xffffff00, v145
    v_and_b32 v146, 0xffffff00, v146
    v_and_b32 v147, 0xffffff00, v147
    v_and_b32 v148, 0xffffff00, v148
    v_and_b32 v149, 0xffffff00, v149
    v_and_b32 v150, 0xffffff00, v150
    v_and_b32 v151, 0xffffff00, v151
    v_and_b32 v152, 0xffffff00, v152
    v_and_b32 v153, 0xffffff00, v153
    v_and_b32 v154, 0xffffff00, v154
    v_and_b32 v155, 0xffffff00, v155
    v_and_b32 v156, 0xffffff00, v156
    v_and_b32 v157, 0xffffff00, v157
    v_and_b32 v158, 0xffffff00, v158
    v_and_b32 v159, 0xffffff00, v159
    v_pk_add_f32 v[144:145], v[144:145], v[148:149]
    v_pk_add_f32 v[146:147], v[146:147], v[150:151]
    v_pk_add_f32 v[152:153], v[152:153], v[156:157]
    v_pk_add_f32 v[154:155], v[154:155], v[158:159]
    v_pk_add_f32 v[144:145], v[144:145], v[152:153]
    v_pk_add_f32 v[146:147], v[146:147], v[154:155]
    v_cndmask_b32_e64 v144, 0, v144, s[98:99]
    v_cndmask_b32_e64 v145, 0, v145, s[98:99]
    v_cndmask_b32_e64 v146, 0, v146, s[98:99]
    v_cndmask_b32_e64 v147, 0, v147, s[98:99]
    v_add_f32_dpp v144, v144, v144 row_ror:4 row_mask:0xf bank_mask:0xf
    v_add_f32_dpp v145, v145, v145 row_ror:4 row_mask:0xf bank_mask:0xf
    v_add_f32_dpp v146, v146, v146 row_ror:4 row_mask:0xf bank_mask:0xf
    v_add_f32_dpp v147, v147, v147 row_ror:4 row_mask:0xf bank_mask:0xf
    v_add_f32_dpp v144, v144, v144 row_ror:8 row_mask:0xf bank_mask:0xf
    v_add_f32_dpp v145, v145, v145 row_ror:8 row_mask:0xf bank_mask:0xf
    v_add_f32_dpp v146, v146, v146 row_ror:8 row_mask:0xf bank_mask:0xf
    v_add_f32_dpp v147, v147, v147 row_ror:8 row_mask:0xf bank_mask:0xf
    v_mov_b32 v148, v144
    v_mov_b32 v149, v145
    v_mov_b32 v150, v146
    v_mov_b32 v151, v147
    v_permlane16_swap_b32 v144, v148
    v_permlane16_swap_b32 v145, v149
    v_permlane16_swap_b32 v146, v150
    v_permlane16_swap_b32 v147, v151
    v_add_f32 v144, v144, v148
    v_add_f32 v145, v145, v149
    v_add_f32 v146, v146, v150
    v_add_f32 v147, v147, v151
    v_mov_b32 v148, v144
    v_mov_b32 v149, v145
    v_mov_b32 v150, v146
    v_mov_b32 v151, v147
    v_permlane32_swap_b32 v144, v148
    v_permlane32_swap_b32 v145, v149
    v_permlane32_swap_b32 v146, v150
    v_permlane32_swap_b32 v147, v151
    v_add_f32 v144, v144, v148
    v_add_f32 v145, v145, v149
    v_add_f32 v146, v146, v150
    v_add_f32 v147, v147, v151
    s_lshl_b32 s3, s32, 6
    v_add_u32 v216, s3, v23
    ds_write_b128 v216, v[144:147] offset:18432
    s_waitcnt lgkmcnt(0)
    s_barrier
    s_cmp_lg_u32 s32, 0
    s_cbranch_scc1 L_done
    ds_read_b128 v[144:147], v23 offset:18432
    ds_read_b128 v[148:151], v23 offset:18496
    ds_read_b128 v[152:155], v23 offset:18560
    ds_read_b128 v[156:159], v23 offset:18624
    v_lshlrev_b32 v172, 16, v168
    v_and_b32 v173, 0xffff0000, v168
    v_lshlrev_b32 v174, 16, v169
    v_and_b32 v175, 0xffff0000, v169
    v_and_b32 v160, 0xffff0000, v160
    v_and_b32 v161, 0xffff0000, v161
    v_and_b32 v162, 0xffff0000, v162
    v_and_b32 v163, 0xffff0000, v163
    v_and_b32 v164, 0xffff0000, v164
    v_and_b32 v165, 0xffff0000, v165
    v_and_b32 v166, 0xffff0000, v166
    v_and_b32 v167, 0xffff0000, v167
    s_waitcnt lgkmcnt(2)
    v_add_f32 v144, v144, v148
    v_add_f32 v145, v145, v149
    v_add_f32 v146, v146, v150
    v_add_f32 v147, v147, v151
    s_waitcnt lgkmcnt(0)
    v_add_f32 v152, v152, v156
    v_add_f32 v153, v153, v157
    v_add_f32 v154, v154, v158
    v_add_f32 v155, v155, v159
    v_add_f32 v144, v144, v152
    v_add_f32 v145, v145, v153
    v_add_f32 v146, v146, v154
    v_add_f32 v147, v147, v155
    v_cvt_pk_bf16_f32 v218, v144, v145
    v_cvt_pk_bf16_f32 v219, v146, v147
    v_lshlrev_b32 v144, 16, v218
    v_and_b32 v145, 0xffff0000, v218
    v_lshlrev_b32 v146, 16, v219
    v_and_b32 v147, 0xffff0000, v219
    v_mul_f32 v144, v144, v211
    v_mul_f32 v145, v145, v211
    v_mul_f32 v146, v146, v211
    v_mul_f32 v147, v147, v211
    v_cvt_pk_bf16_f32 v218, v144, v145
    v_cvt_pk_bf16_f32 v219, v146, v147
    v_lshlrev_b32 v144, 16, v218
    v_and_b32 v145, 0xffff0000, v218
    v_lshlrev_b32 v146, 16, v219
    v_and_b32 v147, 0xffff0000, v219
    v_add_f32 v144, v144, v160
    v_add_f32 v145, v145, v161
    v_add_f32 v146, v146, v162
    v_add_f32 v147, v147, v163
    v_cvt_pk_bf16_f32 v218, v144, v145
    v_cvt_pk_bf16_f32 v219, v146, v147
    v_lshlrev_b32 v144, 16, v218
    v_and_b32 v145, 0xffff0000, v218
    v_lshlrev_b32 v146, 16, v219
    v_and_b32 v147, 0xffff0000, v219
    v_fma_f32 v144, v144, v172, v164
    v_fma_f32 v145, v145, v173, v165
    v_fma_f32 v146, v146, v174, v166
    v_fma_f32 v147, v147, v175, v167
    v_cvt_pk_bf16_f32 v218, v144, v145
    v_cvt_pk_bf16_f32 v219, v146, v147
    s_mov_b64 exec, 0xf
    buffer_store_dwordx2 v[218:219], v217, s[8:11], s50 offen nt
    s_cmp_eq_u32 s40, 0
    s_cbranch_scc0 L_done
    buffer_store_dword v17, v0, s[20:23], 0 offen offset:0
    s_branch L_done
L_again:
    s_mov_b32 s48, 1
    s_barrier
    s_branch L_rerun
L_cs_retry:
    buffer_load_dwordx4 v[44:47], v57, s[20:23], 0 offen sc1
    s_waitcnt vmcnt(0)
    v_cmp_eq_u64_e64 s[4:5], s[80:81], v[44:45]
    v_cmp_eq_u64 vcc, s[80:81], v[46:47]
    s_and_b64 s[4:5], s[4:5], vcc
    s_cmp_eq_u64 s[4:5], -1
    s_cbranch_scc1 L_cs_back
    s_sub_u32 s82, s82, 1
    s_cbranch_scc0 L_cs_retry
    s_mov_b32 s82, 0
    s_branch L_cs_back
L_cl_retry:
    buffer_load_dwordx4 v[204:207], v208, s[20:23], 0 offen sc1
    s_waitcnt vmcnt(0)
    v_cmp_eq_u64_e64 s[4:5], s[80:81], v[204:205]
    v_cmp_eq_u64 vcc, s[80:81], v[206:207]
    s_and_b64 s[4:5], s[4:5], vcc
    s_cmp_eq_u64 s[4:5], -1
    s_cbranch_scc1 L_cl_back
    s_sub_u32 s82, s82, 1
    s_cbranch_scc0 L_cl_retry
    s_mov_b32 s82, 0
    s_branch L_cl_back
L_af_retry:
    buffer_load_dwordx4 v[192:195], v209, s[20:23], 0 offen offset:0 sc1
    buffer_load_dwordx4 v[196:199], v209, s[20:23], 0 offen offset:16 sc1
    buffer_load_dwordx4 v[200:203], v210, s[20:23], 0 offen offset:0 sc1
    s_waitcnt vmcnt(0)
    v_cmp_eq_u64_e64 s[4:5], s[80:81], v[192:193]
    v_cmp_eq_u64 vcc, s[80:81], v[194:195]
    s_and_b64 s[4:5], s[4:5], vcc
    v_cmp_eq_u64 vcc, s[80:81], v[196:197]
    s_and_b64 s[4:5], s[4:5], vcc
    v_cmp_eq_u64 vcc, s[80:81], v[198:199]
    s_and_b64 s[4:5], s[4:5], vcc
    v_cmp_eq_u64 vcc, s[80:81], v[200:201]
    s_and_b64 s[4:5], s[4:5], vcc
    v_cmp_eq_u64 vcc, s[80:81], v[202:203]
    s_and_b64 s[4:5], s[4:5], vcc
    s_cmp_eq_u64 s[4:5], -1
    s_cbranch_scc1 L_af_back
    s_sub_u32 s82, s82, 1
    s_cbranch_scc0 L_af_retry
    s_mov_b32 s82, 0
    s_branch L_af_back
L_mod_retry:
    buffer_load_dwordx4 a[88:91], v5, s[20:23], 0 offen offset:0 sc1
    buffer_load_dwordx4 a[92:95], v5, s[20:23], 0 offen offset:16 sc1
    buffer_load_dwordx4 a[96:99], v5, s[20:23], 0 offen offset:2048 sc1
    buffer_load_dwordx4 a[100:103], v5, s[20:23], 0 offen offset:2064 sc1
    s_waitcnt vmcnt(0)
    v_accvgpr_read_b32 v16, a89
    v_accvgpr_read_b32 v17, a91
    v_accvgpr_read_b32 v18, a93
    v_accvgpr_read_b32 v19, a95
    v_accvgpr_read_b32 v20, a97
    v_accvgpr_read_b32 v21, a99
    v_accvgpr_read_b32 v22, a101
    v_accvgpr_read_b32 v23, a103
    v_cmp_eq_u64_e64 s[4:5], s[80:81], v[16:17]
    v_cmp_eq_u64 vcc, s[80:81], v[18:19]
    s_and_b64 s[4:5], s[4:5], vcc
    v_cmp_eq_u64 vcc, s[80:81], v[20:21]
    s_and_b64 s[4:5], s[4:5], vcc
    v_cmp_eq_u64 vcc, s[80:81], v[22:23]
    s_and_b64 s[4:5], s[4:5], vcc
    s_cmp_eq_u64 s[4:5], -1
    s_cbranch_scc1 L_mod_back
    s_sub_u32 s82, s82, 1
    s_cbranch_scc0 L_mod_retry
    s_mov_b32 s82, 0
    s_branch L_mod_back
L_hf_retry:
    buffer_load_dwordx4 v[28:31], v21, s[20:23], 0 offen sc1
    s_waitcnt vmcnt(0)
    v_cmp_eq_u64_e64 s[4:5], s[80:81], v[28:29]
    v_cmp_eq_u64 vcc, s[80:81], v[30:31]
    s_and_b64 s[4:5], s[4:5], vcc
    s_cmp_eq_u64 s[4:5], -1
    s_cbranch_scc1 L_hf_back
    s_sub_u32 s82, s82, 1
    s_cbranch_scc0 L_hf_retry
    s_mov_b32 s82, 0
    s_branch L_hf_back
L_k0_retry:
    buffer_load_dwordx4 v[36:39], v35, s[20:23], 0 offen sc1
    s_waitcnt vmcnt(0)
    v_cmp_eq_u64_e64 s[94:95], s[80:81], v[36:37]
    v_cmp_eq_u64 vcc, s[80:81], v[38:39]
    s_and_b64 s[94:95], s[94:95], vcc
    s_cmp_eq_u64 s[94:95], -1
    s_cbranch_scc1 L_k0_back
    s_sub_u32 s82, s82, 1
    s_cbranch_scc0 L_k0_retry
    s_mov_b32 s82, 0
    s_branch L_k0_back
L_ka_retry:
    buffer_load_dwordx4 v[44:47], v56, s[20:23], 0 offen sc1
    s_waitcnt vmcnt(0)
    v_cmp_eq_u64_e64 s[4:5], s[80:81], v[44:45]
    v_cmp_eq_u64 vcc, s[80:81], v[46:47]
    s_and_b64 s[4:5], s[4:5], vcc
    s_cmp_eq_u64 s[4:5], -1
    s_cbranch_scc1 L_ka_back
    s_sub_u32 s82, s82, 1
    s_cbranch_scc0 L_ka_retry
    s_mov_b32 s82, 0
    s_branch L_ka_back
L_km_retry:
    buffer_load_dwordx4 v[44:47], v56, s[20:23], 0 offen sc1
    s_waitcnt vmcnt(0)
    v_cmp_eq_u64_e64 s[4:5], s[80:81], v[44:45]
    v_cmp_eq_u64 vcc, s[80:81], v[46:47]
    s_and_b64 s[4:5], s[4:5], vcc
    s_cmp_eq_u64 s[4:5], -1
    s_cbranch_scc1 L_km_back
    s_sub_u32 s82, s82, 1
    s_cbranch_scc0 L_km_retry
    s_mov_b32 s82, 0
    s_branch L_km_back
L_rerun:
    s_waitcnt vmcnt(0) lgkmcnt(0)
    s_mov_b32 s66, 0
    s_mov_b32 s68, 0
    s_and_b32 s78, s78, 0xffffffbf
    s_lshl_b32 s38, s32, 12
    v_lshrrev_b32 v32, 8, v2
    v_lshrrev_b32 v33, 4, v2
    v_and_b32 v33, 15, v33
    v_or_b32 v34, 0, v32
    v_lshrrev_b32 v35, 1, v33
    v_xor_b32 v34, v35, v34
    v_lshlrev_b32 v34, 1, v34
    v_and_b32 v35, 1, v33
    v_or_b32 v34, v34, v35
    v_lshlrev_b32 v34, 4, v34
    v_lshl_add_u32 v34, v32, 13, v34
    v_add_u32 v10, 0, v34
    v_or_b32 v34, 0, v32
    v_lshrrev_b32 v35, 1, v33
    v_xor_b32 v34, v35, v34
    v_lshlrev_b32 v34, 1, v34
    v_and_b32 v35, 1, v33
    v_or_b32 v34, v34, v35
    v_lshlrev_b32 v34, 4, v34
    v_lshl_add_u32 v34, v32, 13, v34
    v_add_u32 v11, 31744, v34
    v_or_b32 v34, 4, v32
    v_lshrrev_b32 v35, 1, v33
    v_xor_b32 v34, v35, v34
    v_lshlrev_b32 v34, 1, v34
    v_and_b32 v35, 1, v33
    v_or_b32 v34, v34, v35
    v_lshlrev_b32 v34, 4, v34
    v_lshl_add_u32 v34, v32, 13, v34
    v_add_u32 v12, 63488, v34
    v_or_b32 v34, 4, v32
    v_lshrrev_b32 v35, 1, v33
    v_xor_b32 v34, v35, v34
    v_lshlrev_b32 v34, 1, v34
    v_and_b32 v35, 1, v33
    v_or_b32 v34, v34, v35
    v_lshlrev_b32 v34, 4, v34
    v_lshl_add_u32 v34, v32, 13, v34
    v_add_u32 v13, 95232, v34
    s_add_u32 m0, s38, 0x20000
    s_mov_b32 s3, s91
    s_and_b32 s3, s3, 0x3fffff
    buffer_load_dwordx4 v10, s[12:15], s3 offen offset:0 lds
    buffer_load_dwordx4 v11, s[12:15], s3 offen offset:1024 lds
    buffer_load_dwordx4 v12, s[12:15], s3 offen offset:2048 lds
    buffer_load_dwordx4 v13, s[12:15], s3 offen offset:3072 lds
    s_add_u32 m0, s38, 0x24000
    s_add_u32 s3, s91, 0x80000
    s_and_b32 s3, s3, 0x3fffff
    buffer_load_dwordx4 v10, s[12:15], s3 offen offset:0 lds
    buffer_load_dwordx4 v11, s[12:15], s3 offen offset:1024 lds
    buffer_load_dwordx4 v12, s[12:15], s3 offen offset:2048 lds
    buffer_load_dwordx4 v13, s[12:15], s3 offen offset:3072 lds
    s_mov_b32 m0, s38
    s_add_u32 s3, s91, 0x100000
    s_and_b32 s3, s3, 0x3fffff
    buffer_load_dwordx4 v10, s[12:15], s3 offen offset:0 lds
    buffer_load_dwordx4 v11, s[12:15], s3 offen offset:1024 lds
    buffer_load_dwordx4 v12, s[12:15], s3 offen offset:2048 lds
    buffer_load_dwordx4 v13, s[12:15], s3 offen offset:3072 lds
    s_add_u32 m0, s38, 0x4000
    s_add_u32 s3, s91, 0x180000
    s_and_b32 s3, s3, 0x3fffff
    buffer_load_dwordx4 v10, s[12:15], s3 offen offset:0 lds
    buffer_load_dwordx4 v11, s[12:15], s3 offen offset:1024 lds
    buffer_load_dwordx4 v12, s[12:15], s3 offen offset:2048 lds
    buffer_load_dwordx4 v13, s[12:15], s3 offen offset:3072 lds
    s_add_u32 m0, s38, 0x10000
    s_add_u32 s3, s91, 0x200000
    s_and_b32 s3, s3, 0x3fffff
    buffer_load_dwordx4 v10, s[12:15], s3 offen offset:0 lds
    buffer_load_dwordx4 v11, s[12:15], s3 offen offset:1024 lds
    buffer_load_dwordx4 v12, s[12:15], s3 offen offset:2048 lds
    buffer_load_dwordx4 v13, s[12:15], s3 offen offset:3072 lds
    s_add_u32 m0, s38, 0x14000
    s_add_u32 s3, s91, 0x280000
    s_and_b32 s3, s3, 0x3fffff
    buffer_load_dwordx4 v10, s[12:15], s3 offen offset:0 lds
    buffer_load_dwordx4 v11, s[12:15], s3 offen offset:1024 lds
    buffer_load_dwordx4 v12, s[12:15], s3 offen offset:2048 lds
    buffer_load_dwordx4 v13, s[12:15], s3 offen offset:3072 lds
    s_and_b32 s4, s33, 3
    s_lshl_b32 s4, s4, 12
    v_add_u32 v30, s4, v2
    buffer_load_dwordx4 a[192:195], v30, s[16:19], s40 offen offset:0 sc1
    buffer_load_dwordx4 a[196:199], v30, s[16:19], s40 offen offset:1024 sc1
    buffer_load_dwordx4 a[200:203], v30, s[16:19], s41 offen offset:0 sc1
    buffer_load_dwordx4 a[204:207], v30, s[16:19], s41 offen offset:1024 sc1
    buffer_load_dwordx4 a[208:211], v30, s[16:19], s42 offen offset:0 sc1
    buffer_load_dwordx4 a[212:215], v30, s[16:19], s42 offen offset:1024 sc1
    buffer_load_dwordx4 a[216:219], v30, s[16:19], s43 offen offset:0 sc1
    buffer_load_dwordx4 a[220:223], v30, s[16:19], s43 offen offset:1024 sc1
    buffer_load_dwordx4 a[224:227], v30, s[16:19], s40 offen offset:2048 sc1
    buffer_load_dwordx4 a[228:231], v30, s[16:19], s40 offen offset:3072 sc1
    buffer_load_dwordx4 a[232:235], v30, s[16:19], s41 offen offset:2048 sc1
    buffer_load_dwordx4 a[236:239], v30, s[16:19], s41 offen offset:3072 sc1
    buffer_load_dwordx4 a[240:243], v30, s[16:19], s42 offen offset:2048 sc1
    buffer_load_dwordx4 a[244:247], v30, s[16:19], s42 offen offset:3072 sc1
    buffer_load_dwordx4 a[248:251], v30, s[16:19], s43 offen offset:2048 sc1
    buffer_load_dwordx4 a[252:255], v30, s[16:19], s43 offen offset:3072 sc1
    v_add_u32 v9, 0x1000, v30
    v_and_b32 v9, 0x3fff, v9
    v_lshrrev_b32 v34, 2, v33
    v_and_b32 v35, 1, v32
    v_lshl_or_b32 v35, v35, 2, v34
    v_lshl_add_u32 v34, v32, 3, v34
    v_lshlrev_b32 v34, 8, v34
    v_lshl_add_u32 v34, v35, 5, v34
    v_and_b32 v35, 3, v33
    v_lshl_add_u32 v24, v35, 3, v34
    v_xor_b32 v24, 0x20000, v24
    v_xor_b32 v25, 32, v24
    v_xor_b32 v26, 64, v24
    v_xor_b32 v27, 96, v24
    v_xor_b32 v28, 128, v24
    v_xor_b32 v29, 160, v24
    v_xor_b32 v30, 192, v24
    v_xor_b32 v31, 224, v24
    s_waitcnt vmcnt(0)
    s_barrier
    ds_read_b64_tr_b16 a[64:65], v24 offset:0
    ds_read_b64_tr_b16 a[66:67], v24 offset:1024
    ds_read_b64_tr_b16 a[68:69], v24 offset:8192
    ds_read_b64_tr_b16 a[70:71], v24 offset:9216
    ds_read_b64_tr_b16 a[72:73], v25 offset:0
    ds_read_b64_tr_b16 a[74:75], v25 offset:1024
    ds_read_b64_tr_b16 a[76:77], v25 offset:8192
    ds_read_b64_tr_b16 a[78:79], v25 offset:9216
    ds_read_b64_tr_b16 a[80:81], v26 offset:0
    ds_read_b64_tr_b16 a[82:83], v26 offset:1024
    ds_read_b64_tr_b16 a[84:85], v26 offset:8192
    ds_read_b64_tr_b16 a[86:87], v26 offset:9216
    ds_read_b64_tr_b16 a[88:89], v27 offset:0
    ds_read_b64_tr_b16 a[90:91], v27 offset:1024
    ds_read_b64_tr_b16 a[92:93], v27 offset:8192
    ds_read_b64_tr_b16 a[94:95], v27 offset:9216
    ds_read_b64_tr_b16 a[96:97], v28 offset:0
    ds_read_b64_tr_b16 a[98:99], v28 offset:1024
    ds_read_b64_tr_b16 a[100:101], v28 offset:8192
    ds_read_b64_tr_b16 a[102:103], v28 offset:9216
    ds_read_b64_tr_b16 a[104:105], v29 offset:0
    ds_read_b64_tr_b16 a[106:107], v29 offset:1024
    ds_read_b64_tr_b16 a[108:109], v29 offset:8192
    ds_read_b64_tr_b16 a[110:111], v29 offset:9216
    ds_read_b64_tr_b16 a[112:113], v30 offset:0
    ds_read_b64_tr_b16 a[114:115], v30 offset:1024
    ds_read_b64_tr_b16 a[116:117], v30 offset:8192
    ds_read_b64_tr_b16 a[118:119], v30 offset:9216
    ds_read_b64_tr_b16 a[120:121], v31 offset:0
    ds_read_b64_tr_b16 a[122:123], v31 offset:1024
    ds_read_b64_tr_b16 a[124:125], v31 offset:8192
    ds_read_b64_tr_b16 a[126:127], v31 offset:9216
    s_branch L_q
L_slow:
    s_branch L_ks_retry
L_ks_back:
    v_mov_b32 v32, v7
    v_mov_b32 v33, v7
    v_mov_b32 v34, v7
    v_mov_b32 v35, v7
    v_mov_b32 v36, v7
    v_mov_b32 v37, v7
    s_mov_b32 s52, 0
L_slowloop:
    s_lshr_b32 s53, s52, 2
    s_lshl_b32 s53, s53, 15
    s_and_b32 s3, s52, 3
    s_lshl_b32 s3, s3, 12
    s_add_u32 s53, s53, s3
    buffer_load_dwordx4 v[64:67], v2, s[8:11], s53 offen offset:0 sc1
    buffer_load_dwordx4 v[68:71], v2, s[8:11], s53 offen offset:1024 sc1
    buffer_load_dwordx4 v[72:75], v2, s[8:11], s53 offen offset:2048 sc1
    buffer_load_dwordx4 v[76:79], v2, s[8:11], s53 offen offset:3072 sc1
    s_waitcnt vmcnt(0)
    s_cmp_lt_u32 s52, s96
    s_cselect_b64 s[4:5], -1, 0
    s_cmp_eq_u32 s52, s96
    s_cselect_b64 s[6:7], s[24:25], s[4:5]
    v_cndmask_b32_e64 v20, v7, 0, s[6:7]
    s_cselect_b64 s[6:7], s[26:27], s[4:5]
    v_cndmask_b32_e64 v21, v7, 0, s[6:7]
    s_cselect_b64 s[6:7], s[28:29], s[4:5]
    v_cndmask_b32_e64 v22, v7, 0, s[6:7]
    s_cselect_b64 s[6:7], s[30:31], s[4:5]
    v_cndmask_b32_e64 v23, v7, 0, s[6:7]
    s_nop 1
    v_mfma_f32_16x16x32_bf16 v[40:43], v[64:67], a[0:3], v[20:23]
    v_mfma_f32_16x16x32_bf16 v[40:43], v[68:71], a[4:7], v[40:43]
    v_mfma_f32_16x16x32_bf16 v[40:43], v[72:75], a[8:11], v[40:43]
    v_mfma_f32_16x16x32_bf16 v[40:43], v[76:79], a[12:15], v[40:43]
    s_cmp_lt_u32 s52, s97
    s_cselect_b64 s[4:5], -1, 0
    s_cmp_eq_u32 s52, s97
    s_cselect_b64 s[6:7], s[24:25], s[4:5]
    v_cndmask_b32_e64 v20, v7, 0, s[6:7]
    s_cselect_b64 s[6:7], s[26:27], s[4:5]
    v_cndmask_b32_e64 v21, v7, 0, s[6:7]
    s_cselect_b64 s[6:7], s[28:29], s[4:5]
    v_cndmask_b32_e64 v22, v7, 0, s[6:7]
    s_cselect_b64 s[6:7], s[30:31], s[4:5]
    v_cndmask_b32_e64 v23, v7, 0, s[6:7]
    s_nop 1
    v_mfma_f32_16x16x32_bf16 v[44:47], v[64:67], a[16:19], v[20:23]
    v_mfma_f32_16x16x32_bf16 v[44:47], v[68:71], a[20:23], v[44:47]
    v_mfma_f32_16x16x32_bf16 v[44:47], v[72:75], a[24:27], v[44:47]
    v_mfma_f32_16x16x32_bf16 v[44:47], v[76:79], a[28:31], v[44:47]
    s_cmp_lt_u32 s52, s98
    s_cselect_b64 s[4:5], -1, 0
    s_cmp_eq_u32 s52, s98
    s_cselect_b64 s[6:7], s[24:25], s[4:5]
    v_cndmask_b32_e64 v20, v7, 0, s[6:7]
    s_cselect_b64 s[6:7], s[26:27], s[4:5]
    v_cndmask_b32_e64 v21, v7, 0, s[6:7]
    s_cselect_b64 s[6:7], s[28:29], s[4:5]
    v_cndmask_b32_e64 v22, v7, 0, s[6:7]
    s_cselect_b64 s[6:7], s[30:31], s[4:5]
    v_cndmask_b32_e64 v23, v7, 0, s[6:7]
    s_nop 1
    v_mfma_f32_16x16x32_bf16 v[48:51], v[64:67], a[32:35], v[20:23]
    v_mfma_f32_16x16x32_bf16 v[48:51], v[68:71], a[36:39], v[48:51]
    v_mfma_f32_16x16x32_bf16 v[48:51], v[72:75], a[40:43], v[48:51]
    v_mfma_f32_16x16x32_bf16 v[48:51], v[76:79], a[44:47], v[48:51]
    s_cmp_lt_u32 s52, s99
    s_cselect_b64 s[4:5], -1, 0
    s_cmp_eq_u32 s52, s99
    s_cselect_b64 s[6:7], s[24:25], s[4:5]
    v_cndmask_b32_e64 v20, v7, 0, s[6:7]
    s_cselect_b64 s[6:7], s[26:27], s[4:5]
    v_cndmask_b32_e64 v21, v7, 0, s[6:7]
    s_cselect_b64 s[6:7], s[28:29], s[4:5]
    v_cndmask_b32_e64 v22, v7, 0, s[6:7]
    s_cselect_b64 s[6:7], s[30:31], s[4:5]
    v_cndmask_b32_e64 v23, v7, 0, s[6:7]
    s_nop 1
    v_mfma_f32_16x16x32_bf16 v[52:55], v[64:67], a[48:51], v[20:23]
    v_mfma_f32_16x16x32_bf16 v[52:55], v[68:71], a[52:55], v[52:55]
    v_mfma_f32_16x16x32_bf16 v[52:55], v[72:75], a[56:59], v[52:55]
    v_mfma_f32_16x16x32_bf16 v[52:55], v[76:79], a[60:63], v[52:55]
    s_cmp_lt_u32 s52, s100
    s_cselect_b64 s[4:5], -1, 0
    s_cmp_eq_u32 s52, s100
    s_cselect_b64 s[6:7], s[24:25], s[4:5]
    v_cndmask_b32_e64 v20, v7, 0, s[6:7]
    s_cselect_b64 s[6:7], s[26:27], s[4:5]
    v_cndmask_b32_e64 v21, v7, 0, s[6:7]
    s_cselect_b64 s[6:7], s[28:29], s[4:5]
    v_cndmask_b32_e64 v22, v7, 0, s[6:7]
    s_cselect_b64 s[6:7], s[30:31], s[4:5]
    v_cndmask_b32_e64 v23, v7, 0, s[6:7]
    s_nop 1
    v_mfma_f32_16x16x32_bf16 v[104:107], v[64:67], a[128:131], v[20:23]
    v_mfma_f32_16x16x32_bf16 v[104:107], v[68:71], a[132:135], v[104:107]
    v_mfma_f32_16x16x32_bf16 v[104:107], v[72:75], a[136:139], v[104:107]
    v_mfma_f32_16x16x32_bf16 v[104:107], v[76:79], a[140:143], v[104:107]
    s_cmp_lt_u32 s52, s101
    s_cselect_b64 s[4:5], -1, 0
    s_cmp_eq_u32 s52, s101
    s_cselect_b64 s[6:7], s[24:25], s[4:5]
    v_cndmask_b32_e64 v20, v7, 0, s[6:7]
    s_cselect_b64 s[6:7], s[26:27], s[4:5]
    v_cndmask_b32_e64 v21, v7, 0, s[6:7]
    s_cselect_b64 s[6:7], s[28:29], s[4:5]
    v_cndmask_b32_e64 v22, v7, 0, s[6:7]
    s_cselect_b64 s[6:7], s[30:31], s[4:5]
    v_cndmask_b32_e64 v23, v7, 0, s[6:7]
    s_nop 1
    v_mfma_f32_16x16x32_bf16 v[108:111], v[64:67], a[144:147], v[20:23]
    v_mfma_f32_16x16x32_bf16 v[108:111], v[68:71], a[148:151], v[108:111]
    v_mfma_f32_16x16x32_bf16 v[108:111], v[72:75], a[152:155], v[108:111]
    v_mfma_f32_16x16x32_bf16 v[108:111], v[76:79], a[156:159], v[108:111]
    s_nop 7
    v_max3_f32 v32, v32, v40, v41
    v_max3_f32 v32, v32, v42, v43
    v_max3_f32 v33, v33, v44, v45
    v_max3_f32 v33, v33, v46, v47
    v_max3_f32 v34, v34, v48, v49
    v_max3_f32 v34, v34, v50, v51
    v_max3_f32 v35, v35, v52, v53
    v_max3_f32 v35, v35, v54, v55
    v_max3_f32 v36, v36, v104, v105
    v_max3_f32 v36, v36, v106, v107
    v_max3_f32 v37, v37, v108, v109
    v_max3_f32 v37, v37, v110, v111
    s_add_u32 s52, s52, 1
    s_cmp_lt_u32 s52, 128
    s_cbranch_scc1 L_slowloop
    v_mov_b32 v38, v32
    s_nop 1
    v_permlane16_swap_b32 v32, v38
    v_max_f32 v32, v32, v38
    v_mov_b32 v38, v32
    s_nop 1
    v_permlane32_swap_b32 v32, v38
    v_max_f32 v32, v32, v38
    v_sub_f32 v112, 0, v32
    v_sub_f32 v113, 0, v32
    v_sub_f32 v114, 0, v32
    v_sub_f32 v115, 0, v32
    v_mov_b32 v39, v33
    s_nop 1
    v_permlane16_swap_b32 v33, v39
    v_max_f32 v33, v33, v39
    v_mov_b32 v39, v33
    s_nop 1
    v_permlane32_swap_b32 v33, v39
    v_max_f32 v33, v33, v39
    v_sub_f32 v116, 0, v33
    v_sub_f32 v117, 0, v33
    v_sub_f32 v118, 0, v33
    v_sub_f32 v119, 0, v33
    v_mov_b32 v38, v34
    s_nop 1
    v_permlane16_swap_b32 v34, v38
    v_max_f32 v34, v34, v38
    v_mov_b32 v38, v34
    s_nop 1
    v_permlane32_swap_b32 v34, v38
    v_max_f32 v34, v34, v38
    v_sub_f32 v120, 0, v34
    v_sub_f32 v121, 0, v34
    v_sub_f32 v122, 0, v34
    v_sub_f32 v123, 0, v34
    v_mov_b32 v39, v35
    s_nop 1
    v_permlane16_swap_b32 v35, v39
    v_max_f32 v35, v35, v39
    v_mov_b32 v39, v35
    s_nop 1
    v_permlane32_swap_b32 v35, v39
    v_max_f32 v35, v35, v39
    v_sub_f32 v124, 0, v35
    v_sub_f32 v125, 0, v35
    v_sub_f32 v126, 0, v35
    v_sub_f32 v127, 0, v35
    v_mov_b32 v38, v36
    s_nop 1
    v_permlane16_swap_b32 v36, v38
    v_max_f32 v36, v36, v38
    v_mov_b32 v38, v36
    s_nop 1
    v_permlane32_swap_b32 v36, v38
    v_max_f32 v36, v36, v38
    v_sub_f32 v12, 0, v36
    v_mov_b32 v39, v37
    s_nop 1
    v_permlane16_swap_b32 v37, v39
    v_max_f32 v37, v37, v39
    v_mov_b32 v39, v37
    s_nop 1
    v_permlane32_swap_b32 v37, v39
    v_max_f32 v37, v37, v39
    v_sub_f32 v13, 0, v37
    s_branch L_go2
L_ks_retry:
    buffer_load_dwordx4 v[44:47], v56, s[20:23], 0 offen sc1
    s_waitcnt vmcnt(0)
    v_cmp_eq_u64_e64 s[4:5], s[80:81], v[44:45]
    v_cmp_eq_u64 vcc, s[80:81], v[46:47]
    s_and_b64 s[4:5], s[4:5], vcc
    s_cmp_eq_u64 s[4:5], -1
    s_cbranch_scc1 L_ks_back
    s_sub_u32 s82, s82, 1
    s_cbranch_scc0 L_ks_retry
    s_mov_b32 s82, 0
    s_branch L_ks_back
L_codeend:
.section .rodata,"a"
.p2align 6
.amdhsa_kernel adaLN_cond__compressed_kv_cla__moe_arch_mod__prompt_kernel
  .amdhsa_next_free_vgpr 512
  .amdhsa_next_free_sgpr 102
  .amdhsa_accum_offset 256
  .amdhsa_group_segment_fixed_size 0
  .amdhsa_kernarg_size 128
  .amdhsa_user_sgpr_count 2
  .amdhsa_user_sgpr_kernarg_segment_ptr 1
  .amdhsa_system_sgpr_workgroup_id_x 1
.end_amdhsa_kernel
```
